```python
import torch

def _softmax(x, axis=-1):
    return torch.softmax(x, dim=axis)
def _gelu(x):
    return torch.nn.functional.gelu(x, approximate="tanh")
def _silu(x):
    return torch.nn.functional.silu(x)
def _sigmoid(x):
    return torch.sigmoid(x)
def _layernorm(x, axis=-1, eps=1e-5):
    m = x.mean(dim=axis, keepdim=True)
    v = x.var(dim=axis, keepdim=True, unbiased=False)
    return (x - m) / torch.sqrt(v + eps)
def _scatter_add(tgt, idx, src, axis=0):
    return tgt.clone().index_add_(axis, idx, src)
def _segment_sum(src, seg, n):
    out = torch.zeros((n,) + src.shape[1:], dtype=src.dtype)
    return out.index_add_(0, seg, src)
def _pad(x, pw):
    flat = tuple(v for pair in reversed(pw) for v in pair)
    return torch.nn.functional.pad(x, flat)

kernel_name = 'concat_heads__mha_block_cached__mha_block_cached__near_ridge'

def setup_inputs():

    _w = (lambda a: (lambda t: t.to(torch.bfloat16) if t.is_floating_point() else t)(torch.as_tensor(a)))
    def _A_setup():
        B, Sq, D = 8, 224, 1024
        H, Sk, Dh = 32, 1024, 128
        return {
            "x": _w((lambda *s: torch.randn(*s, dtype=torch.bfloat16) * 0.8)(B, Sq, D)),
            "k_cache": _w((lambda *s: torch.randn(*s, dtype=torch.bfloat16) * 0.8)(B, H, Sk, Dh)),
            "v_cache": _w((lambda *s: torch.randn(*s, dtype=torch.bfloat16) * 0.05)(B, H, Sk, Dh)),
            "wq": _w((lambda *s: torch.randn(*s, dtype=torch.bfloat16) * 0.8)(D, H * Dh) * (D ** -0.5)),
            "wo": _w((lambda *s: torch.randn(*s, dtype=torch.bfloat16) * 0.05)(H * Dh, D) * ((H * Dh) ** -0.5)),
        }
    _A_in = _A_setup()

    def _B_setup():
        B, Sq, D = 8, 224, 1024
        H, Sk, Dh = 32, 1024, 128
        return {
            "x": _w((lambda *s: torch.randn(*s, dtype=torch.bfloat16) * 0.8)(B, Sq, D)),
            "k_cache": _w((lambda *s: torch.randn(*s, dtype=torch.bfloat16) * 0.8)(B, H, Sk, Dh)),
            "v_cache": _w((lambda *s: torch.randn(*s, dtype=torch.bfloat16) * 0.05)(B, H, Sk, Dh)),
            "wq": _w((lambda *s: torch.randn(*s, dtype=torch.bfloat16) * 0.8)(D, H * Dh) * (D ** -0.5)),
            "wo": _w((lambda *s: torch.randn(*s, dtype=torch.bfloat16) * 0.05)(H * Dh, D) * ((H * Dh) ** -0.5)),
        }
    _B_in = _B_setup()

    return {
        "A_x": _A_in["x"],
        "A_k_cache": _A_in["k_cache"],
        "A_v_cache": _A_in["v_cache"],
        "A_wq": _A_in["wq"],
        "A_wo": _A_in["wo"],
        "B_x": _B_in["x"],
        "B_k_cache": _B_in["k_cache"],
        "B_v_cache": _B_in["v_cache"],
        "B_wq": _B_in["wq"],
        "B_wo": _B_in["wo"],
    }

def reference(A_x, A_k_cache, A_v_cache, A_wq, A_wo, B_x, B_k_cache, B_v_cache, B_wq, B_wo):
    def _A_ref(x, k_cache, v_cache, wq, wo):
        B, Sq, D = x.shape
        H, Dh = 32, 128
        q = (lambda x, *d: x.permute(*d))((x @ wq).reshape(B, Sq, H, Dh), 0, 2, 1, 3)
        scores = torch.einsum("bhqd,bhkd->bhqk", q, k_cache) * (Dh ** -0.5)
        p = _softmax(scores, axis=-1)
        o = torch.einsum("bhqk,bhkd->bhqd", p, v_cache)
        return (lambda x, *d: x.permute(*d))(o, 0, 2, 1, 3).reshape(B, Sq, H * Dh) @ wo

    def _B_ref(x, k_cache, v_cache, wq, wo):
        B, Sq, D = x.shape
        H, Dh = 32, 128
        q = (lambda x, *d: x.permute(*d))((x @ wq).reshape(B, Sq, H, Dh), 0, 2, 1, 3)
        scores = torch.einsum("bhqd,bhkd->bhqk", q, k_cache) * (Dh ** -0.5)
        p = _softmax(scores, axis=-1)
        o = torch.einsum("bhqk,bhkd->bhqd", p, v_cache)
        return (lambda x, *d: x.permute(*d))(o, 0, 2, 1, 3).reshape(B, Sq, H * Dh) @ wo

    a = _A_ref(A_x, A_k_cache, A_v_cache, A_wq, A_wo)
    b = _B_ref(B_x, B_k_cache, B_v_cache, B_wq, B_wo)
    return torch.concatenate([a, b], axis=-1)
```

```asm
; @launch grid=(256,1,1) block=(256,1,1) lds=163840
.amdgcn_target "amdgcn-amd-amdhsa--gfx950"
.text
.globl concat_heads__mha_block_cached__mha_block_cached__near_ridge_kernel
.p2align 8
.type concat_heads__mha_block_cached__mha_block_cached__near_ridge_kernel,@function
concat_heads__mha_block_cached__mha_block_cached__near_ridge_kernel:
    s_cmp_ge_u32 s2, 256
    s_cbranch_scc1 L_end
    s_and_b32 s20, s2, 7
    s_lshr_b32 s21, s2, 3
    s_lshr_b32 s32, s20, 2
    s_mul_i32 s25, s32, 40
    s_add_u32 s26, s0, s25
    s_addc_u32 s27, s1, 0
    s_load_dwordx8 s[36:43], s[26:27], 0
    s_load_dwordx2 s[34:35], s[26:27], 32
    s_load_dwordx2 s[44:45], s[0:1], 96
    s_load_dwordx4 s[96:99], s[0:1], 80
    v_lshrrev_b32 v1, 6, v0
    v_and_b32 v0, 63, v0
    v_readfirstlane_b32 s28, v1
    s_and_b32 s23, s20, 3
    s_lshl_b32 s23, s23, 2
    s_and_b32 s24, s21, 3
    s_or_b32 s3, s23, s24
    s_lshr_b32 s33, s21, 2
    s_lshr_b32 s29, s28, 1
    s_and_b32 s30, s28, 1
    s_lshl_b32 s31, s3, 1
    s_add_u32 s31, s31, s29
    v_lshrrev_b32 v32, 4, v0
    v_and_b32 v33, 15, v0
    v_lshlrev_b32 v34, 2, v32
    v_xor_b32 v34, v34, v33
    v_lshlrev_b32 v34, 4, v34
    v_lshl_add_u32 v11, v32, 13, v34
    v_lshrrev_b32 v35, 3, v0
    v_and_b32 v36, 7, v0
    v_lshrrev_b32 v37, 1, v35
    v_xor_b32 v36, v36, v37
    v_lshlrev_b32 v36, 4, v36
    v_lshl_add_u32 v12, v35, 11, v36
    s_mul_i32 s50, s29, 8224
    s_mul_i32 s20, s30, 4112
    s_add_u32 s50, s50, s20
    s_mul_i32 s51, s28, 7616
    s_lshl_b32 s62, s3, 0
    s_add_u32 s62, s62, s33
    s_and_b32 s62, s62, 3
    s_mov_b32 s59, 0
    s_lshl_b32 s46, s62, 7
    s_lshl_b32 s47, s62, 19
    s_mul_i32 s20, s33, 224
    s_mul_i32 s21, s28, 56
    s_add_u32 s20, s20, s21
    s_lshl_b32 s20, s20, 11
    s_lshl_b32 s21, s31, 8
    s_lshl_b32 s25, s30, 17
    s_add_u32 s21, s21, s25
    s_waitcnt lgkmcnt(0)
    s_add_u32 s4, s36, s20
    s_addc_u32 s5, s37, 0
    s_sub_u32 s6, 3670016, s20
    s_mov_b32 s7, 0x20000
    s_add_u32 s8, s42, s21
    s_addc_u32 s9, s43, 0
    s_sub_u32 s10, 8388608, s21
    s_mov_b32 s11, 0x20000
    s_add_u32 m0, s51, 68736
    s_nop 0
    buffer_load_dwordx4 v12, s[4:7], s46 offen lds
    s_add_u32 m0, s51, 69824
    s_add_u32 s49, s46, 16384
    buffer_load_dwordx4 v12, s[4:7], s49 offen lds
    s_add_u32 m0, s51, 70912
    s_add_u32 s49, s46, 32768
    buffer_load_dwordx4 v12, s[4:7], s49 offen lds
    s_add_u32 m0, s51, 72000
    s_add_u32 s49, s46, 49152
    buffer_load_dwordx4 v12, s[4:7], s49 offen lds
    s_add_u32 m0, s51, 73088
    s_add_u32 s49, s46, 65536
    buffer_load_dwordx4 v12, s[4:7], s49 offen lds
    s_add_u32 m0, s51, 74176
    s_add_u32 s49, s46, 81920
    buffer_load_dwordx4 v12, s[4:7], s49 offen lds
    s_add_u32 m0, s51, 75264
    s_add_u32 s49, s46, 98304
    buffer_load_dwordx4 v12, s[4:7], s49 offen lds
    s_add_u32 m0, s50, 35840
    s_nop 0
    buffer_load_dwordx4 v11, s[8:11], s47 offen lds
    s_add_u32 m0, s50, 36864
    s_add_u32 s49, s47, 32768
    buffer_load_dwordx4 v11, s[8:11], s49 offen lds
    s_add_u32 m0, s50, 37896
    s_add_u32 s49, s47, 65536
    buffer_load_dwordx4 v11, s[8:11], s49 offen lds
    s_cmp_eq_u32 s30, 0
    s_cselect_b32 s12, s38, s40
    s_cselect_b32 s13, s39, s41
    s_cselect_b32 s53, 0, 64
    s_cselect_b32 s21, 0, 17408
    s_mul_i32 s20, s30, 512
    s_add_u32 s20, s20, 8704
    s_mul_i32 s20, s20, s29
    s_add_u32 s52, s20, s21
    s_add_u32 s53, s53, 1088
    s_lshl_b32 s20, s33, 5
    s_add_u32 s20, s20, s31
    s_lshl_b32 s20, s20, 18
    s_add_u32 s12, s12, s20
    s_addc_u32 s13, s13, 0
    s_mov_b32 s14, 262144
    s_mov_b32 s15, 0x20000
    s_mov_b32 s42, 0
    s_mov_b32 s48, s42
    s_lshl_b32 s20, s32, 3
    s_add_u32 s20, s20, s33
    s_lshl_b32 s20, s20, 1
    s_add_u32 s20, s20, s30
    s_lshl_b32 s20, s20, 5
    s_add_u32 s20, s20, s31
    s_mul_i32 s20, s20, 28672
    s_add_u32 s16, s44, s20
    s_addc_u32 s17, s45, 0
    s_mov_b32 s18, 28672
    s_mov_b32 s19, 0x20000
    s_mov_b32 s56, 1040356334
    s_mov_b32 s57, 1040356334
    s_lshl_b32 s20, s32, 3
    s_add_u32 s20, s20, s33
    s_lshl_b32 s21, s20, 4
    s_add_u32 s24, s98, s21
    s_addc_u32 s25, s99, 0
    s_mov_b32 s26, 4
    s_mov_b32 s27, 0x20000
    s_lshl_b32 s20, s20, 12
    s_add_u32 s20, s20, 31457280
    s_add_u32 s36, s44, s20
    s_addc_u32 s37, s45, 0
    s_mov_b32 s38, 64
    s_mov_b32 s39, 0x20000
    s_lshl_b32 s20, s28, 8
    v_lshl_add_u32 v25, v0, 2, s20
    buffer_load_dword v24, v25, s[36:39], 0 offen sc1
    v_lshrrev_b32 v34, 2, v33
    v_and_b32 v35, 3, v33
    v_lshlrev_b32 v13, s30, v32
    v_xor_b32 v13, v13, v33
    v_lshlrev_b32 v13, 4, v13
    v_lshl_add_u32 v13, v32, 8, v13
    v_lshlrev_b32 v31, 4, v0
    s_mul_i32 s20, s29, 8224
    s_add_u32 s20, s20, 35840
    v_mul_u32_u24 v36, 2056, v32
    v_lshl_add_u32 v36, v34, 8, v36
    v_lshl_add_u32 v36, v35, 4, v36
    v_add_u32 v36, s20, v36
    v_xor_b32 v37, 0, v34
    v_lshl_add_u32 v1, v37, 6, v36
    v_add_u32 v5, 63360, v1
    v_xor_b32 v37, 1, v34
    v_lshl_add_u32 v2, v37, 6, v36
    v_add_u32 v6, 63360, v2
    v_xor_b32 v37, 2, v34
    v_lshl_add_u32 v3, v37, 6, v36
    v_add_u32 v7, 63360, v3
    v_xor_b32 v37, 3, v34
    v_lshl_add_u32 v4, v37, 6, v36
    v_add_u32 v8, 63360, v4
    s_mul_i32 s20, s30, 15232
    s_add_u32 s20, s20, 68736
    v_lshrrev_b32 v36, 3, v33
    v_mul_u32_u24 v36, 1088, v36
    v_and_b32 v37, 7, v33
    v_lshl_add_u32 v36, v37, 7, v36
    v_lshrrev_b32 v37, 1, v37
    v_xor_b32 v37, v37, v32
    v_lshl_add_u32 v36, v37, 4, v36
    v_add_u32 v9, s20, v36
    v_add_u32 v10, 63360, v9
    s_mul_i32 s20, s29, 8704
    v_mul_u32_u24 v36, 1088, v34
    v_lshl_add_u32 v36, v35, 8, v36
    v_xor_b32 v37, v35, v32
    v_lshl_add_u32 v36, v37, 4, v36
    v_add_u32 v14, s20, v36
    v_add_u32 v15, 71680, v14
    s_mul_i32 s20, s29, 9216
    s_add_u32 s20, s20, 17408
    v_mul_u32_u24 v36, 1152, v32
    v_lshl_add_u32 v36, v34, 8, v36
    v_lshl_add_u32 v36, v35, 3, v36
    v_add_u32 v36, s20, v36
    v_xor_b32 v37, 0, v34
    v_lshl_add_u32 v16, v37, 5, v36
    v_add_u32 v20, 71680, v16
    v_xor_b32 v37, 1, v34
    v_lshl_add_u32 v17, v37, 5, v36
    v_add_u32 v21, 71680, v17
    v_xor_b32 v37, 2, v34
    v_lshl_add_u32 v18, v37, 5, v36
    v_add_u32 v22, 71680, v18
    v_xor_b32 v37, 3, v34
    v_lshl_add_u32 v19, v37, 5, v36
    v_add_u32 v23, 71680, v19
    v_mov_b32 v56, 0
    v_mov_b32 v57, 0
    v_mov_b32 v58, 0
    v_mov_b32 v59, 0
    v_mov_b32 v60, 0
    v_mov_b32 v61, 0
    v_mov_b32 v62, 0
    v_mov_b32 v63, 0
    s_nop 1
    v_mfma_f32_32x32x16_bf16 v[64:79], v[56:59], v[56:59], 0
    v_mfma_f32_32x32x16_bf16 v[80:95], v[56:59], v[56:59], 0
    v_mfma_f32_32x32x16_bf16 v[96:111], v[56:59], v[56:59], 0
    v_mfma_f32_32x32x16_bf16 v[112:127], v[56:59], v[56:59], 0
    v_mfma_f32_32x32x16_bf16 v[128:143], v[56:59], v[56:59], 0
    v_mfma_f32_32x32x16_bf16 v[144:159], v[56:59], v[56:59], 0
    v_mfma_f32_32x32x16_bf16 v[160:175], v[56:59], v[56:59], 0
    v_mfma_f32_32x32x16_bf16 v[176:191], v[56:59], v[56:59], 0
    v_mfma_f32_32x32x16_bf16 v[192:207], v[56:59], v[56:59], 0
    v_mfma_f32_32x32x16_bf16 v[208:223], v[56:59], v[56:59], 0
    v_mfma_f32_32x32x16_bf16 v[224:239], v[56:59], v[56:59], 0
    v_mfma_f32_32x32x16_bf16 v[240:255], v[56:59], v[56:59], 0
    v_mfma_f32_32x32x16_bf16 a[0:15], v[56:59], v[56:59], 0
    v_mfma_f32_32x32x16_bf16 a[16:31], v[56:59], v[56:59], 0
    s_add_u32 m0, s50, 38920
    s_add_u32 s49, s47, 98304
    buffer_load_dwordx4 v11, s[8:11], s49 offen lds
    s_add_u32 m0, s50, 52288
    s_add_u32 s49, s47, 262144
    buffer_load_dwordx4 v11, s[8:11], s49 offen lds
    s_add_u32 m0, s50, 53312
    s_add_u32 s49, s47, 294912
    buffer_load_dwordx4 v11, s[8:11], s49 offen lds
    s_add_u32 m0, s50, 54344
    s_add_u32 s49, s47, 327680
    buffer_load_dwordx4 v11, s[8:11], s49 offen lds
    s_add_u32 m0, s50, 55368
    s_add_u32 s49, s47, 360448
    buffer_load_dwordx4 v11, s[8:11], s49 offen lds
    s_add_u32 s59, s59, 1
    s_add_u32 s60, s59, s62
    s_and_b32 s60, s60, 3
    s_and_b32 s61, s59, -4
    s_or_b32 s60, s60, s61
    s_lshl_b32 s47, s60, 19
    s_lshl_b32 s46, s60, 7
    s_add_u32 m0, s50, 99200
    s_nop 0
    buffer_load_dwordx4 v11, s[8:11], s47 offen lds
    s_add_u32 m0, s50, 100224
    s_add_u32 s49, s47, 32768
    buffer_load_dwordx4 v11, s[8:11], s49 offen lds
    s_add_u32 m0, s50, 101256
    s_add_u32 s49, s47, 65536
    buffer_load_dwordx4 v11, s[8:11], s49 offen lds
    s_add_u32 m0, s50, 102280
    s_add_u32 s49, s47, 98304
    buffer_load_dwordx4 v11, s[8:11], s49 offen lds
    s_add_u32 m0, s50, 115648
    s_add_u32 s49, s47, 262144
    buffer_load_dwordx4 v11, s[8:11], s49 offen lds
    s_add_u32 m0, s50, 116672
    s_add_u32 s49, s47, 294912
    buffer_load_dwordx4 v11, s[8:11], s49 offen lds
    s_add_u32 m0, s50, 117704
    s_add_u32 s49, s47, 327680
    buffer_load_dwordx4 v11, s[8:11], s49 offen lds
    s_add_u32 m0, s50, 118728
    s_add_u32 s49, s47, 360448
    buffer_load_dwordx4 v11, s[8:11], s49 offen lds
    s_add_u32 m0, s51, 132096
    s_nop 0
    buffer_load_dwordx4 v12, s[4:7], s46 offen lds
    s_add_u32 m0, s51, 133184
    s_add_u32 s49, s46, 16384
    buffer_load_dwordx4 v12, s[4:7], s49 offen lds
    s_add_u32 m0, s51, 134272
    s_add_u32 s49, s46, 32768
    buffer_load_dwordx4 v12, s[4:7], s49 offen lds
    s_add_u32 m0, s51, 135360
    s_add_u32 s49, s46, 49152
    buffer_load_dwordx4 v12, s[4:7], s49 offen lds
    s_add_u32 m0, s51, 136448
    s_add_u32 s49, s46, 65536
    buffer_load_dwordx4 v12, s[4:7], s49 offen lds
    s_add_u32 m0, s51, 137536
    s_add_u32 s49, s46, 81920
    buffer_load_dwordx4 v12, s[4:7], s49 offen lds
    s_add_u32 m0, s51, 138624
    s_add_u32 s49, s46, 98304
    buffer_load_dwordx4 v12, s[4:7], s49 offen lds
    s_add_u32 s59, s59, 1
    s_add_u32 s60, s59, s62
    s_and_b32 s60, s60, 3
    s_and_b32 s61, s59, -4
    s_or_b32 s60, s60, s61
    s_lshl_b32 s47, s60, 19
    s_lshl_b32 s46, s60, 7
    s_waitcnt vmcnt(15)
    v_add_u32 v24, 1, v24
    v_cmp_gt_u32 vcc, 64, v25
    v_mov_b32 v38, 1
    s_nop 0
    v_cndmask_b32 v24, 0, v24, vcc
    buffer_atomic_add v38, v25, s[24:27], 0 offen sc1
    s_barrier
    ds_read_b128 a[208:211], v9 offset:0
    ds_read_b128 a[212:215], v9 offset:64
    ds_read_b128 a[216:219], v9 offset:2176
    ds_read_b128 a[220:223], v9 offset:2240
    ds_read_b128 a[224:227], v9 offset:4352
    ds_read_b128 a[228:231], v9 offset:4416
    ds_read_b128 a[232:235], v9 offset:6528
    ds_read_b128 a[236:239], v9 offset:6592
    s_waitcnt lgkmcnt(7)
    ds_read_b128 a[248:251], v9 offset:8704
    ds_read_b128 a[252:255], v9 offset:8768
    ds_read_b128 v[32:35], v9 offset:10880
    ds_read_b128 v[36:39], v9 offset:10944
    ds_read_b128 v[40:43], v9 offset:13056
    ds_read_b128 v[44:47], v9 offset:13120
    ds_read_b64_tr_b16 a[144:145], v1 offset:0
    ds_read_b64_tr_b16 a[146:147], v1 offset:1024
    s_waitcnt lgkmcnt(7)
    ds_read_b64_tr_b16 a[148:149], v1 offset:16448
    ds_read_b64_tr_b16 a[150:151], v1 offset:17472
    ds_read_b64_tr_b16 a[152:153], v1 offset:8
    ds_read_b64_tr_b16 a[154:155], v1 offset:1032
    ds_read_b64_tr_b16 a[156:157], v1 offset:16456
    ds_read_b64_tr_b16 a[158:159], v1 offset:17480
    ds_read_b64_tr_b16 a[160:161], v2 offset:0
    ds_read_b64_tr_b16 a[162:163], v2 offset:1024
    s_waitcnt lgkmcnt(7)
    ds_read_b64_tr_b16 a[164:165], v2 offset:16448
    ds_read_b64_tr_b16 a[166:167], v2 offset:17472
    ds_read_b64_tr_b16 a[168:169], v2 offset:8
    ds_read_b64_tr_b16 a[170:171], v2 offset:1032
    ds_read_b64_tr_b16 a[172:173], v2 offset:16456
    ds_read_b64_tr_b16 a[174:175], v2 offset:17480
    ds_read_b64_tr_b16 a[176:177], v3 offset:0
    ds_read_b64_tr_b16 a[178:179], v3 offset:1024
    s_waitcnt lgkmcnt(7)
    ds_read_b64_tr_b16 a[180:181], v3 offset:16448
    ds_read_b64_tr_b16 a[182:183], v3 offset:17472
    ds_read_b64_tr_b16 a[184:185], v3 offset:8
    ds_read_b64_tr_b16 a[186:187], v3 offset:1032
    ds_read_b64_tr_b16 a[188:189], v3 offset:16456
    ds_read_b64_tr_b16 a[190:191], v3 offset:17480
    ds_read_b64_tr_b16 a[192:193], v4 offset:0
    ds_read_b64_tr_b16 a[194:195], v4 offset:1024
    s_waitcnt lgkmcnt(7)
    ds_read_b64_tr_b16 a[196:197], v4 offset:16448
    ds_read_b64_tr_b16 a[198:199], v4 offset:17472
    ds_read_b64_tr_b16 a[200:201], v4 offset:8
    ds_read_b64_tr_b16 a[202:203], v4 offset:1032
    ds_read_b64_tr_b16 a[204:205], v4 offset:16456
    ds_read_b64_tr_b16 a[206:207], v4 offset:17480
    s_waitcnt lgkmcnt(0)
    s_barrier
    v_mfma_f32_16x16x32_bf16 v[64:67], a[144:147], a[208:211], v[64:67]
    v_mfma_f32_16x16x32_bf16 v[64:67], a[148:151], a[212:215], v[64:67]
    s_add_u32 m0, s50, 35840
    v_mfma_f32_16x16x32_bf16 v[96:99], a[144:147], a[216:219], v[96:99]
    buffer_load_dwordx4 v11, s[8:11], s47 offen lds
    v_mfma_f32_16x16x32_bf16 v[96:99], a[148:151], a[220:223], v[96:99]
    s_add_u32 m0, s50, 36864
    s_add_u32 s49, s47, 32768
    v_mfma_f32_16x16x32_bf16 v[128:131], a[144:147], a[224:227], v[128:131]
    buffer_load_dwordx4 v11, s[8:11], s49 offen lds
    v_mfma_f32_16x16x32_bf16 v[128:131], a[148:151], a[228:231], v[128:131]
    v_mfma_f32_16x16x32_bf16 v[160:163], a[144:147], a[232:235], v[160:163]
    s_add_u32 m0, s50, 37896
    s_add_u32 s49, s47, 65536
    v_mfma_f32_16x16x32_bf16 v[160:163], a[148:151], a[236:239], v[160:163]
    buffer_load_dwordx4 v11, s[8:11], s49 offen lds
    v_mfma_f32_16x16x32_bf16 v[192:195], a[144:147], a[248:251], v[192:195]
    v_mfma_f32_16x16x32_bf16 v[192:195], a[148:151], a[252:255], v[192:195]
    s_add_u32 m0, s50, 38920
    s_add_u32 s49, s47, 98304
    v_mfma_f32_16x16x32_bf16 v[224:227], a[144:147], v[32:35], v[224:227]
    buffer_load_dwordx4 v11, s[8:11], s49 offen lds
    v_mfma_f32_16x16x32_bf16 v[224:227], a[148:151], v[36:39], v[224:227]
    v_mfma_f32_16x16x32_bf16 a[0:3], a[144:147], v[40:43], a[0:3]
    s_add_u32 m0, s50, 52288
    s_add_u32 s49, s47, 262144
    v_mfma_f32_16x16x32_bf16 a[0:3], a[148:151], v[44:47], a[0:3]
    buffer_load_dwordx4 v11, s[8:11], s49 offen lds
    v_mfma_f32_16x16x32_bf16 v[68:71], a[152:155], a[208:211], v[68:71]
    v_mfma_f32_16x16x32_bf16 v[68:71], a[156:159], a[212:215], v[68:71]
    s_add_u32 m0, s50, 53312
    s_add_u32 s49, s47, 294912
    v_mfma_f32_16x16x32_bf16 v[100:103], a[152:155], a[216:219], v[100:103]
    buffer_load_dwordx4 v11, s[8:11], s49 offen lds
    v_mfma_f32_16x16x32_bf16 v[100:103], a[156:159], a[220:223], v[100:103]
    v_mfma_f32_16x16x32_bf16 v[132:135], a[152:155], a[224:227], v[132:135]
    s_add_u32 m0, s50, 54344
    s_add_u32 s49, s47, 327680
    v_mfma_f32_16x16x32_bf16 v[132:135], a[156:159], a[228:231], v[132:135]
    buffer_load_dwordx4 v11, s[8:11], s49 offen lds
    v_mfma_f32_16x16x32_bf16 v[164:167], a[152:155], a[232:235], v[164:167]
    v_mfma_f32_16x16x32_bf16 v[164:167], a[156:159], a[236:239], v[164:167]
    s_add_u32 m0, s50, 55368
    s_add_u32 s49, s47, 360448
    v_mfma_f32_16x16x32_bf16 v[196:199], a[152:155], a[248:251], v[196:199]
    buffer_load_dwordx4 v11, s[8:11], s49 offen lds
    v_mfma_f32_16x16x32_bf16 v[196:199], a[156:159], a[252:255], v[196:199]
    v_mfma_f32_16x16x32_bf16 v[228:231], a[152:155], v[32:35], v[228:231]
    s_add_u32 m0, s51, 68736
    v_mfma_f32_16x16x32_bf16 v[228:231], a[156:159], v[36:39], v[228:231]
    buffer_load_dwordx4 v12, s[4:7], s46 offen lds
    v_mfma_f32_16x16x32_bf16 a[4:7], a[152:155], v[40:43], a[4:7]
    v_mfma_f32_16x16x32_bf16 a[4:7], a[156:159], v[44:47], a[4:7]
    s_add_u32 m0, s51, 69824
    s_add_u32 s49, s46, 16384
    v_mfma_f32_16x16x32_bf16 v[72:75], a[160:163], a[208:211], v[72:75]
    buffer_load_dwordx4 v12, s[4:7], s49 offen lds
    v_mfma_f32_16x16x32_bf16 v[72:75], a[164:167], a[212:215], v[72:75]
    v_mfma_f32_16x16x32_bf16 v[104:107], a[160:163], a[216:219], v[104:107]
    s_add_u32 m0, s51, 70912
    s_add_u32 s49, s46, 32768
    v_mfma_f32_16x16x32_bf16 v[104:107], a[164:167], a[220:223], v[104:107]
    buffer_load_dwordx4 v12, s[4:7], s49 offen lds
    v_mfma_f32_16x16x32_bf16 v[136:139], a[160:163], a[224:227], v[136:139]
    v_mfma_f32_16x16x32_bf16 v[136:139], a[164:167], a[228:231], v[136:139]
    s_add_u32 m0, s51, 72000
    s_add_u32 s49, s46, 49152
    v_mfma_f32_16x16x32_bf16 v[168:171], a[160:163], a[232:235], v[168:171]
    buffer_load_dwordx4 v12, s[4:7], s49 offen lds
    v_mfma_f32_16x16x32_bf16 v[168:171], a[164:167], a[236:239], v[168:171]
    v_mfma_f32_16x16x32_bf16 v[200:203], a[160:163], a[248:251], v[200:203]
    s_add_u32 m0, s51, 73088
    s_add_u32 s49, s46, 65536
    v_mfma_f32_16x16x32_bf16 v[200:203], a[164:167], a[252:255], v[200:203]
    buffer_load_dwordx4 v12, s[4:7], s49 offen lds
    v_mfma_f32_16x16x32_bf16 v[232:235], a[160:163], v[32:35], v[232:235]
    v_mfma_f32_16x16x32_bf16 v[232:235], a[164:167], v[36:39], v[232:235]
    s_add_u32 m0, s51, 74176
    s_add_u32 s49, s46, 81920
    v_mfma_f32_16x16x32_bf16 a[8:11], a[160:163], v[40:43], a[8:11]
    buffer_load_dwordx4 v12, s[4:7], s49 offen lds
    v_mfma_f32_16x16x32_bf16 a[8:11], a[164:167], v[44:47], a[8:11]
    v_mfma_f32_16x16x32_bf16 v[76:79], a[168:171], a[208:211], v[76:79]
    s_add_u32 m0, s51, 75264
    s_add_u32 s49, s46, 98304
    v_mfma_f32_16x16x32_bf16 v[76:79], a[172:175], a[212:215], v[76:79]
    buffer_load_dwordx4 v12, s[4:7], s49 offen lds
    v_mfma_f32_16x16x32_bf16 v[108:111], a[168:171], a[216:219], v[108:111]
    s_waitcnt vmcnt(16)
    s_add_u32 s59, s59, 1
    s_add_u32 s60, s59, s62
    s_and_b32 s60, s60, 3
    s_and_b32 s61, s59, -4
    s_or_b32 s60, s60, s61
    s_lshl_b32 s47, s60, 19
    s_lshl_b32 s46, s60, 7
    v_mfma_f32_16x16x32_bf16 v[108:111], a[172:175], a[220:223], v[108:111]
    s_barrier
    ds_read_b128 a[96:99], v10 offset:0
    v_mfma_f32_16x16x32_bf16 v[140:143], a[168:171], a[224:227], v[140:143]
    ds_read_b64_tr_b16 a[32:33], v5 offset:0
    ds_read_b64_tr_b16 a[34:35], v5 offset:1024
    v_mfma_f32_16x16x32_bf16 v[140:143], a[172:175], a[228:231], v[140:143]
    ds_read_b128 a[100:103], v10 offset:64
    v_mfma_f32_16x16x32_bf16 v[172:175], a[168:171], a[232:235], v[172:175]
    ds_read_b64_tr_b16 a[36:37], v5 offset:16448
    ds_read_b64_tr_b16 a[38:39], v5 offset:17472
    v_mfma_f32_16x16x32_bf16 v[172:175], a[172:175], a[236:239], v[172:175]
    ds_read_b128 a[104:107], v10 offset:2176
    v_mfma_f32_16x16x32_bf16 v[204:207], a[168:171], a[248:251], v[204:207]
    ds_read_b64_tr_b16 a[40:41], v5 offset:8
    ds_read_b64_tr_b16 a[42:43], v5 offset:1032
    v_mfma_f32_16x16x32_bf16 v[204:207], a[172:175], a[252:255], v[204:207]
    ds_read_b128 a[108:111], v10 offset:2240
    v_mfma_f32_16x16x32_bf16 v[236:239], a[168:171], v[32:35], v[236:239]
    ds_read_b64_tr_b16 a[44:45], v5 offset:16456
    ds_read_b64_tr_b16 a[46:47], v5 offset:17480
    v_mfma_f32_16x16x32_bf16 v[236:239], a[172:175], v[36:39], v[236:239]
    ds_read_b128 a[112:115], v10 offset:4352
    v_mfma_f32_16x16x32_bf16 a[12:15], a[168:171], v[40:43], a[12:15]
    ds_read_b64_tr_b16 a[48:49], v6 offset:0
    ds_read_b64_tr_b16 a[50:51], v6 offset:1024
    v_mfma_f32_16x16x32_bf16 a[12:15], a[172:175], v[44:47], a[12:15]
    ds_read_b128 a[116:119], v10 offset:4416
    v_mfma_f32_16x16x32_bf16 v[80:83], a[176:179], a[208:211], v[80:83]
    ds_read_b64_tr_b16 a[52:53], v6 offset:16448
    ds_read_b64_tr_b16 a[54:55], v6 offset:17472
    v_mfma_f32_16x16x32_bf16 v[80:83], a[180:183], a[212:215], v[80:83]
    ds_read_b128 a[120:123], v10 offset:6528
    v_mfma_f32_16x16x32_bf16 v[112:115], a[176:179], a[216:219], v[112:115]
    ds_read_b64_tr_b16 a[56:57], v6 offset:8
    ds_read_b64_tr_b16 a[58:59], v6 offset:1032
    v_mfma_f32_16x16x32_bf16 v[112:115], a[180:183], a[220:223], v[112:115]
    ds_read_b128 a[124:127], v10 offset:6592
    v_mfma_f32_16x16x32_bf16 v[144:147], a[176:179], a[224:227], v[144:147]
    ds_read_b64_tr_b16 a[60:61], v6 offset:16456
    ds_read_b64_tr_b16 a[62:63], v6 offset:17480
    v_mfma_f32_16x16x32_bf16 v[144:147], a[180:183], a[228:231], v[144:147]
    ds_read_b128 a[128:131], v10 offset:8704
    v_mfma_f32_16x16x32_bf16 v[176:179], a[176:179], a[232:235], v[176:179]
    ds_read_b64_tr_b16 a[64:65], v7 offset:0
    ds_read_b64_tr_b16 a[66:67], v7 offset:1024
    v_mfma_f32_16x16x32_bf16 v[176:179], a[180:183], a[236:239], v[176:179]
    ds_read_b128 a[132:135], v10 offset:8768
    v_mfma_f32_16x16x32_bf16 v[208:211], a[176:179], a[248:251], v[208:211]
    ds_read_b64_tr_b16 a[68:69], v7 offset:16448
    ds_read_b64_tr_b16 a[70:71], v7 offset:17472
    v_mfma_f32_16x16x32_bf16 v[208:211], a[180:183], a[252:255], v[208:211]
    ds_read_b128 a[136:139], v10 offset:10880
    v_mfma_f32_16x16x32_bf16 v[240:243], a[176:179], v[32:35], v[240:243]
    ds_read_b64_tr_b16 a[72:73], v7 offset:8
    ds_read_b64_tr_b16 a[74:75], v7 offset:1032
    v_mfma_f32_16x16x32_bf16 v[240:243], a[180:183], v[36:39], v[240:243]
    ds_read_b128 a[140:143], v10 offset:10944
    v_mfma_f32_16x16x32_bf16 a[16:19], a[176:179], v[40:43], a[16:19]
    ds_read_b64_tr_b16 a[76:77], v7 offset:16456
    ds_read_b64_tr_b16 a[78:79], v7 offset:17480
    v_mfma_f32_16x16x32_bf16 a[16:19], a[180:183], v[44:47], a[16:19]
    ds_read_b128 a[240:243], v10 offset:13056
    v_mfma_f32_16x16x32_bf16 v[84:87], a[184:187], a[208:211], v[84:87]
    ds_read_b64_tr_b16 a[80:81], v8 offset:0
    ds_read_b64_tr_b16 a[82:83], v8 offset:1024
    v_mfma_f32_16x16x32_bf16 v[84:87], a[188:191], a[212:215], v[84:87]
    ds_read_b128 a[244:247], v10 offset:13120
    v_mfma_f32_16x16x32_bf16 v[116:119], a[184:187], a[216:219], v[116:119]
    ds_read_b64_tr_b16 a[84:85], v8 offset:16448
    ds_read_b64_tr_b16 a[86:87], v8 offset:17472
    v_mfma_f32_16x16x32_bf16 v[116:119], a[188:191], a[220:223], v[116:119]
    ds_read_b64_tr_b16 a[88:89], v8 offset:8
    ds_read_b64_tr_b16 a[90:91], v8 offset:1032
    v_mfma_f32_16x16x32_bf16 v[148:151], a[184:187], a[224:227], v[148:151]
    ds_read_b64_tr_b16 a[92:93], v8 offset:16456
    ds_read_b64_tr_b16 a[94:95], v8 offset:17480
    v_mfma_f32_16x16x32_bf16 v[148:151], a[188:191], a[228:231], v[148:151]
    v_mfma_f32_16x16x32_bf16 v[180:183], a[184:187], a[232:235], v[180:183]
    v_mfma_f32_16x16x32_bf16 v[180:183], a[188:191], a[236:239], v[180:183]
    v_mfma_f32_16x16x32_bf16 v[212:215], a[184:187], a[248:251], v[212:215]
    v_mfma_f32_16x16x32_bf16 v[212:215], a[188:191], a[252:255], v[212:215]
    s_waitcnt lgkmcnt(0)
    v_mfma_f32_16x16x32_bf16 v[244:247], a[184:187], v[32:35], v[244:247]
    s_barrier
    v_mfma_f32_16x16x32_bf16 v[244:247], a[188:191], v[36:39], v[244:247]
    v_mfma_f32_16x16x32_bf16 a[20:23], a[184:187], v[40:43], a[20:23]
    v_mfma_f32_16x16x32_bf16 a[20:23], a[188:191], v[44:47], a[20:23]
    s_add_u32 m0, s50, 99200
    s_nop 0
    buffer_load_dwordx4 v11, s[8:11], s47 offen lds
    v_mfma_f32_16x16x32_bf16 v[88:91], a[192:195], a[208:211], v[88:91]
    s_add_u32 m0, s50, 100224
    s_add_u32 s49, s47, 32768
    buffer_load_dwordx4 v11, s[8:11], s49 offen lds
    v_mfma_f32_16x16x32_bf16 v[88:91], a[196:199], a[212:215], v[88:91]
    s_add_u32 m0, s50, 101256
    s_add_u32 s49, s47, 65536
    buffer_load_dwordx4 v11, s[8:11], s49 offen lds
    v_mfma_f32_16x16x32_bf16 v[120:123], a[192:195], a[216:219], v[120:123]
    s_add_u32 m0, s50, 102280
    s_add_u32 s49, s47, 98304
    buffer_load_dwordx4 v11, s[8:11], s49 offen lds
    v_mfma_f32_16x16x32_bf16 v[120:123], a[196:199], a[220:223], v[120:123]
    s_add_u32 m0, s50, 115648
    s_add_u32 s49, s47, 262144
    buffer_load_dwordx4 v11, s[8:11], s49 offen lds
    v_mfma_f32_16x16x32_bf16 v[152:155], a[192:195], a[224:227], v[152:155]
    v_mfma_f32_16x16x32_bf16 v[152:155], a[196:199], a[228:231], v[152:155]
    s_add_u32 m0, s50, 116672
    s_add_u32 s49, s47, 294912
    buffer_load_dwordx4 v11, s[8:11], s49 offen lds
    v_mfma_f32_16x16x32_bf16 v[184:187], a[192:195], a[232:235], v[184:187]
    s_add_u32 m0, s50, 117704
    s_add_u32 s49, s47, 327680
    buffer_load_dwordx4 v11, s[8:11], s49 offen lds
    v_mfma_f32_16x16x32_bf16 v[184:187], a[196:199], a[236:239], v[184:187]
    s_add_u32 m0, s50, 118728
    s_add_u32 s49, s47, 360448
    buffer_load_dwordx4 v11, s[8:11], s49 offen lds
    v_mfma_f32_16x16x32_bf16 v[216:219], a[192:195], a[248:251], v[216:219]
    s_add_u32 m0, s51, 132096
    s_nop 0
    buffer_load_dwordx4 v12, s[4:7], s46 offen lds
    v_mfma_f32_16x16x32_bf16 v[216:219], a[196:199], a[252:255], v[216:219]
    s_add_u32 m0, s51, 133184
    s_add_u32 s49, s46, 16384
    buffer_load_dwordx4 v12, s[4:7], s49 offen lds
    v_mfma_f32_16x16x32_bf16 v[248:251], a[192:195], v[32:35], v[248:251]
    v_mfma_f32_16x16x32_bf16 v[248:251], a[196:199], v[36:39], v[248:251]
    s_add_u32 m0, s51, 134272
    s_add_u32 s49, s46, 32768
    buffer_load_dwordx4 v12, s[4:7], s49 offen lds
    v_mfma_f32_16x16x32_bf16 a[24:27], a[192:195], v[40:43], a[24:27]
    s_add_u32 m0, s51, 135360
    s_add_u32 s49, s46, 49152
    buffer_load_dwordx4 v12, s[4:7], s49 offen lds
    v_mfma_f32_16x16x32_bf16 a[24:27], a[196:199], v[44:47], a[24:27]
    s_add_u32 m0, s51, 136448
    s_add_u32 s49, s46, 65536
    buffer_load_dwordx4 v12, s[4:7], s49 offen lds
    v_mfma_f32_16x16x32_bf16 v[92:95], a[200:203], a[208:211], v[92:95]
    s_add_u32 m0, s51, 137536
    s_add_u32 s49, s46, 81920
    buffer_load_dwordx4 v12, s[4:7], s49 offen lds
    v_mfma_f32_16x16x32_bf16 v[92:95], a[204:207], a[212:215], v[92:95]
    v_mfma_f32_16x16x32_bf16 v[124:127], a[200:203], a[216:219], v[124:127]
    s_add_u32 m0, s51, 138624
    s_add_u32 s49, s46, 98304
    buffer_load_dwordx4 v12, s[4:7], s49 offen lds
    v_mfma_f32_16x16x32_bf16 v[124:127], a[204:207], a[220:223], v[124:127]
    s_add_u32 s59, s59, 1
    v_mfma_f32_16x16x32_bf16 v[156:159], a[200:203], a[224:227], v[156:159]
    s_add_u32 s60, s59, s62
    v_mfma_f32_16x16x32_bf16 v[156:159], a[204:207], a[228:231], v[156:159]
    s_and_b32 s60, s60, 3
    v_mfma_f32_16x16x32_bf16 v[188:191], a[200:203], a[232:235], v[188:191]
    s_and_b32 s61, s59, -4
    v_mfma_f32_16x16x32_bf16 v[188:191], a[204:207], a[236:239], v[188:191]
    s_or_b32 s60, s60, s61
    v_mfma_f32_16x16x32_bf16 v[220:223], a[200:203], a[248:251], v[220:223]
    s_lshl_b32 s47, s60, 19
    v_mfma_f32_16x16x32_bf16 v[220:223], a[204:207], a[252:255], v[220:223]
    s_lshl_b32 s46, s60, 7
    v_mfma_f32_16x16x32_bf16 v[252:255], a[200:203], v[32:35], v[252:255]
    v_mfma_f32_16x16x32_bf16 v[252:255], a[204:207], v[36:39], v[252:255]
    v_mfma_f32_16x16x32_bf16 a[28:31], a[200:203], v[40:43], a[28:31]
    v_mfma_f32_16x16x32_bf16 a[28:31], a[204:207], v[44:47], a[28:31]
    s_mov_b32 s55, 6
    .p2align 6
L_q:
    v_mfma_f32_16x16x32_bf16 v[64:67], a[32:35], a[96:99], v[64:67]
    s_waitcnt vmcnt(15)
    v_mfma_f32_16x16x32_bf16 v[64:67], a[36:39], a[100:103], v[64:67]
    s_barrier
    ds_read_b128 a[208:211], v9 offset:0
    v_mfma_f32_16x16x32_bf16 v[96:99], a[32:35], a[104:107], v[96:99]
    ds_read_b64_tr_b16 a[144:145], v1 offset:0
    v_mfma_f32_16x16x32_bf16 v[96:99], a[36:39], a[108:111], v[96:99]
    ds_read_b64_tr_b16 a[146:147], v1 offset:1024
    v_mfma_f32_16x16x32_bf16 v[128:131], a[32:35], a[112:115], v[128:131]
    ds_read_b128 a[212:215], v9 offset:64
    v_mfma_f32_16x16x32_bf16 v[128:131], a[36:39], a[116:119], v[128:131]
    ds_read_b64_tr_b16 a[148:149], v1 offset:16448
    v_mfma_f32_16x16x32_bf16 v[160:163], a[32:35], a[120:123], v[160:163]
    ds_read_b64_tr_b16 a[150:151], v1 offset:17472
    v_mfma_f32_16x16x32_bf16 v[160:163], a[36:39], a[124:127], v[160:163]
    ds_read_b128 a[216:219], v9 offset:2176
    v_mfma_f32_16x16x32_bf16 v[192:195], a[32:35], a[128:131], v[192:195]
    ds_read_b64_tr_b16 a[152:153], v1 offset:8
    v_mfma_f32_16x16x32_bf16 v[192:195], a[36:39], a[132:135], v[192:195]
    ds_read_b64_tr_b16 a[154:155], v1 offset:1032
    v_mfma_f32_16x16x32_bf16 v[224:227], a[32:35], a[136:139], v[224:227]
    ds_read_b128 a[220:223], v9 offset:2240
    v_mfma_f32_16x16x32_bf16 v[224:227], a[36:39], a[140:143], v[224:227]
    ds_read_b64_tr_b16 a[156:157], v1 offset:16456
    v_mfma_f32_16x16x32_bf16 a[0:3], a[32:35], a[240:243], a[0:3]
    ds_read_b64_tr_b16 a[158:159], v1 offset:17480
    v_mfma_f32_16x16x32_bf16 a[0:3], a[36:39], a[244:247], a[0:3]
    ds_read_b128 a[224:227], v9 offset:4352
    v_mfma_f32_16x16x32_bf16 v[68:71], a[40:43], a[96:99], v[68:71]
    ds_read_b64_tr_b16 a[160:161], v2 offset:0
    v_mfma_f32_16x16x32_bf16 v[68:71], a[44:47], a[100:103], v[68:71]
    ds_read_b64_tr_b16 a[162:163], v2 offset:1024
    v_mfma_f32_16x16x32_bf16 v[100:103], a[40:43], a[104:107], v[100:103]
    ds_read_b128 a[228:231], v9 offset:4416
    v_mfma_f32_16x16x32_bf16 v[100:103], a[44:47], a[108:111], v[100:103]
    ds_read_b64_tr_b16 a[164:165], v2 offset:16448
    v_mfma_f32_16x16x32_bf16 v[132:135], a[40:43], a[112:115], v[132:135]
    ds_read_b64_tr_b16 a[166:167], v2 offset:17472
    v_mfma_f32_16x16x32_bf16 v[132:135], a[44:47], a[116:119], v[132:135]
    ds_read_b128 a[232:235], v9 offset:6528
    v_mfma_f32_16x16x32_bf16 v[164:167], a[40:43], a[120:123], v[164:167]
    ds_read_b64_tr_b16 a[168:169], v2 offset:8
    v_mfma_f32_16x16x32_bf16 v[164:167], a[44:47], a[124:127], v[164:167]
    ds_read_b64_tr_b16 a[170:171], v2 offset:1032
    v_mfma_f32_16x16x32_bf16 v[196:199], a[40:43], a[128:131], v[196:199]
    ds_read_b128 a[236:239], v9 offset:6592
    v_mfma_f32_16x16x32_bf16 v[196:199], a[44:47], a[132:135], v[196:199]
    ds_read_b64_tr_b16 a[172:173], v2 offset:16456
    v_mfma_f32_16x16x32_bf16 v[228:231], a[40:43], a[136:139], v[228:231]
    ds_read_b64_tr_b16 a[174:175], v2 offset:17480
    v_mfma_f32_16x16x32_bf16 v[228:231], a[44:47], a[140:143], v[228:231]
    ds_read_b128 a[248:251], v9 offset:8704
    v_mfma_f32_16x16x32_bf16 a[4:7], a[40:43], a[240:243], a[4:7]
    ds_read_b64_tr_b16 a[176:177], v3 offset:0
    v_mfma_f32_16x16x32_bf16 a[4:7], a[44:47], a[244:247], a[4:7]
    ds_read_b64_tr_b16 a[178:179], v3 offset:1024
    v_mfma_f32_16x16x32_bf16 v[72:75], a[48:51], a[96:99], v[72:75]
    ds_read_b128 a[252:255], v9 offset:8768
    v_mfma_f32_16x16x32_bf16 v[72:75], a[52:55], a[100:103], v[72:75]
    ds_read_b64_tr_b16 a[180:181], v3 offset:16448
    v_mfma_f32_16x16x32_bf16 v[104:107], a[48:51], a[104:107], v[104:107]
    ds_read_b64_tr_b16 a[182:183], v3 offset:17472
    v_mfma_f32_16x16x32_bf16 v[104:107], a[52:55], a[108:111], v[104:107]
    ds_read_b128 v[32:35], v9 offset:10880
    v_mfma_f32_16x16x32_bf16 v[136:139], a[48:51], a[112:115], v[136:139]
    ds_read_b64_tr_b16 a[184:185], v3 offset:8
    v_mfma_f32_16x16x32_bf16 v[136:139], a[52:55], a[116:119], v[136:139]
    ds_read_b64_tr_b16 a[186:187], v3 offset:1032
    v_mfma_f32_16x16x32_bf16 v[168:171], a[48:51], a[120:123], v[168:171]
    ds_read_b128 v[36:39], v9 offset:10944
    v_mfma_f32_16x16x32_bf16 v[168:171], a[52:55], a[124:127], v[168:171]
    ds_read_b64_tr_b16 a[188:189], v3 offset:16456
    v_mfma_f32_16x16x32_bf16 v[200:203], a[48:51], a[128:131], v[200:203]
    ds_read_b64_tr_b16 a[190:191], v3 offset:17480
    v_mfma_f32_16x16x32_bf16 v[200:203], a[52:55], a[132:135], v[200:203]
    ds_read_b128 v[40:43], v9 offset:13056
    v_mfma_f32_16x16x32_bf16 v[232:235], a[48:51], a[136:139], v[232:235]
    ds_read_b64_tr_b16 a[192:193], v4 offset:0
    v_mfma_f32_16x16x32_bf16 v[232:235], a[52:55], a[140:143], v[232:235]
    ds_read_b64_tr_b16 a[194:195], v4 offset:1024
    v_mfma_f32_16x16x32_bf16 a[8:11], a[48:51], a[240:243], a[8:11]
    ds_read_b128 v[44:47], v9 offset:13120
    v_mfma_f32_16x16x32_bf16 a[8:11], a[52:55], a[244:247], a[8:11]
    ds_read_b64_tr_b16 a[196:197], v4 offset:16448
    v_mfma_f32_16x16x32_bf16 v[76:79], a[56:59], a[96:99], v[76:79]
    ds_read_b64_tr_b16 a[198:199], v4 offset:17472
    v_mfma_f32_16x16x32_bf16 v[76:79], a[60:63], a[100:103], v[76:79]
    ds_read_b64_tr_b16 a[200:201], v4 offset:8
    ds_read_b64_tr_b16 a[202:203], v4 offset:1032
    v_mfma_f32_16x16x32_bf16 v[108:111], a[56:59], a[104:107], v[108:111]
    ds_read_b64_tr_b16 a[204:205], v4 offset:16456
    v_mfma_f32_16x16x32_bf16 v[108:111], a[60:63], a[108:111], v[108:111]
    ds_read_b64_tr_b16 a[206:207], v4 offset:17480
    v_mfma_f32_16x16x32_bf16 v[140:143], a[56:59], a[112:115], v[140:143]
    v_mfma_f32_16x16x32_bf16 v[140:143], a[60:63], a[116:119], v[140:143]
    v_mfma_f32_16x16x32_bf16 v[172:175], a[56:59], a[120:123], v[172:175]
    v_mfma_f32_16x16x32_bf16 v[172:175], a[60:63], a[124:127], v[172:175]
    v_mfma_f32_16x16x32_bf16 v[204:207], a[56:59], a[128:131], v[204:207]
    s_waitcnt lgkmcnt(0)
    v_mfma_f32_16x16x32_bf16 v[204:207], a[60:63], a[132:135], v[204:207]
    s_barrier
    v_mfma_f32_16x16x32_bf16 v[236:239], a[56:59], a[136:139], v[236:239]
    v_mfma_f32_16x16x32_bf16 v[236:239], a[60:63], a[140:143], v[236:239]
    s_add_u32 m0, s50, 35840
    v_mfma_f32_16x16x32_bf16 a[12:15], a[56:59], a[240:243], a[12:15]
    buffer_load_dwordx4 v11, s[8:11], s47 offen lds
    v_mfma_f32_16x16x32_bf16 a[12:15], a[60:63], a[244:247], a[12:15]
    s_add_u32 s49, s47, 32768
    v_mfma_f32_16x16x32_bf16 v[80:83], a[64:67], a[96:99], v[80:83]
    s_add_u32 m0, s50, 36864
    v_mfma_f32_16x16x32_bf16 v[80:83], a[68:71], a[100:103], v[80:83]
    buffer_load_dwordx4 v11, s[8:11], s49 offen lds
    v_mfma_f32_16x16x32_bf16 v[112:115], a[64:67], a[104:107], v[112:115]
    s_add_u32 s49, s47, 65536
    v_mfma_f32_16x16x32_bf16 v[112:115], a[68:71], a[108:111], v[112:115]
    s_add_u32 m0, s50, 37896
    v_mfma_f32_16x16x32_bf16 v[144:147], a[64:67], a[112:115], v[144:147]
    buffer_load_dwordx4 v11, s[8:11], s49 offen lds
    v_mfma_f32_16x16x32_bf16 v[144:147], a[68:71], a[116:119], v[144:147]
    s_add_u32 s49, s47, 98304
    v_mfma_f32_16x16x32_bf16 v[176:179], a[64:67], a[120:123], v[176:179]
    s_add_u32 m0, s50, 38920
    v_mfma_f32_16x16x32_bf16 v[176:179], a[68:71], a[124:127], v[176:179]
    buffer_load_dwordx4 v11, s[8:11], s49 offen lds
    v_mfma_f32_16x16x32_bf16 v[208:211], a[64:67], a[128:131], v[208:211]
    v_mfma_f32_16x16x32_bf16 v[208:211], a[68:71], a[132:135], v[208:211]
    s_add_u32 s49, s47, 262144
    v_mfma_f32_16x16x32_bf16 v[240:243], a[64:67], a[136:139], v[240:243]
    s_add_u32 m0, s50, 52288
    v_mfma_f32_16x16x32_bf16 v[240:243], a[68:71], a[140:143], v[240:243]
    buffer_load_dwordx4 v11, s[8:11], s49 offen lds
    v_mfma_f32_16x16x32_bf16 a[16:19], a[64:67], a[240:243], a[16:19]
    s_add_u32 s49, s47, 294912
    v_mfma_f32_16x16x32_bf16 a[16:19], a[68:71], a[244:247], a[16:19]
    s_add_u32 m0, s50, 53312
    v_mfma_f32_16x16x32_bf16 v[84:87], a[72:75], a[96:99], v[84:87]
    buffer_load_dwordx4 v11, s[8:11], s49 offen lds
    v_mfma_f32_16x16x32_bf16 v[84:87], a[76:79], a[100:103], v[84:87]
    s_add_u32 s49, s47, 327680
    v_mfma_f32_16x16x32_bf16 v[116:119], a[72:75], a[104:107], v[116:119]
    s_add_u32 m0, s50, 54344
    v_mfma_f32_16x16x32_bf16 v[116:119], a[76:79], a[108:111], v[116:119]
    buffer_load_dwordx4 v11, s[8:11], s49 offen lds
    v_mfma_f32_16x16x32_bf16 v[148:151], a[72:75], a[112:115], v[148:151]
    v_mfma_f32_16x16x32_bf16 v[148:151], a[76:79], a[116:119], v[148:151]
    s_add_u32 s49, s47, 360448
    v_mfma_f32_16x16x32_bf16 v[180:183], a[72:75], a[120:123], v[180:183]
    s_add_u32 m0, s50, 55368
    v_mfma_f32_16x16x32_bf16 v[180:183], a[76:79], a[124:127], v[180:183]
    buffer_load_dwordx4 v11, s[8:11], s49 offen lds
    v_mfma_f32_16x16x32_bf16 v[212:215], a[72:75], a[128:131], v[212:215]
    v_mfma_f32_16x16x32_bf16 v[212:215], a[76:79], a[132:135], v[212:215]
    s_add_u32 m0, s51, 68736
    v_mfma_f32_16x16x32_bf16 v[244:247], a[72:75], a[136:139], v[244:247]
    buffer_load_dwordx4 v12, s[4:7], s46 offen lds
    v_mfma_f32_16x16x32_bf16 v[244:247], a[76:79], a[140:143], v[244:247]
    s_add_u32 s49, s46, 16384
    v_mfma_f32_16x16x32_bf16 a[20:23], a[72:75], a[240:243], a[20:23]
    s_add_u32 m0, s51, 69824
    v_mfma_f32_16x16x32_bf16 a[20:23], a[76:79], a[244:247], a[20:23]
    buffer_load_dwordx4 v12, s[4:7], s49 offen lds
    v_mfma_f32_16x16x32_bf16 v[88:91], a[80:83], a[96:99], v[88:91]
    s_add_u32 s49, s46, 32768
    v_mfma_f32_16x16x32_bf16 v[88:91], a[84:87], a[100:103], v[88:91]
    s_add_u32 m0, s51, 70912
    v_mfma_f32_16x16x32_bf16 v[120:123], a[80:83], a[104:107], v[120:123]
    buffer_load_dwordx4 v12, s[4:7], s49 offen lds
    v_mfma_f32_16x16x32_bf16 v[120:123], a[84:87], a[108:111], v[120:123]
    v_mfma_f32_16x16x32_bf16 v[152:155], a[80:83], a[112:115], v[152:155]
    s_add_u32 s49, s46, 49152
    v_mfma_f32_16x16x32_bf16 v[152:155], a[84:87], a[116:119], v[152:155]
    s_add_u32 m0, s51, 72000
    v_mfma_f32_16x16x32_bf16 v[184:187], a[80:83], a[120:123], v[184:187]
    buffer_load_dwordx4 v12, s[4:7], s49 offen lds
    v_mfma_f32_16x16x32_bf16 v[184:187], a[84:87], a[124:127], v[184:187]
    s_add_u32 s49, s46, 65536
    v_mfma_f32_16x16x32_bf16 v[216:219], a[80:83], a[128:131], v[216:219]
    s_add_u32 m0, s51, 73088
    v_mfma_f32_16x16x32_bf16 v[216:219], a[84:87], a[132:135], v[216:219]
    buffer_load_dwordx4 v12, s[4:7], s49 offen lds
    v_mfma_f32_16x16x32_bf16 v[248:251], a[80:83], a[136:139], v[248:251]
    s_add_u32 s49, s46, 81920
    v_mfma_f32_16x16x32_bf16 v[248:251], a[84:87], a[140:143], v[248:251]
    s_add_u32 m0, s51, 74176
    v_mfma_f32_16x16x32_bf16 a[24:27], a[80:83], a[240:243], a[24:27]
    buffer_load_dwordx4 v12, s[4:7], s49 offen lds
    v_mfma_f32_16x16x32_bf16 a[24:27], a[84:87], a[244:247], a[24:27]
    v_mfma_f32_16x16x32_bf16 v[92:95], a[88:91], a[96:99], v[92:95]
    s_add_u32 s49, s46, 98304
    v_mfma_f32_16x16x32_bf16 v[92:95], a[92:95], a[100:103], v[92:95]
    s_add_u32 m0, s51, 75264
    v_mfma_f32_16x16x32_bf16 v[124:127], a[88:91], a[104:107], v[124:127]
    buffer_load_dwordx4 v12, s[4:7], s49 offen lds
    v_mfma_f32_16x16x32_bf16 v[124:127], a[92:95], a[108:111], v[124:127]
    s_add_u32 s59, s59, 1
    v_mfma_f32_16x16x32_bf16 v[156:159], a[88:91], a[112:115], v[156:159]
    s_add_u32 s60, s59, s62
    v_mfma_f32_16x16x32_bf16 v[156:159], a[92:95], a[116:119], v[156:159]
    s_and_b32 s60, s60, 3
    v_mfma_f32_16x16x32_bf16 v[188:191], a[88:91], a[120:123], v[188:191]
    s_and_b32 s61, s59, -4
    v_mfma_f32_16x16x32_bf16 v[188:191], a[92:95], a[124:127], v[188:191]
    s_or_b32 s60, s60, s61
    v_mfma_f32_16x16x32_bf16 v[220:223], a[88:91], a[128:131], v[220:223]
    s_lshl_b32 s47, s60, 19
    v_mfma_f32_16x16x32_bf16 v[220:223], a[92:95], a[132:135], v[220:223]
    s_lshl_b32 s46, s60, 7
    v_mfma_f32_16x16x32_bf16 v[252:255], a[88:91], a[136:139], v[252:255]
    v_mfma_f32_16x16x32_bf16 v[252:255], a[92:95], a[140:143], v[252:255]
    v_mfma_f32_16x16x32_bf16 a[28:31], a[88:91], a[240:243], a[28:31]
    v_mfma_f32_16x16x32_bf16 a[28:31], a[92:95], a[244:247], a[28:31]
    v_mfma_f32_16x16x32_bf16 v[64:67], a[144:147], a[208:211], v[64:67]
    s_waitcnt vmcnt(15)
    v_mfma_f32_16x16x32_bf16 v[64:67], a[148:151], a[212:215], v[64:67]
    s_barrier
    ds_read_b128 a[96:99], v10 offset:0
    v_mfma_f32_16x16x32_bf16 v[96:99], a[144:147], a[216:219], v[96:99]
    ds_read_b64_tr_b16 a[32:33], v5 offset:0
    v_mfma_f32_16x16x32_bf16 v[96:99], a[148:151], a[220:223], v[96:99]
    ds_read_b64_tr_b16 a[34:35], v5 offset:1024
    v_mfma_f32_16x16x32_bf16 v[128:131], a[144:147], a[224:227], v[128:131]
    ds_read_b128 a[100:103], v10 offset:64
    v_mfma_f32_16x16x32_bf16 v[128:131], a[148:151], a[228:231], v[128:131]
    ds_read_b64_tr_b16 a[36:37], v5 offset:16448
    v_mfma_f32_16x16x32_bf16 v[160:163], a[144:147], a[232:235], v[160:163]
    ds_read_b64_tr_b16 a[38:39], v5 offset:17472
    v_mfma_f32_16x16x32_bf16 v[160:163], a[148:151], a[236:239], v[160:163]
    ds_read_b128 a[104:107], v10 offset:2176
    v_mfma_f32_16x16x32_bf16 v[192:195], a[144:147], a[248:251], v[192:195]
    ds_read_b64_tr_b16 a[40:41], v5 offset:8
    v_mfma_f32_16x16x32_bf16 v[192:195], a[148:151], a[252:255], v[192:195]
    ds_read_b64_tr_b16 a[42:43], v5 offset:1032
    v_mfma_f32_16x16x32_bf16 v[224:227], a[144:147], v[32:35], v[224:227]
    ds_read_b128 a[108:111], v10 offset:2240
    v_mfma_f32_16x16x32_bf16 v[224:227], a[148:151], v[36:39], v[224:227]
    ds_read_b64_tr_b16 a[44:45], v5 offset:16456
    v_mfma_f32_16x16x32_bf16 a[0:3], a[144:147], v[40:43], a[0:3]
    ds_read_b64_tr_b16 a[46:47], v5 offset:17480
    v_mfma_f32_16x16x32_bf16 a[0:3], a[148:151], v[44:47], a[0:3]
    ds_read_b128 a[112:115], v10 offset:4352
    v_mfma_f32_16x16x32_bf16 v[68:71], a[152:155], a[208:211], v[68:71]
    ds_read_b64_tr_b16 a[48:49], v6 offset:0
    v_mfma_f32_16x16x32_bf16 v[68:71], a[156:159], a[212:215], v[68:71]
    ds_read_b64_tr_b16 a[50:51], v6 offset:1024
    v_mfma_f32_16x16x32_bf16 v[100:103], a[152:155], a[216:219], v[100:103]
    ds_read_b128 a[116:119], v10 offset:4416
    v_mfma_f32_16x16x32_bf16 v[100:103], a[156:159], a[220:223], v[100:103]
    ds_read_b64_tr_b16 a[52:53], v6 offset:16448
    v_mfma_f32_16x16x32_bf16 v[132:135], a[152:155], a[224:227], v[132:135]
    ds_read_b64_tr_b16 a[54:55], v6 offset:17472
    v_mfma_f32_16x16x32_bf16 v[132:135], a[156:159], a[228:231], v[132:135]
    ds_read_b128 a[120:123], v10 offset:6528
    v_mfma_f32_16x16x32_bf16 v[164:167], a[152:155], a[232:235], v[164:167]
    ds_read_b64_tr_b16 a[56:57], v6 offset:8
    v_mfma_f32_16x16x32_bf16 v[164:167], a[156:159], a[236:239], v[164:167]
    ds_read_b64_tr_b16 a[58:59], v6 offset:1032
    v_mfma_f32_16x16x32_bf16 v[196:199], a[152:155], a[248:251], v[196:199]
    ds_read_b128 a[124:127], v10 offset:6592
    v_mfma_f32_16x16x32_bf16 v[196:199], a[156:159], a[252:255], v[196:199]
    ds_read_b64_tr_b16 a[60:61], v6 offset:16456
    v_mfma_f32_16x16x32_bf16 v[228:231], a[152:155], v[32:35], v[228:231]
    ds_read_b64_tr_b16 a[62:63], v6 offset:17480
    v_mfma_f32_16x16x32_bf16 v[228:231], a[156:159], v[36:39], v[228:231]
    ds_read_b128 a[128:131], v10 offset:8704
    v_mfma_f32_16x16x32_bf16 a[4:7], a[152:155], v[40:43], a[4:7]
    ds_read_b64_tr_b16 a[64:65], v7 offset:0
    v_mfma_f32_16x16x32_bf16 a[4:7], a[156:159], v[44:47], a[4:7]
    ds_read_b64_tr_b16 a[66:67], v7 offset:1024
    v_mfma_f32_16x16x32_bf16 v[72:75], a[160:163], a[208:211], v[72:75]
    ds_read_b128 a[132:135], v10 offset:8768
    v_mfma_f32_16x16x32_bf16 v[72:75], a[164:167], a[212:215], v[72:75]
    ds_read_b64_tr_b16 a[68:69], v7 offset:16448
    v_mfma_f32_16x16x32_bf16 v[104:107], a[160:163], a[216:219], v[104:107]
    ds_read_b64_tr_b16 a[70:71], v7 offset:17472
    v_mfma_f32_16x16x32_bf16 v[104:107], a[164:167], a[220:223], v[104:107]
    ds_read_b128 a[136:139], v10 offset:10880
    v_mfma_f32_16x16x32_bf16 v[136:139], a[160:163], a[224:227], v[136:139]
    ds_read_b64_tr_b16 a[72:73], v7 offset:8
    v_mfma_f32_16x16x32_bf16 v[136:139], a[164:167], a[228:231], v[136:139]
    ds_read_b64_tr_b16 a[74:75], v7 offset:1032
    v_mfma_f32_16x16x32_bf16 v[168:171], a[160:163], a[232:235], v[168:171]
    ds_read_b128 a[140:143], v10 offset:10944
    v_mfma_f32_16x16x32_bf16 v[168:171], a[164:167], a[236:239], v[168:171]
    ds_read_b64_tr_b16 a[76:77], v7 offset:16456
    v_mfma_f32_16x16x32_bf16 v[200:203], a[160:163], a[248:251], v[200:203]
    ds_read_b64_tr_b16 a[78:79], v7 offset:17480
    v_mfma_f32_16x16x32_bf16 v[200:203], a[164:167], a[252:255], v[200:203]
    ds_read_b128 a[240:243], v10 offset:13056
    v_mfma_f32_16x16x32_bf16 v[232:235], a[160:163], v[32:35], v[232:235]
    ds_read_b64_tr_b16 a[80:81], v8 offset:0
    v_mfma_f32_16x16x32_bf16 v[232:235], a[164:167], v[36:39], v[232:235]
    ds_read_b64_tr_b16 a[82:83], v8 offset:1024
    v_mfma_f32_16x16x32_bf16 a[8:11], a[160:163], v[40:43], a[8:11]
    ds_read_b128 a[244:247], v10 offset:13120
    v_mfma_f32_16x16x32_bf16 a[8:11], a[164:167], v[44:47], a[8:11]
    ds_read_b64_tr_b16 a[84:85], v8 offset:16448
    v_mfma_f32_16x16x32_bf16 v[76:79], a[168:171], a[208:211], v[76:79]
    ds_read_b64_tr_b16 a[86:87], v8 offset:17472
    v_mfma_f32_16x16x32_bf16 v[76:79], a[172:175], a[212:215], v[76:79]
    ds_read_b64_tr_b16 a[88:89], v8 offset:8
    ds_read_b64_tr_b16 a[90:91], v8 offset:1032
    v_mfma_f32_16x16x32_bf16 v[108:111], a[168:171], a[216:219], v[108:111]
    ds_read_b64_tr_b16 a[92:93], v8 offset:16456
    v_mfma_f32_16x16x32_bf16 v[108:111], a[172:175], a[220:223], v[108:111]
    ds_read_b64_tr_b16 a[94:95], v8 offset:17480
    v_mfma_f32_16x16x32_bf16 v[140:143], a[168:171], a[224:227], v[140:143]
    v_mfma_f32_16x16x32_bf16 v[140:143], a[172:175], a[228:231], v[140:143]
    v_mfma_f32_16x16x32_bf16 v[172:175], a[168:171], a[232:235], v[172:175]
    v_mfma_f32_16x16x32_bf16 v[172:175], a[172:175], a[236:239], v[172:175]
    v_mfma_f32_16x16x32_bf16 v[204:207], a[168:171], a[248:251], v[204:207]
    s_waitcnt lgkmcnt(0)
    v_mfma_f32_16x16x32_bf16 v[204:207], a[172:175], a[252:255], v[204:207]
    s_barrier
    v_mfma_f32_16x16x32_bf16 v[236:239], a[168:171], v[32:35], v[236:239]
    v_mfma_f32_16x16x32_bf16 v[236:239], a[172:175], v[36:39], v[236:239]
    s_add_u32 m0, s50, 99200
    v_mfma_f32_16x16x32_bf16 a[12:15], a[168:171], v[40:43], a[12:15]
    buffer_load_dwordx4 v11, s[8:11], s47 offen lds
    v_mfma_f32_16x16x32_bf16 a[12:15], a[172:175], v[44:47], a[12:15]
    s_add_u32 s49, s47, 32768
    v_mfma_f32_16x16x32_bf16 v[80:83], a[176:179], a[208:211], v[80:83]
    s_add_u32 m0, s50, 100224
    v_mfma_f32_16x16x32_bf16 v[80:83], a[180:183], a[212:215], v[80:83]
    buffer_load_dwordx4 v11, s[8:11], s49 offen lds
    v_mfma_f32_16x16x32_bf16 v[112:115], a[176:179], a[216:219], v[112:115]
    s_add_u32 s49, s47, 65536
    v_mfma_f32_16x16x32_bf16 v[112:115], a[180:183], a[220:223], v[112:115]
    s_add_u32 m0, s50, 101256
    v_mfma_f32_16x16x32_bf16 v[144:147], a[176:179], a[224:227], v[144:147]
    buffer_load_dwordx4 v11, s[8:11], s49 offen lds
    v_mfma_f32_16x16x32_bf16 v[144:147], a[180:183], a[228:231], v[144:147]
    s_add_u32 s49, s47, 98304
    v_mfma_f32_16x16x32_bf16 v[176:179], a[176:179], a[232:235], v[176:179]
    s_add_u32 m0, s50, 102280
    v_mfma_f32_16x16x32_bf16 v[176:179], a[180:183], a[236:239], v[176:179]
    buffer_load_dwordx4 v11, s[8:11], s49 offen lds
    v_mfma_f32_16x16x32_bf16 v[208:211], a[176:179], a[248:251], v[208:211]
    v_mfma_f32_16x16x32_bf16 v[208:211], a[180:183], a[252:255], v[208:211]
    s_add_u32 s49, s47, 262144
    v_mfma_f32_16x16x32_bf16 v[240:243], a[176:179], v[32:35], v[240:243]
    s_add_u32 m0, s50, 115648
    v_mfma_f32_16x16x32_bf16 v[240:243], a[180:183], v[36:39], v[240:243]
    buffer_load_dwordx4 v11, s[8:11], s49 offen lds
    v_mfma_f32_16x16x32_bf16 a[16:19], a[176:179], v[40:43], a[16:19]
    s_add_u32 s49, s47, 294912
    v_mfma_f32_16x16x32_bf16 a[16:19], a[180:183], v[44:47], a[16:19]
    s_add_u32 m0, s50, 116672
    v_mfma_f32_16x16x32_bf16 v[84:87], a[184:187], a[208:211], v[84:87]
    buffer_load_dwordx4 v11, s[8:11], s49 offen lds
    v_mfma_f32_16x16x32_bf16 v[84:87], a[188:191], a[212:215], v[84:87]
    s_add_u32 s49, s47, 327680
    v_mfma_f32_16x16x32_bf16 v[116:119], a[184:187], a[216:219], v[116:119]
    s_add_u32 m0, s50, 117704
    v_mfma_f32_16x16x32_bf16 v[116:119], a[188:191], a[220:223], v[116:119]
    buffer_load_dwordx4 v11, s[8:11], s49 offen lds
    v_mfma_f32_16x16x32_bf16 v[148:151], a[184:187], a[224:227], v[148:151]
    v_mfma_f32_16x16x32_bf16 v[148:151], a[188:191], a[228:231], v[148:151]
    s_add_u32 s49, s47, 360448
    v_mfma_f32_16x16x32_bf16 v[180:183], a[184:187], a[232:235], v[180:183]
    s_add_u32 m0, s50, 118728
    v_mfma_f32_16x16x32_bf16 v[180:183], a[188:191], a[236:239], v[180:183]
    buffer_load_dwordx4 v11, s[8:11], s49 offen lds
    v_mfma_f32_16x16x32_bf16 v[212:215], a[184:187], a[248:251], v[212:215]
    v_mfma_f32_16x16x32_bf16 v[212:215], a[188:191], a[252:255], v[212:215]
    s_add_u32 m0, s51, 132096
    v_mfma_f32_16x16x32_bf16 v[244:247], a[184:187], v[32:35], v[244:247]
    buffer_load_dwordx4 v12, s[4:7], s46 offen lds
    v_mfma_f32_16x16x32_bf16 v[244:247], a[188:191], v[36:39], v[244:247]
    s_add_u32 s49, s46, 16384
    v_mfma_f32_16x16x32_bf16 a[20:23], a[184:187], v[40:43], a[20:23]
    s_add_u32 m0, s51, 133184
    v_mfma_f32_16x16x32_bf16 a[20:23], a[188:191], v[44:47], a[20:23]
    buffer_load_dwordx4 v12, s[4:7], s49 offen lds
    v_mfma_f32_16x16x32_bf16 v[88:91], a[192:195], a[208:211], v[88:91]
    s_add_u32 s49, s46, 32768
    v_mfma_f32_16x16x32_bf16 v[88:91], a[196:199], a[212:215], v[88:91]
    s_add_u32 m0, s51, 134272
    v_mfma_f32_16x16x32_bf16 v[120:123], a[192:195], a[216:219], v[120:123]
    buffer_load_dwordx4 v12, s[4:7], s49 offen lds
    v_mfma_f32_16x16x32_bf16 v[120:123], a[196:199], a[220:223], v[120:123]
    v_mfma_f32_16x16x32_bf16 v[152:155], a[192:195], a[224:227], v[152:155]
    s_add_u32 s49, s46, 49152
    v_mfma_f32_16x16x32_bf16 v[152:155], a[196:199], a[228:231], v[152:155]
    s_add_u32 m0, s51, 135360
    v_mfma_f32_16x16x32_bf16 v[184:187], a[192:195], a[232:235], v[184:187]
    buffer_load_dwordx4 v12, s[4:7], s49 offen lds
    v_mfma_f32_16x16x32_bf16 v[184:187], a[196:199], a[236:239], v[184:187]
    s_add_u32 s49, s46, 65536
    v_mfma_f32_16x16x32_bf16 v[216:219], a[192:195], a[248:251], v[216:219]
    s_add_u32 m0, s51, 136448
    v_mfma_f32_16x16x32_bf16 v[216:219], a[196:199], a[252:255], v[216:219]
    buffer_load_dwordx4 v12, s[4:7], s49 offen lds
    v_mfma_f32_16x16x32_bf16 v[248:251], a[192:195], v[32:35], v[248:251]
    s_add_u32 s49, s46, 81920
    v_mfma_f32_16x16x32_bf16 v[248:251], a[196:199], v[36:39], v[248:251]
    s_add_u32 m0, s51, 137536
    v_mfma_f32_16x16x32_bf16 a[24:27], a[192:195], v[40:43], a[24:27]
    buffer_load_dwordx4 v12, s[4:7], s49 offen lds
    v_mfma_f32_16x16x32_bf16 a[24:27], a[196:199], v[44:47], a[24:27]
    v_mfma_f32_16x16x32_bf16 v[92:95], a[200:203], a[208:211], v[92:95]
    s_add_u32 s49, s46, 98304
    v_mfma_f32_16x16x32_bf16 v[92:95], a[204:207], a[212:215], v[92:95]
    s_add_u32 m0, s51, 138624
    v_mfma_f32_16x16x32_bf16 v[124:127], a[200:203], a[216:219], v[124:127]
    buffer_load_dwordx4 v12, s[4:7], s49 offen lds
    v_mfma_f32_16x16x32_bf16 v[124:127], a[204:207], a[220:223], v[124:127]
    s_add_u32 s59, s59, 1
    v_mfma_f32_16x16x32_bf16 v[156:159], a[200:203], a[224:227], v[156:159]
    s_add_u32 s60, s59, s62
    v_mfma_f32_16x16x32_bf16 v[156:159], a[204:207], a[228:231], v[156:159]
    s_and_b32 s60, s60, 3
    v_mfma_f32_16x16x32_bf16 v[188:191], a[200:203], a[232:235], v[188:191]
    s_and_b32 s61, s59, -4
    v_mfma_f32_16x16x32_bf16 v[188:191], a[204:207], a[236:239], v[188:191]
    s_or_b32 s60, s60, s61
    v_mfma_f32_16x16x32_bf16 v[220:223], a[200:203], a[248:251], v[220:223]
    s_lshl_b32 s47, s60, 19
    v_mfma_f32_16x16x32_bf16 v[220:223], a[204:207], a[252:255], v[220:223]
    s_lshl_b32 s46, s60, 7
    v_mfma_f32_16x16x32_bf16 v[252:255], a[200:203], v[32:35], v[252:255]
    v_mfma_f32_16x16x32_bf16 v[252:255], a[204:207], v[36:39], v[252:255]
    v_mfma_f32_16x16x32_bf16 a[28:31], a[200:203], v[40:43], a[28:31]
    s_sub_u32 s55, s55, 1
    v_mfma_f32_16x16x32_bf16 a[28:31], a[204:207], v[44:47], a[28:31]
    s_cmp_lg_u32 s55, 0
    s_cbranch_scc1 L_q
    v_mfma_f32_16x16x32_bf16 v[64:67], a[32:35], a[96:99], v[64:67]
    s_waitcnt vmcnt(15)
    v_mfma_f32_16x16x32_bf16 v[64:67], a[36:39], a[100:103], v[64:67]
    s_barrier
    ds_read_b128 a[208:211], v9 offset:0
    v_mfma_f32_16x16x32_bf16 v[96:99], a[32:35], a[104:107], v[96:99]
    ds_read_b64_tr_b16 a[144:145], v1 offset:0
    v_mfma_f32_16x16x32_bf16 v[96:99], a[36:39], a[108:111], v[96:99]
    s_add_u32 m0, s52, 0
    ds_read_b64_tr_b16 a[146:147], v1 offset:1024
    v_mfma_f32_16x16x32_bf16 v[128:131], a[32:35], a[112:115], v[128:131]
    ds_read_b128 a[212:215], v9 offset:64
    buffer_load_dwordx4 v13, s[12:15], s48 offen nt lds
    v_mfma_f32_16x16x32_bf16 v[128:131], a[36:39], a[116:119], v[128:131]
    ds_read_b64_tr_b16 a[148:149], v1 offset:16448
    v_mfma_f32_16x16x32_bf16 v[160:163], a[32:35], a[120:123], v[160:163]
    ds_read_b64_tr_b16 a[150:151], v1 offset:17472
    v_mfma_f32_16x16x32_bf16 v[160:163], a[36:39], a[124:127], v[160:163]
    ds_read_b128 a[216:219], v9 offset:2176
    v_mfma_f32_16x16x32_bf16 v[192:195], a[32:35], a[128:131], v[192:195]
    ds_read_b64_tr_b16 a[152:153], v1 offset:8
    v_mfma_f32_16x16x32_bf16 v[192:195], a[36:39], a[132:135], v[192:195]
    ds_read_b64_tr_b16 a[154:155], v1 offset:1032
    v_mfma_f32_16x16x32_bf16 v[224:227], a[32:35], a[136:139], v[224:227]
    ds_read_b128 a[220:223], v9 offset:2240
    v_mfma_f32_16x16x32_bf16 v[224:227], a[36:39], a[140:143], v[224:227]
    ds_read_b64_tr_b16 a[156:157], v1 offset:16456
    v_mfma_f32_16x16x32_bf16 a[0:3], a[32:35], a[240:243], a[0:3]
    ds_read_b64_tr_b16 a[158:159], v1 offset:17480
    v_mfma_f32_16x16x32_bf16 a[0:3], a[36:39], a[244:247], a[0:3]
    ds_read_b128 a[224:227], v9 offset:4352
    v_mfma_f32_16x16x32_bf16 v[68:71], a[40:43], a[96:99], v[68:71]
    s_add_u32 s48, s48, 5120
    ds_read_b64_tr_b16 a[160:161], v2 offset:0
    v_mfma_f32_16x16x32_bf16 v[68:71], a[44:47], a[100:103], v[68:71]
    s_add_u32 m0, m0, s53
    ds_read_b64_tr_b16 a[162:163], v2 offset:1024
    v_mfma_f32_16x16x32_bf16 v[100:103], a[40:43], a[104:107], v[100:103]
    ds_read_b128 a[228:231], v9 offset:4416
    buffer_load_dwordx4 v13, s[12:15], s48 offen nt lds
    v_mfma_f32_16x16x32_bf16 v[100:103], a[44:47], a[108:111], v[100:103]
    ds_read_b64_tr_b16 a[164:165], v2 offset:16448
    v_mfma_f32_16x16x32_bf16 v[132:135], a[40:43], a[112:115], v[132:135]
    ds_read_b64_tr_b16 a[166:167], v2 offset:17472
    v_mfma_f32_16x16x32_bf16 v[132:135], a[44:47], a[116:119], v[132:135]
    ds_read_b128 a[232:235], v9 offset:6528
    v_mfma_f32_16x16x32_bf16 v[164:167], a[40:43], a[120:123], v[164:167]
    ds_read_b64_tr_b16 a[168:169], v2 offset:8
    v_mfma_f32_16x16x32_bf16 v[164:167], a[44:47], a[124:127], v[164:167]
    ds_read_b64_tr_b16 a[170:171], v2 offset:1032
    v_mfma_f32_16x16x32_bf16 v[196:199], a[40:43], a[128:131], v[196:199]
    ds_read_b128 a[236:239], v9 offset:6592
    v_mfma_f32_16x16x32_bf16 v[196:199], a[44:47], a[132:135], v[196:199]
    ds_read_b64_tr_b16 a[172:173], v2 offset:16456
    v_mfma_f32_16x16x32_bf16 v[228:231], a[40:43], a[136:139], v[228:231]
    ds_read_b64_tr_b16 a[174:175], v2 offset:17480
    v_mfma_f32_16x16x32_bf16 v[228:231], a[44:47], a[140:143], v[228:231]
    ds_read_b128 a[248:251], v9 offset:8704
    v_mfma_f32_16x16x32_bf16 a[4:7], a[40:43], a[240:243], a[4:7]
    s_add_u32 s48, s48, 5120
    ds_read_b64_tr_b16 a[176:177], v3 offset:0
    v_mfma_f32_16x16x32_bf16 a[4:7], a[44:47], a[244:247], a[4:7]
    s_add_u32 m0, m0, s53
    ds_read_b64_tr_b16 a[178:179], v3 offset:1024
    v_mfma_f32_16x16x32_bf16 v[72:75], a[48:51], a[96:99], v[72:75]
    ds_read_b128 a[252:255], v9 offset:8768
    buffer_load_dwordx4 v13, s[12:15], s48 offen nt lds
    v_mfma_f32_16x16x32_bf16 v[72:75], a[52:55], a[100:103], v[72:75]
    ds_read_b64_tr_b16 a[180:181], v3 offset:16448
    v_mfma_f32_16x16x32_bf16 v[104:107], a[48:51], a[104:107], v[104:107]
    ds_read_b64_tr_b16 a[182:183], v3 offset:17472
    v_mfma_f32_16x16x32_bf16 v[104:107], a[52:55], a[108:111], v[104:107]
    ds_read_b128 v[32:35], v9 offset:10880
    v_mfma_f32_16x16x32_bf16 v[136:139], a[48:51], a[112:115], v[136:139]
    ds_read_b64_tr_b16 a[184:185], v3 offset:8
    v_mfma_f32_16x16x32_bf16 v[136:139], a[52:55], a[116:119], v[136:139]
    ds_read_b64_tr_b16 a[186:187], v3 offset:1032
    v_mfma_f32_16x16x32_bf16 v[168:171], a[48:51], a[120:123], v[168:171]
    ds_read_b128 v[36:39], v9 offset:10944
    v_mfma_f32_16x16x32_bf16 v[168:171], a[52:55], a[124:127], v[168:171]
    ds_read_b64_tr_b16 a[188:189], v3 offset:16456
    v_mfma_f32_16x16x32_bf16 v[200:203], a[48:51], a[128:131], v[200:203]
    ds_read_b64_tr_b16 a[190:191], v3 offset:17480
    v_mfma_f32_16x16x32_bf16 v[200:203], a[52:55], a[132:135], v[200:203]
    ds_read_b128 v[40:43], v9 offset:13056
    v_mfma_f32_16x16x32_bf16 v[232:235], a[48:51], a[136:139], v[232:235]
    s_add_u32 s48, s48, 5120
    ds_read_b64_tr_b16 a[192:193], v4 offset:0
    v_mfma_f32_16x16x32_bf16 v[232:235], a[52:55], a[140:143], v[232:235]
    s_add_u32 m0, m0, s53
    ds_read_b64_tr_b16 a[194:195], v4 offset:1024
    v_mfma_f32_16x16x32_bf16 a[8:11], a[48:51], a[240:243], a[8:11]
    ds_read_b128 v[44:47], v9 offset:13120
    buffer_load_dwordx4 v13, s[12:15], s48 offen nt lds
    v_mfma_f32_16x16x32_bf16 a[8:11], a[52:55], a[244:247], a[8:11]
    ds_read_b64_tr_b16 a[196:197], v4 offset:16448
    v_mfma_f32_16x16x32_bf16 v[76:79], a[56:59], a[96:99], v[76:79]
    ds_read_b64_tr_b16 a[198:199], v4 offset:17472
    v_mfma_f32_16x16x32_bf16 v[76:79], a[60:63], a[100:103], v[76:79]
    ds_read_b64_tr_b16 a[200:201], v4 offset:8
    ds_read_b64_tr_b16 a[202:203], v4 offset:1032
    v_mfma_f32_16x16x32_bf16 v[108:111], a[56:59], a[104:107], v[108:111]
    ds_read_b64_tr_b16 a[204:205], v4 offset:16456
    v_mfma_f32_16x16x32_bf16 v[108:111], a[60:63], a[108:111], v[108:111]
    ds_read_b64_tr_b16 a[206:207], v4 offset:17480
    v_mfma_f32_16x16x32_bf16 v[140:143], a[56:59], a[112:115], v[140:143]
    v_mfma_f32_16x16x32_bf16 v[140:143], a[60:63], a[116:119], v[140:143]
    v_mfma_f32_16x16x32_bf16 v[172:175], a[56:59], a[120:123], v[172:175]
    v_mfma_f32_16x16x32_bf16 v[172:175], a[60:63], a[124:127], v[172:175]
    v_mfma_f32_16x16x32_bf16 v[204:207], a[56:59], a[128:131], v[204:207]
    s_waitcnt lgkmcnt(0)
    v_mfma_f32_16x16x32_bf16 v[204:207], a[60:63], a[132:135], v[204:207]
    s_barrier
    v_mfma_f32_16x16x32_bf16 v[236:239], a[56:59], a[136:139], v[236:239]
    v_mfma_f32_16x16x32_bf16 v[236:239], a[60:63], a[140:143], v[236:239]
    s_add_u32 s48, s48, 1024
    v_mfma_f32_16x16x32_bf16 a[12:15], a[56:59], a[240:243], a[12:15]
    s_add_u32 m0, m0, s53
    v_mfma_f32_16x16x32_bf16 a[12:15], a[60:63], a[244:247], a[12:15]
    buffer_load_dwordx4 v13, s[12:15], s48 offen nt lds
    v_mfma_f32_16x16x32_bf16 v[80:83], a[64:67], a[96:99], v[80:83]
    v_mfma_f32_16x16x32_bf16 v[80:83], a[68:71], a[100:103], v[80:83]
    v_mfma_f32_16x16x32_bf16 v[112:115], a[64:67], a[104:107], v[112:115]
    v_mfma_f32_16x16x32_bf16 v[112:115], a[68:71], a[108:111], v[112:115]
    v_mfma_f32_16x16x32_bf16 v[144:147], a[64:67], a[112:115], v[144:147]
    v_mfma_f32_16x16x32_bf16 v[144:147], a[68:71], a[116:119], v[144:147]
    v_mfma_f32_16x16x32_bf16 v[176:179], a[64:67], a[120:123], v[176:179]
    v_mfma_f32_16x16x32_bf16 v[176:179], a[68:71], a[124:127], v[176:179]
    v_mfma_f32_16x16x32_bf16 v[208:211], a[64:67], a[128:131], v[208:211]
    v_mfma_f32_16x16x32_bf16 v[208:211], a[68:71], a[132:135], v[208:211]
    s_add_u32 s48, s48, 5120
    v_mfma_f32_16x16x32_bf16 v[240:243], a[64:67], a[136:139], v[240:243]
    s_add_u32 m0, m0, s53
    v_mfma_f32_16x16x32_bf16 v[240:243], a[68:71], a[140:143], v[240:243]
    buffer_load_dwordx4 v13, s[12:15], s48 offen nt lds
    v_mfma_f32_16x16x32_bf16 a[16:19], a[64:67], a[240:243], a[16:19]
    v_mfma_f32_16x16x32_bf16 a[16:19], a[68:71], a[244:247], a[16:19]
    v_mfma_f32_16x16x32_bf16 v[84:87], a[72:75], a[96:99], v[84:87]
    v_mfma_f32_16x16x32_bf16 v[84:87], a[76:79], a[100:103], v[84:87]
    v_mfma_f32_16x16x32_bf16 v[116:119], a[72:75], a[104:107], v[116:119]
    v_mfma_f32_16x16x32_bf16 v[116:119], a[76:79], a[108:111], v[116:119]
    v_mfma_f32_16x16x32_bf16 v[148:151], a[72:75], a[112:115], v[148:151]
    v_mfma_f32_16x16x32_bf16 v[148:151], a[76:79], a[116:119], v[148:151]
    v_mfma_f32_16x16x32_bf16 v[180:183], a[72:75], a[120:123], v[180:183]
    v_mfma_f32_16x16x32_bf16 v[180:183], a[76:79], a[124:127], v[180:183]
    s_add_u32 s48, s48, 5120
    v_mfma_f32_16x16x32_bf16 v[212:215], a[72:75], a[128:131], v[212:215]
    s_add_u32 m0, m0, s53
    v_mfma_f32_16x16x32_bf16 v[212:215], a[76:79], a[132:135], v[212:215]
    buffer_load_dwordx4 v13, s[12:15], s48 offen nt lds
    v_mfma_f32_16x16x32_bf16 v[244:247], a[72:75], a[136:139], v[244:247]
    v_mfma_f32_16x16x32_bf16 v[244:247], a[76:79], a[140:143], v[244:247]
    v_mfma_f32_16x16x32_bf16 a[20:23], a[72:75], a[240:243], a[20:23]
    v_mfma_f32_16x16x32_bf16 a[20:23], a[76:79], a[244:247], a[20:23]
    v_mfma_f32_16x16x32_bf16 v[88:91], a[80:83], a[96:99], v[88:91]
    v_mfma_f32_16x16x32_bf16 v[88:91], a[84:87], a[100:103], v[88:91]
    v_mfma_f32_16x16x32_bf16 v[120:123], a[80:83], a[104:107], v[120:123]
    v_mfma_f32_16x16x32_bf16 v[120:123], a[84:87], a[108:111], v[120:123]
    v_mfma_f32_16x16x32_bf16 v[152:155], a[80:83], a[112:115], v[152:155]
    v_mfma_f32_16x16x32_bf16 v[152:155], a[84:87], a[116:119], v[152:155]
    s_add_u32 s48, s48, 5120
    v_mfma_f32_16x16x32_bf16 v[184:187], a[80:83], a[120:123], v[184:187]
    s_add_u32 m0, m0, s53
    v_mfma_f32_16x16x32_bf16 v[184:187], a[84:87], a[124:127], v[184:187]
    buffer_load_dwordx4 v13, s[12:15], s48 offen nt lds
    v_mfma_f32_16x16x32_bf16 v[216:219], a[80:83], a[128:131], v[216:219]
    s_add_u32 s48, s48, -30720
    v_mfma_f32_16x16x32_bf16 v[216:219], a[84:87], a[132:135], v[216:219]
    v_mfma_f32_16x16x32_bf16 v[248:251], a[80:83], a[136:139], v[248:251]
    v_mfma_f32_16x16x32_bf16 v[248:251], a[84:87], a[140:143], v[248:251]
    v_mfma_f32_16x16x32_bf16 a[24:27], a[80:83], a[240:243], a[24:27]
    v_mfma_f32_16x16x32_bf16 a[24:27], a[84:87], a[244:247], a[24:27]
    v_mfma_f32_16x16x32_bf16 v[92:95], a[88:91], a[96:99], v[92:95]
    v_mfma_f32_16x16x32_bf16 v[92:95], a[92:95], a[100:103], v[92:95]
    v_mfma_f32_16x16x32_bf16 v[124:127], a[88:91], a[104:107], v[124:127]
    v_mfma_f32_16x16x32_bf16 v[124:127], a[92:95], a[108:111], v[124:127]
    v_mfma_f32_16x16x32_bf16 v[156:159], a[88:91], a[112:115], v[156:159]
    v_mfma_f32_16x16x32_bf16 v[156:159], a[92:95], a[116:119], v[156:159]
    v_mfma_f32_16x16x32_bf16 v[188:191], a[88:91], a[120:123], v[188:191]
    v_mfma_f32_16x16x32_bf16 v[188:191], a[92:95], a[124:127], v[188:191]
    v_mfma_f32_16x16x32_bf16 v[220:223], a[88:91], a[128:131], v[220:223]
    v_mfma_f32_16x16x32_bf16 v[220:223], a[92:95], a[132:135], v[220:223]
    v_mfma_f32_16x16x32_bf16 v[252:255], a[88:91], a[136:139], v[252:255]
    v_mfma_f32_16x16x32_bf16 v[252:255], a[92:95], a[140:143], v[252:255]
    v_mfma_f32_16x16x32_bf16 a[28:31], a[88:91], a[240:243], a[28:31]
    v_mfma_f32_16x16x32_bf16 a[28:31], a[92:95], a[244:247], a[28:31]
    v_mfma_f32_16x16x32_bf16 v[64:67], a[144:147], a[208:211], v[64:67]
    s_waitcnt vmcnt(8)
    v_mfma_f32_16x16x32_bf16 v[64:67], a[148:151], a[212:215], v[64:67]
    s_barrier
    ds_read_b128 a[96:99], v10 offset:0
    v_mfma_f32_16x16x32_bf16 v[96:99], a[144:147], a[216:219], v[96:99]
    ds_read_b64_tr_b16 a[32:33], v5 offset:0
    v_mfma_f32_16x16x32_bf16 v[96:99], a[148:151], a[220:223], v[96:99]
    s_add_u32 m0, s52, 35840
    ds_read_b64_tr_b16 a[34:35], v5 offset:1024
    v_mfma_f32_16x16x32_bf16 v[128:131], a[144:147], a[224:227], v[128:131]
    ds_read_b128 a[100:103], v10 offset:64
    buffer_load_dwordx4 v13, s[12:15], s48 offen nt lds
    v_mfma_f32_16x16x32_bf16 v[128:131], a[148:151], a[228:231], v[128:131]
    ds_read_b64_tr_b16 a[36:37], v5 offset:16448
    v_mfma_f32_16x16x32_bf16 v[160:163], a[144:147], a[232:235], v[160:163]
    ds_read_b64_tr_b16 a[38:39], v5 offset:17472
    v_mfma_f32_16x16x32_bf16 v[160:163], a[148:151], a[236:239], v[160:163]
    ds_read_b128 a[104:107], v10 offset:2176
    v_mfma_f32_16x16x32_bf16 v[192:195], a[144:147], a[248:251], v[192:195]
    ds_read_b64_tr_b16 a[40:41], v5 offset:8
    v_mfma_f32_16x16x32_bf16 v[192:195], a[148:151], a[252:255], v[192:195]
    ds_read_b64_tr_b16 a[42:43], v5 offset:1032
    v_mfma_f32_16x16x32_bf16 v[224:227], a[144:147], v[32:35], v[224:227]
    ds_read_b128 a[108:111], v10 offset:2240
    v_mfma_f32_16x16x32_bf16 v[224:227], a[148:151], v[36:39], v[224:227]
    ds_read_b64_tr_b16 a[44:45], v5 offset:16456
    v_mfma_f32_16x16x32_bf16 a[0:3], a[144:147], v[40:43], a[0:3]
    ds_read_b64_tr_b16 a[46:47], v5 offset:17480
    v_mfma_f32_16x16x32_bf16 a[0:3], a[148:151], v[44:47], a[0:3]
    ds_read_b128 a[112:115], v10 offset:4352
    v_mfma_f32_16x16x32_bf16 v[68:71], a[152:155], a[208:211], v[68:71]
    s_add_u32 s48, s48, 5120
    ds_read_b64_tr_b16 a[48:49], v6 offset:0
    v_mfma_f32_16x16x32_bf16 v[68:71], a[156:159], a[212:215], v[68:71]
    s_add_u32 m0, m0, s53
    ds_read_b64_tr_b16 a[50:51], v6 offset:1024
    v_mfma_f32_16x16x32_bf16 v[100:103], a[152:155], a[216:219], v[100:103]
    ds_read_b128 a[116:119], v10 offset:4416
    buffer_load_dwordx4 v13, s[12:15], s48 offen nt lds
    v_mfma_f32_16x16x32_bf16 v[100:103], a[156:159], a[220:223], v[100:103]
    ds_read_b64_tr_b16 a[52:53], v6 offset:16448
    v_mfma_f32_16x16x32_bf16 v[132:135], a[152:155], a[224:227], v[132:135]
    ds_read_b64_tr_b16 a[54:55], v6 offset:17472
    v_mfma_f32_16x16x32_bf16 v[132:135], a[156:159], a[228:231], v[132:135]
    ds_read_b128 a[120:123], v10 offset:6528
    v_mfma_f32_16x16x32_bf16 v[164:167], a[152:155], a[232:235], v[164:167]
    ds_read_b64_tr_b16 a[56:57], v6 offset:8
    v_mfma_f32_16x16x32_bf16 v[164:167], a[156:159], a[236:239], v[164:167]
    ds_read_b64_tr_b16 a[58:59], v6 offset:1032
    v_mfma_f32_16x16x32_bf16 v[196:199], a[152:155], a[248:251], v[196:199]
    ds_read_b128 a[124:127], v10 offset:6592
    v_mfma_f32_16x16x32_bf16 v[196:199], a[156:159], a[252:255], v[196:199]
    ds_read_b64_tr_b16 a[60:61], v6 offset:16456
    v_mfma_f32_16x16x32_bf16 v[228:231], a[152:155], v[32:35], v[228:231]
    ds_read_b64_tr_b16 a[62:63], v6 offset:17480
    v_mfma_f32_16x16x32_bf16 v[228:231], a[156:159], v[36:39], v[228:231]
    ds_read_b128 a[128:131], v10 offset:8704
    v_mfma_f32_16x16x32_bf16 a[4:7], a[152:155], v[40:43], a[4:7]
    s_add_u32 s48, s48, 5120
    ds_read_b64_tr_b16 a[64:65], v7 offset:0
    v_mfma_f32_16x16x32_bf16 a[4:7], a[156:159], v[44:47], a[4:7]
    s_add_u32 m0, m0, s53
    ds_read_b64_tr_b16 a[66:67], v7 offset:1024
    v_mfma_f32_16x16x32_bf16 v[72:75], a[160:163], a[208:211], v[72:75]
    ds_read_b128 a[132:135], v10 offset:8768
    buffer_load_dwordx4 v13, s[12:15], s48 offen nt lds
    v_mfma_f32_16x16x32_bf16 v[72:75], a[164:167], a[212:215], v[72:75]
    ds_read_b64_tr_b16 a[68:69], v7 offset:16448
    v_mfma_f32_16x16x32_bf16 v[104:107], a[160:163], a[216:219], v[104:107]
    ds_read_b64_tr_b16 a[70:71], v7 offset:17472
    v_mfma_f32_16x16x32_bf16 v[104:107], a[164:167], a[220:223], v[104:107]
    ds_read_b128 a[136:139], v10 offset:10880
    v_mfma_f32_16x16x32_bf16 v[136:139], a[160:163], a[224:227], v[136:139]
    ds_read_b64_tr_b16 a[72:73], v7 offset:8
    v_mfma_f32_16x16x32_bf16 v[136:139], a[164:167], a[228:231], v[136:139]
    ds_read_b64_tr_b16 a[74:75], v7 offset:1032
    v_mfma_f32_16x16x32_bf16 v[168:171], a[160:163], a[232:235], v[168:171]
    ds_read_b128 a[140:143], v10 offset:10944
    v_mfma_f32_16x16x32_bf16 v[168:171], a[164:167], a[236:239], v[168:171]
    ds_read_b64_tr_b16 a[76:77], v7 offset:16456
    v_mfma_f32_16x16x32_bf16 v[200:203], a[160:163], a[248:251], v[200:203]
    ds_read_b64_tr_b16 a[78:79], v7 offset:17480
    v_mfma_f32_16x16x32_bf16 v[200:203], a[164:167], a[252:255], v[200:203]
    ds_read_b128 a[240:243], v10 offset:13056
    v_mfma_f32_16x16x32_bf16 v[232:235], a[160:163], v[32:35], v[232:235]
    s_add_u32 s48, s48, 1024
    ds_read_b64_tr_b16 a[80:81], v8 offset:0
    v_mfma_f32_16x16x32_bf16 v[232:235], a[164:167], v[36:39], v[232:235]
    s_add_u32 m0, m0, s53
    ds_read_b64_tr_b16 a[82:83], v8 offset:1024
    v_mfma_f32_16x16x32_bf16 a[8:11], a[160:163], v[40:43], a[8:11]
    ds_read_b128 a[244:247], v10 offset:13120
    buffer_load_dwordx4 v13, s[12:15], s48 offen nt lds
    v_mfma_f32_16x16x32_bf16 a[8:11], a[164:167], v[44:47], a[8:11]
    ds_read_b64_tr_b16 a[84:85], v8 offset:16448
    v_mfma_f32_16x16x32_bf16 v[76:79], a[168:171], a[208:211], v[76:79]
    ds_read_b64_tr_b16 a[86:87], v8 offset:17472
    v_mfma_f32_16x16x32_bf16 v[76:79], a[172:175], a[212:215], v[76:79]
    ds_read_b64_tr_b16 a[88:89], v8 offset:8
    ds_read_b64_tr_b16 a[90:91], v8 offset:1032
    v_mfma_f32_16x16x32_bf16 v[108:111], a[168:171], a[216:219], v[108:111]
    ds_read_b64_tr_b16 a[92:93], v8 offset:16456
    v_mfma_f32_16x16x32_bf16 v[108:111], a[172:175], a[220:223], v[108:111]
    ds_read_b64_tr_b16 a[94:95], v8 offset:17480
    v_mfma_f32_16x16x32_bf16 v[140:143], a[168:171], a[224:227], v[140:143]
    v_mfma_f32_16x16x32_bf16 v[140:143], a[172:175], a[228:231], v[140:143]
    v_mfma_f32_16x16x32_bf16 v[172:175], a[168:171], a[232:235], v[172:175]
    v_mfma_f32_16x16x32_bf16 v[172:175], a[172:175], a[236:239], v[172:175]
    v_mfma_f32_16x16x32_bf16 v[204:207], a[168:171], a[248:251], v[204:207]
    s_waitcnt lgkmcnt(0)
    v_mfma_f32_16x16x32_bf16 v[204:207], a[172:175], a[252:255], v[204:207]
    s_barrier
    v_mfma_f32_16x16x32_bf16 v[236:239], a[168:171], v[32:35], v[236:239]
    v_mfma_f32_16x16x32_bf16 v[236:239], a[172:175], v[36:39], v[236:239]
    s_add_u32 s48, s48, 5120
    v_mfma_f32_16x16x32_bf16 a[12:15], a[168:171], v[40:43], a[12:15]
    s_add_u32 m0, m0, s53
    v_mfma_f32_16x16x32_bf16 a[12:15], a[172:175], v[44:47], a[12:15]
    buffer_load_dwordx4 v13, s[12:15], s48 offen nt lds
    v_mfma_f32_16x16x32_bf16 v[80:83], a[176:179], a[208:211], v[80:83]
    v_mfma_f32_16x16x32_bf16 v[80:83], a[180:183], a[212:215], v[80:83]
    v_mfma_f32_16x16x32_bf16 v[112:115], a[176:179], a[216:219], v[112:115]
    v_mfma_f32_16x16x32_bf16 v[112:115], a[180:183], a[220:223], v[112:115]
    v_mfma_f32_16x16x32_bf16 v[144:147], a[176:179], a[224:227], v[144:147]
    v_mfma_f32_16x16x32_bf16 v[144:147], a[180:183], a[228:231], v[144:147]
    v_mfma_f32_16x16x32_bf16 v[176:179], a[176:179], a[232:235], v[176:179]
    v_mfma_f32_16x16x32_bf16 v[176:179], a[180:183], a[236:239], v[176:179]
    v_mfma_f32_16x16x32_bf16 v[208:211], a[176:179], a[248:251], v[208:211]
    v_mfma_f32_16x16x32_bf16 v[208:211], a[180:183], a[252:255], v[208:211]
    s_add_u32 s48, s48, 5120
    v_mfma_f32_16x16x32_bf16 v[240:243], a[176:179], v[32:35], v[240:243]
    s_add_u32 m0, m0, s53
    v_mfma_f32_16x16x32_bf16 v[240:243], a[180:183], v[36:39], v[240:243]
    buffer_load_dwordx4 v13, s[12:15], s48 offen nt lds
    v_mfma_f32_16x16x32_bf16 a[16:19], a[176:179], v[40:43], a[16:19]
    v_mfma_f32_16x16x32_bf16 a[16:19], a[180:183], v[44:47], a[16:19]
    v_mfma_f32_16x16x32_bf16 v[84:87], a[184:187], a[208:211], v[84:87]
    v_mfma_f32_16x16x32_bf16 v[84:87], a[188:191], a[212:215], v[84:87]
    v_mfma_f32_16x16x32_bf16 v[116:119], a[184:187], a[216:219], v[116:119]
    v_mfma_f32_16x16x32_bf16 v[116:119], a[188:191], a[220:223], v[116:119]
    v_mfma_f32_16x16x32_bf16 v[148:151], a[184:187], a[224:227], v[148:151]
    v_mfma_f32_16x16x32_bf16 v[148:151], a[188:191], a[228:231], v[148:151]
    v_mfma_f32_16x16x32_bf16 v[180:183], a[184:187], a[232:235], v[180:183]
    v_mfma_f32_16x16x32_bf16 v[180:183], a[188:191], a[236:239], v[180:183]
    s_add_u32 s48, s48, 5120
    v_mfma_f32_16x16x32_bf16 v[212:215], a[184:187], a[248:251], v[212:215]
    s_add_u32 m0, m0, s53
    v_mfma_f32_16x16x32_bf16 v[212:215], a[188:191], a[252:255], v[212:215]
    buffer_load_dwordx4 v13, s[12:15], s48 offen nt lds
    v_mfma_f32_16x16x32_bf16 v[244:247], a[184:187], v[32:35], v[244:247]
    v_mfma_f32_16x16x32_bf16 v[244:247], a[188:191], v[36:39], v[244:247]
    v_mfma_f32_16x16x32_bf16 a[20:23], a[184:187], v[40:43], a[20:23]
    v_mfma_f32_16x16x32_bf16 a[20:23], a[188:191], v[44:47], a[20:23]
    v_mfma_f32_16x16x32_bf16 v[88:91], a[192:195], a[208:211], v[88:91]
    v_mfma_f32_16x16x32_bf16 v[88:91], a[196:199], a[212:215], v[88:91]
    v_mfma_f32_16x16x32_bf16 v[120:123], a[192:195], a[216:219], v[120:123]
    v_mfma_f32_16x16x32_bf16 v[120:123], a[196:199], a[220:223], v[120:123]
    v_mfma_f32_16x16x32_bf16 v[152:155], a[192:195], a[224:227], v[152:155]
    v_mfma_f32_16x16x32_bf16 v[152:155], a[196:199], a[228:231], v[152:155]
    s_add_u32 s48, s48, 1024
    v_mfma_f32_16x16x32_bf16 v[184:187], a[192:195], a[232:235], v[184:187]
    s_add_u32 m0, m0, s53
    v_mfma_f32_16x16x32_bf16 v[184:187], a[196:199], a[236:239], v[184:187]
    buffer_load_dwordx4 v13, s[12:15], s48 offen nt lds
    v_mfma_f32_16x16x32_bf16 v[216:219], a[192:195], a[248:251], v[216:219]
    s_add_u32 s48, s48, -26624
    v_mfma_f32_16x16x32_bf16 v[216:219], a[196:199], a[252:255], v[216:219]
    v_mfma_f32_16x16x32_bf16 v[248:251], a[192:195], v[32:35], v[248:251]
    v_mfma_f32_16x16x32_bf16 v[248:251], a[196:199], v[36:39], v[248:251]
    v_mfma_f32_16x16x32_bf16 a[24:27], a[192:195], v[40:43], a[24:27]
    v_mfma_f32_16x16x32_bf16 a[24:27], a[196:199], v[44:47], a[24:27]
    v_mfma_f32_16x16x32_bf16 v[92:95], a[200:203], a[208:211], v[92:95]
    v_mfma_f32_16x16x32_bf16 v[92:95], a[204:207], a[212:215], v[92:95]
    v_mfma_f32_16x16x32_bf16 v[124:127], a[200:203], a[216:219], v[124:127]
    v_mfma_f32_16x16x32_bf16 v[124:127], a[204:207], a[220:223], v[124:127]
    v_mfma_f32_16x16x32_bf16 v[156:159], a[200:203], a[224:227], v[156:159]
    v_mfma_f32_16x16x32_bf16 v[156:159], a[204:207], a[228:231], v[156:159]
    v_mfma_f32_16x16x32_bf16 v[188:191], a[200:203], a[232:235], v[188:191]
    v_mfma_f32_16x16x32_bf16 v[188:191], a[204:207], a[236:239], v[188:191]
    v_mfma_f32_16x16x32_bf16 v[220:223], a[200:203], a[248:251], v[220:223]
    v_mfma_f32_16x16x32_bf16 v[220:223], a[204:207], a[252:255], v[220:223]
    v_mfma_f32_16x16x32_bf16 v[252:255], a[200:203], v[32:35], v[252:255]
    v_mfma_f32_16x16x32_bf16 v[252:255], a[204:207], v[36:39], v[252:255]
    v_mfma_f32_16x16x32_bf16 a[28:31], a[200:203], v[40:43], a[28:31]
    v_mfma_f32_16x16x32_bf16 a[28:31], a[204:207], v[44:47], a[28:31]
    v_mfma_f32_16x16x32_bf16 v[64:67], a[32:35], a[96:99], v[64:67]
    s_waitcnt vmcnt(8)
    v_mfma_f32_16x16x32_bf16 v[64:67], a[36:39], a[100:103], v[64:67]
    s_barrier
    ds_read_b128 a[144:147], v14 offset:0
    v_mfma_f32_16x16x32_bf16 v[96:99], a[32:35], a[104:107], v[96:99]
    ds_read_b64_tr_b16 a[176:177], v16 offset:0
    v_mfma_f32_16x16x32_bf16 v[96:99], a[36:39], a[108:111], v[96:99]
    s_add_u32 m0, s52, 71680
    ds_read_b64_tr_b16 a[178:179], v16 offset:4608
    v_mfma_f32_16x16x32_bf16 v[128:131], a[32:35], a[112:115], v[128:131]
    ds_read_b128 a[148:151], v14 offset:64
    buffer_load_dwordx4 v13, s[12:15], s48 offen nt lds
    v_mfma_f32_16x16x32_bf16 v[128:131], a[36:39], a[116:119], v[128:131]
    ds_read_b64_tr_b16 a[180:181], v17 offset:0
    v_mfma_f32_16x16x32_bf16 v[160:163], a[32:35], a[120:123], v[160:163]
    ds_read_b64_tr_b16 a[182:183], v17 offset:4608
    v_mfma_f32_16x16x32_bf16 v[160:163], a[36:39], a[124:127], v[160:163]
    ds_read_b128 a[152:155], v14 offset:128
    v_mfma_f32_16x16x32_bf16 v[192:195], a[32:35], a[128:131], v[192:195]
    ds_read_b64_tr_b16 a[184:185], v18 offset:0
    v_mfma_f32_16x16x32_bf16 v[192:195], a[36:39], a[132:135], v[192:195]
    ds_read_b64_tr_b16 a[186:187], v18 offset:4608
    v_mfma_f32_16x16x32_bf16 v[224:227], a[32:35], a[136:139], v[224:227]
    ds_read_b128 a[156:159], v14 offset:192
    v_mfma_f32_16x16x32_bf16 v[224:227], a[36:39], a[140:143], v[224:227]
    ds_read_b64_tr_b16 a[188:189], v19 offset:0
    v_mfma_f32_16x16x32_bf16 a[0:3], a[32:35], a[240:243], a[0:3]
    ds_read_b64_tr_b16 a[190:191], v19 offset:4608
    v_mfma_f32_16x16x32_bf16 a[0:3], a[36:39], a[244:247], a[0:3]
    ds_read_b128 a[160:163], v14 offset:4352
    v_mfma_f32_16x16x32_bf16 v[68:71], a[40:43], a[96:99], v[68:71]
    s_add_u32 s48, s48, 5120
    ds_read_b64_tr_b16 a[192:193], v16 offset:128
    v_mfma_f32_16x16x32_bf16 v[68:71], a[44:47], a[100:103], v[68:71]
    s_add_u32 m0, m0, s53
    ds_read_b64_tr_b16 a[194:195], v16 offset:4736
    v_mfma_f32_16x16x32_bf16 v[100:103], a[40:43], a[104:107], v[100:103]
    ds_read_b128 a[164:167], v14 offset:4416
    buffer_load_dwordx4 v13, s[12:15], s48 offen nt lds
    v_mfma_f32_16x16x32_bf16 v[100:103], a[44:47], a[108:111], v[100:103]
    ds_read_b64_tr_b16 a[196:197], v17 offset:128
    v_mfma_f32_16x16x32_bf16 v[132:135], a[40:43], a[112:115], v[132:135]
    ds_read_b64_tr_b16 a[198:199], v17 offset:4736
    v_mfma_f32_16x16x32_bf16 v[132:135], a[44:47], a[116:119], v[132:135]
    ds_read_b128 a[168:171], v14 offset:4480
    v_mfma_f32_16x16x32_bf16 v[164:167], a[40:43], a[120:123], v[164:167]
    ds_read_b64_tr_b16 a[200:201], v18 offset:128
    v_mfma_f32_16x16x32_bf16 v[164:167], a[44:47], a[124:127], v[164:167]
    ds_read_b64_tr_b16 a[202:203], v18 offset:4736
    v_mfma_f32_16x16x32_bf16 v[196:199], a[40:43], a[128:131], v[196:199]
    ds_read_b128 a[172:175], v14 offset:4544
    v_mfma_f32_16x16x32_bf16 v[196:199], a[44:47], a[132:135], v[196:199]
    ds_read_b64_tr_b16 a[204:205], v19 offset:128
    v_mfma_f32_16x16x32_bf16 v[228:231], a[40:43], a[136:139], v[228:231]
    ds_read_b64_tr_b16 a[206:207], v19 offset:4736
    v_mfma_f32_16x16x32_bf16 v[228:231], a[44:47], a[140:143], v[228:231]
    v_mfma_f32_16x16x32_bf16 a[4:7], a[40:43], a[240:243], a[4:7]
    s_add_u32 s48, s48, 1024
    v_mfma_f32_16x16x32_bf16 a[4:7], a[44:47], a[244:247], a[4:7]
    s_add_u32 m0, m0, s53
    v_mfma_f32_16x16x32_bf16 v[72:75], a[48:51], a[96:99], v[72:75]
    buffer_load_dwordx4 v13, s[12:15], s48 offen nt lds
    v_mfma_f32_16x16x32_bf16 v[72:75], a[52:55], a[100:103], v[72:75]
    v_mfma_f32_16x16x32_bf16 v[104:107], a[48:51], a[104:107], v[104:107]
    v_mfma_f32_16x16x32_bf16 v[104:107], a[52:55], a[108:111], v[104:107]
    v_mfma_f32_16x16x32_bf16 v[136:139], a[48:51], a[112:115], v[136:139]
    v_mfma_f32_16x16x32_bf16 v[136:139], a[52:55], a[116:119], v[136:139]
    v_mfma_f32_16x16x32_bf16 v[168:171], a[48:51], a[120:123], v[168:171]
    v_mfma_f32_16x16x32_bf16 v[168:171], a[52:55], a[124:127], v[168:171]
    v_mfma_f32_16x16x32_bf16 v[200:203], a[48:51], a[128:131], v[200:203]
    v_mfma_f32_16x16x32_bf16 v[200:203], a[52:55], a[132:135], v[200:203]
    v_mfma_f32_16x16x32_bf16 v[232:235], a[48:51], a[136:139], v[232:235]
    v_mfma_f32_16x16x32_bf16 v[232:235], a[52:55], a[140:143], v[232:235]
    v_mfma_f32_16x16x32_bf16 a[8:11], a[48:51], a[240:243], a[8:11]
    v_mfma_f32_16x16x32_bf16 a[8:11], a[52:55], a[244:247], a[8:11]
    s_add_u32 s48, s48, 5120
    v_mfma_f32_16x16x32_bf16 v[76:79], a[56:59], a[96:99], v[76:79]
    s_add_u32 m0, m0, s53
    v_mfma_f32_16x16x32_bf16 v[76:79], a[60:63], a[100:103], v[76:79]
    buffer_load_dwordx4 v13, s[12:15], s48 offen nt lds
    v_mfma_f32_16x16x32_bf16 v[108:111], a[56:59], a[104:107], v[108:111]
    v_mfma_f32_16x16x32_bf16 v[108:111], a[60:63], a[108:111], v[108:111]
    v_mfma_f32_16x16x32_bf16 v[140:143], a[56:59], a[112:115], v[140:143]
    v_mfma_f32_16x16x32_bf16 v[140:143], a[60:63], a[116:119], v[140:143]
    v_mfma_f32_16x16x32_bf16 v[172:175], a[56:59], a[120:123], v[172:175]
    v_mfma_f32_16x16x32_bf16 v[172:175], a[60:63], a[124:127], v[172:175]
    v_mfma_f32_16x16x32_bf16 v[204:207], a[56:59], a[128:131], v[204:207]
    v_mfma_f32_16x16x32_bf16 v[204:207], a[60:63], a[132:135], v[204:207]
    v_mfma_f32_16x16x32_bf16 v[236:239], a[56:59], a[136:139], v[236:239]
    v_mfma_f32_16x16x32_bf16 v[236:239], a[60:63], a[140:143], v[236:239]
    s_add_u32 s48, s48, 5120
    v_mfma_f32_16x16x32_bf16 a[12:15], a[56:59], a[240:243], a[12:15]
    s_add_u32 m0, m0, s53
    v_mfma_f32_16x16x32_bf16 a[12:15], a[60:63], a[244:247], a[12:15]
    buffer_load_dwordx4 v13, s[12:15], s48 offen nt lds
    v_mfma_f32_16x16x32_bf16 v[80:83], a[64:67], a[96:99], v[80:83]
    v_mfma_f32_16x16x32_bf16 v[80:83], a[68:71], a[100:103], v[80:83]
    v_mfma_f32_16x16x32_bf16 v[112:115], a[64:67], a[104:107], v[112:115]
    v_mfma_f32_16x16x32_bf16 v[112:115], a[68:71], a[108:111], v[112:115]
    v_mfma_f32_16x16x32_bf16 v[144:147], a[64:67], a[112:115], v[144:147]
    v_mfma_f32_16x16x32_bf16 v[144:147], a[68:71], a[116:119], v[144:147]
    v_mfma_f32_16x16x32_bf16 v[176:179], a[64:67], a[120:123], v[176:179]
    v_mfma_f32_16x16x32_bf16 v[176:179], a[68:71], a[124:127], v[176:179]
    v_mfma_f32_16x16x32_bf16 v[208:211], a[64:67], a[128:131], v[208:211]
    v_mfma_f32_16x16x32_bf16 v[208:211], a[68:71], a[132:135], v[208:211]
    s_add_u32 s48, s48, 5120
    v_mfma_f32_16x16x32_bf16 v[240:243], a[64:67], a[136:139], v[240:243]
    s_add_u32 m0, m0, s53
    v_mfma_f32_16x16x32_bf16 v[240:243], a[68:71], a[140:143], v[240:243]
    buffer_load_dwordx4 v13, s[12:15], s48 offen nt lds
    v_mfma_f32_16x16x32_bf16 a[16:19], a[64:67], a[240:243], a[16:19]
    v_mfma_f32_16x16x32_bf16 a[16:19], a[68:71], a[244:247], a[16:19]
    v_mfma_f32_16x16x32_bf16 v[84:87], a[72:75], a[96:99], v[84:87]
    v_mfma_f32_16x16x32_bf16 v[84:87], a[76:79], a[100:103], v[84:87]
    v_mfma_f32_16x16x32_bf16 v[116:119], a[72:75], a[104:107], v[116:119]
    v_mfma_f32_16x16x32_bf16 v[116:119], a[76:79], a[108:111], v[116:119]
    v_mfma_f32_16x16x32_bf16 v[148:151], a[72:75], a[112:115], v[148:151]
    v_mfma_f32_16x16x32_bf16 v[148:151], a[76:79], a[116:119], v[148:151]
    v_mfma_f32_16x16x32_bf16 v[180:183], a[72:75], a[120:123], v[180:183]
    v_mfma_f32_16x16x32_bf16 v[180:183], a[76:79], a[124:127], v[180:183]
    s_add_u32 s48, s48, 1024
    v_mfma_f32_16x16x32_bf16 v[212:215], a[72:75], a[128:131], v[212:215]
    s_add_u32 m0, m0, s53
    v_mfma_f32_16x16x32_bf16 v[212:215], a[76:79], a[132:135], v[212:215]
    buffer_load_dwordx4 v13, s[12:15], s48 offen nt lds
    v_mfma_f32_16x16x32_bf16 v[244:247], a[72:75], a[136:139], v[244:247]
    v_mfma_f32_16x16x32_bf16 v[244:247], a[76:79], a[140:143], v[244:247]
    v_mfma_f32_16x16x32_bf16 a[20:23], a[72:75], a[240:243], a[20:23]
    v_mfma_f32_16x16x32_bf16 a[20:23], a[76:79], a[244:247], a[20:23]
    v_mfma_f32_16x16x32_bf16 v[88:91], a[80:83], a[96:99], v[88:91]
    v_mfma_f32_16x16x32_bf16 v[88:91], a[84:87], a[100:103], v[88:91]
    v_mfma_f32_16x16x32_bf16 v[120:123], a[80:83], a[104:107], v[120:123]
    v_mfma_f32_16x16x32_bf16 v[120:123], a[84:87], a[108:111], v[120:123]
    v_mfma_f32_16x16x32_bf16 v[152:155], a[80:83], a[112:115], v[152:155]
    v_mfma_f32_16x16x32_bf16 v[152:155], a[84:87], a[116:119], v[152:155]
    s_add_u32 s48, s48, 5120
    v_mfma_f32_16x16x32_bf16 v[184:187], a[80:83], a[120:123], v[184:187]
    s_add_u32 m0, m0, s53
    v_mfma_f32_16x16x32_bf16 v[184:187], a[84:87], a[124:127], v[184:187]
    buffer_load_dwordx4 v13, s[12:15], s48 offen nt lds
    v_mfma_f32_16x16x32_bf16 v[216:219], a[80:83], a[128:131], v[216:219]
    s_add_u32 s48, s48, -26624
    v_mfma_f32_16x16x32_bf16 v[216:219], a[84:87], a[132:135], v[216:219]
    v_mfma_f32_16x16x32_bf16 v[248:251], a[80:83], a[136:139], v[248:251]
    v_mfma_f32_16x16x32_bf16 v[248:251], a[84:87], a[140:143], v[248:251]
    v_mfma_f32_16x16x32_bf16 a[24:27], a[80:83], a[240:243], a[24:27]
    v_mfma_f32_16x16x32_bf16 a[24:27], a[84:87], a[244:247], a[24:27]
    v_mfma_f32_16x16x32_bf16 v[92:95], a[88:91], a[96:99], v[92:95]
    v_mfma_f32_16x16x32_bf16 v[92:95], a[92:95], a[100:103], v[92:95]
    v_mfma_f32_16x16x32_bf16 v[124:127], a[88:91], a[104:107], v[124:127]
    v_mfma_f32_16x16x32_bf16 v[124:127], a[92:95], a[108:111], v[124:127]
    v_mfma_f32_16x16x32_bf16 v[156:159], a[88:91], a[112:115], v[156:159]
    v_mfma_f32_16x16x32_bf16 v[156:159], a[92:95], a[116:119], v[156:159]
    v_mfma_f32_16x16x32_bf16 v[188:191], a[88:91], a[120:123], v[188:191]
    v_mfma_f32_16x16x32_bf16 v[188:191], a[92:95], a[124:127], v[188:191]
    v_mfma_f32_16x16x32_bf16 v[220:223], a[88:91], a[128:131], v[220:223]
    v_mfma_f32_16x16x32_bf16 v[220:223], a[92:95], a[132:135], v[220:223]
    v_mfma_f32_16x16x32_bf16 v[252:255], a[88:91], a[136:139], v[252:255]
    v_mfma_f32_16x16x32_bf16 v[252:255], a[92:95], a[140:143], v[252:255]
    v_mfma_f32_16x16x32_bf16 a[28:31], a[88:91], a[240:243], a[28:31]
    s_waitcnt lgkmcnt(0)
    v_mfma_f32_16x16x32_bf16 a[28:31], a[92:95], a[244:247], a[28:31]
    v_mov_b32 v11, v24
    v_pk_mul_f32 v[64:65], v[64:65], s[56:57]
    v_pk_mul_f32 v[66:67], v[66:67], s[56:57]
    v_pk_mul_f32 v[68:69], v[68:69], s[56:57]
    v_pk_mul_f32 v[70:71], v[70:71], s[56:57]
    s_add_u32 m0, s52, 107520
    s_nop 0
    buffer_load_dwordx4 v13, s[12:15], s48 offen nt lds
    v_pk_mul_f32 v[72:73], v[72:73], s[56:57]
    v_pk_mul_f32 v[74:75], v[74:75], s[56:57]
    v_pk_mul_f32 v[76:77], v[76:77], s[56:57]
    v_pk_mul_f32 v[78:79], v[78:79], s[56:57]
    v_cvt_pk_bf16_f32 v48, v64, v65
    v_cvt_pk_bf16_f32 v49, v66, v67
    v_cvt_pk_bf16_f32 v50, v68, v69
    v_cvt_pk_bf16_f32 v51, v70, v71
    v_pk_mul_f32 v[96:97], v[96:97], s[56:57]
    v_pk_mul_f32 v[98:99], v[98:99], s[56:57]
    v_pk_mul_f32 v[100:101], v[100:101], s[56:57]
    v_pk_mul_f32 v[102:103], v[102:103], s[56:57]
    v_cvt_pk_bf16_f32 v52, v72, v73
    v_cvt_pk_bf16_f32 v53, v74, v75
    v_cvt_pk_bf16_f32 v54, v76, v77
    v_cvt_pk_bf16_f32 v55, v78, v79
    v_accvgpr_write_b32 a32, v48
    v_accvgpr_write_b32 a33, v49
    v_accvgpr_write_b32 a34, v50
    v_accvgpr_write_b32 a35, v51
    v_pk_mul_f32 v[104:105], v[104:105], s[56:57]
    v_pk_mul_f32 v[106:107], v[106:107], s[56:57]
    v_pk_mul_f32 v[108:109], v[108:109], s[56:57]
    v_pk_mul_f32 v[110:111], v[110:111], s[56:57]
    v_cvt_pk_bf16_f32 v48, v96, v97
    v_cvt_pk_bf16_f32 v49, v98, v99
    v_cvt_pk_bf16_f32 v50, v100, v101
    v_cvt_pk_bf16_f32 v51, v102, v103
    v_accvgpr_write_b32 a36, v52
    v_accvgpr_write_b32 a37, v53
    v_accvgpr_write_b32 a38, v54
    v_accvgpr_write_b32 a39, v55
    s_add_u32 m0, m0, s53
    s_add_u32 s48, s48, 1024
    buffer_load_dwordx4 v13, s[12:15], s48 offen nt lds
    v_pk_mul_f32 v[128:129], v[128:129], s[56:57]
    v_pk_mul_f32 v[130:131], v[130:131], s[56:57]
    v_pk_mul_f32 v[132:133], v[132:133], s[56:57]
    v_pk_mul_f32 v[134:135], v[134:135], s[56:57]
    v_mfma_f32_32x32x16_bf16 v[64:79], v[56:59], v[56:59], 0
    v_cvt_pk_bf16_f32 v52, v104, v105
    v_cvt_pk_bf16_f32 v53, v106, v107
    v_cvt_pk_bf16_f32 v54, v108, v109
    v_cvt_pk_bf16_f32 v55, v110, v111
    v_accvgpr_write_b32 a48, v48
    v_accvgpr_write_b32 a49, v49
    v_accvgpr_write_b32 a50, v50
    v_accvgpr_write_b32 a51, v51
    v_pk_mul_f32 v[136:137], v[136:137], s[56:57]
    v_pk_mul_f32 v[138:139], v[138:139], s[56:57]
    v_pk_mul_f32 v[140:141], v[140:141], s[56:57]
    v_pk_mul_f32 v[142:143], v[142:143], s[56:57]
    v_cvt_pk_bf16_f32 v48, v128, v129
    v_cvt_pk_bf16_f32 v49, v130, v131
    v_cvt_pk_bf16_f32 v50, v132, v133
    v_cvt_pk_bf16_f32 v51, v134, v135
    v_accvgpr_write_b32 a52, v52
    v_accvgpr_write_b32 a53, v53
    v_accvgpr_write_b32 a54, v54
    v_accvgpr_write_b32 a55, v55
    v_pk_mul_f32 v[160:161], v[160:161], s[56:57]
    v_pk_mul_f32 v[162:163], v[162:163], s[56:57]
    v_pk_mul_f32 v[164:165], v[164:165], s[56:57]
    v_pk_mul_f32 v[166:167], v[166:167], s[56:57]
    v_mfma_f32_32x32x16_bf16 v[96:111], v[56:59], v[56:59], 0
    v_cvt_pk_bf16_f32 v52, v136, v137
    v_cvt_pk_bf16_f32 v53, v138, v139
    v_cvt_pk_bf16_f32 v54, v140, v141
    v_cvt_pk_bf16_f32 v55, v142, v143
    v_accvgpr_write_b32 a64, v48
    v_accvgpr_write_b32 a65, v49
    v_accvgpr_write_b32 a66, v50
    v_accvgpr_write_b32 a67, v51
    s_add_u32 m0, m0, s53
    s_add_u32 s48, s48, 5120
    buffer_load_dwordx4 v13, s[12:15], s48 offen nt lds
    v_pk_mul_f32 v[168:169], v[168:169], s[56:57]
    v_pk_mul_f32 v[170:171], v[170:171], s[56:57]
    v_pk_mul_f32 v[172:173], v[172:173], s[56:57]
    v_pk_mul_f32 v[174:175], v[174:175], s[56:57]
    v_cvt_pk_bf16_f32 v48, v160, v161
    v_cvt_pk_bf16_f32 v49, v162, v163
    v_cvt_pk_bf16_f32 v50, v164, v165
    v_cvt_pk_bf16_f32 v51, v166, v167
    v_accvgpr_write_b32 a68, v52
    v_accvgpr_write_b32 a69, v53
    v_accvgpr_write_b32 a70, v54
    v_accvgpr_write_b32 a71, v55
    v_pk_mul_f32 v[192:193], v[192:193], s[56:57]
    v_pk_mul_f32 v[194:195], v[194:195], s[56:57]
    v_pk_mul_f32 v[196:197], v[196:197], s[56:57]
    v_pk_mul_f32 v[198:199], v[198:199], s[56:57]
    v_mfma_f32_32x32x16_bf16 v[128:143], v[56:59], v[56:59], 0
    v_cvt_pk_bf16_f32 v52, v168, v169
    v_cvt_pk_bf16_f32 v53, v170, v171
    v_cvt_pk_bf16_f32 v54, v172, v173
    v_cvt_pk_bf16_f32 v55, v174, v175
    v_accvgpr_write_b32 a80, v48
    v_accvgpr_write_b32 a81, v49
    v_accvgpr_write_b32 a82, v50
    v_accvgpr_write_b32 a83, v51
    v_pk_mul_f32 v[200:201], v[200:201], s[56:57]
    v_pk_mul_f32 v[202:203], v[202:203], s[56:57]
    v_pk_mul_f32 v[204:205], v[204:205], s[56:57]
    v_pk_mul_f32 v[206:207], v[206:207], s[56:57]
    v_cvt_pk_bf16_f32 v48, v192, v193
    v_cvt_pk_bf16_f32 v49, v194, v195
    v_cvt_pk_bf16_f32 v50, v196, v197
    v_cvt_pk_bf16_f32 v51, v198, v199
    v_accvgpr_write_b32 a84, v52
    v_accvgpr_write_b32 a85, v53
    v_accvgpr_write_b32 a86, v54
    v_accvgpr_write_b32 a87, v55
    s_add_u32 m0, m0, s53
    s_add_u32 s48, s48, 5120
    buffer_load_dwordx4 v13, s[12:15], s48 offen nt lds
    v_accvgpr_read_b32 v32, a0
    v_accvgpr_read_b32 v33, a1
    v_accvgpr_read_b32 v34, a2
    v_accvgpr_read_b32 v35, a3
    v_accvgpr_read_b32 v36, a4
    v_accvgpr_read_b32 v37, a5
    v_accvgpr_read_b32 v38, a6
    v_accvgpr_read_b32 v39, a7
    v_pk_mul_f32 v[224:225], v[224:225], s[56:57]
    v_pk_mul_f32 v[226:227], v[226:227], s[56:57]
    v_pk_mul_f32 v[228:229], v[228:229], s[56:57]
    v_pk_mul_f32 v[230:231], v[230:231], s[56:57]
    v_mfma_f32_32x32x16_bf16 v[160:175], v[56:59], v[56:59], 0
    v_cvt_pk_bf16_f32 v52, v200, v201
    v_cvt_pk_bf16_f32 v53, v202, v203
    v_cvt_pk_bf16_f32 v54, v204, v205
    v_cvt_pk_bf16_f32 v55, v206, v207
    v_accvgpr_write_b32 a96, v48
    v_accvgpr_write_b32 a97, v49
    v_accvgpr_write_b32 a98, v50
    v_accvgpr_write_b32 a99, v51
    v_accvgpr_read_b32 v40, a8
    v_accvgpr_read_b32 v41, a9
    v_accvgpr_read_b32 v42, a10
    v_accvgpr_read_b32 v43, a11
    v_accvgpr_read_b32 v44, a12
    v_accvgpr_read_b32 v45, a13
    v_accvgpr_read_b32 v46, a14
    v_accvgpr_read_b32 v47, a15
    v_pk_mul_f32 v[232:233], v[232:233], s[56:57]
    v_pk_mul_f32 v[234:235], v[234:235], s[56:57]
    v_pk_mul_f32 v[236:237], v[236:237], s[56:57]
    v_pk_mul_f32 v[238:239], v[238:239], s[56:57]
    v_cvt_pk_bf16_f32 v48, v224, v225
    v_cvt_pk_bf16_f32 v49, v226, v227
    v_cvt_pk_bf16_f32 v50, v228, v229
    v_cvt_pk_bf16_f32 v51, v230, v231
    v_accvgpr_write_b32 a100, v52
    v_accvgpr_write_b32 a101, v53
    v_accvgpr_write_b32 a102, v54
    v_accvgpr_write_b32 a103, v55
    v_pk_mul_f32 v[32:33], v[32:33], s[56:57]
    v_pk_mul_f32 v[34:35], v[34:35], s[56:57]
    v_pk_mul_f32 v[36:37], v[36:37], s[56:57]
    v_pk_mul_f32 v[38:39], v[38:39], s[56:57]
    v_mfma_f32_32x32x16_bf16 v[192:207], v[56:59], v[56:59], 0
    v_cvt_pk_bf16_f32 v52, v232, v233
    v_cvt_pk_bf16_f32 v53, v234, v235
    v_cvt_pk_bf16_f32 v54, v236, v237
    v_cvt_pk_bf16_f32 v55, v238, v239
    v_accvgpr_write_b32 a112, v48
    v_accvgpr_write_b32 a113, v49
    v_accvgpr_write_b32 a114, v50
    v_accvgpr_write_b32 a115, v51
    s_add_u32 m0, m0, s53
    s_add_u32 s48, s48, 5120
    buffer_load_dwordx4 v13, s[12:15], s48 offen nt lds
    v_pk_mul_f32 v[40:41], v[40:41], s[56:57]
    v_pk_mul_f32 v[42:43], v[42:43], s[56:57]
    v_pk_mul_f32 v[44:45], v[44:45], s[56:57]
    v_pk_mul_f32 v[46:47], v[46:47], s[56:57]
    v_cvt_pk_bf16_f32 v48, v32, v33
    v_cvt_pk_bf16_f32 v49, v34, v35
    v_cvt_pk_bf16_f32 v50, v36, v37
    v_cvt_pk_bf16_f32 v51, v38, v39
    v_accvgpr_write_b32 a116, v52
    v_accvgpr_write_b32 a117, v53
    v_accvgpr_write_b32 a118, v54
    v_accvgpr_write_b32 a119, v55
    v_pk_mul_f32 v[80:81], v[80:81], s[56:57]
    v_pk_mul_f32 v[82:83], v[82:83], s[56:57]
    v_pk_mul_f32 v[84:85], v[84:85], s[56:57]
    v_pk_mul_f32 v[86:87], v[86:87], s[56:57]
    v_mfma_f32_32x32x16_bf16 v[224:239], v[56:59], v[56:59], 0
    v_cvt_pk_bf16_f32 v52, v40, v41
    v_cvt_pk_bf16_f32 v53, v42, v43
    v_cvt_pk_bf16_f32 v54, v44, v45
    v_cvt_pk_bf16_f32 v55, v46, v47
    v_accvgpr_write_b32 a128, v48
    v_accvgpr_write_b32 a129, v49
    v_accvgpr_write_b32 a130, v50
    v_accvgpr_write_b32 a131, v51
    v_pk_mul_f32 v[88:89], v[88:89], s[56:57]
    v_pk_mul_f32 v[90:91], v[90:91], s[56:57]
    v_pk_mul_f32 v[92:93], v[92:93], s[56:57]
    v_pk_mul_f32 v[94:95], v[94:95], s[56:57]
    v_cvt_pk_bf16_f32 v48, v80, v81
    v_cvt_pk_bf16_f32 v49, v82, v83
    v_cvt_pk_bf16_f32 v50, v84, v85
    v_cvt_pk_bf16_f32 v51, v86, v87
    v_accvgpr_write_b32 a132, v52
    v_accvgpr_write_b32 a133, v53
    v_accvgpr_write_b32 a134, v54
    v_accvgpr_write_b32 a135, v55
    s_add_u32 m0, m0, s53
    s_add_u32 s48, s48, 1024
    buffer_load_dwordx4 v13, s[12:15], s48 offen nt lds
    v_pk_mul_f32 v[112:113], v[112:113], s[56:57]
    v_pk_mul_f32 v[114:115], v[114:115], s[56:57]
    v_pk_mul_f32 v[116:117], v[116:117], s[56:57]
    v_pk_mul_f32 v[118:119], v[118:119], s[56:57]
    v_mfma_f32_32x32x16_bf16 a[0:15], v[56:59], v[56:59], 0
    v_cvt_pk_bf16_f32 v52, v88, v89
    v_cvt_pk_bf16_f32 v53, v90, v91
    v_cvt_pk_bf16_f32 v54, v92, v93
    v_cvt_pk_bf16_f32 v55, v94, v95
    v_accvgpr_write_b32 a40, v48
    v_accvgpr_write_b32 a41, v49
    v_accvgpr_write_b32 a42, v50
    v_accvgpr_write_b32 a43, v51
    v_pk_mul_f32 v[120:121], v[120:121], s[56:57]
    v_pk_mul_f32 v[122:123], v[122:123], s[56:57]
    v_pk_mul_f32 v[124:125], v[124:125], s[56:57]
    v_pk_mul_f32 v[126:127], v[126:127], s[56:57]
    v_cvt_pk_bf16_f32 v48, v112, v113
    v_cvt_pk_bf16_f32 v49, v114, v115
    v_cvt_pk_bf16_f32 v50, v116, v117
    v_cvt_pk_bf16_f32 v51, v118, v119
    v_accvgpr_write_b32 a44, v52
    v_accvgpr_write_b32 a45, v53
    v_accvgpr_write_b32 a46, v54
    v_accvgpr_write_b32 a47, v55
    v_pk_mul_f32 v[144:145], v[144:145], s[56:57]
    v_pk_mul_f32 v[146:147], v[146:147], s[56:57]
    v_pk_mul_f32 v[148:149], v[148:149], s[56:57]
    v_pk_mul_f32 v[150:151], v[150:151], s[56:57]
    v_mfma_f32_32x32x16_bf16 v[80:95], v[56:59], v[56:59], 0
    v_cvt_pk_bf16_f32 v52, v120, v121
    v_cvt_pk_bf16_f32 v53, v122, v123
    v_cvt_pk_bf16_f32 v54, v124, v125
    v_cvt_pk_bf16_f32 v55, v126, v127
    v_accvgpr_write_b32 a56, v48
    v_accvgpr_write_b32 a57, v49
    v_accvgpr_write_b32 a58, v50
    v_accvgpr_write_b32 a59, v51
    s_add_u32 m0, m0, s53
    s_add_u32 s48, s48, 5120
    buffer_load_dwordx4 v13, s[12:15], s48 offen nt lds
    v_pk_mul_f32 v[152:153], v[152:153], s[56:57]
    v_pk_mul_f32 v[154:155], v[154:155], s[56:57]
    v_pk_mul_f32 v[156:157], v[156:157], s[56:57]
    v_pk_mul_f32 v[158:159], v[158:159], s[56:57]
    v_cvt_pk_bf16_f32 v48, v144, v145
    v_cvt_pk_bf16_f32 v49, v146, v147
    v_cvt_pk_bf16_f32 v50, v148, v149
    v_cvt_pk_bf16_f32 v51, v150, v151
    v_accvgpr_write_b32 a60, v52
    v_accvgpr_write_b32 a61, v53
    v_accvgpr_write_b32 a62, v54
    v_accvgpr_write_b32 a63, v55
    v_pk_mul_f32 v[176:177], v[176:177], s[56:57]
    v_pk_mul_f32 v[178:179], v[178:179], s[56:57]
    v_pk_mul_f32 v[180:181], v[180:181], s[56:57]
    v_pk_mul_f32 v[182:183], v[182:183], s[56:57]
    v_mfma_f32_32x32x16_bf16 v[112:127], v[56:59], v[56:59], 0
    v_cvt_pk_bf16_f32 v52, v152, v153
    v_cvt_pk_bf16_f32 v53, v154, v155
    v_cvt_pk_bf16_f32 v54, v156, v157
    v_cvt_pk_bf16_f32 v55, v158, v159
    v_accvgpr_write_b32 a72, v48
    v_accvgpr_write_b32 a73, v49
    v_accvgpr_write_b32 a74, v50
    v_accvgpr_write_b32 a75, v51
    v_pk_mul_f32 v[184:185], v[184:185], s[56:57]
    v_pk_mul_f32 v[186:187], v[186:187], s[56:57]
    v_pk_mul_f32 v[188:189], v[188:189], s[56:57]
    v_pk_mul_f32 v[190:191], v[190:191], s[56:57]
    v_cvt_pk_bf16_f32 v48, v176, v177
    v_cvt_pk_bf16_f32 v49, v178, v179
    v_cvt_pk_bf16_f32 v50, v180, v181
    v_cvt_pk_bf16_f32 v51, v182, v183
    v_accvgpr_write_b32 a76, v52
    v_accvgpr_write_b32 a77, v53
    v_accvgpr_write_b32 a78, v54
    v_accvgpr_write_b32 a79, v55
    s_add_u32 m0, m0, s53
    s_add_u32 s48, s48, 5120
    buffer_load_dwordx4 v13, s[12:15], s48 offen nt lds
    v_pk_mul_f32 v[208:209], v[208:209], s[56:57]
    v_pk_mul_f32 v[210:211], v[210:211], s[56:57]
    v_pk_mul_f32 v[212:213], v[212:213], s[56:57]
    v_pk_mul_f32 v[214:215], v[214:215], s[56:57]
    v_mfma_f32_32x32x16_bf16 v[144:159], v[56:59], v[56:59], 0
    v_cvt_pk_bf16_f32 v52, v184, v185
    v_cvt_pk_bf16_f32 v53, v186, v187
    v_cvt_pk_bf16_f32 v54, v188, v189
    v_cvt_pk_bf16_f32 v55, v190, v191
    v_accvgpr_write_b32 a88, v48
    v_accvgpr_write_b32 a89, v49
    v_accvgpr_write_b32 a90, v50
    v_accvgpr_write_b32 a91, v51
    v_pk_mul_f32 v[216:217], v[216:217], s[56:57]
    v_pk_mul_f32 v[218:219], v[218:219], s[56:57]
    v_pk_mul_f32 v[220:221], v[220:221], s[56:57]
    v_pk_mul_f32 v[222:223], v[222:223], s[56:57]
    v_cvt_pk_bf16_f32 v48, v208, v209
    v_cvt_pk_bf16_f32 v49, v210, v211
    v_cvt_pk_bf16_f32 v50, v212, v213
    v_cvt_pk_bf16_f32 v51, v214, v215
    v_accvgpr_write_b32 a92, v52
    v_accvgpr_write_b32 a93, v53
    v_accvgpr_write_b32 a94, v54
    v_accvgpr_write_b32 a95, v55
    s_add_u32 s48, s48, 2048
    v_accvgpr_read_b32 v32, a16
    v_accvgpr_read_b32 v33, a17
    v_accvgpr_read_b32 v34, a18
    v_accvgpr_read_b32 v35, a19
    v_accvgpr_read_b32 v36, a20
    v_accvgpr_read_b32 v37, a21
    v_accvgpr_read_b32 v38, a22
    v_accvgpr_read_b32 v39, a23
    v_pk_mul_f32 v[240:241], v[240:241], s[56:57]
    v_pk_mul_f32 v[242:243], v[242:243], s[56:57]
    v_pk_mul_f32 v[244:245], v[244:245], s[56:57]
    v_pk_mul_f32 v[246:247], v[246:247], s[56:57]
    v_mfma_f32_32x32x16_bf16 v[176:191], v[56:59], v[56:59], 0
    v_cvt_pk_bf16_f32 v52, v216, v217
    v_cvt_pk_bf16_f32 v53, v218, v219
    v_cvt_pk_bf16_f32 v54, v220, v221
    v_cvt_pk_bf16_f32 v55, v222, v223
    v_accvgpr_write_b32 a104, v48
    v_accvgpr_write_b32 a105, v49
    v_accvgpr_write_b32 a106, v50
    v_accvgpr_write_b32 a107, v51
    v_accvgpr_read_b32 v40, a24
    v_accvgpr_read_b32 v41, a25
    v_accvgpr_read_b32 v42, a26
    v_accvgpr_read_b32 v43, a27
    v_accvgpr_read_b32 v44, a28
    v_accvgpr_read_b32 v45, a29
    v_accvgpr_read_b32 v46, a30
    v_accvgpr_read_b32 v47, a31
    v_pk_mul_f32 v[248:249], v[248:249], s[56:57]
    v_pk_mul_f32 v[250:251], v[250:251], s[56:57]
    v_pk_mul_f32 v[252:253], v[252:253], s[56:57]
    v_pk_mul_f32 v[254:255], v[254:255], s[56:57]
    v_cvt_pk_bf16_f32 v48, v240, v241
    v_cvt_pk_bf16_f32 v49, v242, v243
    v_cvt_pk_bf16_f32 v50, v244, v245
    v_cvt_pk_bf16_f32 v51, v246, v247
    v_accvgpr_write_b32 a108, v52
    v_accvgpr_write_b32 a109, v53
    v_accvgpr_write_b32 a110, v54
    v_accvgpr_write_b32 a111, v55
    v_pk_mul_f32 v[32:33], v[32:33], s[56:57]
    v_pk_mul_f32 v[34:35], v[34:35], s[56:57]
    v_pk_mul_f32 v[36:37], v[36:37], s[56:57]
    v_pk_mul_f32 v[38:39], v[38:39], s[56:57]
    v_mfma_f32_32x32x16_bf16 v[208:223], v[56:59], v[56:59], 0
    v_cvt_pk_bf16_f32 v52, v248, v249
    v_cvt_pk_bf16_f32 v53, v250, v251
    v_cvt_pk_bf16_f32 v54, v252, v253
    v_cvt_pk_bf16_f32 v55, v254, v255
    v_accvgpr_write_b32 a120, v48
    v_accvgpr_write_b32 a121, v49
    v_accvgpr_write_b32 a122, v50
    v_accvgpr_write_b32 a123, v51
    v_pk_mul_f32 v[40:41], v[40:41], s[56:57]
    v_pk_mul_f32 v[42:43], v[42:43], s[56:57]
    v_pk_mul_f32 v[44:45], v[44:45], s[56:57]
    v_pk_mul_f32 v[46:47], v[46:47], s[56:57]
    v_cvt_pk_bf16_f32 v48, v32, v33
    v_cvt_pk_bf16_f32 v49, v34, v35
    v_cvt_pk_bf16_f32 v50, v36, v37
    v_cvt_pk_bf16_f32 v51, v38, v39
    v_accvgpr_write_b32 a124, v52
    v_accvgpr_write_b32 a125, v53
    v_accvgpr_write_b32 a126, v54
    v_accvgpr_write_b32 a127, v55
    v_mfma_f32_32x32x16_bf16 v[240:255], v[56:59], v[56:59], 0
    v_cvt_pk_bf16_f32 v52, v40, v41
    v_cvt_pk_bf16_f32 v53, v42, v43
    v_cvt_pk_bf16_f32 v54, v44, v45
    v_cvt_pk_bf16_f32 v55, v46, v47
    v_accvgpr_write_b32 a136, v48
    v_accvgpr_write_b32 a137, v49
    v_accvgpr_write_b32 a138, v50
    v_accvgpr_write_b32 a139, v51
    v_accvgpr_write_b32 a140, v52
    v_accvgpr_write_b32 a141, v53
    v_accvgpr_write_b32 a142, v54
    v_accvgpr_write_b32 a143, v55
    v_mfma_f32_32x32x16_bf16 a[16:31], v[56:59], v[56:59], 0
    v_mfma_f32_32x32x16_bf16 a[208:223], v[56:59], v[56:59], 0
    v_mfma_f32_32x32x16_bf16 a[224:239], v[56:59], v[56:59], 0
    v_mov_b32 v24, 0
    v_mov_b32 v25, 0
    v_mov_b32 v26, 0
    v_mov_b32 v27, 0
    v_mov_b32 v28, 0
    v_mov_b32 v29, 0
    v_mov_b32 v30, 0
    s_add_u32 m0, s52, 0
    v_mfma_f32_16x16x32_bf16 v[32:35], a[144:147], a[32:35], 0
    v_mfma_f32_16x16x32_bf16 v[32:35], a[148:151], a[36:39], v[32:35]
    v_mfma_f32_16x16x32_bf16 v[32:35], a[152:155], a[40:43], v[32:35]
    v_mfma_f32_16x16x32_bf16 v[32:35], a[156:159], a[44:47], v[32:35]
    v_mfma_f32_16x16x32_bf16 v[36:39], a[160:163], a[32:35], 0
    v_mfma_f32_16x16x32_bf16 v[36:39], a[164:167], a[36:39], v[36:39]
    v_mfma_f32_16x16x32_bf16 v[36:39], a[168:171], a[40:43], v[36:39]
    v_mfma_f32_16x16x32_bf16 v[36:39], a[172:175], a[44:47], v[36:39]
    s_nop 3
    s_mov_b32 s55, 7
    .p2align 6
L_a:
    v_mfma_f32_16x16x32_bf16 v[40:43], a[144:147], a[48:51], 0
    s_waitcnt vmcnt(3) lgkmcnt(0)
    v_exp_f32 v32, v32
    v_mfma_f32_16x16x32_bf16 v[40:43], a[148:151], a[52:55], v[40:43]
    s_barrier
    buffer_load_dwordx4 v13, s[12:15], s48 offen nt lds
    v_mfma_f32_16x16x32_bf16 v[40:43], a[152:155], a[56:59], v[40:43]
    v_exp_f32 v33, v33
    v_mfma_f32_16x16x32_bf16 v[40:43], a[156:159], a[60:63], v[40:43]
    v_add_f32 v24, v24, v33
    v_cvt_pk_bf16_f32 v56, v32, v33
    v_mfma_f32_16x16x32_bf16 a[0:3], a[208:211], v[60:63], a[0:3]
    v_exp_f32 v34, v34
    v_mfma_f32_16x16x32_bf16 a[4:7], a[212:215], v[60:63], a[4:7]
    v_add_f32 v24, v24, v32
    v_add_f32 v24, v24, v34
    v_mfma_f32_16x16x32_bf16 a[8:11], a[216:219], v[60:63], a[8:11]
    v_exp_f32 v35, v35
    v_mfma_f32_16x16x32_bf16 a[12:15], a[220:223], v[60:63], a[12:15]
    v_add_f32 v24, v24, v35
    v_cvt_pk_bf16_f32 v57, v34, v35
    v_mfma_f32_16x16x32_bf16 v[44:47], a[160:163], a[48:51], 0
    v_exp_f32 v36, v36
    v_mfma_f32_16x16x32_bf16 v[44:47], a[164:167], a[52:55], v[44:47]
    v_add_f32 v24, v24, v36
    v_mfma_f32_16x16x32_bf16 v[44:47], a[168:171], a[56:59], v[44:47]
    v_exp_f32 v37, v37
    v_mfma_f32_16x16x32_bf16 v[44:47], a[172:175], a[60:63], v[44:47]
    v_add_f32 v24, v24, v37
    v_cvt_pk_bf16_f32 v58, v36, v37
    v_mfma_f32_16x16x32_bf16 a[16:19], a[224:227], v[60:63], a[16:19]
    v_exp_f32 v38, v38
    v_mfma_f32_16x16x32_bf16 a[20:23], a[228:231], v[60:63], a[20:23]
    v_add_f32 v24, v24, v38
    v_mfma_f32_16x16x32_bf16 a[24:27], a[232:235], v[60:63], a[24:27]
    v_exp_f32 v39, v39
    v_mfma_f32_16x16x32_bf16 a[28:31], a[236:239], v[60:63], a[28:31]
    s_add_u32 s48, s48, 5120
    v_add_f32 v24, v24, v39
    v_cvt_pk_bf16_f32 v59, v38, v39
    v_mfma_f32_16x16x32_bf16 v[32:35], a[144:147], a[64:67], 0
    s_add_u32 m0, m0, s53
    v_exp_f32 v40, v40
    v_mfma_f32_16x16x32_bf16 v[32:35], a[148:151], a[68:71], v[32:35]
    s_waitcnt vmcnt(4)
    buffer_load_dwordx4 v13, s[12:15], s48 offen nt lds
    v_mfma_f32_16x16x32_bf16 v[32:35], a[152:155], a[72:75], v[32:35]
    v_exp_f32 v41, v41
    v_mfma_f32_16x16x32_bf16 v[32:35], a[156:159], a[76:79], v[32:35]
    v_add_f32 v25, v25, v41
    v_cvt_pk_bf16_f32 v60, v40, v41
    v_mfma_f32_16x16x32_bf16 v[64:67], a[176:179], v[56:59], v[64:67]
    v_exp_f32 v42, v42
    v_mfma_f32_16x16x32_bf16 v[68:71], a[180:183], v[56:59], v[68:71]
    v_add_f32 v25, v25, v40
    v_add_f32 v25, v25, v42
    v_mfma_f32_16x16x32_bf16 v[72:75], a[184:187], v[56:59], v[72:75]
    v_exp_f32 v43, v43
    v_mfma_f32_16x16x32_bf16 v[76:79], a[188:191], v[56:59], v[76:79]
    v_add_f32 v25, v25, v43
    v_cvt_pk_bf16_f32 v61, v42, v43
    v_mfma_f32_16x16x32_bf16 v[36:39], a[160:163], a[64:67], 0
    v_exp_f32 v44, v44
    v_mfma_f32_16x16x32_bf16 v[36:39], a[164:167], a[68:71], v[36:39]
    ds_read_b64_tr_b16 a[208:209], v16 offset:35840
    v_add_f32 v25, v25, v44
    v_mfma_f32_16x16x32_bf16 v[36:39], a[168:171], a[72:75], v[36:39]
    v_exp_f32 v45, v45
    v_mfma_f32_16x16x32_bf16 v[36:39], a[172:175], a[76:79], v[36:39]
    v_add_f32 v25, v25, v45
    v_cvt_pk_bf16_f32 v62, v44, v45
    v_mfma_f32_16x16x32_bf16 v[80:83], a[192:195], v[56:59], v[80:83]
    v_exp_f32 v46, v46
    v_mfma_f32_16x16x32_bf16 v[84:87], a[196:199], v[56:59], v[84:87]
    ds_read_b64_tr_b16 a[210:211], v16 offset:40448
    v_add_f32 v25, v25, v46
    v_mfma_f32_16x16x32_bf16 v[88:91], a[200:203], v[56:59], v[88:91]
    v_exp_f32 v47, v47
    v_mfma_f32_16x16x32_bf16 v[92:95], a[204:207], v[56:59], v[92:95]
    s_add_u32 s48, s48, 5120
    v_add_f32 v25, v25, v47
    v_cvt_pk_bf16_f32 v63, v46, v47
    v_mfma_f32_16x16x32_bf16 v[40:43], a[144:147], a[80:83], 0
    s_add_u32 m0, m0, s53
    v_exp_f32 v32, v32
    v_mfma_f32_16x16x32_bf16 v[40:43], a[148:151], a[84:87], v[40:43]
    s_waitcnt vmcnt(4)
    buffer_load_dwordx4 v13, s[12:15], s48 offen nt lds
    v_mfma_f32_16x16x32_bf16 v[40:43], a[152:155], a[88:91], v[40:43]
    v_exp_f32 v33, v33
    v_mfma_f32_16x16x32_bf16 v[40:43], a[156:159], a[92:95], v[40:43]
    v_add_f32 v26, v26, v33
    v_cvt_pk_bf16_f32 v56, v32, v33
    v_mfma_f32_16x16x32_bf16 v[96:99], a[176:179], v[60:63], v[96:99]
    v_exp_f32 v34, v34
    v_mfma_f32_16x16x32_bf16 v[100:103], a[180:183], v[60:63], v[100:103]
    v_add_f32 v26, v26, v32
    v_add_f32 v26, v26, v34
    v_mfma_f32_16x16x32_bf16 v[104:107], a[184:187], v[60:63], v[104:107]
    v_exp_f32 v35, v35
    v_mfma_f32_16x16x32_bf16 v[108:111], a[188:191], v[60:63], v[108:111]
    s_add_u32 s48, s48, 5120
    v_add_f32 v26, v26, v35
    v_cvt_pk_bf16_f32 v57, v34, v35
    v_mfma_f32_16x16x32_bf16 v[44:47], a[160:163], a[80:83], 0
    s_add_u32 m0, m0, s53
    v_exp_f32 v36, v36
    v_mfma_f32_16x16x32_bf16 v[44:47], a[164:167], a[84:87], v[44:47]
    s_waitcnt vmcnt(4)
    buffer_load_dwordx4 v13, s[12:15], s48 offen nt lds
    v_mfma_f32_16x16x32_bf16 v[44:47], a[168:171], a[88:91], v[44:47]
    v_exp_f32 v37, v37
    v_mfma_f32_16x16x32_bf16 v[44:47], a[172:175], a[92:95], v[44:47]
    ds_read_b64_tr_b16 a[212:213], v17 offset:35840
    v_add_f32 v26, v26, v37
    v_cvt_pk_bf16_f32 v58, v36, v37
    v_mfma_f32_16x16x32_bf16 v[112:115], a[192:195], v[60:63], v[112:115]
    v_exp_f32 v38, v38
    v_mfma_f32_16x16x32_bf16 v[116:119], a[196:199], v[60:63], v[116:119]
    v_add_f32 v26, v26, v36
    v_add_f32 v26, v26, v38
    v_mfma_f32_16x16x32_bf16 v[120:123], a[200:203], v[60:63], v[120:123]
    v_exp_f32 v39, v39
    v_mfma_f32_16x16x32_bf16 v[124:127], a[204:207], v[60:63], v[124:127]
    ds_read_b64_tr_b16 a[214:215], v17 offset:40448
    v_add_f32 v26, v26, v39
    v_cvt_pk_bf16_f32 v59, v38, v39
    v_mfma_f32_16x16x32_bf16 v[32:35], a[144:147], a[96:99], 0
    v_exp_f32 v40, v40
    v_mfma_f32_16x16x32_bf16 v[32:35], a[148:151], a[100:103], v[32:35]
    ds_read_b64_tr_b16 a[216:217], v18 offset:35840
    v_add_f32 v27, v27, v40
    v_mfma_f32_16x16x32_bf16 v[32:35], a[152:155], a[104:107], v[32:35]
    v_exp_f32 v41, v41
    v_mfma_f32_16x16x32_bf16 v[32:35], a[156:159], a[108:111], v[32:35]
    ds_read_b64_tr_b16 a[218:219], v18 offset:40448
    v_add_f32 v27, v27, v41
    v_cvt_pk_bf16_f32 v60, v40, v41
    v_mfma_f32_16x16x32_bf16 v[128:131], a[176:179], v[56:59], v[128:131]
    v_exp_f32 v42, v42
    v_mfma_f32_16x16x32_bf16 v[132:135], a[180:183], v[56:59], v[132:135]
    ds_read_b64_tr_b16 a[220:221], v19 offset:35840
    v_add_f32 v27, v27, v42
    v_mfma_f32_16x16x32_bf16 v[136:139], a[184:187], v[56:59], v[136:139]
    v_exp_f32 v43, v43
    v_mfma_f32_16x16x32_bf16 v[140:143], a[188:191], v[56:59], v[140:143]
    s_add_u32 s48, s48, 1024
    ds_read_b64_tr_b16 a[222:223], v19 offset:40448
    v_add_f32 v27, v27, v43
    v_cvt_pk_bf16_f32 v61, v42, v43
    v_mfma_f32_16x16x32_bf16 v[36:39], a[160:163], a[96:99], 0
    s_add_u32 m0, m0, s53
    v_exp_f32 v44, v44
    v_mfma_f32_16x16x32_bf16 v[36:39], a[164:167], a[100:103], v[36:39]
    s_waitcnt vmcnt(4)
    buffer_load_dwordx4 v13, s[12:15], s48 offen nt lds
    v_mfma_f32_16x16x32_bf16 v[36:39], a[168:171], a[104:107], v[36:39]
    v_exp_f32 v45, v45
    v_mfma_f32_16x16x32_bf16 v[36:39], a[172:175], a[108:111], v[36:39]
    ds_read_b64_tr_b16 a[224:225], v16 offset:35968
    v_add_f32 v27, v27, v45
    v_cvt_pk_bf16_f32 v62, v44, v45
    v_mfma_f32_16x16x32_bf16 v[144:147], a[192:195], v[56:59], v[144:147]
    v_exp_f32 v46, v46
    v_mfma_f32_16x16x32_bf16 v[148:151], a[196:199], v[56:59], v[148:151]
    v_add_f32 v27, v27, v44
    v_add_f32 v27, v27, v46
    v_mfma_f32_16x16x32_bf16 v[152:155], a[200:203], v[56:59], v[152:155]
    v_exp_f32 v47, v47
    v_mfma_f32_16x16x32_bf16 v[156:159], a[204:207], v[56:59], v[156:159]
    ds_read_b64_tr_b16 a[226:227], v16 offset:40576
    v_add_f32 v27, v27, v47
    v_cvt_pk_bf16_f32 v63, v46, v47
    v_mfma_f32_16x16x32_bf16 v[40:43], a[144:147], a[112:115], 0
    v_exp_f32 v32, v32
    v_mfma_f32_16x16x32_bf16 v[40:43], a[148:151], a[116:119], v[40:43]
    ds_read_b64_tr_b16 a[228:229], v17 offset:35968
    v_add_f32 v28, v28, v32
    v_mfma_f32_16x16x32_bf16 v[40:43], a[152:155], a[120:123], v[40:43]
    v_exp_f32 v33, v33
    v_mfma_f32_16x16x32_bf16 v[40:43], a[156:159], a[124:127], v[40:43]
    ds_read_b64_tr_b16 a[230:231], v17 offset:40576
    v_add_f32 v28, v28, v33
    v_cvt_pk_bf16_f32 v56, v32, v33
    v_mfma_f32_16x16x32_bf16 v[160:163], a[176:179], v[60:63], v[160:163]
    v_exp_f32 v34, v34
    v_mfma_f32_16x16x32_bf16 v[164:167], a[180:183], v[60:63], v[164:167]
    ds_read_b64_tr_b16 a[232:233], v18 offset:35968
    v_add_f32 v28, v28, v34
    v_mfma_f32_16x16x32_bf16 v[168:171], a[184:187], v[60:63], v[168:171]
    v_exp_f32 v35, v35
    v_mfma_f32_16x16x32_bf16 v[172:175], a[188:191], v[60:63], v[172:175]
    s_add_u32 s48, s48, 5120
    ds_read_b64_tr_b16 a[234:235], v18 offset:40576
    v_add_f32 v28, v28, v35
    v_cvt_pk_bf16_f32 v57, v34, v35
    v_mfma_f32_16x16x32_bf16 v[44:47], a[160:163], a[112:115], 0
    s_add_u32 m0, m0, s53
    v_exp_f32 v36, v36
    v_mfma_f32_16x16x32_bf16 v[44:47], a[164:167], a[116:119], v[44:47]
    s_waitcnt vmcnt(4)
    buffer_load_dwordx4 v13, s[12:15], s48 offen nt lds
    v_mfma_f32_16x16x32_bf16 v[44:47], a[168:171], a[120:123], v[44:47]
    v_exp_f32 v37, v37
    v_mfma_f32_16x16x32_bf16 v[44:47], a[172:175], a[124:127], v[44:47]
    ds_read_b64_tr_b16 a[236:237], v19 offset:35968
    v_add_f32 v28, v28, v37
    v_cvt_pk_bf16_f32 v58, v36, v37
    v_mfma_f32_16x16x32_bf16 v[176:179], a[192:195], v[60:63], v[176:179]
    v_exp_f32 v38, v38
    v_mfma_f32_16x16x32_bf16 v[180:183], a[196:199], v[60:63], v[180:183]
    v_add_f32 v28, v28, v36
    v_add_f32 v28, v28, v38
    v_mfma_f32_16x16x32_bf16 v[184:187], a[200:203], v[60:63], v[184:187]
    v_exp_f32 v39, v39
    v_mfma_f32_16x16x32_bf16 v[188:191], a[204:207], v[60:63], v[188:191]
    ds_read_b64_tr_b16 a[238:239], v19 offset:40576
    v_add_f32 v28, v28, v39
    v_cvt_pk_bf16_f32 v59, v38, v39
    v_mfma_f32_16x16x32_bf16 v[32:35], a[144:147], a[128:131], 0
    v_exp_f32 v40, v40
    v_mfma_f32_16x16x32_bf16 v[32:35], a[148:151], a[132:135], v[32:35]
    ds_read_b128 a[144:147], v14 offset:35840
    v_add_f32 v29, v29, v40
    v_mfma_f32_16x16x32_bf16 v[32:35], a[152:155], a[136:139], v[32:35]
    v_exp_f32 v41, v41
    v_mfma_f32_16x16x32_bf16 v[32:35], a[156:159], a[140:143], v[32:35]
    ds_read_b128 a[148:151], v14 offset:35904
    v_add_f32 v29, v29, v41
    v_cvt_pk_bf16_f32 v60, v40, v41
    v_mfma_f32_16x16x32_bf16 v[192:195], a[176:179], v[56:59], v[192:195]
    v_exp_f32 v42, v42
    v_mfma_f32_16x16x32_bf16 v[196:199], a[180:183], v[56:59], v[196:199]
    ds_read_b128 a[152:155], v14 offset:35968
    v_add_f32 v29, v29, v42
    v_mfma_f32_16x16x32_bf16 v[200:203], a[184:187], v[56:59], v[200:203]
    v_exp_f32 v43, v43
    v_mfma_f32_16x16x32_bf16 v[204:207], a[188:191], v[56:59], v[204:207]
    ds_read_b128 a[156:159], v14 offset:36032
    v_add_f32 v29, v29, v43
    v_cvt_pk_bf16_f32 v61, v42, v43
    v_mfma_f32_16x16x32_bf16 v[36:39], a[160:163], a[128:131], 0
    v_exp_f32 v44, v44
    v_mfma_f32_16x16x32_bf16 v[36:39], a[164:167], a[132:135], v[36:39]
    ds_read_b128 a[160:163], v14 offset:40192
    v_add_f32 v29, v29, v44
    v_mfma_f32_16x16x32_bf16 v[36:39], a[168:171], a[136:139], v[36:39]
    v_exp_f32 v45, v45
    v_mfma_f32_16x16x32_bf16 v[36:39], a[172:175], a[140:143], v[36:39]
    ds_read_b128 a[164:167], v14 offset:40256
    v_add_f32 v29, v29, v45
    v_cvt_pk_bf16_f32 v62, v44, v45
    v_mfma_f32_16x16x32_bf16 v[208:211], a[192:195], v[56:59], v[208:211]
    v_exp_f32 v46, v46
    v_mfma_f32_16x16x32_bf16 v[212:215], a[196:199], v[56:59], v[212:215]
    ds_read_b128 a[168:171], v14 offset:40320
    v_add_f32 v29, v29, v46
    v_mfma_f32_16x16x32_bf16 v[216:219], a[200:203], v[56:59], v[216:219]
    v_exp_f32 v47, v47
    v_mfma_f32_16x16x32_bf16 v[220:223], a[204:207], v[56:59], v[220:223]
    s_add_u32 s48, s48, 5120
    s_waitcnt lgkmcnt(3)
    ds_read_b128 a[172:175], v14 offset:40384
    v_add_f32 v29, v29, v47
    v_cvt_pk_bf16_f32 v63, v46, v47
    v_mfma_f32_16x16x32_bf16 v[40:43], a[144:147], a[32:35], 0
    s_add_u32 m0, m0, s53
    v_exp_f32 v32, v32
    v_mfma_f32_16x16x32_bf16 v[40:43], a[148:151], a[36:39], v[40:43]
    s_waitcnt vmcnt(4)
    buffer_load_dwordx4 v13, s[12:15], s48 offen nt lds
    v_mfma_f32_16x16x32_bf16 v[40:43], a[152:155], a[40:43], v[40:43]
    v_exp_f32 v33, v33
    v_mfma_f32_16x16x32_bf16 v[40:43], a[156:159], a[44:47], v[40:43]
    v_add_f32 v30, v30, v33
    v_cvt_pk_bf16_f32 v56, v32, v33
    v_mfma_f32_16x16x32_bf16 v[224:227], a[176:179], v[60:63], v[224:227]
    v_exp_f32 v34, v34
    v_mfma_f32_16x16x32_bf16 v[228:231], a[180:183], v[60:63], v[228:231]
    v_add_f32 v30, v30, v32
    v_add_f32 v30, v30, v34
    v_mfma_f32_16x16x32_bf16 v[232:235], a[184:187], v[60:63], v[232:235]
    v_exp_f32 v35, v35
    v_mfma_f32_16x16x32_bf16 v[236:239], a[188:191], v[60:63], v[236:239]
    s_add_u32 s48, s48, 5120
    s_waitcnt lgkmcnt(0)
    v_add_f32 v30, v30, v35
    v_cvt_pk_bf16_f32 v57, v34, v35
    v_mfma_f32_16x16x32_bf16 v[44:47], a[160:163], a[32:35], 0
    s_add_u32 m0, m0, s53
    v_exp_f32 v36, v36
    v_mfma_f32_16x16x32_bf16 v[44:47], a[164:167], a[36:39], v[44:47]
    s_waitcnt vmcnt(4)
    buffer_load_dwordx4 v13, s[12:15], s48 offen nt lds
    v_mfma_f32_16x16x32_bf16 v[44:47], a[168:171], a[40:43], v[44:47]
    v_exp_f32 v37, v37
    v_mfma_f32_16x16x32_bf16 v[44:47], a[172:175], a[44:47], v[44:47]
    s_add_u32 s48, s48, -30720
    v_add_f32 v30, v30, v37
    v_cvt_pk_bf16_f32 v58, v36, v37
    v_mfma_f32_16x16x32_bf16 v[240:243], a[192:195], v[60:63], v[240:243]
    v_exp_f32 v38, v38
    v_mfma_f32_16x16x32_bf16 v[244:247], a[196:199], v[60:63], v[244:247]
    s_add_u32 m0, s52, 35840
    v_add_f32 v30, v30, v36
    v_add_f32 v30, v30, v38
    v_mfma_f32_16x16x32_bf16 v[248:251], a[200:203], v[60:63], v[248:251]
    v_exp_f32 v39, v39
    v_mfma_f32_16x16x32_bf16 v[252:255], a[204:207], v[60:63], v[252:255]
    v_add_f32 v30, v30, v39
    v_cvt_pk_bf16_f32 v59, v38, v39
    v_mfma_f32_16x16x32_bf16 v[32:35], a[144:147], a[48:51], 0
    s_waitcnt vmcnt(3) lgkmcnt(0)
    v_exp_f32 v40, v40
    v_mfma_f32_16x16x32_bf16 v[32:35], a[148:151], a[52:55], v[32:35]
    s_barrier
    buffer_load_dwordx4 v13, s[12:15], s48 offen nt lds
    v_mfma_f32_16x16x32_bf16 v[32:35], a[152:155], a[56:59], v[32:35]
    v_exp_f32 v41, v41
    v_mfma_f32_16x16x32_bf16 v[32:35], a[156:159], a[60:63], v[32:35]
    v_add_f32 v24, v24, v41
    v_cvt_pk_bf16_f32 v60, v40, v41
    v_mfma_f32_16x16x32_bf16 a[0:3], a[176:179], v[56:59], a[0:3]
    v_exp_f32 v42, v42
    v_mfma_f32_16x16x32_bf16 a[4:7], a[180:183], v[56:59], a[4:7]
    v_add_f32 v24, v24, v40
    v_add_f32 v24, v24, v42
    v_mfma_f32_16x16x32_bf16 a[8:11], a[184:187], v[56:59], a[8:11]
    v_exp_f32 v43, v43
    v_mfma_f32_16x16x32_bf16 a[12:15], a[188:191], v[56:59], a[12:15]
    v_add_f32 v24, v24, v43
    v_cvt_pk_bf16_f32 v61, v42, v43
    v_mfma_f32_16x16x32_bf16 v[36:39], a[160:163], a[48:51], 0
    v_exp_f32 v44, v44
    v_mfma_f32_16x16x32_bf16 v[36:39], a[164:167], a[52:55], v[36:39]
    v_add_f32 v24, v24, v44
    v_mfma_f32_16x16x32_bf16 v[36:39], a[168:171], a[56:59], v[36:39]
    v_exp_f32 v45, v45
    v_mfma_f32_16x16x32_bf16 v[36:39], a[172:175], a[60:63], v[36:39]
    v_add_f32 v24, v24, v45
    v_cvt_pk_bf16_f32 v62, v44, v45
    v_mfma_f32_16x16x32_bf16 a[16:19], a[192:195], v[56:59], a[16:19]
    v_exp_f32 v46, v46
    v_mfma_f32_16x16x32_bf16 a[20:23], a[196:199], v[56:59], a[20:23]
    v_add_f32 v24, v24, v46
    v_mfma_f32_16x16x32_bf16 a[24:27], a[200:203], v[56:59], a[24:27]
    v_exp_f32 v47, v47
    v_mfma_f32_16x16x32_bf16 a[28:31], a[204:207], v[56:59], a[28:31]
    s_add_u32 s48, s48, 5120
    v_add_f32 v24, v24, v47
    v_cvt_pk_bf16_f32 v63, v46, v47
    v_mfma_f32_16x16x32_bf16 v[40:43], a[144:147], a[64:67], 0
    s_add_u32 m0, m0, s53
    v_exp_f32 v32, v32
    v_mfma_f32_16x16x32_bf16 v[40:43], a[148:151], a[68:71], v[40:43]
    s_waitcnt vmcnt(4)
    buffer_load_dwordx4 v13, s[12:15], s48 offen nt lds
    v_mfma_f32_16x16x32_bf16 v[40:43], a[152:155], a[72:75], v[40:43]
    v_exp_f32 v33, v33
    v_mfma_f32_16x16x32_bf16 v[40:43], a[156:159], a[76:79], v[40:43]
    v_add_f32 v25, v25, v33
    v_cvt_pk_bf16_f32 v56, v32, v33
    v_mfma_f32_16x16x32_bf16 v[64:67], a[208:211], v[60:63], v[64:67]
    v_exp_f32 v34, v34
    v_mfma_f32_16x16x32_bf16 v[68:71], a[212:215], v[60:63], v[68:71]
    v_add_f32 v25, v25, v32
    v_add_f32 v25, v25, v34
    v_mfma_f32_16x16x32_bf16 v[72:75], a[216:219], v[60:63], v[72:75]
    v_exp_f32 v35, v35
    v_mfma_f32_16x16x32_bf16 v[76:79], a[220:223], v[60:63], v[76:79]
    v_add_f32 v25, v25, v35
    v_cvt_pk_bf16_f32 v57, v34, v35
    v_mfma_f32_16x16x32_bf16 v[44:47], a[160:163], a[64:67], 0
    v_exp_f32 v36, v36
    v_mfma_f32_16x16x32_bf16 v[44:47], a[164:167], a[68:71], v[44:47]
    ds_read_b64_tr_b16 a[176:177], v20 offset:0
    v_add_f32 v25, v25, v36
    v_mfma_f32_16x16x32_bf16 v[44:47], a[168:171], a[72:75], v[44:47]
    v_exp_f32 v37, v37
    v_mfma_f32_16x16x32_bf16 v[44:47], a[172:175], a[76:79], v[44:47]
    v_add_f32 v25, v25, v37
    v_cvt_pk_bf16_f32 v58, v36, v37
    v_mfma_f32_16x16x32_bf16 v[80:83], a[224:227], v[60:63], v[80:83]
    v_exp_f32 v38, v38
    v_mfma_f32_16x16x32_bf16 v[84:87], a[228:231], v[60:63], v[84:87]
    ds_read_b64_tr_b16 a[178:179], v20 offset:4608
    v_add_f32 v25, v25, v38
    v_mfma_f32_16x16x32_bf16 v[88:91], a[232:235], v[60:63], v[88:91]
    v_exp_f32 v39, v39
    v_mfma_f32_16x16x32_bf16 v[92:95], a[236:239], v[60:63], v[92:95]
    s_add_u32 s48, s48, 5120
    v_add_f32 v25, v25, v39
    v_cvt_pk_bf16_f32 v59, v38, v39
    v_mfma_f32_16x16x32_bf16 v[32:35], a[144:147], a[80:83], 0
    s_add_u32 m0, m0, s53
    v_exp_f32 v40, v40
    v_mfma_f32_16x16x32_bf16 v[32:35], a[148:151], a[84:87], v[32:35]
    s_waitcnt vmcnt(4)
    buffer_load_dwordx4 v13, s[12:15], s48 offen nt lds
    v_mfma_f32_16x16x32_bf16 v[32:35], a[152:155], a[88:91], v[32:35]
    v_exp_f32 v41, v41
    v_mfma_f32_16x16x32_bf16 v[32:35], a[156:159], a[92:95], v[32:35]
    v_add_f32 v26, v26, v41
    v_cvt_pk_bf16_f32 v60, v40, v41
    v_mfma_f32_16x16x32_bf16 v[96:99], a[208:211], v[56:59], v[96:99]
    v_exp_f32 v42, v42
    v_mfma_f32_16x16x32_bf16 v[100:103], a[212:215], v[56:59], v[100:103]
    v_add_f32 v26, v26, v40
    v_add_f32 v26, v26, v42
    v_mfma_f32_16x16x32_bf16 v[104:107], a[216:219], v[56:59], v[104:107]
    v_exp_f32 v43, v43
    v_mfma_f32_16x16x32_bf16 v[108:111], a[220:223], v[56:59], v[108:111]
    s_add_u32 s48, s48, 1024
    v_add_f32 v26, v26, v43
    v_cvt_pk_bf16_f32 v61, v42, v43
    v_mfma_f32_16x16x32_bf16 v[36:39], a[160:163], a[80:83], 0
    s_add_u32 m0, m0, s53
    v_exp_f32 v44, v44
    v_mfma_f32_16x16x32_bf16 v[36:39], a[164:167], a[84:87], v[36:39]
    s_waitcnt vmcnt(4)
    buffer_load_dwordx4 v13, s[12:15], s48 offen nt lds
    v_mfma_f32_16x16x32_bf16 v[36:39], a[168:171], a[88:91], v[36:39]
    v_exp_f32 v45, v45
    v_mfma_f32_16x16x32_bf16 v[36:39], a[172:175], a[92:95], v[36:39]
    ds_read_b64_tr_b16 a[180:181], v21 offset:0
    v_add_f32 v26, v26, v45
    v_cvt_pk_bf16_f32 v62, v44, v45
    v_mfma_f32_16x16x32_bf16 v[112:115], a[224:227], v[56:59], v[112:115]
    v_exp_f32 v46, v46
    v_mfma_f32_16x16x32_bf16 v[116:119], a[228:231], v[56:59], v[116:119]
    v_add_f32 v26, v26, v44
    v_add_f32 v26, v26, v46
    v_mfma_f32_16x16x32_bf16 v[120:123], a[232:235], v[56:59], v[120:123]
    v_exp_f32 v47, v47
    v_mfma_f32_16x16x32_bf16 v[124:127], a[236:239], v[56:59], v[124:127]
    ds_read_b64_tr_b16 a[182:183], v21 offset:4608
    v_add_f32 v26, v26, v47
    v_cvt_pk_bf16_f32 v63, v46, v47
    v_mfma_f32_16x16x32_bf16 v[40:43], a[144:147], a[96:99], 0
    v_exp_f32 v32, v32
    v_mfma_f32_16x16x32_bf16 v[40:43], a[148:151], a[100:103], v[40:43]
    ds_read_b64_tr_b16 a[184:185], v22 offset:0
    v_add_f32 v27, v27, v32
    v_mfma_f32_16x16x32_bf16 v[40:43], a[152:155], a[104:107], v[40:43]
    v_exp_f32 v33, v33
    v_mfma_f32_16x16x32_bf16 v[40:43], a[156:159], a[108:111], v[40:43]
    ds_read_b64_tr_b16 a[186:187], v22 offset:4608
    v_add_f32 v27, v27, v33
    v_cvt_pk_bf16_f32 v56, v32, v33
    v_mfma_f32_16x16x32_bf16 v[128:131], a[208:211], v[60:63], v[128:131]
    v_exp_f32 v34, v34
    v_mfma_f32_16x16x32_bf16 v[132:135], a[212:215], v[60:63], v[132:135]
    ds_read_b64_tr_b16 a[188:189], v23 offset:0
    v_add_f32 v27, v27, v34
    v_mfma_f32_16x16x32_bf16 v[136:139], a[216:219], v[60:63], v[136:139]
    v_exp_f32 v35, v35
    v_mfma_f32_16x16x32_bf16 v[140:143], a[220:223], v[60:63], v[140:143]
    s_add_u32 s48, s48, 5120
    ds_read_b64_tr_b16 a[190:191], v23 offset:4608
    v_add_f32 v27, v27, v35
    v_cvt_pk_bf16_f32 v57, v34, v35
    v_mfma_f32_16x16x32_bf16 v[44:47], a[160:163], a[96:99], 0
    s_add_u32 m0, m0, s53
    v_exp_f32 v36, v36
    v_mfma_f32_16x16x32_bf16 v[44:47], a[164:167], a[100:103], v[44:47]
    s_waitcnt vmcnt(4)
    buffer_load_dwordx4 v13, s[12:15], s48 offen nt lds
    v_mfma_f32_16x16x32_bf16 v[44:47], a[168:171], a[104:107], v[44:47]
    v_exp_f32 v37, v37
    v_mfma_f32_16x16x32_bf16 v[44:47], a[172:175], a[108:111], v[44:47]
    ds_read_b64_tr_b16 a[192:193], v20 offset:128
    v_add_f32 v27, v27, v37
    v_cvt_pk_bf16_f32 v58, v36, v37
    v_mfma_f32_16x16x32_bf16 v[144:147], a[224:227], v[60:63], v[144:147]
    v_exp_f32 v38, v38
    v_mfma_f32_16x16x32_bf16 v[148:151], a[228:231], v[60:63], v[148:151]
    v_add_f32 v27, v27, v36
    v_add_f32 v27, v27, v38
    v_mfma_f32_16x16x32_bf16 v[152:155], a[232:235], v[60:63], v[152:155]
    v_exp_f32 v39, v39
    v_mfma_f32_16x16x32_bf16 v[156:159], a[236:239], v[60:63], v[156:159]
    ds_read_b64_tr_b16 a[194:195], v20 offset:4736
    v_add_f32 v27, v27, v39
    v_cvt_pk_bf16_f32 v59, v38, v39
    v_mfma_f32_16x16x32_bf16 v[32:35], a[144:147], a[112:115], 0
    v_exp_f32 v40, v40
    v_mfma_f32_16x16x32_bf16 v[32:35], a[148:151], a[116:119], v[32:35]
    ds_read_b64_tr_b16 a[196:197], v21 offset:128
    v_add_f32 v28, v28, v40
    v_mfma_f32_16x16x32_bf16 v[32:35], a[152:155], a[120:123], v[32:35]
    v_exp_f32 v41, v41
    v_mfma_f32_16x16x32_bf16 v[32:35], a[156:159], a[124:127], v[32:35]
    ds_read_b64_tr_b16 a[198:199], v21 offset:4736
    v_add_f32 v28, v28, v41
    v_cvt_pk_bf16_f32 v60, v40, v41
    v_mfma_f32_16x16x32_bf16 v[160:163], a[208:211], v[56:59], v[160:163]
    v_exp_f32 v42, v42
    v_mfma_f32_16x16x32_bf16 v[164:167], a[212:215], v[56:59], v[164:167]
    ds_read_b64_tr_b16 a[200:201], v22 offset:128
    v_add_f32 v28, v28, v42
    v_mfma_f32_16x16x32_bf16 v[168:171], a[216:219], v[56:59], v[168:171]
    v_exp_f32 v43, v43
    v_mfma_f32_16x16x32_bf16 v[172:175], a[220:223], v[56:59], v[172:175]
    s_add_u32 s48, s48, 5120
    ds_read_b64_tr_b16 a[202:203], v22 offset:4736
    v_add_f32 v28, v28, v43
    v_cvt_pk_bf16_f32 v61, v42, v43
    v_mfma_f32_16x16x32_bf16 v[36:39], a[160:163], a[112:115], 0
    s_add_u32 m0, m0, s53
    v_exp_f32 v44, v44
    v_mfma_f32_16x16x32_bf16 v[36:39], a[164:167], a[116:119], v[36:39]
    s_waitcnt vmcnt(4)
    buffer_load_dwordx4 v13, s[12:15], s48 offen nt lds
    v_mfma_f32_16x16x32_bf16 v[36:39], a[168:171], a[120:123], v[36:39]
    v_exp_f32 v45, v45
    v_mfma_f32_16x16x32_bf16 v[36:39], a[172:175], a[124:127], v[36:39]
    ds_read_b64_tr_b16 a[204:205], v23 offset:128
    v_add_f32 v28, v28, v45
    v_cvt_pk_bf16_f32 v62, v44, v45
    v_mfma_f32_16x16x32_bf16 v[176:179], a[224:227], v[56:59], v[176:179]
    v_exp_f32 v46, v46
    v_mfma_f32_16x16x32_bf16 v[180:183], a[228:231], v[56:59], v[180:183]
    v_add_f32 v28, v28, v44
    v_add_f32 v28, v28, v46
    v_mfma_f32_16x16x32_bf16 v[184:187], a[232:235], v[56:59], v[184:187]
    v_exp_f32 v47, v47
    v_mfma_f32_16x16x32_bf16 v[188:191], a[236:239], v[56:59], v[188:191]
    ds_read_b64_tr_b16 a[206:207], v23 offset:4736
    v_add_f32 v28, v28, v47
    v_cvt_pk_bf16_f32 v63, v46, v47
    v_mfma_f32_16x16x32_bf16 v[40:43], a[144:147], a[128:131], 0
    v_exp_f32 v32, v32
    v_mfma_f32_16x16x32_bf16 v[40:43], a[148:151], a[132:135], v[40:43]
    ds_read_b128 a[144:147], v15 offset:0
    v_add_f32 v29, v29, v32
    v_mfma_f32_16x16x32_bf16 v[40:43], a[152:155], a[136:139], v[40:43]
    v_exp_f32 v33, v33
    v_mfma_f32_16x16x32_bf16 v[40:43], a[156:159], a[140:143], v[40:43]
    ds_read_b128 a[148:151], v15 offset:64
    v_add_f32 v29, v29, v33
    v_cvt_pk_bf16_f32 v56, v32, v33
    v_mfma_f32_16x16x32_bf16 v[192:195], a[208:211], v[60:63], v[192:195]
    v_exp_f32 v34, v34
    v_mfma_f32_16x16x32_bf16 v[196:199], a[212:215], v[60:63], v[196:199]
    ds_read_b128 a[152:155], v15 offset:128
    v_add_f32 v29, v29, v34
    v_mfma_f32_16x16x32_bf16 v[200:203], a[216:219], v[60:63], v[200:203]
    v_exp_f32 v35, v35
    v_mfma_f32_16x16x32_bf16 v[204:207], a[220:223], v[60:63], v[204:207]
    ds_read_b128 a[156:159], v15 offset:192
    v_add_f32 v29, v29, v35
    v_cvt_pk_bf16_f32 v57, v34, v35
    v_mfma_f32_16x16x32_bf16 v[44:47], a[160:163], a[128:131], 0
    v_exp_f32 v36, v36
    v_mfma_f32_16x16x32_bf16 v[44:47], a[164:167], a[132:135], v[44:47]
    ds_read_b128 a[160:163], v15 offset:4352
    v_add_f32 v29, v29, v36
    v_mfma_f32_16x16x32_bf16 v[44:47], a[168:171], a[136:139], v[44:47]
    v_exp_f32 v37, v37
    v_mfma_f32_16x16x32_bf16 v[44:47], a[172:175], a[140:143], v[44:47]
    ds_read_b128 a[164:167], v15 offset:4416
    v_add_f32 v29, v29, v37
    v_cvt_pk_bf16_f32 v58, v36, v37
    v_mfma_f32_16x16x32_bf16 v[208:211], a[224:227], v[60:63], v[208:211]
    v_exp_f32 v38, v38
    v_mfma_f32_16x16x32_bf16 v[212:215], a[228:231], v[60:63], v[212:215]
    ds_read_b128 a[168:171], v15 offset:4480
    v_add_f32 v29, v29, v38
    v_mfma_f32_16x16x32_bf16 v[216:219], a[232:235], v[60:63], v[216:219]
    v_exp_f32 v39, v39
    v_mfma_f32_16x16x32_bf16 v[220:223], a[236:239], v[60:63], v[220:223]
    s_add_u32 s48, s48, 5120
    s_waitcnt lgkmcnt(3)
    ds_read_b128 a[172:175], v15 offset:4544
    v_add_f32 v29, v29, v39
    v_cvt_pk_bf16_f32 v59, v38, v39
    v_mfma_f32_16x16x32_bf16 v[32:35], a[144:147], a[32:35], 0
    s_add_u32 m0, m0, s53
    v_exp_f32 v40, v40
    v_mfma_f32_16x16x32_bf16 v[32:35], a[148:151], a[36:39], v[32:35]
    s_waitcnt vmcnt(4)
    buffer_load_dwordx4 v13, s[12:15], s48 offen nt lds
    v_mfma_f32_16x16x32_bf16 v[32:35], a[152:155], a[40:43], v[32:35]
    v_exp_f32 v41, v41
    v_mfma_f32_16x16x32_bf16 v[32:35], a[156:159], a[44:47], v[32:35]
    v_add_f32 v30, v30, v41
    v_cvt_pk_bf16_f32 v60, v40, v41
    v_mfma_f32_16x16x32_bf16 v[224:227], a[208:211], v[56:59], v[224:227]
    v_exp_f32 v42, v42
    v_mfma_f32_16x16x32_bf16 v[228:231], a[212:215], v[56:59], v[228:231]
    v_add_f32 v30, v30, v40
    v_add_f32 v30, v30, v42
    v_mfma_f32_16x16x32_bf16 v[232:235], a[216:219], v[56:59], v[232:235]
    v_exp_f32 v43, v43
    v_mfma_f32_16x16x32_bf16 v[236:239], a[220:223], v[56:59], v[236:239]
    s_add_u32 s48, s48, 1024
    s_waitcnt lgkmcnt(0)
    v_add_f32 v30, v30, v43
    v_cvt_pk_bf16_f32 v61, v42, v43
    v_mfma_f32_16x16x32_bf16 v[36:39], a[160:163], a[32:35], 0
    s_add_u32 m0, m0, s53
    v_exp_f32 v44, v44
    v_mfma_f32_16x16x32_bf16 v[36:39], a[164:167], a[36:39], v[36:39]
    s_waitcnt vmcnt(4)
    buffer_load_dwordx4 v13, s[12:15], s48 offen nt lds
    v_mfma_f32_16x16x32_bf16 v[36:39], a[168:171], a[40:43], v[36:39]
    v_exp_f32 v45, v45
    v_mfma_f32_16x16x32_bf16 v[36:39], a[172:175], a[44:47], v[36:39]
    s_add_u32 s48, s48, -26624
    v_add_f32 v30, v30, v45
    v_cvt_pk_bf16_f32 v62, v44, v45
    v_mfma_f32_16x16x32_bf16 v[240:243], a[224:227], v[56:59], v[240:243]
    v_exp_f32 v46, v46
    v_mfma_f32_16x16x32_bf16 v[244:247], a[228:231], v[56:59], v[244:247]
    s_add_u32 m0, s52, 71680
    v_add_f32 v30, v30, v44
    v_add_f32 v30, v30, v46
    v_mfma_f32_16x16x32_bf16 v[248:251], a[232:235], v[56:59], v[248:251]
    v_exp_f32 v47, v47
    v_mfma_f32_16x16x32_bf16 v[252:255], a[236:239], v[56:59], v[252:255]
    v_add_f32 v30, v30, v47
    v_cvt_pk_bf16_f32 v63, v46, v47
    v_mfma_f32_16x16x32_bf16 v[40:43], a[144:147], a[48:51], 0
    s_waitcnt vmcnt(3) lgkmcnt(0)
    v_exp_f32 v32, v32
    v_mfma_f32_16x16x32_bf16 v[40:43], a[148:151], a[52:55], v[40:43]
    s_barrier
    buffer_load_dwordx4 v13, s[12:15], s48 offen nt lds
    v_mfma_f32_16x16x32_bf16 v[40:43], a[152:155], a[56:59], v[40:43]
    v_exp_f32 v33, v33
    v_mfma_f32_16x16x32_bf16 v[40:43], a[156:159], a[60:63], v[40:43]
    v_add_f32 v24, v24, v33
    v_cvt_pk_bf16_f32 v56, v32, v33
    v_mfma_f32_16x16x32_bf16 a[0:3], a[208:211], v[60:63], a[0:3]
    v_exp_f32 v34, v34
    v_mfma_f32_16x16x32_bf16 a[4:7], a[212:215], v[60:63], a[4:7]
    v_add_f32 v24, v24, v32
    v_add_f32 v24, v24, v34
    v_mfma_f32_16x16x32_bf16 a[8:11], a[216:219], v[60:63], a[8:11]
    v_exp_f32 v35, v35
    v_mfma_f32_16x16x32_bf16 a[12:15], a[220:223], v[60:63], a[12:15]
    v_add_f32 v24, v24, v35
    v_cvt_pk_bf16_f32 v57, v34, v35
    v_mfma_f32_16x16x32_bf16 v[44:47], a[160:163], a[48:51], 0
    v_exp_f32 v36, v36
    v_mfma_f32_16x16x32_bf16 v[44:47], a[164:167], a[52:55], v[44:47]
    v_add_f32 v24, v24, v36
    v_mfma_f32_16x16x32_bf16 v[44:47], a[168:171], a[56:59], v[44:47]
    v_exp_f32 v37, v37
    v_mfma_f32_16x16x32_bf16 v[44:47], a[172:175], a[60:63], v[44:47]
    v_add_f32 v24, v24, v37
    v_cvt_pk_bf16_f32 v58, v36, v37
    v_mfma_f32_16x16x32_bf16 a[16:19], a[224:227], v[60:63], a[16:19]
    v_exp_f32 v38, v38
    v_mfma_f32_16x16x32_bf16 a[20:23], a[228:231], v[60:63], a[20:23]
    v_add_f32 v24, v24, v38
    v_mfma_f32_16x16x32_bf16 a[24:27], a[232:235], v[60:63], a[24:27]
    v_exp_f32 v39, v39
    v_mfma_f32_16x16x32_bf16 a[28:31], a[236:239], v[60:63], a[28:31]
    s_add_u32 s48, s48, 5120
    v_add_f32 v24, v24, v39
    v_cvt_pk_bf16_f32 v59, v38, v39
    v_mfma_f32_16x16x32_bf16 v[32:35], a[144:147], a[64:67], 0
    s_add_u32 m0, m0, s53
    v_exp_f32 v40, v40
    v_mfma_f32_16x16x32_bf16 v[32:35], a[148:151], a[68:71], v[32:35]
    s_waitcnt vmcnt(4)
    buffer_load_dwordx4 v13, s[12:15], s48 offen nt lds
    v_mfma_f32_16x16x32_bf16 v[32:35], a[152:155], a[72:75], v[32:35]
    v_exp_f32 v41, v41
    v_mfma_f32_16x16x32_bf16 v[32:35], a[156:159], a[76:79], v[32:35]
    v_add_f32 v25, v25, v41
    v_cvt_pk_bf16_f32 v60, v40, v41
    v_mfma_f32_16x16x32_bf16 v[64:67], a[176:179], v[56:59], v[64:67]
    v_exp_f32 v42, v42
    v_mfma_f32_16x16x32_bf16 v[68:71], a[180:183], v[56:59], v[68:71]
    v_add_f32 v25, v25, v40
    v_add_f32 v25, v25, v42
    v_mfma_f32_16x16x32_bf16 v[72:75], a[184:187], v[56:59], v[72:75]
    v_exp_f32 v43, v43
    v_mfma_f32_16x16x32_bf16 v[76:79], a[188:191], v[56:59], v[76:79]
    v_add_f32 v25, v25, v43
    v_cvt_pk_bf16_f32 v61, v42, v43
    v_mfma_f32_16x16x32_bf16 v[36:39], a[160:163], a[64:67], 0
    v_exp_f32 v44, v44
    v_mfma_f32_16x16x32_bf16 v[36:39], a[164:167], a[68:71], v[36:39]
    ds_read_b64_tr_b16 a[208:209], v20 offset:35840
    v_add_f32 v25, v25, v44
    v_mfma_f32_16x16x32_bf16 v[36:39], a[168:171], a[72:75], v[36:39]
    v_exp_f32 v45, v45
    v_mfma_f32_16x16x32_bf16 v[36:39], a[172:175], a[76:79], v[36:39]
    v_add_f32 v25, v25, v45
    v_cvt_pk_bf16_f32 v62, v44, v45
    v_mfma_f32_16x16x32_bf16 v[80:83], a[192:195], v[56:59], v[80:83]
    v_exp_f32 v46, v46
    v_mfma_f32_16x16x32_bf16 v[84:87], a[196:199], v[56:59], v[84:87]
    ds_read_b64_tr_b16 a[210:211], v20 offset:40448
    v_add_f32 v25, v25, v46
    v_mfma_f32_16x16x32_bf16 v[88:91], a[200:203], v[56:59], v[88:91]
    v_exp_f32 v47, v47
    v_mfma_f32_16x16x32_bf16 v[92:95], a[204:207], v[56:59], v[92:95]
    s_add_u32 s48, s48, 1024
    v_add_f32 v25, v25, v47
    v_cvt_pk_bf16_f32 v63, v46, v47
    v_mfma_f32_16x16x32_bf16 v[40:43], a[144:147], a[80:83], 0
    s_add_u32 m0, m0, s53
    v_exp_f32 v32, v32
    v_mfma_f32_16x16x32_bf16 v[40:43], a[148:151], a[84:87], v[40:43]
    s_waitcnt vmcnt(4)
    buffer_load_dwordx4 v13, s[12:15], s48 offen nt lds
    v_mfma_f32_16x16x32_bf16 v[40:43], a[152:155], a[88:91], v[40:43]
    v_exp_f32 v33, v33
    v_mfma_f32_16x16x32_bf16 v[40:43], a[156:159], a[92:95], v[40:43]
    v_add_f32 v26, v26, v33
    v_cvt_pk_bf16_f32 v56, v32, v33
    v_mfma_f32_16x16x32_bf16 v[96:99], a[176:179], v[60:63], v[96:99]
    v_exp_f32 v34, v34
    v_mfma_f32_16x16x32_bf16 v[100:103], a[180:183], v[60:63], v[100:103]
    v_add_f32 v26, v26, v32
    v_add_f32 v26, v26, v34
    v_mfma_f32_16x16x32_bf16 v[104:107], a[184:187], v[60:63], v[104:107]
    v_exp_f32 v35, v35
    v_mfma_f32_16x16x32_bf16 v[108:111], a[188:191], v[60:63], v[108:111]
    s_add_u32 s48, s48, 5120
    v_add_f32 v26, v26, v35
    v_cvt_pk_bf16_f32 v57, v34, v35
    v_mfma_f32_16x16x32_bf16 v[44:47], a[160:163], a[80:83], 0
    s_add_u32 m0, m0, s53
    v_exp_f32 v36, v36
    v_mfma_f32_16x16x32_bf16 v[44:47], a[164:167], a[84:87], v[44:47]
    s_waitcnt vmcnt(4)
    buffer_load_dwordx4 v13, s[12:15], s48 offen nt lds
    v_mfma_f32_16x16x32_bf16 v[44:47], a[168:171], a[88:91], v[44:47]
    v_exp_f32 v37, v37
    v_mfma_f32_16x16x32_bf16 v[44:47], a[172:175], a[92:95], v[44:47]
    ds_read_b64_tr_b16 a[212:213], v21 offset:35840
    v_add_f32 v26, v26, v37
    v_cvt_pk_bf16_f32 v58, v36, v37
    v_mfma_f32_16x16x32_bf16 v[112:115], a[192:195], v[60:63], v[112:115]
    v_exp_f32 v38, v38
    v_mfma_f32_16x16x32_bf16 v[116:119], a[196:199], v[60:63], v[116:119]
    v_add_f32 v26, v26, v36
    v_add_f32 v26, v26, v38
    v_mfma_f32_16x16x32_bf16 v[120:123], a[200:203], v[60:63], v[120:123]
    v_exp_f32 v39, v39
    v_mfma_f32_16x16x32_bf16 v[124:127], a[204:207], v[60:63], v[124:127]
    ds_read_b64_tr_b16 a[214:215], v21 offset:40448
    v_add_f32 v26, v26, v39
    v_cvt_pk_bf16_f32 v59, v38, v39
    v_mfma_f32_16x16x32_bf16 v[32:35], a[144:147], a[96:99], 0
    v_exp_f32 v40, v40
    v_mfma_f32_16x16x32_bf16 v[32:35], a[148:151], a[100:103], v[32:35]
    ds_read_b64_tr_b16 a[216:217], v22 offset:35840
    v_add_f32 v27, v27, v40
    v_mfma_f32_16x16x32_bf16 v[32:35], a[152:155], a[104:107], v[32:35]
    v_exp_f32 v41, v41
    v_mfma_f32_16x16x32_bf16 v[32:35], a[156:159], a[108:111], v[32:35]
    ds_read_b64_tr_b16 a[218:219], v22 offset:40448
    v_add_f32 v27, v27, v41
    v_cvt_pk_bf16_f32 v60, v40, v41
    v_mfma_f32_16x16x32_bf16 v[128:131], a[176:179], v[56:59], v[128:131]
    v_exp_f32 v42, v42
    v_mfma_f32_16x16x32_bf16 v[132:135], a[180:183], v[56:59], v[132:135]
    ds_read_b64_tr_b16 a[220:221], v23 offset:35840
    v_add_f32 v27, v27, v42
    v_mfma_f32_16x16x32_bf16 v[136:139], a[184:187], v[56:59], v[136:139]
    v_exp_f32 v43, v43
    v_mfma_f32_16x16x32_bf16 v[140:143], a[188:191], v[56:59], v[140:143]
    s_add_u32 s48, s48, 5120
    ds_read_b64_tr_b16 a[222:223], v23 offset:40448
    v_add_f32 v27, v27, v43
    v_cvt_pk_bf16_f32 v61, v42, v43
    v_mfma_f32_16x16x32_bf16 v[36:39], a[160:163], a[96:99], 0
    s_add_u32 m0, m0, s53
    v_exp_f32 v44, v44
    v_mfma_f32_16x16x32_bf16 v[36:39], a[164:167], a[100:103], v[36:39]
    s_waitcnt vmcnt(4)
    buffer_load_dwordx4 v13, s[12:15], s48 offen nt lds
    v_mfma_f32_16x16x32_bf16 v[36:39], a[168:171], a[104:107], v[36:39]
    v_exp_f32 v45, v45
    v_mfma_f32_16x16x32_bf16 v[36:39], a[172:175], a[108:111], v[36:39]
    ds_read_b64_tr_b16 a[224:225], v20 offset:35968
    v_add_f32 v27, v27, v45
    v_cvt_pk_bf16_f32 v62, v44, v45
    v_mfma_f32_16x16x32_bf16 v[144:147], a[192:195], v[56:59], v[144:147]
    v_exp_f32 v46, v46
    v_mfma_f32_16x16x32_bf16 v[148:151], a[196:199], v[56:59], v[148:151]
    v_add_f32 v27, v27, v44
    v_add_f32 v27, v27, v46
    v_mfma_f32_16x16x32_bf16 v[152:155], a[200:203], v[56:59], v[152:155]
    v_exp_f32 v47, v47
    v_mfma_f32_16x16x32_bf16 v[156:159], a[204:207], v[56:59], v[156:159]
    ds_read_b64_tr_b16 a[226:227], v20 offset:40576
    v_add_f32 v27, v27, v47
    v_cvt_pk_bf16_f32 v63, v46, v47
    v_mfma_f32_16x16x32_bf16 v[40:43], a[144:147], a[112:115], 0
    v_exp_f32 v32, v32
    v_mfma_f32_16x16x32_bf16 v[40:43], a[148:151], a[116:119], v[40:43]
    ds_read_b64_tr_b16 a[228:229], v21 offset:35968
    v_add_f32 v28, v28, v32
    v_mfma_f32_16x16x32_bf16 v[40:43], a[152:155], a[120:123], v[40:43]
    v_exp_f32 v33, v33
    v_mfma_f32_16x16x32_bf16 v[40:43], a[156:159], a[124:127], v[40:43]
    ds_read_b64_tr_b16 a[230:231], v21 offset:40576
    v_add_f32 v28, v28, v33
    v_cvt_pk_bf16_f32 v56, v32, v33
    v_mfma_f32_16x16x32_bf16 v[160:163], a[176:179], v[60:63], v[160:163]
    v_exp_f32 v34, v34
    v_mfma_f32_16x16x32_bf16 v[164:167], a[180:183], v[60:63], v[164:167]
    ds_read_b64_tr_b16 a[232:233], v22 offset:35968
    v_add_f32 v28, v28, v34
    v_mfma_f32_16x16x32_bf16 v[168:171], a[184:187], v[60:63], v[168:171]
    v_exp_f32 v35, v35
    v_mfma_f32_16x16x32_bf16 v[172:175], a[188:191], v[60:63], v[172:175]
    s_add_u32 s48, s48, 5120
    ds_read_b64_tr_b16 a[234:235], v22 offset:40576
    v_add_f32 v28, v28, v35
    v_cvt_pk_bf16_f32 v57, v34, v35
    v_mfma_f32_16x16x32_bf16 v[44:47], a[160:163], a[112:115], 0
    s_add_u32 m0, m0, s53
    v_exp_f32 v36, v36
    v_mfma_f32_16x16x32_bf16 v[44:47], a[164:167], a[116:119], v[44:47]
    s_waitcnt vmcnt(4)
    buffer_load_dwordx4 v13, s[12:15], s48 offen nt lds
    v_mfma_f32_16x16x32_bf16 v[44:47], a[168:171], a[120:123], v[44:47]
    v_exp_f32 v37, v37
    v_mfma_f32_16x16x32_bf16 v[44:47], a[172:175], a[124:127], v[44:47]
    ds_read_b64_tr_b16 a[236:237], v23 offset:35968
    v_add_f32 v28, v28, v37
    v_cvt_pk_bf16_f32 v58, v36, v37
    v_mfma_f32_16x16x32_bf16 v[176:179], a[192:195], v[60:63], v[176:179]
    v_exp_f32 v38, v38
    v_mfma_f32_16x16x32_bf16 v[180:183], a[196:199], v[60:63], v[180:183]
    v_add_f32 v28, v28, v36
    v_add_f32 v28, v28, v38
    v_mfma_f32_16x16x32_bf16 v[184:187], a[200:203], v[60:63], v[184:187]
    v_exp_f32 v39, v39
    v_mfma_f32_16x16x32_bf16 v[188:191], a[204:207], v[60:63], v[188:191]
    ds_read_b64_tr_b16 a[238:239], v23 offset:40576
    v_add_f32 v28, v28, v39
    v_cvt_pk_bf16_f32 v59, v38, v39
    v_mfma_f32_16x16x32_bf16 v[32:35], a[144:147], a[128:131], 0
    v_exp_f32 v40, v40
    v_mfma_f32_16x16x32_bf16 v[32:35], a[148:151], a[132:135], v[32:35]
    ds_read_b128 a[144:147], v15 offset:35840
    v_add_f32 v29, v29, v40
    v_mfma_f32_16x16x32_bf16 v[32:35], a[152:155], a[136:139], v[32:35]
    v_exp_f32 v41, v41
    v_mfma_f32_16x16x32_bf16 v[32:35], a[156:159], a[140:143], v[32:35]
    ds_read_b128 a[148:151], v15 offset:35904
    v_add_f32 v29, v29, v41
    v_cvt_pk_bf16_f32 v60, v40, v41
    v_mfma_f32_16x16x32_bf16 v[192:195], a[176:179], v[56:59], v[192:195]
    v_exp_f32 v42, v42
    v_mfma_f32_16x16x32_bf16 v[196:199], a[180:183], v[56:59], v[196:199]
    ds_read_b128 a[152:155], v15 offset:35968
    v_add_f32 v29, v29, v42
    v_mfma_f32_16x16x32_bf16 v[200:203], a[184:187], v[56:59], v[200:203]
    v_exp_f32 v43, v43
    v_mfma_f32_16x16x32_bf16 v[204:207], a[188:191], v[56:59], v[204:207]
    ds_read_b128 a[156:159], v15 offset:36032
    v_add_f32 v29, v29, v43
    v_cvt_pk_bf16_f32 v61, v42, v43
    v_mfma_f32_16x16x32_bf16 v[36:39], a[160:163], a[128:131], 0
    v_exp_f32 v44, v44
    v_mfma_f32_16x16x32_bf16 v[36:39], a[164:167], a[132:135], v[36:39]
    ds_read_b128 a[160:163], v15 offset:40192
    v_add_f32 v29, v29, v44
    v_mfma_f32_16x16x32_bf16 v[36:39], a[168:171], a[136:139], v[36:39]
    v_exp_f32 v45, v45
    v_mfma_f32_16x16x32_bf16 v[36:39], a[172:175], a[140:143], v[36:39]
    ds_read_b128 a[164:167], v15 offset:40256
    v_add_f32 v29, v29, v45
    v_cvt_pk_bf16_f32 v62, v44, v45
    v_mfma_f32_16x16x32_bf16 v[208:211], a[192:195], v[56:59], v[208:211]
    v_exp_f32 v46, v46
    v_mfma_f32_16x16x32_bf16 v[212:215], a[196:199], v[56:59], v[212:215]
    ds_read_b128 a[168:171], v15 offset:40320
    v_add_f32 v29, v29, v46
    v_mfma_f32_16x16x32_bf16 v[216:219], a[200:203], v[56:59], v[216:219]
    v_exp_f32 v47, v47
    v_mfma_f32_16x16x32_bf16 v[220:223], a[204:207], v[56:59], v[220:223]
    s_add_u32 s48, s48, 1024
    s_waitcnt lgkmcnt(3)
    ds_read_b128 a[172:175], v15 offset:40384
    v_add_f32 v29, v29, v47
    v_cvt_pk_bf16_f32 v63, v46, v47
    v_mfma_f32_16x16x32_bf16 v[40:43], a[144:147], a[32:35], 0
    s_add_u32 m0, m0, s53
    v_exp_f32 v32, v32
    v_mfma_f32_16x16x32_bf16 v[40:43], a[148:151], a[36:39], v[40:43]
    s_waitcnt vmcnt(4)
    buffer_load_dwordx4 v13, s[12:15], s48 offen nt lds
    v_mfma_f32_16x16x32_bf16 v[40:43], a[152:155], a[40:43], v[40:43]
    v_exp_f32 v33, v33
    v_mfma_f32_16x16x32_bf16 v[40:43], a[156:159], a[44:47], v[40:43]
    v_add_f32 v30, v30, v33
    v_cvt_pk_bf16_f32 v56, v32, v33
    v_mfma_f32_16x16x32_bf16 v[224:227], a[176:179], v[60:63], v[224:227]
    v_exp_f32 v34, v34
    v_mfma_f32_16x16x32_bf16 v[228:231], a[180:183], v[60:63], v[228:231]
    v_add_f32 v30, v30, v32
    v_add_f32 v30, v30, v34
    v_mfma_f32_16x16x32_bf16 v[232:235], a[184:187], v[60:63], v[232:235]
    v_exp_f32 v35, v35
    v_mfma_f32_16x16x32_bf16 v[236:239], a[188:191], v[60:63], v[236:239]
    s_add_u32 s48, s48, 5120
    s_waitcnt lgkmcnt(0)
    v_add_f32 v30, v30, v35
    v_cvt_pk_bf16_f32 v57, v34, v35
    v_mfma_f32_16x16x32_bf16 v[44:47], a[160:163], a[32:35], 0
    s_add_u32 m0, m0, s53
    v_exp_f32 v36, v36
    v_mfma_f32_16x16x32_bf16 v[44:47], a[164:167], a[36:39], v[44:47]
    s_waitcnt vmcnt(4)
    buffer_load_dwordx4 v13, s[12:15], s48 offen nt lds
    v_mfma_f32_16x16x32_bf16 v[44:47], a[168:171], a[40:43], v[44:47]
    v_exp_f32 v37, v37
    v_mfma_f32_16x16x32_bf16 v[44:47], a[172:175], a[44:47], v[44:47]
    s_add_u32 s48, s48, -26624
    v_add_f32 v30, v30, v37
    v_cvt_pk_bf16_f32 v58, v36, v37
    v_mfma_f32_16x16x32_bf16 v[240:243], a[192:195], v[60:63], v[240:243]
    v_exp_f32 v38, v38
    v_mfma_f32_16x16x32_bf16 v[244:247], a[196:199], v[60:63], v[244:247]
    s_add_u32 m0, s52, 107520
    v_add_f32 v30, v30, v36
    v_add_f32 v30, v30, v38
    v_mfma_f32_16x16x32_bf16 v[248:251], a[200:203], v[60:63], v[248:251]
    v_exp_f32 v39, v39
    v_mfma_f32_16x16x32_bf16 v[252:255], a[204:207], v[60:63], v[252:255]
    v_add_f32 v30, v30, v39
    v_cvt_pk_bf16_f32 v59, v38, v39
    v_mfma_f32_16x16x32_bf16 v[32:35], a[144:147], a[48:51], 0
    s_waitcnt vmcnt(3) lgkmcnt(0)
    v_exp_f32 v40, v40
    v_mfma_f32_16x16x32_bf16 v[32:35], a[148:151], a[52:55], v[32:35]
    s_barrier
    buffer_load_dwordx4 v13, s[12:15], s48 offen nt lds
    v_mfma_f32_16x16x32_bf16 v[32:35], a[152:155], a[56:59], v[32:35]
    v_exp_f32 v41, v41
    v_mfma_f32_16x16x32_bf16 v[32:35], a[156:159], a[60:63], v[32:35]
    v_add_f32 v24, v24, v41
    v_cvt_pk_bf16_f32 v60, v40, v41
    v_mfma_f32_16x16x32_bf16 a[0:3], a[176:179], v[56:59], a[0:3]
    v_exp_f32 v42, v42
    v_mfma_f32_16x16x32_bf16 a[4:7], a[180:183], v[56:59], a[4:7]
    v_add_f32 v24, v24, v40
    v_add_f32 v24, v24, v42
    v_mfma_f32_16x16x32_bf16 a[8:11], a[184:187], v[56:59], a[8:11]
    v_exp_f32 v43, v43
    v_mfma_f32_16x16x32_bf16 a[12:15], a[188:191], v[56:59], a[12:15]
    v_add_f32 v24, v24, v43
    v_cvt_pk_bf16_f32 v61, v42, v43
    v_mfma_f32_16x16x32_bf16 v[36:39], a[160:163], a[48:51], 0
    v_exp_f32 v44, v44
    v_mfma_f32_16x16x32_bf16 v[36:39], a[164:167], a[52:55], v[36:39]
    v_add_f32 v24, v24, v44
    v_mfma_f32_16x16x32_bf16 v[36:39], a[168:171], a[56:59], v[36:39]
    v_exp_f32 v45, v45
    v_mfma_f32_16x16x32_bf16 v[36:39], a[172:175], a[60:63], v[36:39]
    v_add_f32 v24, v24, v45
    v_cvt_pk_bf16_f32 v62, v44, v45
    v_mfma_f32_16x16x32_bf16 a[16:19], a[192:195], v[56:59], a[16:19]
    v_exp_f32 v46, v46
    v_mfma_f32_16x16x32_bf16 a[20:23], a[196:199], v[56:59], a[20:23]
    v_add_f32 v24, v24, v46
    v_mfma_f32_16x16x32_bf16 a[24:27], a[200:203], v[56:59], a[24:27]
    v_exp_f32 v47, v47
    v_mfma_f32_16x16x32_bf16 a[28:31], a[204:207], v[56:59], a[28:31]
    s_add_u32 s48, s48, 1024
    v_add_f32 v24, v24, v47
    v_cvt_pk_bf16_f32 v63, v46, v47
    v_mfma_f32_16x16x32_bf16 v[40:43], a[144:147], a[64:67], 0
    s_add_u32 m0, m0, s53
    v_exp_f32 v32, v32
    v_mfma_f32_16x16x32_bf16 v[40:43], a[148:151], a[68:71], v[40:43]
    s_waitcnt vmcnt(4)
    buffer_load_dwordx4 v13, s[12:15], s48 offen nt lds
    v_mfma_f32_16x16x32_bf16 v[40:43], a[152:155], a[72:75], v[40:43]
    v_exp_f32 v33, v33
    v_mfma_f32_16x16x32_bf16 v[40:43], a[156:159], a[76:79], v[40:43]
    v_add_f32 v25, v25, v33
    v_cvt_pk_bf16_f32 v56, v32, v33
    v_mfma_f32_16x16x32_bf16 v[64:67], a[208:211], v[60:63], v[64:67]
    v_exp_f32 v34, v34
    v_mfma_f32_16x16x32_bf16 v[68:71], a[212:215], v[60:63], v[68:71]
    v_add_f32 v25, v25, v32
    v_add_f32 v25, v25, v34
    v_mfma_f32_16x16x32_bf16 v[72:75], a[216:219], v[60:63], v[72:75]
    v_exp_f32 v35, v35
    v_mfma_f32_16x16x32_bf16 v[76:79], a[220:223], v[60:63], v[76:79]
    v_add_f32 v25, v25, v35
    v_cvt_pk_bf16_f32 v57, v34, v35
    v_mfma_f32_16x16x32_bf16 v[44:47], a[160:163], a[64:67], 0
    v_exp_f32 v36, v36
    v_mfma_f32_16x16x32_bf16 v[44:47], a[164:167], a[68:71], v[44:47]
    ds_read_b64_tr_b16 a[176:177], v16 offset:0
    v_add_f32 v25, v25, v36
    v_mfma_f32_16x16x32_bf16 v[44:47], a[168:171], a[72:75], v[44:47]
    v_exp_f32 v37, v37
    v_mfma_f32_16x16x32_bf16 v[44:47], a[172:175], a[76:79], v[44:47]
    v_add_f32 v25, v25, v37
    v_cvt_pk_bf16_f32 v58, v36, v37
    v_mfma_f32_16x16x32_bf16 v[80:83], a[224:227], v[60:63], v[80:83]
    v_exp_f32 v38, v38
    v_mfma_f32_16x16x32_bf16 v[84:87], a[228:231], v[60:63], v[84:87]
    ds_read_b64_tr_b16 a[178:179], v16 offset:4608
    v_add_f32 v25, v25, v38
    v_mfma_f32_16x16x32_bf16 v[88:91], a[232:235], v[60:63], v[88:91]
    v_exp_f32 v39, v39
    v_mfma_f32_16x16x32_bf16 v[92:95], a[236:239], v[60:63], v[92:95]
    s_add_u32 s48, s48, 5120
    v_add_f32 v25, v25, v39
    v_cvt_pk_bf16_f32 v59, v38, v39
    v_mfma_f32_16x16x32_bf16 v[32:35], a[144:147], a[80:83], 0
    s_add_u32 m0, m0, s53
    v_exp_f32 v40, v40
    v_mfma_f32_16x16x32_bf16 v[32:35], a[148:151], a[84:87], v[32:35]
    s_waitcnt vmcnt(4)
    buffer_load_dwordx4 v13, s[12:15], s48 offen nt lds
    v_mfma_f32_16x16x32_bf16 v[32:35], a[152:155], a[88:91], v[32:35]
    v_exp_f32 v41, v41
    v_mfma_f32_16x16x32_bf16 v[32:35], a[156:159], a[92:95], v[32:35]
    v_add_f32 v26, v26, v41
    v_cvt_pk_bf16_f32 v60, v40, v41
    v_mfma_f32_16x16x32_bf16 v[96:99], a[208:211], v[56:59], v[96:99]
    v_exp_f32 v42, v42
    v_mfma_f32_16x16x32_bf16 v[100:103], a[212:215], v[56:59], v[100:103]
    v_add_f32 v26, v26, v40
    v_add_f32 v26, v26, v42
    v_mfma_f32_16x16x32_bf16 v[104:107], a[216:219], v[56:59], v[104:107]
    v_exp_f32 v43, v43
    v_mfma_f32_16x16x32_bf16 v[108:111], a[220:223], v[56:59], v[108:111]
    s_add_u32 s48, s48, 5120
    v_add_f32 v26, v26, v43
    v_cvt_pk_bf16_f32 v61, v42, v43
    v_mfma_f32_16x16x32_bf16 v[36:39], a[160:163], a[80:83], 0
    s_add_u32 m0, m0, s53
    v_exp_f32 v44, v44
    v_mfma_f32_16x16x32_bf16 v[36:39], a[164:167], a[84:87], v[36:39]
    s_waitcnt vmcnt(4)
    buffer_load_dwordx4 v13, s[12:15], s48 offen nt lds
    v_mfma_f32_16x16x32_bf16 v[36:39], a[168:171], a[88:91], v[36:39]
    v_exp_f32 v45, v45
    v_mfma_f32_16x16x32_bf16 v[36:39], a[172:175], a[92:95], v[36:39]
    ds_read_b64_tr_b16 a[180:181], v17 offset:0
    v_add_f32 v26, v26, v45
    v_cvt_pk_bf16_f32 v62, v44, v45
    v_mfma_f32_16x16x32_bf16 v[112:115], a[224:227], v[56:59], v[112:115]
    v_exp_f32 v46, v46
    v_mfma_f32_16x16x32_bf16 v[116:119], a[228:231], v[56:59], v[116:119]
    v_add_f32 v26, v26, v44
    v_add_f32 v26, v26, v46
    v_mfma_f32_16x16x32_bf16 v[120:123], a[232:235], v[56:59], v[120:123]
    v_exp_f32 v47, v47
    v_mfma_f32_16x16x32_bf16 v[124:127], a[236:239], v[56:59], v[124:127]
    ds_read_b64_tr_b16 a[182:183], v17 offset:4608
    v_add_f32 v26, v26, v47
    v_cvt_pk_bf16_f32 v63, v46, v47
    v_mfma_f32_16x16x32_bf16 v[40:43], a[144:147], a[96:99], 0
    v_exp_f32 v32, v32
    v_mfma_f32_16x16x32_bf16 v[40:43], a[148:151], a[100:103], v[40:43]
    ds_read_b64_tr_b16 a[184:185], v18 offset:0
    v_add_f32 v27, v27, v32
    v_mfma_f32_16x16x32_bf16 v[40:43], a[152:155], a[104:107], v[40:43]
    v_exp_f32 v33, v33
    v_mfma_f32_16x16x32_bf16 v[40:43], a[156:159], a[108:111], v[40:43]
    ds_read_b64_tr_b16 a[186:187], v18 offset:4608
    v_add_f32 v27, v27, v33
    v_cvt_pk_bf16_f32 v56, v32, v33
    v_mfma_f32_16x16x32_bf16 v[128:131], a[208:211], v[60:63], v[128:131]
    v_exp_f32 v34, v34
    v_mfma_f32_16x16x32_bf16 v[132:135], a[212:215], v[60:63], v[132:135]
    ds_read_b64_tr_b16 a[188:189], v19 offset:0
    v_add_f32 v27, v27, v34
    v_mfma_f32_16x16x32_bf16 v[136:139], a[216:219], v[60:63], v[136:139]
    v_exp_f32 v35, v35
    v_mfma_f32_16x16x32_bf16 v[140:143], a[220:223], v[60:63], v[140:143]
    s_add_u32 s48, s48, 5120
    ds_read_b64_tr_b16 a[190:191], v19 offset:4608
    v_add_f32 v27, v27, v35
    v_cvt_pk_bf16_f32 v57, v34, v35
    v_mfma_f32_16x16x32_bf16 v[44:47], a[160:163], a[96:99], 0
    s_add_u32 m0, m0, s53
    v_exp_f32 v36, v36
    v_mfma_f32_16x16x32_bf16 v[44:47], a[164:167], a[100:103], v[44:47]
    s_waitcnt vmcnt(4)
    buffer_load_dwordx4 v13, s[12:15], s48 offen nt lds
    v_mfma_f32_16x16x32_bf16 v[44:47], a[168:171], a[104:107], v[44:47]
    v_exp_f32 v37, v37
    v_mfma_f32_16x16x32_bf16 v[44:47], a[172:175], a[108:111], v[44:47]
    ds_read_b64_tr_b16 a[192:193], v16 offset:128
    v_add_f32 v27, v27, v37
    v_cvt_pk_bf16_f32 v58, v36, v37
    v_mfma_f32_16x16x32_bf16 v[144:147], a[224:227], v[60:63], v[144:147]
    v_exp_f32 v38, v38
    v_mfma_f32_16x16x32_bf16 v[148:151], a[228:231], v[60:63], v[148:151]
    v_add_f32 v27, v27, v36
    v_add_f32 v27, v27, v38
    v_mfma_f32_16x16x32_bf16 v[152:155], a[232:235], v[60:63], v[152:155]
    v_exp_f32 v39, v39
    v_mfma_f32_16x16x32_bf16 v[156:159], a[236:239], v[60:63], v[156:159]
    ds_read_b64_tr_b16 a[194:195], v16 offset:4736
    v_add_f32 v27, v27, v39
    v_cvt_pk_bf16_f32 v59, v38, v39
    v_mfma_f32_16x16x32_bf16 v[32:35], a[144:147], a[112:115], 0
    v_exp_f32 v40, v40
    v_mfma_f32_16x16x32_bf16 v[32:35], a[148:151], a[116:119], v[32:35]
    ds_read_b64_tr_b16 a[196:197], v17 offset:128
    v_add_f32 v28, v28, v40
    v_mfma_f32_16x16x32_bf16 v[32:35], a[152:155], a[120:123], v[32:35]
    v_exp_f32 v41, v41
    v_mfma_f32_16x16x32_bf16 v[32:35], a[156:159], a[124:127], v[32:35]
    ds_read_b64_tr_b16 a[198:199], v17 offset:4736
    v_add_f32 v28, v28, v41
    v_cvt_pk_bf16_f32 v60, v40, v41
    v_mfma_f32_16x16x32_bf16 v[160:163], a[208:211], v[56:59], v[160:163]
    v_exp_f32 v42, v42
    v_mfma_f32_16x16x32_bf16 v[164:167], a[212:215], v[56:59], v[164:167]
    ds_read_b64_tr_b16 a[200:201], v18 offset:128
    v_add_f32 v28, v28, v42
    v_mfma_f32_16x16x32_bf16 v[168:171], a[216:219], v[56:59], v[168:171]
    v_exp_f32 v43, v43
    v_mfma_f32_16x16x32_bf16 v[172:175], a[220:223], v[56:59], v[172:175]
    s_add_u32 s48, s48, 1024
    ds_read_b64_tr_b16 a[202:203], v18 offset:4736
    v_add_f32 v28, v28, v43
    v_cvt_pk_bf16_f32 v61, v42, v43
    v_mfma_f32_16x16x32_bf16 v[36:39], a[160:163], a[112:115], 0
    s_add_u32 m0, m0, s53
    v_exp_f32 v44, v44
    v_mfma_f32_16x16x32_bf16 v[36:39], a[164:167], a[116:119], v[36:39]
    s_waitcnt vmcnt(4)
    buffer_load_dwordx4 v13, s[12:15], s48 offen nt lds
    v_mfma_f32_16x16x32_bf16 v[36:39], a[168:171], a[120:123], v[36:39]
    v_exp_f32 v45, v45
    v_mfma_f32_16x16x32_bf16 v[36:39], a[172:175], a[124:127], v[36:39]
    ds_read_b64_tr_b16 a[204:205], v19 offset:128
    v_add_f32 v28, v28, v45
    v_cvt_pk_bf16_f32 v62, v44, v45
    v_mfma_f32_16x16x32_bf16 v[176:179], a[224:227], v[56:59], v[176:179]
    v_exp_f32 v46, v46
    v_mfma_f32_16x16x32_bf16 v[180:183], a[228:231], v[56:59], v[180:183]
    v_add_f32 v28, v28, v44
    v_add_f32 v28, v28, v46
    v_mfma_f32_16x16x32_bf16 v[184:187], a[232:235], v[56:59], v[184:187]
    v_exp_f32 v47, v47
    v_mfma_f32_16x16x32_bf16 v[188:191], a[236:239], v[56:59], v[188:191]
    ds_read_b64_tr_b16 a[206:207], v19 offset:4736
    v_add_f32 v28, v28, v47
    v_cvt_pk_bf16_f32 v63, v46, v47
    v_mfma_f32_16x16x32_bf16 v[40:43], a[144:147], a[128:131], 0
    v_exp_f32 v32, v32
    v_mfma_f32_16x16x32_bf16 v[40:43], a[148:151], a[132:135], v[40:43]
    ds_read_b128 a[144:147], v14 offset:0
    v_add_f32 v29, v29, v32
    v_mfma_f32_16x16x32_bf16 v[40:43], a[152:155], a[136:139], v[40:43]
    v_exp_f32 v33, v33
    v_mfma_f32_16x16x32_bf16 v[40:43], a[156:159], a[140:143], v[40:43]
    ds_read_b128 a[148:151], v14 offset:64
    v_add_f32 v29, v29, v33
    v_cvt_pk_bf16_f32 v56, v32, v33
    v_mfma_f32_16x16x32_bf16 v[192:195], a[208:211], v[60:63], v[192:195]
    v_exp_f32 v34, v34
    v_mfma_f32_16x16x32_bf16 v[196:199], a[212:215], v[60:63], v[196:199]
    ds_read_b128 a[152:155], v14 offset:128
    v_add_f32 v29, v29, v34
    v_mfma_f32_16x16x32_bf16 v[200:203], a[216:219], v[60:63], v[200:203]
    v_exp_f32 v35, v35
    v_mfma_f32_16x16x32_bf16 v[204:207], a[220:223], v[60:63], v[204:207]
    ds_read_b128 a[156:159], v14 offset:192
    v_add_f32 v29, v29, v35
    v_cvt_pk_bf16_f32 v57, v34, v35
    v_mfma_f32_16x16x32_bf16 v[44:47], a[160:163], a[128:131], 0
    v_exp_f32 v36, v36
    v_mfma_f32_16x16x32_bf16 v[44:47], a[164:167], a[132:135], v[44:47]
    ds_read_b128 a[160:163], v14 offset:4352
    v_add_f32 v29, v29, v36
    v_mfma_f32_16x16x32_bf16 v[44:47], a[168:171], a[136:139], v[44:47]
    v_exp_f32 v37, v37
    v_mfma_f32_16x16x32_bf16 v[44:47], a[172:175], a[140:143], v[44:47]
    ds_read_b128 a[164:167], v14 offset:4416
    v_add_f32 v29, v29, v37
    v_cvt_pk_bf16_f32 v58, v36, v37
    v_mfma_f32_16x16x32_bf16 v[208:211], a[224:227], v[60:63], v[208:211]
    v_exp_f32 v38, v38
    v_mfma_f32_16x16x32_bf16 v[212:215], a[228:231], v[60:63], v[212:215]
    ds_read_b128 a[168:171], v14 offset:4480
    v_add_f32 v29, v29, v38
    v_mfma_f32_16x16x32_bf16 v[216:219], a[232:235], v[60:63], v[216:219]
    v_exp_f32 v39, v39
    v_mfma_f32_16x16x32_bf16 v[220:223], a[236:239], v[60:63], v[220:223]
    s_add_u32 s48, s48, 5120
    s_waitcnt lgkmcnt(3)
    ds_read_b128 a[172:175], v14 offset:4544
    v_add_f32 v29, v29, v39
    v_cvt_pk_bf16_f32 v59, v38, v39
    v_mfma_f32_16x16x32_bf16 v[32:35], a[144:147], a[32:35], 0
    s_add_u32 m0, m0, s53
    v_exp_f32 v40, v40
    v_mfma_f32_16x16x32_bf16 v[32:35], a[148:151], a[36:39], v[32:35]
    s_waitcnt vmcnt(4)
    buffer_load_dwordx4 v13, s[12:15], s48 offen nt lds
    v_mfma_f32_16x16x32_bf16 v[32:35], a[152:155], a[40:43], v[32:35]
    v_exp_f32 v41, v41
    v_mfma_f32_16x16x32_bf16 v[32:35], a[156:159], a[44:47], v[32:35]
    v_add_f32 v30, v30, v41
    v_cvt_pk_bf16_f32 v60, v40, v41
    v_mfma_f32_16x16x32_bf16 v[224:227], a[208:211], v[56:59], v[224:227]
    v_exp_f32 v42, v42
    v_mfma_f32_16x16x32_bf16 v[228:231], a[212:215], v[56:59], v[228:231]
    v_add_f32 v30, v30, v40
    v_add_f32 v30, v30, v42
    v_mfma_f32_16x16x32_bf16 v[232:235], a[216:219], v[56:59], v[232:235]
    v_exp_f32 v43, v43
    v_mfma_f32_16x16x32_bf16 v[236:239], a[220:223], v[56:59], v[236:239]
    s_add_u32 s48, s48, 5120
    s_waitcnt lgkmcnt(0)
    v_add_f32 v30, v30, v43
    v_cvt_pk_bf16_f32 v61, v42, v43
    v_mfma_f32_16x16x32_bf16 v[36:39], a[160:163], a[32:35], 0
    s_add_u32 m0, m0, s53
    v_exp_f32 v44, v44
    v_mfma_f32_16x16x32_bf16 v[36:39], a[164:167], a[36:39], v[36:39]
    s_waitcnt vmcnt(4)
    buffer_load_dwordx4 v13, s[12:15], s48 offen nt lds
    v_mfma_f32_16x16x32_bf16 v[36:39], a[168:171], a[40:43], v[36:39]
    v_exp_f32 v45, v45
    v_mfma_f32_16x16x32_bf16 v[36:39], a[172:175], a[44:47], v[36:39]
    s_add_u32 s48, s48, 2048
    v_add_f32 v30, v30, v45
    v_cvt_pk_bf16_f32 v62, v44, v45
    v_mfma_f32_16x16x32_bf16 v[240:243], a[224:227], v[56:59], v[240:243]
    v_exp_f32 v46, v46
    v_mfma_f32_16x16x32_bf16 v[244:247], a[228:231], v[56:59], v[244:247]
    s_add_u32 m0, s52, 0
    v_add_f32 v30, v30, v44
    v_add_f32 v30, v30, v46
    v_mfma_f32_16x16x32_bf16 v[248:251], a[232:235], v[56:59], v[248:251]
    s_sub_u32 s55, s55, 1
    v_exp_f32 v47, v47
    v_mfma_f32_16x16x32_bf16 v[252:255], a[236:239], v[56:59], v[252:255]
    s_cmp_lg_u32 s55, 0
    v_add_f32 v30, v30, v47
    v_cvt_pk_bf16_f32 v63, v46, v47
    s_cbranch_scc1 L_a
    v_mfma_f32_16x16x32_bf16 v[40:43], a[144:147], a[48:51], 0
    s_waitcnt vmcnt(16) lgkmcnt(0)
    v_exp_f32 v32, v32
    v_mfma_f32_16x16x32_bf16 v[40:43], a[148:151], a[52:55], v[40:43]
    s_barrier
    v_add_f32 v24, v24, v32
    v_mfma_f32_16x16x32_bf16 v[40:43], a[152:155], a[56:59], v[40:43]
    v_exp_f32 v33, v33
    s_lshl_b32 s20, s33, 4
    v_mfma_f32_16x16x32_bf16 v[40:43], a[156:159], a[60:63], v[40:43]
    v_add_f32 v24, v24, v33
    v_cvt_pk_bf16_f32 v56, v32, v33
    v_mfma_f32_16x16x32_bf16 a[0:3], a[208:211], v[60:63], a[0:3]
    v_exp_f32 v34, v34
    s_add_u32 s20, s20, s3
    v_mfma_f32_16x16x32_bf16 a[4:7], a[212:215], v[60:63], a[4:7]
    v_add_f32 v24, v24, v34
    v_mfma_f32_16x16x32_bf16 a[8:11], a[216:219], v[60:63], a[8:11]
    v_exp_f32 v35, v35
    s_lshl_b32 s20, s20, 2
    v_mfma_f32_16x16x32_bf16 a[12:15], a[220:223], v[60:63], a[12:15]
    v_add_f32 v24, v24, v35
    v_cvt_pk_bf16_f32 v57, v34, v35
    v_mfma_f32_16x16x32_bf16 v[44:47], a[160:163], a[48:51], 0
    v_exp_f32 v36, v36
    s_add_u32 s20, s20, s28
    v_mfma_f32_16x16x32_bf16 v[44:47], a[164:167], a[52:55], v[44:47]
    v_add_f32 v24, v24, v36
    v_mfma_f32_16x16x32_bf16 v[44:47], a[168:171], a[56:59], v[44:47]
    v_exp_f32 v37, v37
    s_lshl_b32 s20, s20, 14
    v_mfma_f32_16x16x32_bf16 v[44:47], a[172:175], a[60:63], v[44:47]
    v_add_f32 v24, v24, v37
    v_cvt_pk_bf16_f32 v58, v36, v37
    v_mfma_f32_16x16x32_bf16 a[16:19], a[224:227], v[60:63], a[16:19]
    v_exp_f32 v38, v38
    v_mfma_f32_16x16x32_bf16 a[20:23], a[228:231], v[60:63], a[20:23]
    v_add_f32 v24, v24, v38
    s_add_u32 s20, s34, s20
    v_mfma_f32_16x16x32_bf16 a[24:27], a[232:235], v[60:63], a[24:27]
    v_exp_f32 v39, v39
    v_mfma_f32_16x16x32_bf16 a[28:31], a[236:239], v[60:63], a[28:31]
    v_add_f32 v24, v24, v39
    v_cvt_pk_bf16_f32 v59, v38, v39
    s_addc_u32 s21, s35, 0
    v_mfma_f32_16x16x32_bf16 v[32:35], a[144:147], a[64:67], 0
    v_exp_f32 v40, v40
    v_mfma_f32_16x16x32_bf16 v[32:35], a[148:151], a[68:71], v[32:35]
    ds_read_b64_tr_b16 a[208:209], v16 offset:35840
    v_add_f32 v25, v25, v40
    s_mov_b32 s22, 16384
    v_mfma_f32_16x16x32_bf16 v[32:35], a[152:155], a[72:75], v[32:35]
    v_exp_f32 v41, v41
    v_mfma_f32_16x16x32_bf16 v[32:35], a[156:159], a[76:79], v[32:35]
    v_add_f32 v25, v25, v41
    v_cvt_pk_bf16_f32 v60, v40, v41
    s_mov_b32 s23, 0x20000
    v_mfma_f32_16x16x32_bf16 v[64:67], a[176:179], v[56:59], v[64:67]
    v_exp_f32 v42, v42
    v_mfma_f32_16x16x32_bf16 v[68:71], a[180:183], v[56:59], v[68:71]
    ds_read_b64_tr_b16 a[210:211], v16 offset:40448
    v_add_f32 v25, v25, v42
    v_mfma_f32_16x16x32_bf16 v[72:75], a[184:187], v[56:59], v[72:75]
    v_exp_f32 v43, v43
    v_lshlrev_b32 v9, 7, v0
    v_mfma_f32_16x16x32_bf16 v[76:79], a[188:191], v[56:59], v[76:79]
    v_add_f32 v25, v25, v43
    v_cvt_pk_bf16_f32 v61, v42, v43
    v_mfma_f32_16x16x32_bf16 v[36:39], a[160:163], a[64:67], 0
    v_exp_f32 v44, v44
    s_mov_b32 s49, 8192
    v_mfma_f32_16x16x32_bf16 v[36:39], a[164:167], a[68:71], v[36:39]
    ds_read_b64_tr_b16 a[212:213], v17 offset:35840
    v_add_f32 v25, v25, v44
    v_mfma_f32_16x16x32_bf16 v[36:39], a[168:171], a[72:75], v[36:39]
    v_exp_f32 v45, v45
    buffer_load_dword v10, v9, s[20:23], 0 offen
    v_mfma_f32_16x16x32_bf16 v[36:39], a[172:175], a[76:79], v[36:39]
    v_add_f32 v25, v25, v45
    v_cvt_pk_bf16_f32 v62, v44, v45
    v_mfma_f32_16x16x32_bf16 v[80:83], a[192:195], v[56:59], v[80:83]
    v_exp_f32 v46, v46
    buffer_load_dword v10, v9, s[20:23], s49 offen
    v_mfma_f32_16x16x32_bf16 v[84:87], a[196:199], v[56:59], v[84:87]
    ds_read_b64_tr_b16 a[214:215], v17 offset:40448
    v_add_f32 v25, v25, v46
    v_mfma_f32_16x16x32_bf16 v[88:91], a[200:203], v[56:59], v[88:91]
    v_exp_f32 v47, v47
    v_mfma_f32_16x16x32_bf16 v[92:95], a[204:207], v[56:59], v[92:95]
    v_add_f32 v25, v25, v47
    v_cvt_pk_bf16_f32 v63, v46, v47
    v_mfma_f32_16x16x32_bf16 v[40:43], a[144:147], a[80:83], 0
    v_exp_f32 v32, v32
    v_mfma_f32_16x16x32_bf16 v[40:43], a[148:151], a[84:87], v[40:43]
    ds_read_b64_tr_b16 a[216:217], v18 offset:35840
    v_add_f32 v26, v26, v32
    v_mfma_f32_16x16x32_bf16 v[40:43], a[152:155], a[88:91], v[40:43]
    v_exp_f32 v33, v33
    v_mfma_f32_16x16x32_bf16 v[40:43], a[156:159], a[92:95], v[40:43]
    v_add_f32 v26, v26, v33
    v_cvt_pk_bf16_f32 v56, v32, v33
    v_mfma_f32_16x16x32_bf16 v[96:99], a[176:179], v[60:63], v[96:99]
    v_exp_f32 v34, v34
    v_mfma_f32_16x16x32_bf16 v[100:103], a[180:183], v[60:63], v[100:103]
    ds_read_b64_tr_b16 a[218:219], v18 offset:40448
    v_add_f32 v26, v26, v34
    v_mfma_f32_16x16x32_bf16 v[104:107], a[184:187], v[60:63], v[104:107]
    v_exp_f32 v35, v35
    v_mfma_f32_16x16x32_bf16 v[108:111], a[188:191], v[60:63], v[108:111]
    v_add_f32 v26, v26, v35
    v_cvt_pk_bf16_f32 v57, v34, v35
    v_mfma_f32_16x16x32_bf16 v[44:47], a[160:163], a[80:83], 0
    v_exp_f32 v36, v36
    v_mfma_f32_16x16x32_bf16 v[44:47], a[164:167], a[84:87], v[44:47]
    ds_read_b64_tr_b16 a[220:221], v19 offset:35840
    v_add_f32 v26, v26, v36
    v_mfma_f32_16x16x32_bf16 v[44:47], a[168:171], a[88:91], v[44:47]
    v_exp_f32 v37, v37
    v_mfma_f32_16x16x32_bf16 v[44:47], a[172:175], a[92:95], v[44:47]
    v_add_f32 v26, v26, v37
    v_cvt_pk_bf16_f32 v58, v36, v37
    v_mfma_f32_16x16x32_bf16 v[112:115], a[192:195], v[60:63], v[112:115]
    v_exp_f32 v38, v38
    v_mfma_f32_16x16x32_bf16 v[116:119], a[196:199], v[60:63], v[116:119]
    ds_read_b64_tr_b16 a[222:223], v19 offset:40448
    v_add_f32 v26, v26, v38
    v_mfma_f32_16x16x32_bf16 v[120:123], a[200:203], v[60:63], v[120:123]
    v_exp_f32 v39, v39
    v_mfma_f32_16x16x32_bf16 v[124:127], a[204:207], v[60:63], v[124:127]
    v_add_f32 v26, v26, v39
    v_cvt_pk_bf16_f32 v59, v38, v39
    v_mfma_f32_16x16x32_bf16 v[32:35], a[144:147], a[96:99], 0
    v_exp_f32 v40, v40
    v_mfma_f32_16x16x32_bf16 v[32:35], a[148:151], a[100:103], v[32:35]
    ds_read_b64_tr_b16 a[224:225], v16 offset:35968
    v_add_f32 v27, v27, v40
    v_mfma_f32_16x16x32_bf16 v[32:35], a[152:155], a[104:107], v[32:35]
    v_exp_f32 v41, v41
    v_mfma_f32_16x16x32_bf16 v[32:35], a[156:159], a[108:111], v[32:35]
    v_add_f32 v27, v27, v41
    v_cvt_pk_bf16_f32 v60, v40, v41
    v_mfma_f32_16x16x32_bf16 v[128:131], a[176:179], v[56:59], v[128:131]
    v_exp_f32 v42, v42
    v_mfma_f32_16x16x32_bf16 v[132:135], a[180:183], v[56:59], v[132:135]
    ds_read_b64_tr_b16 a[226:227], v16 offset:40576
    v_add_f32 v27, v27, v42
    v_mfma_f32_16x16x32_bf16 v[136:139], a[184:187], v[56:59], v[136:139]
    v_exp_f32 v43, v43
    v_mfma_f32_16x16x32_bf16 v[140:143], a[188:191], v[56:59], v[140:143]
    v_add_f32 v27, v27, v43
    v_cvt_pk_bf16_f32 v61, v42, v43
    v_mfma_f32_16x16x32_bf16 v[36:39], a[160:163], a[96:99], 0
    v_exp_f32 v44, v44
    v_mfma_f32_16x16x32_bf16 v[36:39], a[164:167], a[100:103], v[36:39]
    ds_read_b64_tr_b16 a[228:229], v17 offset:35968
    v_add_f32 v27, v27, v44
    v_mfma_f32_16x16x32_bf16 v[36:39], a[168:171], a[104:107], v[36:39]
    v_exp_f32 v45, v45
    v_mfma_f32_16x16x32_bf16 v[36:39], a[172:175], a[108:111], v[36:39]
    v_add_f32 v27, v27, v45
    v_cvt_pk_bf16_f32 v62, v44, v45
    v_mfma_f32_16x16x32_bf16 v[144:147], a[192:195], v[56:59], v[144:147]
    v_exp_f32 v46, v46
    v_mfma_f32_16x16x32_bf16 v[148:151], a[196:199], v[56:59], v[148:151]
    ds_read_b64_tr_b16 a[230:231], v17 offset:40576
    v_add_f32 v27, v27, v46
    v_mfma_f32_16x16x32_bf16 v[152:155], a[200:203], v[56:59], v[152:155]
    v_exp_f32 v47, v47
    v_mfma_f32_16x16x32_bf16 v[156:159], a[204:207], v[56:59], v[156:159]
    v_add_f32 v27, v27, v47
    v_cvt_pk_bf16_f32 v63, v46, v47
    v_mfma_f32_16x16x32_bf16 v[40:43], a[144:147], a[112:115], 0
    v_exp_f32 v32, v32
    v_mfma_f32_16x16x32_bf16 v[40:43], a[148:151], a[116:119], v[40:43]
    ds_read_b64_tr_b16 a[232:233], v18 offset:35968
    v_add_f32 v28, v28, v32
    v_mfma_f32_16x16x32_bf16 v[40:43], a[152:155], a[120:123], v[40:43]
    v_exp_f32 v33, v33
    v_mfma_f32_16x16x32_bf16 v[40:43], a[156:159], a[124:127], v[40:43]
    v_add_f32 v28, v28, v33
    v_cvt_pk_bf16_f32 v56, v32, v33
    v_mfma_f32_16x16x32_bf16 v[160:163], a[176:179], v[60:63], v[160:163]
    v_exp_f32 v34, v34
    v_mfma_f32_16x16x32_bf16 v[164:167], a[180:183], v[60:63], v[164:167]
    ds_read_b64_tr_b16 a[234:235], v18 offset:40576
    v_add_f32 v28, v28, v34
    v_mfma_f32_16x16x32_bf16 v[168:171], a[184:187], v[60:63], v[168:171]
    v_exp_f32 v35, v35
    v_mfma_f32_16x16x32_bf16 v[172:175], a[188:191], v[60:63], v[172:175]
    v_add_f32 v28, v28, v35
    v_cvt_pk_bf16_f32 v57, v34, v35
    v_mfma_f32_16x16x32_bf16 v[44:47], a[160:163], a[112:115], 0
    v_exp_f32 v36, v36
    v_mfma_f32_16x16x32_bf16 v[44:47], a[164:167], a[116:119], v[44:47]
    ds_read_b64_tr_b16 a[236:237], v19 offset:35968
    v_add_f32 v28, v28, v36
    v_mfma_f32_16x16x32_bf16 v[44:47], a[168:171], a[120:123], v[44:47]
    v_exp_f32 v37, v37
    v_mfma_f32_16x16x32_bf16 v[44:47], a[172:175], a[124:127], v[44:47]
    v_add_f32 v28, v28, v37
    v_cvt_pk_bf16_f32 v58, v36, v37
    v_mfma_f32_16x16x32_bf16 v[176:179], a[192:195], v[60:63], v[176:179]
    v_exp_f32 v38, v38
    v_mfma_f32_16x16x32_bf16 v[180:183], a[196:199], v[60:63], v[180:183]
    ds_read_b64_tr_b16 a[238:239], v19 offset:40576
    v_add_f32 v28, v28, v38
    v_mfma_f32_16x16x32_bf16 v[184:187], a[200:203], v[60:63], v[184:187]
    v_exp_f32 v39, v39
    v_mfma_f32_16x16x32_bf16 v[188:191], a[204:207], v[60:63], v[188:191]
    v_add_f32 v28, v28, v39
    v_cvt_pk_bf16_f32 v59, v38, v39
    v_mfma_f32_16x16x32_bf16 v[32:35], a[144:147], a[128:131], 0
    v_exp_f32 v40, v40
    v_mfma_f32_16x16x32_bf16 v[32:35], a[148:151], a[132:135], v[32:35]
    ds_read_b128 a[144:147], v14 offset:35840
    v_add_f32 v29, v29, v40
    v_mfma_f32_16x16x32_bf16 v[32:35], a[152:155], a[136:139], v[32:35]
    v_exp_f32 v41, v41
    v_mfma_f32_16x16x32_bf16 v[32:35], a[156:159], a[140:143], v[32:35]
    ds_read_b128 a[148:151], v14 offset:35904
    v_add_f32 v29, v29, v41
    v_cvt_pk_bf16_f32 v60, v40, v41
    v_mfma_f32_16x16x32_bf16 v[192:195], a[176:179], v[56:59], v[192:195]
    v_exp_f32 v42, v42
    v_mfma_f32_16x16x32_bf16 v[196:199], a[180:183], v[56:59], v[196:199]
    ds_read_b128 a[152:155], v14 offset:35968
    v_add_f32 v29, v29, v42
    v_mfma_f32_16x16x32_bf16 v[200:203], a[184:187], v[56:59], v[200:203]
    v_exp_f32 v43, v43
    v_mfma_f32_16x16x32_bf16 v[204:207], a[188:191], v[56:59], v[204:207]
    ds_read_b128 a[156:159], v14 offset:36032
    v_add_f32 v29, v29, v43
    v_cvt_pk_bf16_f32 v61, v42, v43
    v_mfma_f32_16x16x32_bf16 v[36:39], a[160:163], a[128:131], 0
    v_exp_f32 v44, v44
    v_mfma_f32_16x16x32_bf16 v[36:39], a[164:167], a[132:135], v[36:39]
    ds_read_b128 a[160:163], v14 offset:40192
    v_add_f32 v29, v29, v44
    v_mfma_f32_16x16x32_bf16 v[36:39], a[168:171], a[136:139], v[36:39]
    v_exp_f32 v45, v45
    v_mfma_f32_16x16x32_bf16 v[36:39], a[172:175], a[140:143], v[36:39]
    ds_read_b128 a[164:167], v14 offset:40256
    v_add_f32 v29, v29, v45
    v_cvt_pk_bf16_f32 v62, v44, v45
    v_mfma_f32_16x16x32_bf16 v[208:211], a[192:195], v[56:59], v[208:211]
    v_exp_f32 v46, v46
    v_mfma_f32_16x16x32_bf16 v[212:215], a[196:199], v[56:59], v[212:215]
    ds_read_b128 a[168:171], v14 offset:40320
    v_add_f32 v29, v29, v46
    v_mfma_f32_16x16x32_bf16 v[216:219], a[200:203], v[56:59], v[216:219]
    v_exp_f32 v47, v47
    v_mfma_f32_16x16x32_bf16 v[220:223], a[204:207], v[56:59], v[220:223]
    s_waitcnt lgkmcnt(3)
    ds_read_b128 a[172:175], v14 offset:40384
    v_add_f32 v29, v29, v47
    v_cvt_pk_bf16_f32 v63, v46, v47
    v_mfma_f32_16x16x32_bf16 v[40:43], a[144:147], a[32:35], 0
    v_exp_f32 v32, v32
    v_mfma_f32_16x16x32_bf16 v[40:43], a[148:151], a[36:39], v[40:43]
    v_add_f32 v30, v30, v32
    v_mfma_f32_16x16x32_bf16 v[40:43], a[152:155], a[40:43], v[40:43]
    v_exp_f32 v33, v33
    v_mfma_f32_16x16x32_bf16 v[40:43], a[156:159], a[44:47], v[40:43]
    v_add_f32 v30, v30, v33
    v_cvt_pk_bf16_f32 v56, v32, v33
    v_mfma_f32_16x16x32_bf16 v[224:227], a[176:179], v[60:63], v[224:227]
    v_exp_f32 v34, v34
    v_mfma_f32_16x16x32_bf16 v[228:231], a[180:183], v[60:63], v[228:231]
    v_add_f32 v30, v30, v34
    v_mfma_f32_16x16x32_bf16 v[232:235], a[184:187], v[60:63], v[232:235]
    v_exp_f32 v35, v35
    v_mfma_f32_16x16x32_bf16 v[236:239], a[188:191], v[60:63], v[236:239]
    s_waitcnt lgkmcnt(0)
    v_add_f32 v30, v30, v35
    v_cvt_pk_bf16_f32 v57, v34, v35
    v_mfma_f32_16x16x32_bf16 v[44:47], a[160:163], a[32:35], 0
    v_exp_f32 v36, v36
    v_mfma_f32_16x16x32_bf16 v[44:47], a[164:167], a[36:39], v[44:47]
    v_add_f32 v30, v30, v36
    v_mfma_f32_16x16x32_bf16 v[44:47], a[168:171], a[40:43], v[44:47]
    v_exp_f32 v37, v37
    v_mfma_f32_16x16x32_bf16 v[44:47], a[172:175], a[44:47], v[44:47]
    v_add_f32 v30, v30, v37
    v_cvt_pk_bf16_f32 v58, v36, v37
    v_mfma_f32_16x16x32_bf16 v[240:243], a[192:195], v[60:63], v[240:243]
    v_exp_f32 v38, v38
    v_mfma_f32_16x16x32_bf16 v[244:247], a[196:199], v[60:63], v[244:247]
    v_add_f32 v30, v30, v38
    v_mfma_f32_16x16x32_bf16 v[248:251], a[200:203], v[60:63], v[248:251]
    v_exp_f32 v39, v39
    v_mfma_f32_16x16x32_bf16 v[252:255], a[204:207], v[60:63], v[252:255]
    v_add_f32 v30, v30, v39
    v_cvt_pk_bf16_f32 v59, v38, v39
    v_mfma_f32_16x16x32_bf16 v[32:35], a[144:147], a[48:51], 0
    s_waitcnt vmcnt(10) lgkmcnt(0)
    v_exp_f32 v40, v40
    v_mfma_f32_16x16x32_bf16 v[32:35], a[148:151], a[52:55], v[32:35]
    s_barrier
    v_add_f32 v24, v24, v40
    v_mfma_f32_16x16x32_bf16 v[32:35], a[152:155], a[56:59], v[32:35]
    v_exp_f32 v41, v41
    v_mfma_f32_16x16x32_bf16 v[32:35], a[156:159], a[60:63], v[32:35]
    v_add_f32 v24, v24, v41
    v_cvt_pk_bf16_f32 v60, v40, v41
    v_mfma_f32_16x16x32_bf16 a[0:3], a[176:179], v[56:59], a[0:3]
    v_exp_f32 v42, v42
    v_mfma_f32_16x16x32_bf16 a[4:7], a[180:183], v[56:59], a[4:7]
    v_add_f32 v24, v24, v42
    v_mfma_f32_16x16x32_bf16 a[8:11], a[184:187], v[56:59], a[8:11]
    v_exp_f32 v43, v43
    v_mfma_f32_16x16x32_bf16 a[12:15], a[188:191], v[56:59], a[12:15]
    v_add_f32 v24, v24, v43
    v_cvt_pk_bf16_f32 v61, v42, v43
    v_mfma_f32_16x16x32_bf16 v[36:39], a[160:163], a[48:51], 0
    v_exp_f32 v44, v44
    v_mfma_f32_16x16x32_bf16 v[36:39], a[164:167], a[52:55], v[36:39]
    v_add_f32 v24, v24, v44
    v_mfma_f32_16x16x32_bf16 v[36:39], a[168:171], a[56:59], v[36:39]
    v_exp_f32 v45, v45
    v_mfma_f32_16x16x32_bf16 v[36:39], a[172:175], a[60:63], v[36:39]
    v_add_f32 v24, v24, v45
    v_cvt_pk_bf16_f32 v62, v44, v45
    v_mfma_f32_16x16x32_bf16 a[16:19], a[192:195], v[56:59], a[16:19]
    v_exp_f32 v46, v46
    v_mfma_f32_16x16x32_bf16 a[20:23], a[196:199], v[56:59], a[20:23]
    v_add_f32 v24, v24, v46
    v_mfma_f32_16x16x32_bf16 a[24:27], a[200:203], v[56:59], a[24:27]
    v_exp_f32 v47, v47
    v_mfma_f32_16x16x32_bf16 a[28:31], a[204:207], v[56:59], a[28:31]
    v_add_f32 v24, v24, v47
    v_cvt_pk_bf16_f32 v63, v46, v47
    v_mfma_f32_16x16x32_bf16 v[40:43], a[144:147], a[64:67], 0
    v_exp_f32 v32, v32
    v_mfma_f32_16x16x32_bf16 v[40:43], a[148:151], a[68:71], v[40:43]
    ds_read_b64_tr_b16 a[176:177], v20 offset:0
    v_add_f32 v25, v25, v32
    v_mfma_f32_16x16x32_bf16 v[40:43], a[152:155], a[72:75], v[40:43]
    v_exp_f32 v33, v33
    v_mfma_f32_16x16x32_bf16 v[40:43], a[156:159], a[76:79], v[40:43]
    v_add_f32 v25, v25, v33
    v_cvt_pk_bf16_f32 v56, v32, v33
    v_mfma_f32_16x16x32_bf16 v[64:67], a[208:211], v[60:63], v[64:67]
    v_exp_f32 v34, v34
    v_mfma_f32_16x16x32_bf16 v[68:71], a[212:215], v[60:63], v[68:71]
    ds_read_b64_tr_b16 a[178:179], v20 offset:4608
    v_add_f32 v25, v25, v34
    v_mfma_f32_16x16x32_bf16 v[72:75], a[216:219], v[60:63], v[72:75]
    v_exp_f32 v35, v35
    v_mfma_f32_16x16x32_bf16 v[76:79], a[220:223], v[60:63], v[76:79]
    v_add_f32 v25, v25, v35
    v_cvt_pk_bf16_f32 v57, v34, v35
    v_mfma_f32_16x16x32_bf16 v[44:47], a[160:163], a[64:67], 0
    v_exp_f32 v36, v36
    v_mfma_f32_16x16x32_bf16 v[44:47], a[164:167], a[68:71], v[44:47]
    ds_read_b64_tr_b16 a[180:181], v21 offset:0
    v_add_f32 v25, v25, v36
    v_mfma_f32_16x16x32_bf16 v[44:47], a[168:171], a[72:75], v[44:47]
    v_exp_f32 v37, v37
    v_mfma_f32_16x16x32_bf16 v[44:47], a[172:175], a[76:79], v[44:47]
    v_add_f32 v25, v25, v37
    v_cvt_pk_bf16_f32 v58, v36, v37
    v_mfma_f32_16x16x32_bf16 v[80:83], a[224:227], v[60:63], v[80:83]
    v_exp_f32 v38, v38
    v_mfma_f32_16x16x32_bf16 v[84:87], a[228:231], v[60:63], v[84:87]
    ds_read_b64_tr_b16 a[182:183], v21 offset:4608
    v_add_f32 v25, v25, v38
    v_mfma_f32_16x16x32_bf16 v[88:91], a[232:235], v[60:63], v[88:91]
    v_exp_f32 v39, v39
    v_mfma_f32_16x16x32_bf16 v[92:95], a[236:239], v[60:63], v[92:95]
    v_add_f32 v25, v25, v39
    v_cvt_pk_bf16_f32 v59, v38, v39
    v_mfma_f32_16x16x32_bf16 v[32:35], a[144:147], a[80:83], 0
    v_exp_f32 v40, v40
    v_mfma_f32_16x16x32_bf16 v[32:35], a[148:151], a[84:87], v[32:35]
    ds_read_b64_tr_b16 a[184:185], v22 offset:0
    v_add_f32 v26, v26, v40
    v_mfma_f32_16x16x32_bf16 v[32:35], a[152:155], a[88:91], v[32:35]
    v_exp_f32 v41, v41
    v_mfma_f32_16x16x32_bf16 v[32:35], a[156:159], a[92:95], v[32:35]
    v_add_f32 v26, v26, v41
    v_cvt_pk_bf16_f32 v60, v40, v41
    v_mfma_f32_16x16x32_bf16 v[96:99], a[208:211], v[56:59], v[96:99]
    v_exp_f32 v42, v42
    v_mfma_f32_16x16x32_bf16 v[100:103], a[212:215], v[56:59], v[100:103]
    ds_read_b64_tr_b16 a[186:187], v22 offset:4608
    v_add_f32 v26, v26, v42
    v_mfma_f32_16x16x32_bf16 v[104:107], a[216:219], v[56:59], v[104:107]
    v_exp_f32 v43, v43
    v_mfma_f32_16x16x32_bf16 v[108:111], a[220:223], v[56:59], v[108:111]
    v_add_f32 v26, v26, v43
    v_cvt_pk_bf16_f32 v61, v42, v43
    v_mfma_f32_16x16x32_bf16 v[36:39], a[160:163], a[80:83], 0
    v_exp_f32 v44, v44
    v_mfma_f32_16x16x32_bf16 v[36:39], a[164:167], a[84:87], v[36:39]
    ds_read_b64_tr_b16 a[188:189], v23 offset:0
    v_add_f32 v26, v26, v44
    v_mfma_f32_16x16x32_bf16 v[36:39], a[168:171], a[88:91], v[36:39]
    v_exp_f32 v45, v45
    v_mfma_f32_16x16x32_bf16 v[36:39], a[172:175], a[92:95], v[36:39]
    v_add_f32 v26, v26, v45
    v_cvt_pk_bf16_f32 v62, v44, v45
    v_mfma_f32_16x16x32_bf16 v[112:115], a[224:227], v[56:59], v[112:115]
    v_exp_f32 v46, v46
    v_mfma_f32_16x16x32_bf16 v[116:119], a[228:231], v[56:59], v[116:119]
    ds_read_b64_tr_b16 a[190:191], v23 offset:4608
    v_add_f32 v26, v26, v46
    v_mfma_f32_16x16x32_bf16 v[120:123], a[232:235], v[56:59], v[120:123]
    v_exp_f32 v47, v47
    v_mfma_f32_16x16x32_bf16 v[124:127], a[236:239], v[56:59], v[124:127]
    v_add_f32 v26, v26, v47
    v_cvt_pk_bf16_f32 v63, v46, v47
    v_mfma_f32_16x16x32_bf16 v[40:43], a[144:147], a[96:99], 0
    v_exp_f32 v32, v32
    v_mfma_f32_16x16x32_bf16 v[40:43], a[148:151], a[100:103], v[40:43]
    ds_read_b64_tr_b16 a[192:193], v20 offset:128
    v_add_f32 v27, v27, v32
    v_mfma_f32_16x16x32_bf16 v[40:43], a[152:155], a[104:107], v[40:43]
    v_exp_f32 v33, v33
    v_mfma_f32_16x16x32_bf16 v[40:43], a[156:159], a[108:111], v[40:43]
    v_add_f32 v27, v27, v33
    v_cvt_pk_bf16_f32 v56, v32, v33
    v_mfma_f32_16x16x32_bf16 v[128:131], a[208:211], v[60:63], v[128:131]
    v_exp_f32 v34, v34
    v_mfma_f32_16x16x32_bf16 v[132:135], a[212:215], v[60:63], v[132:135]
    ds_read_b64_tr_b16 a[194:195], v20 offset:4736
    v_add_f32 v27, v27, v34
    v_mfma_f32_16x16x32_bf16 v[136:139], a[216:219], v[60:63], v[136:139]
    v_exp_f32 v35, v35
    v_mfma_f32_16x16x32_bf16 v[140:143], a[220:223], v[60:63], v[140:143]
    v_add_f32 v27, v27, v35
    v_cvt_pk_bf16_f32 v57, v34, v35
    v_mfma_f32_16x16x32_bf16 v[44:47], a[160:163], a[96:99], 0
    v_exp_f32 v36, v36
    v_mfma_f32_16x16x32_bf16 v[44:47], a[164:167], a[100:103], v[44:47]
    ds_read_b64_tr_b16 a[196:197], v21 offset:128
    v_add_f32 v27, v27, v36
    v_mfma_f32_16x16x32_bf16 v[44:47], a[168:171], a[104:107], v[44:47]
    v_exp_f32 v37, v37
    v_mfma_f32_16x16x32_bf16 v[44:47], a[172:175], a[108:111], v[44:47]
    v_add_f32 v27, v27, v37
    v_cvt_pk_bf16_f32 v58, v36, v37
    v_mfma_f32_16x16x32_bf16 v[144:147], a[224:227], v[60:63], v[144:147]
    v_exp_f32 v38, v38
    v_mfma_f32_16x16x32_bf16 v[148:151], a[228:231], v[60:63], v[148:151]
    ds_read_b64_tr_b16 a[198:199], v21 offset:4736
    v_add_f32 v27, v27, v38
    v_mfma_f32_16x16x32_bf16 v[152:155], a[232:235], v[60:63], v[152:155]
    v_exp_f32 v39, v39
    v_mfma_f32_16x16x32_bf16 v[156:159], a[236:239], v[60:63], v[156:159]
    v_add_f32 v27, v27, v39
    v_cvt_pk_bf16_f32 v59, v38, v39
    v_mfma_f32_16x16x32_bf16 v[32:35], a[144:147], a[112:115], 0
    v_exp_f32 v40, v40
    v_mfma_f32_16x16x32_bf16 v[32:35], a[148:151], a[116:119], v[32:35]
    ds_read_b64_tr_b16 a[200:201], v22 offset:128
    v_add_f32 v28, v28, v40
    v_mfma_f32_16x16x32_bf16 v[32:35], a[152:155], a[120:123], v[32:35]
    v_exp_f32 v41, v41
    v_mfma_f32_16x16x32_bf16 v[32:35], a[156:159], a[124:127], v[32:35]
    v_add_f32 v28, v28, v41
    v_cvt_pk_bf16_f32 v60, v40, v41
    v_mfma_f32_16x16x32_bf16 v[160:163], a[208:211], v[56:59], v[160:163]
    v_exp_f32 v42, v42
    v_mfma_f32_16x16x32_bf16 v[164:167], a[212:215], v[56:59], v[164:167]
    ds_read_b64_tr_b16 a[202:203], v22 offset:4736
    v_add_f32 v28, v28, v42
    v_mfma_f32_16x16x32_bf16 v[168:171], a[216:219], v[56:59], v[168:171]
    v_exp_f32 v43, v43
    v_mfma_f32_16x16x32_bf16 v[172:175], a[220:223], v[56:59], v[172:175]
    v_add_f32 v28, v28, v43
    v_cvt_pk_bf16_f32 v61, v42, v43
    v_mfma_f32_16x16x32_bf16 v[36:39], a[160:163], a[112:115], 0
    v_exp_f32 v44, v44
    v_mfma_f32_16x16x32_bf16 v[36:39], a[164:167], a[116:119], v[36:39]
    ds_read_b64_tr_b16 a[204:205], v23 offset:128
    v_add_f32 v28, v28, v44
    v_mfma_f32_16x16x32_bf16 v[36:39], a[168:171], a[120:123], v[36:39]
    v_exp_f32 v45, v45
    v_mfma_f32_16x16x32_bf16 v[36:39], a[172:175], a[124:127], v[36:39]
    v_add_f32 v28, v28, v45
    v_cvt_pk_bf16_f32 v62, v44, v45
    v_mfma_f32_16x16x32_bf16 v[176:179], a[224:227], v[56:59], v[176:179]
    v_exp_f32 v46, v46
    v_mfma_f32_16x16x32_bf16 v[180:183], a[228:231], v[56:59], v[180:183]
    ds_read_b64_tr_b16 a[206:207], v23 offset:4736
    v_add_f32 v28, v28, v46
    v_mfma_f32_16x16x32_bf16 v[184:187], a[232:235], v[56:59], v[184:187]
    v_exp_f32 v47, v47
    v_mfma_f32_16x16x32_bf16 v[188:191], a[236:239], v[56:59], v[188:191]
    v_add_f32 v28, v28, v47
    v_cvt_pk_bf16_f32 v63, v46, v47
    v_mfma_f32_16x16x32_bf16 v[40:43], a[144:147], a[128:131], 0
    v_exp_f32 v32, v32
    v_mfma_f32_16x16x32_bf16 v[40:43], a[148:151], a[132:135], v[40:43]
    ds_read_b128 a[144:147], v15 offset:0
    v_add_f32 v29, v29, v32
    v_mfma_f32_16x16x32_bf16 v[40:43], a[152:155], a[136:139], v[40:43]
    v_exp_f32 v33, v33
    v_mfma_f32_16x16x32_bf16 v[40:43], a[156:159], a[140:143], v[40:43]
    ds_read_b128 a[148:151], v15 offset:64
    v_add_f32 v29, v29, v33
    v_cvt_pk_bf16_f32 v56, v32, v33
    v_mfma_f32_16x16x32_bf16 v[192:195], a[208:211], v[60:63], v[192:195]
    v_exp_f32 v34, v34
    v_mfma_f32_16x16x32_bf16 v[196:199], a[212:215], v[60:63], v[196:199]
    ds_read_b128 a[152:155], v15 offset:128
    v_add_f32 v29, v29, v34
    v_mfma_f32_16x16x32_bf16 v[200:203], a[216:219], v[60:63], v[200:203]
    v_exp_f32 v35, v35
    v_mfma_f32_16x16x32_bf16 v[204:207], a[220:223], v[60:63], v[204:207]
    ds_read_b128 a[156:159], v15 offset:192
    v_add_f32 v29, v29, v35
    v_cvt_pk_bf16_f32 v57, v34, v35
    v_mfma_f32_16x16x32_bf16 v[44:47], a[160:163], a[128:131], 0
    v_exp_f32 v36, v36
    v_mfma_f32_16x16x32_bf16 v[44:47], a[164:167], a[132:135], v[44:47]
    ds_read_b128 a[160:163], v15 offset:4352
    v_add_f32 v29, v29, v36
    v_mfma_f32_16x16x32_bf16 v[44:47], a[168:171], a[136:139], v[44:47]
    v_exp_f32 v37, v37
    v_mfma_f32_16x16x32_bf16 v[44:47], a[172:175], a[140:143], v[44:47]
    ds_read_b128 a[164:167], v15 offset:4416
    v_add_f32 v29, v29, v37
    v_cvt_pk_bf16_f32 v58, v36, v37
    v_mfma_f32_16x16x32_bf16 v[208:211], a[224:227], v[60:63], v[208:211]
    v_exp_f32 v38, v38
    v_mfma_f32_16x16x32_bf16 v[212:215], a[228:231], v[60:63], v[212:215]
    ds_read_b128 a[168:171], v15 offset:4480
    v_add_f32 v29, v29, v38
    v_mfma_f32_16x16x32_bf16 v[216:219], a[232:235], v[60:63], v[216:219]
    v_exp_f32 v39, v39
    v_mfma_f32_16x16x32_bf16 v[220:223], a[236:239], v[60:63], v[220:223]
    s_waitcnt lgkmcnt(3)
    ds_read_b128 a[172:175], v15 offset:4544
    v_add_f32 v29, v29, v39
    v_cvt_pk_bf16_f32 v59, v38, v39
    v_mfma_f32_16x16x32_bf16 v[32:35], a[144:147], a[32:35], 0
    v_exp_f32 v40, v40
    v_mfma_f32_16x16x32_bf16 v[32:35], a[148:151], a[36:39], v[32:35]
    v_add_f32 v30, v30, v40
    v_mfma_f32_16x16x32_bf16 v[32:35], a[152:155], a[40:43], v[32:35]
    v_exp_f32 v41, v41
    v_mfma_f32_16x16x32_bf16 v[32:35], a[156:159], a[44:47], v[32:35]
    v_add_f32 v30, v30, v41
    v_cvt_pk_bf16_f32 v60, v40, v41
    v_mfma_f32_16x16x32_bf16 v[224:227], a[208:211], v[56:59], v[224:227]
    v_exp_f32 v42, v42
    v_mfma_f32_16x16x32_bf16 v[228:231], a[212:215], v[56:59], v[228:231]
    v_add_f32 v30, v30, v42
    v_mfma_f32_16x16x32_bf16 v[232:235], a[216:219], v[56:59], v[232:235]
    v_exp_f32 v43, v43
    v_mfma_f32_16x16x32_bf16 v[236:239], a[220:223], v[56:59], v[236:239]
    s_waitcnt lgkmcnt(0)
    v_add_f32 v30, v30, v43
    v_cvt_pk_bf16_f32 v61, v42, v43
    v_mfma_f32_16x16x32_bf16 v[36:39], a[160:163], a[32:35], 0
    v_exp_f32 v44, v44
    v_mfma_f32_16x16x32_bf16 v[36:39], a[164:167], a[36:39], v[36:39]
    v_add_f32 v30, v30, v44
    v_mfma_f32_16x16x32_bf16 v[36:39], a[168:171], a[40:43], v[36:39]
    v_exp_f32 v45, v45
    v_mfma_f32_16x16x32_bf16 v[36:39], a[172:175], a[44:47], v[36:39]
    v_add_f32 v30, v30, v45
    v_cvt_pk_bf16_f32 v62, v44, v45
    v_mfma_f32_16x16x32_bf16 v[240:243], a[224:227], v[56:59], v[240:243]
    v_exp_f32 v46, v46
    v_mfma_f32_16x16x32_bf16 v[244:247], a[228:231], v[56:59], v[244:247]
    v_add_f32 v30, v30, v46
    v_mfma_f32_16x16x32_bf16 v[248:251], a[232:235], v[56:59], v[248:251]
    v_exp_f32 v47, v47
    v_mfma_f32_16x16x32_bf16 v[252:255], a[236:239], v[56:59], v[252:255]
    v_add_f32 v30, v30, v47
    v_cvt_pk_bf16_f32 v63, v46, v47
    v_mfma_f32_16x16x32_bf16 v[40:43], a[144:147], a[48:51], 0
    s_waitcnt vmcnt(2) lgkmcnt(0)
    v_exp_f32 v32, v32
    v_mfma_f32_16x16x32_bf16 v[40:43], a[148:151], a[52:55], v[40:43]
    s_barrier
    v_add_f32 v24, v24, v32
    v_mfma_f32_16x16x32_bf16 v[40:43], a[152:155], a[56:59], v[40:43]
    v_exp_f32 v33, v33
    v_mfma_f32_16x16x32_bf16 v[40:43], a[156:159], a[60:63], v[40:43]
    v_add_f32 v24, v24, v33
    v_cvt_pk_bf16_f32 v56, v32, v33
    v_mfma_f32_16x16x32_bf16 a[0:3], a[208:211], v[60:63], a[0:3]
    v_exp_f32 v34, v34
    v_mfma_f32_16x16x32_bf16 a[4:7], a[212:215], v[60:63], a[4:7]
    v_add_f32 v24, v24, v34
    v_mfma_f32_16x16x32_bf16 a[8:11], a[216:219], v[60:63], a[8:11]
    v_exp_f32 v35, v35
    v_mfma_f32_16x16x32_bf16 a[12:15], a[220:223], v[60:63], a[12:15]
    v_add_f32 v24, v24, v35
    v_cvt_pk_bf16_f32 v57, v34, v35
    v_mfma_f32_16x16x32_bf16 v[44:47], a[160:163], a[48:51], 0
    v_exp_f32 v36, v36
    v_mfma_f32_16x16x32_bf16 v[44:47], a[164:167], a[52:55], v[44:47]
    v_add_f32 v24, v24, v36
    v_mfma_f32_16x16x32_bf16 v[44:47], a[168:171], a[56:59], v[44:47]
    v_exp_f32 v37, v37
    v_mfma_f32_16x16x32_bf16 v[44:47], a[172:175], a[60:63], v[44:47]
    v_add_f32 v24, v24, v37
    v_cvt_pk_bf16_f32 v58, v36, v37
    v_mfma_f32_16x16x32_bf16 a[16:19], a[224:227], v[60:63], a[16:19]
    v_exp_f32 v38, v38
    v_mfma_f32_16x16x32_bf16 a[20:23], a[228:231], v[60:63], a[20:23]
    v_add_f32 v24, v24, v38
    v_mfma_f32_16x16x32_bf16 a[24:27], a[232:235], v[60:63], a[24:27]
    v_exp_f32 v39, v39
    v_mfma_f32_16x16x32_bf16 a[28:31], a[236:239], v[60:63], a[28:31]
    v_add_f32 v24, v24, v39
    v_cvt_pk_bf16_f32 v59, v38, v39
    v_mfma_f32_16x16x32_bf16 v[32:35], a[144:147], a[64:67], 0
    v_exp_f32 v40, v40
    v_mfma_f32_16x16x32_bf16 v[32:35], a[148:151], a[68:71], v[32:35]
    ds_read_b64_tr_b16 a[208:209], v20 offset:35840
    v_add_f32 v25, v25, v40
    v_mfma_f32_16x16x32_bf16 v[32:35], a[152:155], a[72:75], v[32:35]
    v_exp_f32 v41, v41
    v_mfma_f32_16x16x32_bf16 v[32:35], a[156:159], a[76:79], v[32:35]
    v_add_f32 v25, v25, v41
    v_cvt_pk_bf16_f32 v60, v40, v41
    v_mfma_f32_16x16x32_bf16 v[64:67], a[176:179], v[56:59], v[64:67]
    v_exp_f32 v42, v42
    v_mfma_f32_16x16x32_bf16 v[68:71], a[180:183], v[56:59], v[68:71]
    ds_read_b64_tr_b16 a[210:211], v20 offset:40448
    v_add_f32 v25, v25, v42
    v_mfma_f32_16x16x32_bf16 v[72:75], a[184:187], v[56:59], v[72:75]
    v_exp_f32 v43, v43
    v_mfma_f32_16x16x32_bf16 v[76:79], a[188:191], v[56:59], v[76:79]
    v_add_f32 v25, v25, v43
    v_cvt_pk_bf16_f32 v61, v42, v43
    v_mfma_f32_16x16x32_bf16 v[36:39], a[160:163], a[64:67], 0
    v_exp_f32 v44, v44
    v_mfma_f32_16x16x32_bf16 v[36:39], a[164:167], a[68:71], v[36:39]
    ds_read_b64_tr_b16 a[212:213], v21 offset:35840
    v_add_f32 v25, v25, v44
    v_mfma_f32_16x16x32_bf16 v[36:39], a[168:171], a[72:75], v[36:39]
    v_exp_f32 v45, v45
    v_mfma_f32_16x16x32_bf16 v[36:39], a[172:175], a[76:79], v[36:39]
    v_add_f32 v25, v25, v45
    v_cvt_pk_bf16_f32 v62, v44, v45
    v_mfma_f32_16x16x32_bf16 v[80:83], a[192:195], v[56:59], v[80:83]
    v_exp_f32 v46, v46
    v_mfma_f32_16x16x32_bf16 v[84:87], a[196:199], v[56:59], v[84:87]
    ds_read_b64_tr_b16 a[214:215], v21 offset:40448
    v_add_f32 v25, v25, v46
    v_mfma_f32_16x16x32_bf16 v[88:91], a[200:203], v[56:59], v[88:91]
    v_exp_f32 v47, v47
    v_mfma_f32_16x16x32_bf16 v[92:95], a[204:207], v[56:59], v[92:95]
    v_add_f32 v25, v25, v47
    v_cvt_pk_bf16_f32 v63, v46, v47
    v_mfma_f32_16x16x32_bf16 v[40:43], a[144:147], a[80:83], 0
    v_exp_f32 v32, v32
    v_mfma_f32_16x16x32_bf16 v[40:43], a[148:151], a[84:87], v[40:43]
    ds_read_b64_tr_b16 a[216:217], v22 offset:35840
    v_add_f32 v26, v26, v32
    v_mfma_f32_16x16x32_bf16 v[40:43], a[152:155], a[88:91], v[40:43]
    v_exp_f32 v33, v33
    s_and_b32 s22, s3, 7
    v_mfma_f32_16x16x32_bf16 v[40:43], a[156:159], a[92:95], v[40:43]
    v_add_f32 v26, v26, v33
    v_cvt_pk_bf16_f32 v56, v32, v33
    v_mfma_f32_16x16x32_bf16 v[96:99], a[176:179], v[60:63], v[96:99]
    v_exp_f32 v34, v34
    v_mfma_f32_16x16x32_bf16 v[100:103], a[180:183], v[60:63], v[100:103]
    ds_read_b64_tr_b16 a[218:219], v22 offset:40448
    v_add_f32 v26, v26, v34
    s_add_u32 s62, s33, s22
    v_mfma_f32_16x16x32_bf16 v[104:107], a[184:187], v[60:63], v[104:107]
    v_exp_f32 v35, v35
    v_mfma_f32_16x16x32_bf16 v[108:111], a[188:191], v[60:63], v[108:111]
    v_add_f32 v26, v26, v35
    v_cvt_pk_bf16_f32 v57, v34, v35
    v_mfma_f32_16x16x32_bf16 v[44:47], a[160:163], a[80:83], 0
    v_exp_f32 v36, v36
    s_and_b32 s62, s62, 0
    v_mfma_f32_16x16x32_bf16 v[44:47], a[164:167], a[84:87], v[44:47]
    ds_read_b64_tr_b16 a[220:221], v23 offset:35840
    v_add_f32 v26, v26, v36
    v_mfma_f32_16x16x32_bf16 v[44:47], a[168:171], a[88:91], v[44:47]
    v_exp_f32 v37, v37
    v_mfma_f32_16x16x32_bf16 v[44:47], a[172:175], a[92:95], v[44:47]
    v_add_f32 v26, v26, v37
    v_cvt_pk_bf16_f32 v58, v36, v37
    s_mov_b32 s59, 0
    v_mfma_f32_16x16x32_bf16 v[112:115], a[192:195], v[60:63], v[112:115]
    v_exp_f32 v38, v38
    v_mfma_f32_16x16x32_bf16 v[116:119], a[196:199], v[60:63], v[116:119]
    ds_read_b64_tr_b16 a[222:223], v23 offset:40448
    v_add_f32 v26, v26, v38
    v_mfma_f32_16x16x32_bf16 v[120:123], a[200:203], v[60:63], v[120:123]
    v_exp_f32 v39, v39
    s_mov_b32 s60, s62
    v_mfma_f32_16x16x32_bf16 v[124:127], a[204:207], v[60:63], v[124:127]
    v_add_f32 v26, v26, v39
    v_cvt_pk_bf16_f32 v59, v38, v39
    v_mfma_f32_16x16x32_bf16 v[32:35], a[144:147], a[96:99], 0
    v_exp_f32 v40, v40
    v_mfma_f32_16x16x32_bf16 v[32:35], a[148:151], a[100:103], v[32:35]
    ds_read_b64_tr_b16 a[224:225], v20 offset:35968
    v_add_f32 v27, v27, v40
    s_lshl_b32 s47, s62, 17
    v_mfma_f32_16x16x32_bf16 v[32:35], a[152:155], a[104:107], v[32:35]
    v_exp_f32 v41, v41
    v_mfma_f32_16x16x32_bf16 v[32:35], a[156:159], a[108:111], v[32:35]
    v_add_f32 v27, v27, v41
    v_cvt_pk_bf16_f32 v60, v40, v41
    v_mfma_f32_16x16x32_bf16 v[128:131], a[176:179], v[56:59], v[128:131]
    v_exp_f32 v42, v42
    s_mul_i32 s50, s28, 36864
    v_mfma_f32_16x16x32_bf16 v[132:135], a[180:183], v[56:59], v[132:135]
    ds_read_b64_tr_b16 a[226:227], v20 offset:40576
    v_add_f32 v27, v27, v42
    v_mfma_f32_16x16x32_bf16 v[136:139], a[184:187], v[56:59], v[136:139]
    v_exp_f32 v43, v43
    v_mfma_f32_16x16x32_bf16 v[140:143], a[188:191], v[56:59], v[140:143]
    v_add_f32 v27, v27, v43
    v_cvt_pk_bf16_f32 v61, v42, v43
    s_lshl_b32 s20, s28, 21
    v_mfma_f32_16x16x32_bf16 v[36:39], a[160:163], a[96:99], 0
    v_exp_f32 v44, v44
    v_mfma_f32_16x16x32_bf16 v[36:39], a[164:167], a[100:103], v[36:39]
    ds_read_b64_tr_b16 a[228:229], v21 offset:35968
    v_add_f32 v27, v27, v44
    v_mfma_f32_16x16x32_bf16 v[36:39], a[168:171], a[104:107], v[36:39]
    v_exp_f32 v45, v45
    s_lshl_b32 s23, s22, 8
    v_mfma_f32_16x16x32_bf16 v[36:39], a[172:175], a[108:111], v[36:39]
    v_add_f32 v27, v27, v45
    v_cvt_pk_bf16_f32 v62, v44, v45
    v_mfma_f32_16x16x32_bf16 v[144:147], a[192:195], v[56:59], v[144:147]
    v_exp_f32 v46, v46
    v_mfma_f32_16x16x32_bf16 v[148:151], a[196:199], v[56:59], v[148:151]
    ds_read_b64_tr_b16 a[230:231], v21 offset:40576
    v_add_f32 v27, v27, v46
    s_add_u32 s20, s20, s23
    v_mfma_f32_16x16x32_bf16 v[152:155], a[200:203], v[56:59], v[152:155]
    v_exp_f32 v47, v47
    v_mfma_f32_16x16x32_bf16 v[156:159], a[204:207], v[56:59], v[156:159]
    v_add_f32 v27, v27, v47
    v_cvt_pk_bf16_f32 v63, v46, v47
    v_mfma_f32_16x16x32_bf16 v[40:43], a[144:147], a[112:115], 0
    v_exp_f32 v32, v32
    s_add_u32 s4, s34, s20
    v_mfma_f32_16x16x32_bf16 v[40:43], a[148:151], a[116:119], v[40:43]
    ds_read_b64_tr_b16 a[232:233], v22 offset:35968
    v_add_f32 v28, v28, v32
    v_mfma_f32_16x16x32_bf16 v[40:43], a[152:155], a[120:123], v[40:43]
    v_exp_f32 v33, v33
    v_mfma_f32_16x16x32_bf16 v[40:43], a[156:159], a[124:127], v[40:43]
    v_add_f32 v28, v28, v33
    v_cvt_pk_bf16_f32 v56, v32, v33
    s_addc_u32 s5, s35, 0
    v_mfma_f32_16x16x32_bf16 v[160:163], a[176:179], v[60:63], v[160:163]
    v_exp_f32 v34, v34
    v_mfma_f32_16x16x32_bf16 v[164:167], a[180:183], v[60:63], v[164:167]
    ds_read_b64_tr_b16 a[234:235], v22 offset:40576
    v_add_f32 v28, v28, v34
    v_mfma_f32_16x16x32_bf16 v[168:171], a[184:187], v[60:63], v[168:171]
    v_exp_f32 v35, v35
    s_mov_b32 s6, 2095360
    v_mfma_f32_16x16x32_bf16 v[172:175], a[188:191], v[60:63], v[172:175]
    v_add_f32 v28, v28, v35
    v_cvt_pk_bf16_f32 v57, v34, v35
    v_mfma_f32_16x16x32_bf16 v[44:47], a[160:163], a[112:115], 0
    v_exp_f32 v36, v36
    v_mfma_f32_16x16x32_bf16 v[44:47], a[164:167], a[116:119], v[44:47]
    ds_read_b64_tr_b16 a[236:237], v23 offset:35968
    v_add_f32 v28, v28, v36
    s_mov_b32 s7, 0x20000
    v_mfma_f32_16x16x32_bf16 v[44:47], a[168:171], a[120:123], v[44:47]
    v_exp_f32 v37, v37
    v_mfma_f32_16x16x32_bf16 v[44:47], a[172:175], a[124:127], v[44:47]
    v_add_f32 v28, v28, v37
    v_cvt_pk_bf16_f32 v58, v36, v37
    v_mfma_f32_16x16x32_bf16 v[176:179], a[192:195], v[60:63], v[176:179]
    v_exp_f32 v38, v38
    v_lshrrev_b32 v1, 4, v0
    v_mfma_f32_16x16x32_bf16 v[180:183], a[196:199], v[60:63], v[180:183]
    ds_read_b64_tr_b16 a[238:239], v23 offset:40576
    v_add_f32 v28, v28, v38
    v_mfma_f32_16x16x32_bf16 v[184:187], a[200:203], v[60:63], v[184:187]
    v_exp_f32 v39, v39
    v_mfma_f32_16x16x32_bf16 v[188:191], a[204:207], v[60:63], v[188:191]
    v_add_f32 v28, v28, v39
    v_cvt_pk_bf16_f32 v59, v38, v39
    v_and_b32 v2, 15, v0
    v_mfma_f32_16x16x32_bf16 v[32:35], a[144:147], a[128:131], 0
    v_exp_f32 v40, v40
    v_mfma_f32_16x16x32_bf16 v[32:35], a[148:151], a[132:135], v[32:35]
    ds_read_b128 a[144:147], v15 offset:35840
    v_add_f32 v29, v29, v40
    v_mfma_f32_16x16x32_bf16 v[32:35], a[152:155], a[136:139], v[32:35]
    v_exp_f32 v41, v41
    s_lshl_b32 s20, s28, 2
    v_mfma_f32_16x16x32_bf16 v[32:35], a[156:159], a[140:143], v[32:35]
    ds_read_b128 a[148:151], v15 offset:35904
    v_add_f32 v29, v29, v41
    v_cvt_pk_bf16_f32 v60, v40, v41
    v_mfma_f32_16x16x32_bf16 v[192:195], a[176:179], v[56:59], v[192:195]
    v_exp_f32 v42, v42
    v_mfma_f32_16x16x32_bf16 v[196:199], a[180:183], v[56:59], v[196:199]
    ds_read_b128 a[152:155], v15 offset:35968
    v_add_f32 v29, v29, v42
    v_lshlrev_b32 v3, 1, v1
    v_mfma_f32_16x16x32_bf16 v[200:203], a[184:187], v[56:59], v[200:203]
    v_exp_f32 v43, v43
    v_mfma_f32_16x16x32_bf16 v[204:207], a[188:191], v[56:59], v[204:207]
    ds_read_b128 a[156:159], v15 offset:36032
    v_add_f32 v29, v29, v43
    v_cvt_pk_bf16_f32 v61, v42, v43
    v_mfma_f32_16x16x32_bf16 v[36:39], a[160:163], a[128:131], 0
    v_exp_f32 v44, v44
    v_xor_b32 v3, v3, v2
    v_mfma_f32_16x16x32_bf16 v[36:39], a[164:167], a[132:135], v[36:39]
    ds_read_b128 a[160:163], v15 offset:40192
    v_add_f32 v29, v29, v44
    v_mfma_f32_16x16x32_bf16 v[36:39], a[168:171], a[136:139], v[36:39]
    v_exp_f32 v45, v45
    v_mfma_f32_16x16x32_bf16 v[36:39], a[172:175], a[140:143], v[36:39]
    ds_read_b128 a[164:167], v15 offset:40256
    v_add_f32 v29, v29, v45
    v_cvt_pk_bf16_f32 v62, v44, v45
    v_xor_b32 v3, s20, v3
    v_mfma_f32_16x16x32_bf16 v[208:211], a[192:195], v[56:59], v[208:211]
    v_exp_f32 v46, v46
    v_mfma_f32_16x16x32_bf16 v[212:215], a[196:199], v[56:59], v[212:215]
    ds_read_b128 a[168:171], v15 offset:40320
    v_add_f32 v29, v29, v46
    v_mfma_f32_16x16x32_bf16 v[216:219], a[200:203], v[56:59], v[216:219]
    v_exp_f32 v47, v47
    v_lshlrev_b32 v3, 4, v3
    v_mfma_f32_16x16x32_bf16 v[220:223], a[204:207], v[56:59], v[220:223]
    s_waitcnt lgkmcnt(3)
    ds_read_b128 a[172:175], v15 offset:40384
    v_add_f32 v29, v29, v47
    v_cvt_pk_bf16_f32 v63, v46, v47
    v_mfma_f32_16x16x32_bf16 v[40:43], a[144:147], a[32:35], 0
    v_exp_f32 v32, v32
    v_mfma_f32_16x16x32_bf16 v[40:43], a[148:151], a[36:39], v[40:43]
    v_add_f32 v30, v30, v32
    v_lshl_add_u32 v5, v1, 11, v3
    v_mfma_f32_16x16x32_bf16 v[40:43], a[152:155], a[40:43], v[40:43]
    v_exp_f32 v33, v33
    v_mfma_f32_16x16x32_bf16 v[40:43], a[156:159], a[44:47], v[40:43]
    v_add_f32 v30, v30, v33
    v_cvt_pk_bf16_f32 v56, v32, v33
    v_mfma_f32_16x16x32_bf16 v[224:227], a[176:179], v[60:63], v[224:227]
    v_exp_f32 v34, v34
    v_mfma_f32_16x16x32_bf16 v[228:231], a[180:183], v[60:63], v[228:231]
    v_add_f32 v30, v30, v34
    v_mfma_f32_16x16x32_bf16 v[232:235], a[184:187], v[60:63], v[232:235]
    v_exp_f32 v35, v35
    v_mfma_f32_16x16x32_bf16 v[236:239], a[188:191], v[60:63], v[236:239]
    s_waitcnt lgkmcnt(0)
    v_add_f32 v30, v30, v35
    v_cvt_pk_bf16_f32 v57, v34, v35
    v_mfma_f32_16x16x32_bf16 v[44:47], a[160:163], a[32:35], 0
    v_exp_f32 v36, v36
    v_mfma_f32_16x16x32_bf16 v[44:47], a[164:167], a[36:39], v[44:47]
    v_add_f32 v30, v30, v36
    v_mfma_f32_16x16x32_bf16 v[44:47], a[168:171], a[40:43], v[44:47]
    v_exp_f32 v37, v37
    v_mfma_f32_16x16x32_bf16 v[44:47], a[172:175], a[44:47], v[44:47]
    v_add_f32 v30, v30, v37
    v_cvt_pk_bf16_f32 v58, v36, v37
    v_mfma_f32_16x16x32_bf16 v[240:243], a[192:195], v[60:63], v[240:243]
    v_exp_f32 v38, v38
    v_mfma_f32_16x16x32_bf16 v[244:247], a[196:199], v[60:63], v[244:247]
    v_add_f32 v30, v30, v38
    v_mfma_f32_16x16x32_bf16 v[248:251], a[200:203], v[60:63], v[248:251]
    v_exp_f32 v39, v39
    v_mfma_f32_16x16x32_bf16 v[252:255], a[204:207], v[60:63], v[252:255]
    v_add_f32 v30, v30, v39
    v_cvt_pk_bf16_f32 v59, v38, v39
    v_mfma_f32_16x16x32_bf16 v[32:35], a[144:147], a[48:51], 0
    s_waitcnt lgkmcnt(0)
    v_exp_f32 v40, v40
    v_mfma_f32_16x16x32_bf16 v[32:35], a[148:151], a[52:55], v[32:35]
    s_barrier
    v_add_f32 v24, v24, v40
    s_add_u32 m0, s50, 0
    s_nop 0
    buffer_load_dwordx4 v5, s[4:7], s47 offen lds
    v_mfma_f32_16x16x32_bf16 v[32:35], a[152:155], a[56:59], v[32:35]
    v_exp_f32 v41, v41
    v_mfma_f32_16x16x32_bf16 v[32:35], a[156:159], a[60:63], v[32:35]
    v_add_f32 v24, v24, v41
    v_cvt_pk_bf16_f32 v60, v40, v41
    s_add_u32 m0, s50, 1152
    s_add_u32 s49, s47, 8192
    buffer_load_dwordx4 v5, s[4:7], s49 offen lds
    v_mfma_f32_16x16x32_bf16 a[0:3], a[176:179], v[56:59], a[0:3]
    v_exp_f32 v42, v42
    v_mfma_f32_16x16x32_bf16 a[4:7], a[180:183], v[56:59], a[4:7]
    v_add_f32 v24, v24, v42
    s_add_u32 m0, s50, 2304
    s_add_u32 s49, s47, 16384
    buffer_load_dwordx4 v5, s[4:7], s49 offen lds
    v_mfma_f32_16x16x32_bf16 a[8:11], a[184:187], v[56:59], a[8:11]
    v_exp_f32 v43, v43
    v_mfma_f32_16x16x32_bf16 a[12:15], a[188:191], v[56:59], a[12:15]
    v_add_f32 v24, v24, v43
    v_cvt_pk_bf16_f32 v61, v42, v43
    s_add_u32 m0, s50, 3456
    s_add_u32 s49, s47, 24576
    buffer_load_dwordx4 v5, s[4:7], s49 offen lds
    v_mfma_f32_16x16x32_bf16 v[36:39], a[160:163], a[48:51], 0
    v_exp_f32 v44, v44
    v_mfma_f32_16x16x32_bf16 v[36:39], a[164:167], a[52:55], v[36:39]
    v_add_f32 v24, v24, v44
    s_add_u32 m0, s50, 4608
    s_add_u32 s49, s47, 32768
    buffer_load_dwordx4 v5, s[4:7], s49 offen lds
    v_mfma_f32_16x16x32_bf16 v[36:39], a[168:171], a[56:59], v[36:39]
    v_exp_f32 v45, v45
    v_mfma_f32_16x16x32_bf16 v[36:39], a[172:175], a[60:63], v[36:39]
    v_add_f32 v24, v24, v45
    v_cvt_pk_bf16_f32 v62, v44, v45
    s_add_u32 m0, s50, 5760
    s_add_u32 s49, s47, 40960
    buffer_load_dwordx4 v5, s[4:7], s49 offen lds
    v_mfma_f32_16x16x32_bf16 a[16:19], a[192:195], v[56:59], a[16:19]
    v_exp_f32 v46, v46
    v_mfma_f32_16x16x32_bf16 a[20:23], a[196:199], v[56:59], a[20:23]
    v_add_f32 v24, v24, v46
    s_add_u32 m0, s50, 6912
    s_add_u32 s49, s47, 49152
    buffer_load_dwordx4 v5, s[4:7], s49 offen lds
    v_mfma_f32_16x16x32_bf16 a[24:27], a[200:203], v[56:59], a[24:27]
    v_exp_f32 v47, v47
    v_mfma_f32_16x16x32_bf16 a[28:31], a[204:207], v[56:59], a[28:31]
    v_add_f32 v24, v24, v47
    v_cvt_pk_bf16_f32 v63, v46, v47
    s_add_u32 m0, s50, 8064
    s_add_u32 s49, s47, 57344
    buffer_load_dwordx4 v5, s[4:7], s49 offen lds
    v_mfma_f32_16x16x32_bf16 v[40:43], a[144:147], a[64:67], 0
    v_exp_f32 v32, v32
    v_mfma_f32_16x16x32_bf16 v[40:43], a[148:151], a[68:71], v[40:43]
    v_add_f32 v25, v25, v32
    s_add_u32 m0, s50, 9216
    s_add_u32 s49, s47, 65536
    buffer_load_dwordx4 v5, s[4:7], s49 offen lds
    v_mov_b32 v8, v24
    v_mfma_f32_16x16x32_bf16 v[40:43], a[152:155], a[72:75], v[40:43]
    v_exp_f32 v33, v33
    s_nop 1
    v_mfma_f32_16x16x32_bf16 v[40:43], a[156:159], a[76:79], v[40:43]
    v_add_f32 v25, v25, v33
    v_cvt_pk_bf16_f32 v56, v32, v33
    s_add_u32 m0, s50, 10368
    s_add_u32 s49, s47, 73728
    buffer_load_dwordx4 v5, s[4:7], s49 offen lds
    v_mfma_f32_16x16x32_bf16 v[64:67], a[208:211], v[60:63], v[64:67]
    v_exp_f32 v34, v34
    v_permlane32_swap_b32 v24, v8
    v_mfma_f32_16x16x32_bf16 v[68:71], a[212:215], v[60:63], v[68:71]
    v_add_f32 v25, v25, v34
    s_add_u32 m0, s50, 11520
    s_add_u32 s49, s47, 81920
    buffer_load_dwordx4 v5, s[4:7], s49 offen lds
    v_mfma_f32_16x16x32_bf16 v[72:75], a[216:219], v[60:63], v[72:75]
    v_exp_f32 v35, v35
    v_add_f32 v24, v24, v8
    v_mfma_f32_16x16x32_bf16 v[76:79], a[220:223], v[60:63], v[76:79]
    v_add_f32 v25, v25, v35
    v_cvt_pk_bf16_f32 v57, v34, v35
    s_add_u32 m0, s50, 12672
    s_add_u32 s49, s47, 90112
    buffer_load_dwordx4 v5, s[4:7], s49 offen lds
    v_mov_b32 v8, v24
    v_mfma_f32_16x16x32_bf16 v[44:47], a[160:163], a[64:67], 0
    v_exp_f32 v36, v36
    v_mfma_f32_16x16x32_bf16 v[44:47], a[164:167], a[68:71], v[44:47]
    v_add_f32 v25, v25, v36
    s_add_u32 m0, s50, 13824
    s_add_u32 s49, s47, 98304
    buffer_load_dwordx4 v5, s[4:7], s49 offen lds
    s_nop 1
    v_mfma_f32_16x16x32_bf16 v[44:47], a[168:171], a[72:75], v[44:47]
    v_exp_f32 v37, v37
    v_mfma_f32_16x16x32_bf16 v[44:47], a[172:175], a[76:79], v[44:47]
    v_add_f32 v25, v25, v37
    v_cvt_pk_bf16_f32 v58, v36, v37
    s_add_u32 m0, s50, 14976
    s_add_u32 s49, s47, 106496
    buffer_load_dwordx4 v5, s[4:7], s49 offen lds
    v_permlane16_swap_b32 v24, v8
    v_mfma_f32_16x16x32_bf16 v[80:83], a[224:227], v[60:63], v[80:83]
    v_exp_f32 v38, v38
    v_add_f32 v24, v24, v8
    v_mfma_f32_16x16x32_bf16 v[84:87], a[228:231], v[60:63], v[84:87]
    v_add_f32 v25, v25, v38
    s_add_u32 m0, s50, 16128
    s_add_u32 s49, s47, 114688
    buffer_load_dwordx4 v5, s[4:7], s49 offen lds
    v_mfma_f32_16x16x32_bf16 v[88:91], a[232:235], v[60:63], v[88:91]
    v_exp_f32 v39, v39
    v_rcp_f32 v48, v24
    v_mfma_f32_16x16x32_bf16 v[92:95], a[236:239], v[60:63], v[92:95]
    v_add_f32 v25, v25, v39
    v_cvt_pk_bf16_f32 v59, v38, v39
    s_add_u32 m0, s50, 17280
    s_add_u32 s49, s47, 122880
    buffer_load_dwordx4 v5, s[4:7], s49 offen lds
    v_mfma_f32_16x16x32_bf16 v[32:35], a[144:147], a[80:83], 0
    v_exp_f32 v40, v40
    v_mfma_f32_16x16x32_bf16 v[32:35], a[148:151], a[84:87], v[32:35]
    v_add_f32 v26, v26, v40
    s_mov_b32 s46, s48
    s_mul_i32 s48, s60, 14336
    v_mov_b32 v8, v25
    v_mfma_f32_16x16x32_bf16 v[32:35], a[152:155], a[88:91], v[32:35]
    v_exp_f32 v41, v41
    s_add_u32 s60, s59, 1
    s_nop 1
    v_mfma_f32_16x16x32_bf16 v[32:35], a[156:159], a[92:95], v[32:35]
    v_add_f32 v26, v26, v41
    v_cvt_pk_bf16_f32 v60, v40, v41
    s_mov_b32 s59, s60
    v_mfma_f32_16x16x32_bf16 v[96:99], a[208:211], v[56:59], v[96:99]
    v_exp_f32 v42, v42
    s_lshl_b32 s47, s60, 17
    v_permlane32_swap_b32 v25, v8
    v_mfma_f32_16x16x32_bf16 v[100:103], a[212:215], v[56:59], v[100:103]
    v_add_f32 v26, v26, v42
    v_mfma_f32_16x16x32_bf16 v[104:107], a[216:219], v[56:59], v[104:107]
    v_exp_f32 v43, v43
    v_add_f32 v25, v25, v8
    v_mfma_f32_16x16x32_bf16 v[108:111], a[220:223], v[56:59], v[108:111]
    v_add_f32 v26, v26, v43
    v_cvt_pk_bf16_f32 v61, v42, v43
    v_mov_b32 v8, v25
    v_mfma_f32_16x16x32_bf16 v[36:39], a[160:163], a[80:83], 0
    v_exp_f32 v44, v44
    v_mfma_f32_16x16x32_bf16 v[36:39], a[164:167], a[84:87], v[36:39]
    v_add_f32 v26, v26, v44
    s_nop 1
    v_mfma_f32_16x16x32_bf16 v[36:39], a[168:171], a[88:91], v[36:39]
    v_exp_f32 v45, v45
    v_mfma_f32_16x16x32_bf16 v[36:39], a[172:175], a[92:95], v[36:39]
    v_add_f32 v26, v26, v45
    v_cvt_pk_bf16_f32 v62, v44, v45
    v_permlane16_swap_b32 v25, v8
    v_mfma_f32_16x16x32_bf16 v[112:115], a[224:227], v[56:59], v[112:115]
    v_exp_f32 v46, v46
    v_add_f32 v25, v25, v8
    v_mfma_f32_16x16x32_bf16 v[116:119], a[228:231], v[56:59], v[116:119]
    v_add_f32 v26, v26, v46
    v_mfma_f32_16x16x32_bf16 v[120:123], a[232:235], v[56:59], v[120:123]
    v_exp_f32 v47, v47
    v_rcp_f32 v49, v25
    v_mfma_f32_16x16x32_bf16 v[124:127], a[236:239], v[56:59], v[124:127]
    v_add_f32 v26, v26, v47
    v_cvt_pk_bf16_f32 v63, v46, v47
    v_mfma_f32_16x16x32_bf16 v[40:43], a[144:147], a[96:99], 0
    v_exp_f32 v32, v32
    v_mfma_f32_16x16x32_bf16 v[40:43], a[148:151], a[100:103], v[40:43]
    v_add_f32 v27, v27, v32
    v_mov_b32 v8, v26
    v_mfma_f32_16x16x32_bf16 v[40:43], a[152:155], a[104:107], v[40:43]
    v_exp_f32 v33, v33
    s_nop 1
    v_mfma_f32_16x16x32_bf16 v[40:43], a[156:159], a[108:111], v[40:43]
    v_add_f32 v27, v27, v33
    v_cvt_pk_bf16_f32 v56, v32, v33
    v_mfma_f32_16x16x32_bf16 v[128:131], a[208:211], v[60:63], v[128:131]
    v_exp_f32 v34, v34
    v_permlane32_swap_b32 v26, v8
    v_mfma_f32_16x16x32_bf16 v[132:135], a[212:215], v[60:63], v[132:135]
    v_add_f32 v27, v27, v34
    v_mfma_f32_16x16x32_bf16 v[136:139], a[216:219], v[60:63], v[136:139]
    v_exp_f32 v35, v35
    v_add_f32 v26, v26, v8
    v_mfma_f32_16x16x32_bf16 v[140:143], a[220:223], v[60:63], v[140:143]
    v_add_f32 v27, v27, v35
    v_cvt_pk_bf16_f32 v57, v34, v35
    v_mov_b32 v8, v26
    v_mfma_f32_16x16x32_bf16 v[44:47], a[160:163], a[96:99], 0
    v_exp_f32 v36, v36
    v_mfma_f32_16x16x32_bf16 v[44:47], a[164:167], a[100:103], v[44:47]
    v_add_f32 v27, v27, v36
    s_nop 1
    v_mfma_f32_16x16x32_bf16 v[44:47], a[168:171], a[104:107], v[44:47]
    v_exp_f32 v37, v37
    v_mfma_f32_16x16x32_bf16 v[44:47], a[172:175], a[108:111], v[44:47]
    v_add_f32 v27, v27, v37
    v_cvt_pk_bf16_f32 v58, v36, v37
    v_permlane16_swap_b32 v26, v8
    v_mfma_f32_16x16x32_bf16 v[144:147], a[224:227], v[60:63], v[144:147]
    v_exp_f32 v38, v38
    v_add_f32 v26, v26, v8
    v_mfma_f32_16x16x32_bf16 v[148:151], a[228:231], v[60:63], v[148:151]
    v_add_f32 v27, v27, v38
    v_mfma_f32_16x16x32_bf16 v[152:155], a[232:235], v[60:63], v[152:155]
    v_exp_f32 v39, v39
    v_rcp_f32 v50, v26
    v_mfma_f32_16x16x32_bf16 v[156:159], a[236:239], v[60:63], v[156:159]
    v_add_f32 v27, v27, v39
    v_cvt_pk_bf16_f32 v59, v38, v39
    v_mfma_f32_16x16x32_bf16 v[32:35], a[144:147], a[112:115], 0
    v_exp_f32 v40, v40
    v_mfma_f32_16x16x32_bf16 v[32:35], a[148:151], a[116:119], v[32:35]
    v_add_f32 v28, v28, v40
    v_mov_b32 v8, v27
    v_mfma_f32_16x16x32_bf16 v[32:35], a[152:155], a[120:123], v[32:35]
    v_exp_f32 v41, v41
    s_nop 1
    v_mfma_f32_16x16x32_bf16 v[32:35], a[156:159], a[124:127], v[32:35]
    v_add_f32 v28, v28, v41
    v_cvt_pk_bf16_f32 v60, v40, v41
    v_mfma_f32_16x16x32_bf16 v[160:163], a[208:211], v[56:59], v[160:163]
    v_exp_f32 v42, v42
    v_permlane32_swap_b32 v27, v8
    v_mfma_f32_16x16x32_bf16 v[164:167], a[212:215], v[56:59], v[164:167]
    v_add_f32 v28, v28, v42
    v_mfma_f32_16x16x32_bf16 v[168:171], a[216:219], v[56:59], v[168:171]
    v_exp_f32 v43, v43
    v_add_f32 v27, v27, v8
    v_mfma_f32_16x16x32_bf16 v[172:175], a[220:223], v[56:59], v[172:175]
    v_add_f32 v28, v28, v43
    v_cvt_pk_bf16_f32 v61, v42, v43
    v_mov_b32 v8, v27
    v_mfma_f32_16x16x32_bf16 v[36:39], a[160:163], a[112:115], 0
    v_exp_f32 v44, v44
    v_mfma_f32_16x16x32_bf16 v[36:39], a[164:167], a[116:119], v[36:39]
    v_add_f32 v28, v28, v44
    s_nop 1
    v_mfma_f32_16x16x32_bf16 v[36:39], a[168:171], a[120:123], v[36:39]
    v_exp_f32 v45, v45
    v_mfma_f32_16x16x32_bf16 v[36:39], a[172:175], a[124:127], v[36:39]
    v_add_f32 v28, v28, v45
    v_cvt_pk_bf16_f32 v62, v44, v45
    v_permlane16_swap_b32 v27, v8
    v_mfma_f32_16x16x32_bf16 v[176:179], a[224:227], v[56:59], v[176:179]
    v_exp_f32 v46, v46
    v_add_f32 v27, v27, v8
    v_mfma_f32_16x16x32_bf16 v[180:183], a[228:231], v[56:59], v[180:183]
    v_add_f32 v28, v28, v46
    v_mfma_f32_16x16x32_bf16 v[184:187], a[232:235], v[56:59], v[184:187]
    v_exp_f32 v47, v47
    v_rcp_f32 v51, v27
    v_mfma_f32_16x16x32_bf16 v[188:191], a[236:239], v[56:59], v[188:191]
    v_add_f32 v28, v28, v47
    v_cvt_pk_bf16_f32 v63, v46, v47
    v_mfma_f32_16x16x32_bf16 v[40:43], a[144:147], a[128:131], 0
    v_exp_f32 v32, v32
    v_mfma_f32_16x16x32_bf16 v[40:43], a[148:151], a[132:135], v[40:43]
    v_add_f32 v29, v29, v32
    v_mov_b32 v8, v28
    v_mfma_f32_16x16x32_bf16 v[40:43], a[152:155], a[136:139], v[40:43]
    v_exp_f32 v33, v33
    s_nop 1
    v_mfma_f32_16x16x32_bf16 v[40:43], a[156:159], a[140:143], v[40:43]
    v_add_f32 v29, v29, v33
    v_cvt_pk_bf16_f32 v56, v32, v33
    v_mfma_f32_16x16x32_bf16 v[192:195], a[208:211], v[60:63], v[192:195]
    v_exp_f32 v34, v34
    v_permlane32_swap_b32 v28, v8
    v_mfma_f32_16x16x32_bf16 v[196:199], a[212:215], v[60:63], v[196:199]
    v_add_f32 v29, v29, v34
    v_mfma_f32_16x16x32_bf16 v[200:203], a[216:219], v[60:63], v[200:203]
    v_exp_f32 v35, v35
    v_add_f32 v28, v28, v8
    v_mfma_f32_16x16x32_bf16 v[204:207], a[220:223], v[60:63], v[204:207]
    v_add_f32 v29, v29, v35
    v_cvt_pk_bf16_f32 v57, v34, v35
    v_mov_b32 v8, v28
    v_mfma_f32_16x16x32_bf16 v[44:47], a[160:163], a[128:131], 0
    v_exp_f32 v36, v36
    v_mfma_f32_16x16x32_bf16 v[44:47], a[164:167], a[132:135], v[44:47]
    v_add_f32 v29, v29, v36
    s_nop 1
    v_mfma_f32_16x16x32_bf16 v[44:47], a[168:171], a[136:139], v[44:47]
    v_exp_f32 v37, v37
    v_mfma_f32_16x16x32_bf16 v[44:47], a[172:175], a[140:143], v[44:47]
    v_add_f32 v29, v29, v37
    v_cvt_pk_bf16_f32 v58, v36, v37
    v_permlane16_swap_b32 v28, v8
    v_mfma_f32_16x16x32_bf16 v[208:211], a[224:227], v[60:63], v[208:211]
    v_exp_f32 v38, v38
    v_add_f32 v28, v28, v8
    v_mfma_f32_16x16x32_bf16 v[212:215], a[228:231], v[60:63], v[212:215]
    v_add_f32 v29, v29, v38
    v_mfma_f32_16x16x32_bf16 v[216:219], a[232:235], v[60:63], v[216:219]
    v_exp_f32 v39, v39
    v_rcp_f32 v52, v28
    v_mfma_f32_16x16x32_bf16 v[220:223], a[236:239], v[60:63], v[220:223]
    v_add_f32 v29, v29, v39
    v_cvt_pk_bf16_f32 v59, v38, v39
    s_nop 1
    v_mfma_f32_16x16x32_bf16 v[224:227], a[208:211], v[56:59], v[224:227]
    v_exp_f32 v40, v40
    s_nop 0
    v_add_f32 v30, v30, v40
    v_mfma_f32_16x16x32_bf16 v[228:231], a[212:215], v[56:59], v[228:231]
    v_exp_f32 v41, v41
    s_nop 0
    v_add_f32 v30, v30, v41
    v_cvt_pk_bf16_f32 v60, v40, v41
    v_mov_b32 v8, v29
    s_nop 1
    v_mfma_f32_16x16x32_bf16 v[232:235], a[216:219], v[56:59], v[232:235]
    v_exp_f32 v42, v42
    s_nop 0
    v_add_f32 v30, v30, v42
    v_permlane32_swap_b32 v29, v8
    v_mfma_f32_16x16x32_bf16 v[236:239], a[220:223], v[56:59], v[236:239]
    v_exp_f32 v43, v43
    s_nop 0
    v_add_f32 v30, v30, v43
    v_cvt_pk_bf16_f32 v61, v42, v43
    v_add_f32 v29, v29, v8
    v_mfma_f32_16x16x32_bf16 v[240:243], a[224:227], v[56:59], v[240:243]
    v_exp_f32 v44, v44
    s_nop 0
    v_add_f32 v30, v30, v44
    v_mov_b32 v8, v29
    s_nop 1
    v_mfma_f32_16x16x32_bf16 v[244:247], a[228:231], v[56:59], v[244:247]
    v_exp_f32 v45, v45
    s_nop 0
    v_add_f32 v30, v30, v45
    v_cvt_pk_bf16_f32 v62, v44, v45
    v_permlane16_swap_b32 v29, v8
    v_mfma_f32_16x16x32_bf16 v[248:251], a[232:235], v[56:59], v[248:251]
    v_exp_f32 v46, v46
    s_nop 0
    v_add_f32 v30, v30, v46
    v_add_f32 v29, v29, v8
    v_mfma_f32_16x16x32_bf16 v[252:255], a[236:239], v[56:59], v[252:255]
    v_exp_f32 v47, v47
    s_nop 0
    v_add_f32 v30, v30, v47
    v_cvt_pk_bf16_f32 v63, v46, v47
    v_rcp_f32 v53, v29
    s_nop 1
    v_mfma_f32_16x16x32_bf16 a[0:3], a[208:211], v[60:63], a[0:3]
    v_mfma_f32_16x16x32_bf16 a[4:7], a[212:215], v[60:63], a[4:7]
    v_mfma_f32_16x16x32_bf16 a[8:11], a[216:219], v[60:63], a[8:11]
    v_mfma_f32_16x16x32_bf16 a[12:15], a[220:223], v[60:63], a[12:15]
    v_mfma_f32_16x16x32_bf16 a[16:19], a[224:227], v[60:63], a[16:19]
    v_mfma_f32_16x16x32_bf16 a[20:23], a[228:231], v[60:63], a[20:23]
    v_mfma_f32_16x16x32_bf16 a[24:27], a[232:235], v[60:63], a[24:27]
    v_mfma_f32_16x16x32_bf16 a[28:31], a[236:239], v[60:63], a[28:31]
    v_mov_b32 v32, v48
    v_mov_b32 v34, v49
    v_mov_b32 v36, v50
    v_mov_b32 v38, v51
    v_mov_b32 v40, v52
    v_mov_b32 v42, v53
    v_mov_b32 v45, v30
    s_nop 1
    v_permlane32_swap_b32 v30, v45
    v_add_f32 v30, v30, v45
    v_mov_b32 v45, v30
    s_nop 1
    v_permlane16_swap_b32 v30, v45
    v_add_f32 v30, v30, v45
    v_min3_f32 v48, v24, v25, v26
    v_max3_f32 v49, v24, v25, v26
    v_min3_f32 v48, v48, v27, v28
    v_max3_f32 v49, v49, v27, v28
    v_min3_f32 v48, v48, v29, v30
    v_max3_f32 v49, v49, v29, v30
    v_cmp_nle_f32 vcc, 729808896, v48
    s_lshl_b32 s22, s28, 2
    s_add_u32 s22, s22, 163824
    s_mov_b64 s[20:21], vcc
    v_cmp_nge_f32 vcc, 1400897536, v49
    v_mov_b32 v50, s22
    v_mov_b32 v60, 163824
    s_or_b64 s[20:21], s[20:21], vcc
    s_cselect_b32 s22, 1, 0
    v_mov_b32 v51, s22
    ds_write_b32 v50, v51
    v_rcp_f32 v44, v30
    s_waitcnt lgkmcnt(0)
    s_barrier
    ds_read_b128 v[56:59], v60
    v_pk_mul_f32 v[64:65], v[64:65], v[32:33] op_sel_hi:[1,0]
    v_pk_mul_f32 v[66:67], v[66:67], v[32:33] op_sel_hi:[1,0]
    v_pk_mul_f32 v[68:69], v[68:69], v[32:33] op_sel_hi:[1,0]
    v_pk_mul_f32 v[70:71], v[70:71], v[32:33] op_sel_hi:[1,0]
    v_pk_mul_f32 v[72:73], v[72:73], v[32:33] op_sel_hi:[1,0]
    v_pk_mul_f32 v[74:75], v[74:75], v[32:33] op_sel_hi:[1,0]
    v_pk_mul_f32 v[76:77], v[76:77], v[32:33] op_sel_hi:[1,0]
    v_pk_mul_f32 v[78:79], v[78:79], v[32:33] op_sel_hi:[1,0]
    v_cvt_pk_bf16_f32 v48, v64, v65
    v_cvt_pk_bf16_f32 v49, v66, v67
    v_cvt_pk_bf16_f32 v50, v68, v69
    v_cvt_pk_bf16_f32 v51, v70, v71
    s_mov_b32 s58, 0
    buffer_store_dwordx4 v[48:51], v31, s[16:19], s58 offen sc1
    v_pk_mul_f32 v[80:81], v[80:81], v[32:33] op_sel_hi:[1,0]
    v_pk_mul_f32 v[82:83], v[82:83], v[32:33] op_sel_hi:[1,0]
    v_pk_mul_f32 v[84:85], v[84:85], v[32:33] op_sel_hi:[1,0]
    v_pk_mul_f32 v[86:87], v[86:87], v[32:33] op_sel_hi:[1,0]
    v_cvt_pk_bf16_f32 v52, v72, v73
    v_cvt_pk_bf16_f32 v53, v74, v75
    v_cvt_pk_bf16_f32 v54, v76, v77
    v_cvt_pk_bf16_f32 v55, v78, v79
    s_mov_b32 s58, 4096
    buffer_store_dwordx4 v[52:55], v31, s[16:19], s58 offen offset:3072 sc1
    v_pk_mul_f32 v[88:89], v[88:89], v[32:33] op_sel_hi:[1,0]
    v_pk_mul_f32 v[90:91], v[90:91], v[32:33] op_sel_hi:[1,0]
    v_pk_mul_f32 v[92:93], v[92:93], v[32:33] op_sel_hi:[1,0]
    v_pk_mul_f32 v[94:95], v[94:95], v[32:33] op_sel_hi:[1,0]
    v_cvt_pk_bf16_f32 v48, v80, v81
    v_cvt_pk_bf16_f32 v49, v82, v83
    v_cvt_pk_bf16_f32 v50, v84, v85
    v_cvt_pk_bf16_f32 v51, v86, v87
    s_mov_b32 s58, 12288
    buffer_store_dwordx4 v[48:51], v31, s[16:19], s58 offen offset:2048 sc1
    v_pk_mul_f32 v[96:97], v[96:97], v[34:35] op_sel_hi:[1,0]
    v_pk_mul_f32 v[98:99], v[98:99], v[34:35] op_sel_hi:[1,0]
    v_pk_mul_f32 v[100:101], v[100:101], v[34:35] op_sel_hi:[1,0]
    v_pk_mul_f32 v[102:103], v[102:103], v[34:35] op_sel_hi:[1,0]
    v_cvt_pk_bf16_f32 v52, v88, v89
    v_cvt_pk_bf16_f32 v53, v90, v91
    v_cvt_pk_bf16_f32 v54, v92, v93
    v_cvt_pk_bf16_f32 v55, v94, v95
    s_mov_b32 s58, 20480
    buffer_store_dwordx4 v[52:55], v31, s[16:19], s58 offen offset:1024 sc1
    v_pk_mul_f32 v[104:105], v[104:105], v[34:35] op_sel_hi:[1,0]
    v_pk_mul_f32 v[106:107], v[106:107], v[34:35] op_sel_hi:[1,0]
    v_pk_mul_f32 v[108:109], v[108:109], v[34:35] op_sel_hi:[1,0]
    v_pk_mul_f32 v[110:111], v[110:111], v[34:35] op_sel_hi:[1,0]
    v_cvt_pk_bf16_f32 v48, v96, v97
    v_cvt_pk_bf16_f32 v49, v98, v99
    v_cvt_pk_bf16_f32 v50, v100, v101
    v_cvt_pk_bf16_f32 v51, v102, v103
    s_waitcnt lgkmcnt(0)
    v_or3_b32 v56, v56, v57, v58
    v_or_b32 v56, v56, v59
    s_nop 0
    v_readfirstlane_b32 s22, v56
    s_nop 0
    s_cmp_lg_u32 s22, 0
    s_cbranch_scc1 L_slow
    s_mov_b32 s58, 0
    buffer_store_dwordx4 v[48:51], v31, s[16:19], s58 offen offset:1024 sc1
    v_pk_mul_f32 v[112:113], v[112:113], v[34:35] op_sel_hi:[1,0]
    v_pk_mul_f32 v[114:115], v[114:115], v[34:35] op_sel_hi:[1,0]
    v_pk_mul_f32 v[116:117], v[116:117], v[34:35] op_sel_hi:[1,0]
    v_pk_mul_f32 v[118:119], v[118:119], v[34:35] op_sel_hi:[1,0]
    v_cvt_pk_bf16_f32 v52, v104, v105
    v_cvt_pk_bf16_f32 v53, v106, v107
    v_cvt_pk_bf16_f32 v54, v108, v109
    v_cvt_pk_bf16_f32 v55, v110, v111
    s_mov_b32 s58, 8192
    buffer_store_dwordx4 v[52:55], v31, s[16:19], s58 offen sc1
    v_pk_mul_f32 v[120:121], v[120:121], v[34:35] op_sel_hi:[1,0]
    v_pk_mul_f32 v[122:123], v[122:123], v[34:35] op_sel_hi:[1,0]
    v_pk_mul_f32 v[124:125], v[124:125], v[34:35] op_sel_hi:[1,0]
    v_pk_mul_f32 v[126:127], v[126:127], v[34:35] op_sel_hi:[1,0]
    v_cvt_pk_bf16_f32 v48, v112, v113
    v_cvt_pk_bf16_f32 v49, v114, v115
    v_cvt_pk_bf16_f32 v50, v116, v117
    v_cvt_pk_bf16_f32 v51, v118, v119
    s_mov_b32 s58, 12288
    buffer_store_dwordx4 v[48:51], v31, s[16:19], s58 offen offset:3072 sc1
    v_pk_mul_f32 v[128:129], v[128:129], v[36:37] op_sel_hi:[1,0]
    v_pk_mul_f32 v[130:131], v[130:131], v[36:37] op_sel_hi:[1,0]
    v_pk_mul_f32 v[132:133], v[132:133], v[36:37] op_sel_hi:[1,0]
    v_pk_mul_f32 v[134:135], v[134:135], v[36:37] op_sel_hi:[1,0]
    v_cvt_pk_bf16_f32 v52, v120, v121
    v_cvt_pk_bf16_f32 v53, v122, v123
    v_cvt_pk_bf16_f32 v54, v124, v125
    v_cvt_pk_bf16_f32 v55, v126, v127
    s_mov_b32 s58, 20480
    buffer_store_dwordx4 v[52:55], v31, s[16:19], s58 offen offset:2048 sc1
    v_pk_mul_f32 v[136:137], v[136:137], v[36:37] op_sel_hi:[1,0]
    v_pk_mul_f32 v[138:139], v[138:139], v[36:37] op_sel_hi:[1,0]
    v_pk_mul_f32 v[140:141], v[140:141], v[36:37] op_sel_hi:[1,0]
    v_pk_mul_f32 v[142:143], v[142:143], v[36:37] op_sel_hi:[1,0]
    v_cvt_pk_bf16_f32 v48, v128, v129
    v_cvt_pk_bf16_f32 v49, v130, v131
    v_cvt_pk_bf16_f32 v50, v132, v133
    v_cvt_pk_bf16_f32 v51, v134, v135
    s_mov_b32 s58, 0
    buffer_store_dwordx4 v[48:51], v31, s[16:19], s58 offen offset:2048 sc1
    v_pk_mul_f32 v[144:145], v[144:145], v[36:37] op_sel_hi:[1,0]
    v_pk_mul_f32 v[146:147], v[146:147], v[36:37] op_sel_hi:[1,0]
    v_pk_mul_f32 v[148:149], v[148:149], v[36:37] op_sel_hi:[1,0]
    v_pk_mul_f32 v[150:151], v[150:151], v[36:37] op_sel_hi:[1,0]
    v_cvt_pk_bf16_f32 v52, v136, v137
    v_cvt_pk_bf16_f32 v53, v138, v139
    v_cvt_pk_bf16_f32 v54, v140, v141
    v_cvt_pk_bf16_f32 v55, v142, v143
    s_mov_b32 s58, 8192
    buffer_store_dwordx4 v[52:55], v31, s[16:19], s58 offen offset:1024 sc1
    v_pk_mul_f32 v[152:153], v[152:153], v[36:37] op_sel_hi:[1,0]
    v_pk_mul_f32 v[154:155], v[154:155], v[36:37] op_sel_hi:[1,0]
    v_pk_mul_f32 v[156:157], v[156:157], v[36:37] op_sel_hi:[1,0]
    v_pk_mul_f32 v[158:159], v[158:159], v[36:37] op_sel_hi:[1,0]
    v_cvt_pk_bf16_f32 v48, v144, v145
    v_cvt_pk_bf16_f32 v49, v146, v147
    v_cvt_pk_bf16_f32 v50, v148, v149
    v_cvt_pk_bf16_f32 v51, v150, v151
    s_mov_b32 s58, 16384
    buffer_store_dwordx4 v[48:51], v31, s[16:19], s58 offen sc1
    v_pk_mul_f32 v[160:161], v[160:161], v[38:39] op_sel_hi:[1,0]
    v_pk_mul_f32 v[162:163], v[162:163], v[38:39] op_sel_hi:[1,0]
    v_pk_mul_f32 v[164:165], v[164:165], v[38:39] op_sel_hi:[1,0]
    v_pk_mul_f32 v[166:167], v[166:167], v[38:39] op_sel_hi:[1,0]
    v_cvt_pk_bf16_f32 v52, v152, v153
    v_cvt_pk_bf16_f32 v53, v154, v155
    v_cvt_pk_bf16_f32 v54, v156, v157
    v_cvt_pk_bf16_f32 v55, v158, v159
    s_mov_b32 s58, 20480
    buffer_store_dwordx4 v[52:55], v31, s[16:19], s58 offen offset:3072 sc1
    v_pk_mul_f32 v[168:169], v[168:169], v[38:39] op_sel_hi:[1,0]
    v_pk_mul_f32 v[170:171], v[170:171], v[38:39] op_sel_hi:[1,0]
    v_pk_mul_f32 v[172:173], v[172:173], v[38:39] op_sel_hi:[1,0]
    v_pk_mul_f32 v[174:175], v[174:175], v[38:39] op_sel_hi:[1,0]
    v_cvt_pk_bf16_f32 v48, v160, v161
    v_cvt_pk_bf16_f32 v49, v162, v163
    v_cvt_pk_bf16_f32 v50, v164, v165
    v_cvt_pk_bf16_f32 v51, v166, v167
    s_mov_b32 s58, 0
    buffer_store_dwordx4 v[48:51], v31, s[16:19], s58 offen offset:3072 sc1
    v_pk_mul_f32 v[176:177], v[176:177], v[38:39] op_sel_hi:[1,0]
    v_pk_mul_f32 v[178:179], v[178:179], v[38:39] op_sel_hi:[1,0]
    v_pk_mul_f32 v[180:181], v[180:181], v[38:39] op_sel_hi:[1,0]
    v_pk_mul_f32 v[182:183], v[182:183], v[38:39] op_sel_hi:[1,0]
    v_cvt_pk_bf16_f32 v52, v168, v169
    v_cvt_pk_bf16_f32 v53, v170, v171
    v_cvt_pk_bf16_f32 v54, v172, v173
    v_cvt_pk_bf16_f32 v55, v174, v175
    s_mov_b32 s58, 8192
    buffer_store_dwordx4 v[52:55], v31, s[16:19], s58 offen offset:2048 sc1
    v_pk_mul_f32 v[184:185], v[184:185], v[38:39] op_sel_hi:[1,0]
    v_pk_mul_f32 v[186:187], v[186:187], v[38:39] op_sel_hi:[1,0]
    v_pk_mul_f32 v[188:189], v[188:189], v[38:39] op_sel_hi:[1,0]
    v_pk_mul_f32 v[190:191], v[190:191], v[38:39] op_sel_hi:[1,0]
    v_cvt_pk_bf16_f32 v48, v176, v177
    v_cvt_pk_bf16_f32 v49, v178, v179
    v_cvt_pk_bf16_f32 v50, v180, v181
    v_cvt_pk_bf16_f32 v51, v182, v183
    s_mov_b32 s58, 16384
    buffer_store_dwordx4 v[48:51], v31, s[16:19], s58 offen offset:1024 sc1
    v_pk_mul_f32 v[192:193], v[192:193], v[40:41] op_sel_hi:[1,0]
    v_pk_mul_f32 v[194:195], v[194:195], v[40:41] op_sel_hi:[1,0]
    v_pk_mul_f32 v[196:197], v[196:197], v[40:41] op_sel_hi:[1,0]
    v_pk_mul_f32 v[198:199], v[198:199], v[40:41] op_sel_hi:[1,0]
    v_cvt_pk_bf16_f32 v52, v184, v185
    v_cvt_pk_bf16_f32 v53, v186, v187
    v_cvt_pk_bf16_f32 v54, v188, v189
    v_cvt_pk_bf16_f32 v55, v190, v191
    s_mov_b32 s58, 24576
    buffer_store_dwordx4 v[52:55], v31, s[16:19], s58 offen sc1
    v_pk_mul_f32 v[200:201], v[200:201], v[40:41] op_sel_hi:[1,0]
    v_pk_mul_f32 v[202:203], v[202:203], v[40:41] op_sel_hi:[1,0]
    v_pk_mul_f32 v[204:205], v[204:205], v[40:41] op_sel_hi:[1,0]
    v_pk_mul_f32 v[206:207], v[206:207], v[40:41] op_sel_hi:[1,0]
    v_cvt_pk_bf16_f32 v48, v192, v193
    v_cvt_pk_bf16_f32 v49, v194, v195
    v_cvt_pk_bf16_f32 v50, v196, v197
    v_cvt_pk_bf16_f32 v51, v198, v199
    s_mov_b32 s58, 4096
    buffer_store_dwordx4 v[48:51], v31, s[16:19], s58 offen sc1
    v_pk_mul_f32 v[208:209], v[208:209], v[40:41] op_sel_hi:[1,0]
    v_pk_mul_f32 v[210:211], v[210:211], v[40:41] op_sel_hi:[1,0]
    v_pk_mul_f32 v[212:213], v[212:213], v[40:41] op_sel_hi:[1,0]
    v_pk_mul_f32 v[214:215], v[214:215], v[40:41] op_sel_hi:[1,0]
    v_cvt_pk_bf16_f32 v52, v200, v201
    v_cvt_pk_bf16_f32 v53, v202, v203
    v_cvt_pk_bf16_f32 v54, v204, v205
    v_cvt_pk_bf16_f32 v55, v206, v207
    s_mov_b32 s58, 8192
    buffer_store_dwordx4 v[52:55], v31, s[16:19], s58 offen offset:3072 sc1
    v_pk_mul_f32 v[216:217], v[216:217], v[40:41] op_sel_hi:[1,0]
    v_pk_mul_f32 v[218:219], v[218:219], v[40:41] op_sel_hi:[1,0]
    v_pk_mul_f32 v[220:221], v[220:221], v[40:41] op_sel_hi:[1,0]
    v_pk_mul_f32 v[222:223], v[222:223], v[40:41] op_sel_hi:[1,0]
    v_cvt_pk_bf16_f32 v48, v208, v209
    v_cvt_pk_bf16_f32 v49, v210, v211
    v_cvt_pk_bf16_f32 v50, v212, v213
    v_cvt_pk_bf16_f32 v51, v214, v215
    s_mov_b32 s58, 16384
    buffer_store_dwordx4 v[48:51], v31, s[16:19], s58 offen offset:2048 sc1
    v_accvgpr_read_b32 v64, a0
    v_accvgpr_read_b32 v65, a1
    v_accvgpr_read_b32 v66, a2
    v_accvgpr_read_b32 v67, a3
    v_accvgpr_read_b32 v68, a4
    v_accvgpr_read_b32 v69, a5
    v_accvgpr_read_b32 v70, a6
    v_accvgpr_read_b32 v71, a7
    v_pk_mul_f32 v[224:225], v[224:225], v[42:43] op_sel_hi:[1,0]
    v_pk_mul_f32 v[226:227], v[226:227], v[42:43] op_sel_hi:[1,0]
    v_pk_mul_f32 v[228:229], v[228:229], v[42:43] op_sel_hi:[1,0]
    v_pk_mul_f32 v[230:231], v[230:231], v[42:43] op_sel_hi:[1,0]
    v_cvt_pk_bf16_f32 v52, v216, v217
    v_cvt_pk_bf16_f32 v53, v218, v219
    v_cvt_pk_bf16_f32 v54, v220, v221
    v_cvt_pk_bf16_f32 v55, v222, v223
    s_mov_b32 s58, 24576
    buffer_store_dwordx4 v[52:55], v31, s[16:19], s58 offen offset:1024 sc1
    v_accvgpr_read_b32 v72, a8
    v_accvgpr_read_b32 v73, a9
    v_accvgpr_read_b32 v74, a10
    v_accvgpr_read_b32 v75, a11
    v_accvgpr_read_b32 v76, a12
    v_accvgpr_read_b32 v77, a13
    v_accvgpr_read_b32 v78, a14
    v_accvgpr_read_b32 v79, a15
    v_pk_mul_f32 v[232:233], v[232:233], v[42:43] op_sel_hi:[1,0]
    v_pk_mul_f32 v[234:235], v[234:235], v[42:43] op_sel_hi:[1,0]
    v_pk_mul_f32 v[236:237], v[236:237], v[42:43] op_sel_hi:[1,0]
    v_pk_mul_f32 v[238:239], v[238:239], v[42:43] op_sel_hi:[1,0]
    v_cvt_pk_bf16_f32 v48, v224, v225
    v_cvt_pk_bf16_f32 v49, v226, v227
    v_cvt_pk_bf16_f32 v50, v228, v229
    v_cvt_pk_bf16_f32 v51, v230, v231
    s_mov_b32 s58, 4096
    buffer_store_dwordx4 v[48:51], v31, s[16:19], s58 offen offset:1024 sc1
    v_accvgpr_read_b32 v80, a16
    v_accvgpr_read_b32 v81, a17
    v_accvgpr_read_b32 v82, a18
    v_accvgpr_read_b32 v83, a19
    v_accvgpr_read_b32 v84, a20
    v_accvgpr_read_b32 v85, a21
    v_accvgpr_read_b32 v86, a22
    v_accvgpr_read_b32 v87, a23
    v_pk_mul_f32 v[240:241], v[240:241], v[42:43] op_sel_hi:[1,0]
    v_pk_mul_f32 v[242:243], v[242:243], v[42:43] op_sel_hi:[1,0]
    v_pk_mul_f32 v[244:245], v[244:245], v[42:43] op_sel_hi:[1,0]
    v_pk_mul_f32 v[246:247], v[246:247], v[42:43] op_sel_hi:[1,0]
    v_cvt_pk_bf16_f32 v52, v232, v233
    v_cvt_pk_bf16_f32 v53, v234, v235
    v_cvt_pk_bf16_f32 v54, v236, v237
    v_cvt_pk_bf16_f32 v55, v238, v239
    s_mov_b32 s58, 12288
    buffer_store_dwordx4 v[52:55], v31, s[16:19], s58 offen sc1
    v_accvgpr_read_b32 v88, a24
    v_accvgpr_read_b32 v89, a25
    v_accvgpr_read_b32 v90, a26
    v_accvgpr_read_b32 v91, a27
    v_accvgpr_read_b32 v92, a28
    v_accvgpr_read_b32 v93, a29
    v_accvgpr_read_b32 v94, a30
    v_accvgpr_read_b32 v95, a31
    v_pk_mul_f32 v[248:249], v[248:249], v[42:43] op_sel_hi:[1,0]
    v_pk_mul_f32 v[250:251], v[250:251], v[42:43] op_sel_hi:[1,0]
    v_pk_mul_f32 v[252:253], v[252:253], v[42:43] op_sel_hi:[1,0]
    v_pk_mul_f32 v[254:255], v[254:255], v[42:43] op_sel_hi:[1,0]
    v_cvt_pk_bf16_f32 v48, v240, v241
    v_cvt_pk_bf16_f32 v49, v242, v243
    v_cvt_pk_bf16_f32 v50, v244, v245
    v_cvt_pk_bf16_f32 v51, v246, v247
    s_mov_b32 s58, 16384
    buffer_store_dwordx4 v[48:51], v31, s[16:19], s58 offen offset:3072 sc1
    v_pk_mul_f32 v[64:65], v[64:65], v[44:45] op_sel_hi:[1,0]
    v_pk_mul_f32 v[66:67], v[66:67], v[44:45] op_sel_hi:[1,0]
    v_pk_mul_f32 v[68:69], v[68:69], v[44:45] op_sel_hi:[1,0]
    v_pk_mul_f32 v[70:71], v[70:71], v[44:45] op_sel_hi:[1,0]
    v_cvt_pk_bf16_f32 v52, v248, v249
    v_cvt_pk_bf16_f32 v53, v250, v251
    v_cvt_pk_bf16_f32 v54, v252, v253
    v_cvt_pk_bf16_f32 v55, v254, v255
    s_mov_b32 s58, 24576
    buffer_store_dwordx4 v[52:55], v31, s[16:19], s58 offen offset:2048 sc1
    v_pk_mul_f32 v[72:73], v[72:73], v[44:45] op_sel_hi:[1,0]
    v_pk_mul_f32 v[74:75], v[74:75], v[44:45] op_sel_hi:[1,0]
    v_pk_mul_f32 v[76:77], v[76:77], v[44:45] op_sel_hi:[1,0]
    v_pk_mul_f32 v[78:79], v[78:79], v[44:45] op_sel_hi:[1,0]
    v_cvt_pk_bf16_f32 v48, v64, v65
    v_cvt_pk_bf16_f32 v49, v66, v67
    v_cvt_pk_bf16_f32 v50, v68, v69
    v_cvt_pk_bf16_f32 v51, v70, v71
    s_mov_b32 s58, 4096
    buffer_store_dwordx4 v[48:51], v31, s[16:19], s58 offen offset:2048 sc1
    v_pk_mul_f32 v[80:81], v[80:81], v[44:45] op_sel_hi:[1,0]
    v_pk_mul_f32 v[82:83], v[82:83], v[44:45] op_sel_hi:[1,0]
    v_pk_mul_f32 v[84:85], v[84:85], v[44:45] op_sel_hi:[1,0]
    v_pk_mul_f32 v[86:87], v[86:87], v[44:45] op_sel_hi:[1,0]
    v_cvt_pk_bf16_f32 v52, v72, v73
    v_cvt_pk_bf16_f32 v53, v74, v75
    v_cvt_pk_bf16_f32 v54, v76, v77
    v_cvt_pk_bf16_f32 v55, v78, v79
    s_mov_b32 s58, 12288
    buffer_store_dwordx4 v[52:55], v31, s[16:19], s58 offen offset:1024 sc1
    v_pk_mul_f32 v[88:89], v[88:89], v[44:45] op_sel_hi:[1,0]
    v_pk_mul_f32 v[90:91], v[90:91], v[44:45] op_sel_hi:[1,0]
    v_pk_mul_f32 v[92:93], v[92:93], v[44:45] op_sel_hi:[1,0]
    v_pk_mul_f32 v[94:95], v[94:95], v[44:45] op_sel_hi:[1,0]
    v_cvt_pk_bf16_f32 v48, v80, v81
    v_cvt_pk_bf16_f32 v49, v82, v83
    v_cvt_pk_bf16_f32 v50, v84, v85
    v_cvt_pk_bf16_f32 v51, v86, v87
    s_mov_b32 s58, 20480
    buffer_store_dwordx4 v[48:51], v31, s[16:19], s58 offen sc1
    v_cvt_pk_bf16_f32 v52, v88, v89
    v_cvt_pk_bf16_f32 v53, v90, v91
    v_cvt_pk_bf16_f32 v54, v92, v93
    v_cvt_pk_bf16_f32 v55, v94, v95
    s_mov_b32 s58, 24576
    buffer_store_dwordx4 v[52:55], v31, s[16:19], s58 offen offset:3072 sc1
L_join:
    s_lshl_b32 s58, s28, 8
    v_lshl_add_u32 v81, v0, 2, s58
    buffer_load_dword v82, v81, s[24:27], 0 offen sc1
    s_add_u32 m0, s50, 18432
    s_nop 0
    buffer_load_dwordx4 v5, s[4:7], s47 offen lds
    s_add_u32 m0, s50, 19584
    s_add_u32 s49, s47, 8192
    buffer_load_dwordx4 v5, s[4:7], s49 offen lds
    s_add_u32 m0, s50, 20736
    s_add_u32 s49, s47, 16384
    buffer_load_dwordx4 v5, s[4:7], s49 offen lds
    s_add_u32 m0, s50, 21888
    s_add_u32 s49, s47, 24576
    buffer_load_dwordx4 v5, s[4:7], s49 offen lds
    s_add_u32 m0, s50, 23040
    s_add_u32 s49, s47, 32768
    buffer_load_dwordx4 v5, s[4:7], s49 offen lds
    s_add_u32 m0, s50, 24192
    s_add_u32 s49, s47, 40960
    buffer_load_dwordx4 v5, s[4:7], s49 offen lds
    s_add_u32 m0, s50, 25344
    s_add_u32 s49, s47, 49152
    buffer_load_dwordx4 v5, s[4:7], s49 offen lds
    s_add_u32 m0, s50, 26496
    s_add_u32 s49, s47, 57344
    buffer_load_dwordx4 v5, s[4:7], s49 offen lds
    s_add_u32 m0, s50, 27648
    s_add_u32 s49, s47, 65536
    buffer_load_dwordx4 v5, s[4:7], s49 offen lds
    s_add_u32 m0, s50, 28800
    s_add_u32 s49, s47, 73728
    buffer_load_dwordx4 v5, s[4:7], s49 offen lds
    s_add_u32 m0, s50, 29952
    s_add_u32 s49, s47, 81920
    buffer_load_dwordx4 v5, s[4:7], s49 offen lds
    s_add_u32 m0, s50, 31104
    s_add_u32 s49, s47, 90112
    buffer_load_dwordx4 v5, s[4:7], s49 offen lds
    s_add_u32 m0, s50, 32256
    s_add_u32 s49, s47, 98304
    buffer_load_dwordx4 v5, s[4:7], s49 offen lds
    s_add_u32 m0, s50, 33408
    s_add_u32 s49, s47, 106496
    buffer_load_dwordx4 v5, s[4:7], s49 offen lds
    s_add_u32 m0, s50, 34560
    s_add_u32 s49, s47, 114688
    buffer_load_dwordx4 v5, s[4:7], s49 offen lds
    s_add_u32 m0, s50, 35712
    s_add_u32 s49, s47, 122880
    buffer_load_dwordx4 v5, s[4:7], s49 offen lds
    s_mov_b32 s46, s48
    s_mul_i32 s48, s60, 14336
    s_add_u32 s60, s59, 1
    s_mov_b32 s59, s60
    s_lshl_b32 s47, s60, 17
    s_lshr_b32 s20, s3, 3
    s_lshl_b32 s21, s33, 1
    s_add_u32 s21, s21, s20
    s_and_b32 s22, s3, 7
    v_lshrrev_b32 v14, 4, v0
    v_and_b32 v15, 15, v0
    s_lshl_b32 s20, s32, 4
    s_add_u32 s20, s20, s21
    s_lshl_b32 s20, s20, 2
    s_add_u32 s20, s20, s28
    s_mul_i32 s20, s20, 229376
    s_add_u32 s8, s44, s20
    s_addc_u32 s9, s45, 0
    s_mov_b32 s10, 229376
    s_mov_b32 s11, 0x20000
    s_mul_i32 s20, s21, 458752
    s_lshl_b32 s23, s32, 11
    s_add_u32 s20, s20, s23
    s_lshl_b32 s23, s22, 8
    s_add_u32 s20, s20, s23
    s_lshl_b32 s23, s28, 6
    s_add_u32 s20, s20, s23
    s_add_u32 s12, s96, s20
    s_addc_u32 s13, s97, 0
    s_mov_b32 s14, 454720
    s_mov_b32 s15, 0x20000
    v_lshlrev_b32 v6, 4, v0
    v_lshlrev_b32 v13, 4, v14
    v_lshl_add_u32 v7, v15, 12, v13
    v_lshrrev_b32 v13, 2, v15
    v_and_b32 v15, 3, v15
    v_mul_u32_u24 v14, 1152, v14
    v_lshl_add_u32 v14, v13, 8, v14
    v_lshl_add_u32 v14, v15, 3, v14
    v_add_u32 v14, s50, v14
    v_xor_b32 v15, 0, v13
    v_lshl_add_u32 v1, v15, 5, v14
    v_xor_b32 v15, 1, v13
    v_lshl_add_u32 v2, v15, 5, v14
    v_xor_b32 v15, 2, v13
    v_lshl_add_u32 v3, v15, 5, v14
    v_xor_b32 v15, 3, v13
    v_lshl_add_u32 v4, v15, 5, v14
    v_add_u32 v8, s50, v6
    s_xor_b32 s20, s28, 2
    s_mul_i32 s20, s20, 36864
    v_add_u32 v9, s20, v6
    s_xor_b32 s20, s28, 3
    s_mul_i32 s20, s20, 36864
    v_add_u32 v10, s20, v6
    s_cmp_eq_u32 s28, 0
    s_cselect_b32 s51, 16, 0
    s_cselect_b32 s20, s3, -1
    v_cmp_eq_u32 vcc, s20, v0
    v_mov_b32 v83, 0x7ffffff0
    s_mov_b32 s52, 0x40000
    v_cndmask_b32 v83, v83, v81, vcc
    s_waitcnt vmcnt(16)
    v_readfirstlane_b32 s20, v82
    s_nop 0
    s_cmp_lt_u32 s20, s51
    s_cbranch_scc1 L_late
L_all_in:
    s_barrier
    buffer_store_dword v11, v83, s[36:39], 0 offen sc1
    s_waitcnt vmcnt(18)
    ds_read_b64_tr_b16 v[16:17], v1 offset:0
    ds_read_b64_tr_b16 v[18:19], v1 offset:4608
    ds_read_b64_tr_b16 v[20:21], v1 offset:9216
    ds_read_b64_tr_b16 v[22:23], v1 offset:13824
    ds_read_b64_tr_b16 v[24:25], v2 offset:0
    ds_read_b64_tr_b16 v[26:27], v2 offset:4608
    ds_read_b64_tr_b16 v[28:29], v2 offset:9216
    ds_read_b64_tr_b16 v[30:31], v2 offset:13824
    s_waitcnt lgkmcnt(7)
    ds_read_b64_tr_b16 v[32:33], v3 offset:0
    ds_read_b64_tr_b16 v[34:35], v3 offset:4608
    ds_read_b64_tr_b16 v[36:37], v3 offset:9216
    ds_read_b64_tr_b16 v[38:39], v3 offset:13824
    ds_read_b64_tr_b16 v[40:41], v4 offset:0
    ds_read_b64_tr_b16 v[42:43], v4 offset:4608
    ds_read_b64_tr_b16 v[44:45], v4 offset:9216
    ds_read_b64_tr_b16 v[46:47], v4 offset:13824
    s_waitcnt lgkmcnt(7)
    ds_read_b64_tr_b16 v[48:49], v1 offset:128
    ds_read_b64_tr_b16 v[50:51], v1 offset:4736
    ds_read_b64_tr_b16 v[52:53], v1 offset:9344
    ds_read_b64_tr_b16 v[54:55], v1 offset:13952
    ds_read_b64_tr_b16 v[56:57], v2 offset:128
    ds_read_b64_tr_b16 v[58:59], v2 offset:4736
    ds_read_b64_tr_b16 v[60:61], v2 offset:9344
    ds_read_b64_tr_b16 v[62:63], v2 offset:13952
    s_waitcnt lgkmcnt(7)
    ds_read_b64_tr_b16 v[64:65], v3 offset:128
    ds_read_b64_tr_b16 v[66:67], v3 offset:4736
    ds_read_b64_tr_b16 v[68:69], v3 offset:9344
    ds_read_b64_tr_b16 v[70:71], v3 offset:13952
    ds_read_b64_tr_b16 v[72:73], v4 offset:128
    ds_read_b64_tr_b16 v[74:75], v4 offset:4736
    ds_read_b64_tr_b16 v[76:77], v4 offset:9344
    ds_read_b64_tr_b16 v[78:79], v4 offset:13952
    s_waitcnt lgkmcnt(7)
    v_mov_b32 v12, 0
    v_mov_b32 v13, 0
    v_mov_b32 v14, 0
    v_mov_b32 v15, 0
    s_waitcnt lgkmcnt(0)
    s_add_u32 m0, s50, 0
    s_nop 0
    buffer_load_dwordx4 v5, s[4:7], s47 offen lds
    s_add_u32 m0, s50, 1152
    s_add_u32 s49, s47, 8192
    buffer_load_dwordx4 v5, s[4:7], s49 offen lds
    s_add_u32 m0, s50, 2304
    s_add_u32 s49, s47, 16384
    buffer_load_dwordx4 v5, s[4:7], s49 offen lds
    s_add_u32 m0, s50, 3456
    s_add_u32 s49, s47, 24576
    buffer_load_dwordx4 v5, s[4:7], s49 offen lds
    s_add_u32 m0, s50, 4608
    s_add_u32 s49, s47, 32768
    buffer_load_dwordx4 v5, s[4:7], s49 offen lds
    s_add_u32 m0, s50, 5760
    s_add_u32 s49, s47, 40960
    buffer_load_dwordx4 v5, s[4:7], s49 offen lds
    s_add_u32 m0, s50, 6912
    s_add_u32 s49, s47, 49152
    buffer_load_dwordx4 v5, s[4:7], s49 offen lds
    s_add_u32 m0, s50, 8064
    s_add_u32 s49, s47, 57344
    buffer_load_dwordx4 v5, s[4:7], s49 offen lds
    s_add_u32 m0, s50, 9216
    s_add_u32 s49, s47, 65536
    buffer_load_dwordx4 v5, s[4:7], s49 offen lds
    s_add_u32 m0, s50, 10368
    s_add_u32 s49, s47, 73728
    buffer_load_dwordx4 v5, s[4:7], s49 offen lds
    s_add_u32 m0, s50, 11520
    s_add_u32 s49, s47, 81920
    buffer_load_dwordx4 v5, s[4:7], s49 offen lds
    s_add_u32 m0, s50, 12672
    s_add_u32 s49, s47, 90112
    buffer_load_dwordx4 v5, s[4:7], s49 offen lds
    s_add_u32 m0, s50, 13824
    s_add_u32 s49, s47, 98304
    buffer_load_dwordx4 v5, s[4:7], s49 offen lds
    s_add_u32 m0, s50, 14976
    s_add_u32 s49, s47, 106496
    buffer_load_dwordx4 v5, s[4:7], s49 offen lds
    s_add_u32 m0, s50, 16128
    s_add_u32 s49, s47, 114688
    buffer_load_dwordx4 v5, s[4:7], s49 offen lds
    s_add_u32 m0, s50, 17280
    s_add_u32 s49, s47, 122880
    buffer_load_dwordx4 v5, s[4:7], s49 offen lds
    s_mov_b32 s46, s48
    s_mul_i32 s48, s60, 14336
    s_add_u32 s60, s59, 1
    s_mov_b32 s59, s60
    s_lshl_b32 s47, s60, 17
    v_mfma_f32_32x32x16_bf16 v[144:159], v[12:15], v[12:15], 0
    v_mfma_f32_32x32x16_bf16 a[0:15], v[12:15], v[12:15], 0
    v_mfma_f32_32x32x16_bf16 v[160:175], v[12:15], v[12:15], 0
    v_mfma_f32_32x32x16_bf16 a[16:31], v[12:15], v[12:15], 0
    v_mfma_f32_32x32x16_bf16 v[176:191], v[12:15], v[12:15], 0
    v_mfma_f32_32x32x16_bf16 a[32:47], v[12:15], v[12:15], 0
    v_mfma_f32_32x32x16_bf16 v[192:207], v[12:15], v[12:15], 0
    v_mfma_f32_32x32x16_bf16 a[48:63], v[12:15], v[12:15], 0
    v_mfma_f32_32x32x16_bf16 v[208:223], v[12:15], v[12:15], 0
    v_mfma_f32_32x32x16_bf16 a[64:79], v[12:15], v[12:15], 0
    v_mfma_f32_32x32x16_bf16 v[224:239], v[12:15], v[12:15], 0
    v_mfma_f32_32x32x16_bf16 a[80:95], v[12:15], v[12:15], 0
    v_mfma_f32_32x32x16_bf16 v[240:255], v[12:15], v[12:15], 0
    v_mfma_f32_32x32x16_bf16 a[96:111], v[12:15], v[12:15], 0
L_poll:
    buffer_load_dword v80, v81, s[36:39], 0 offen sc1
    s_sub_u32 s52, s52, 1
    s_waitcnt vmcnt(0)
    v_cmp_ne_u32 vcc, v80, v11
    s_cmp_eq_u32 s52, 0
    s_cbranch_scc1 L_go
    s_cbranch_vccz L_go
    s_sleep 2
    s_branch L_poll
L_go:
    s_barrier
    s_mul_i32 s61, s62, 14336
    s_add_u32 s58, s61, 0
    buffer_load_dwordx4 a[112:115], v6, s[8:11], s58 offen sc1
    s_add_u32 s58, s61, 7168
    buffer_load_dwordx4 a[116:119], v6, s[8:11], s58 offen sc1
    s_add_u32 s58, s61, 1024
    buffer_load_dwordx4 a[120:123], v6, s[8:11], s58 offen sc1
    s_add_u32 s58, s61, 8192
    buffer_load_dwordx4 a[124:127], v6, s[8:11], s58 offen sc1
    s_add_u32 s58, s61, 2048
    buffer_load_dwordx4 a[128:131], v6, s[8:11], s58 offen sc1
    s_add_u32 s58, s61, 9216
    buffer_load_dwordx4 a[132:135], v6, s[8:11], s58 offen sc1
    s_add_u32 s58, s61, 3072
    buffer_load_dwordx4 a[136:139], v6, s[8:11], s58 offen sc1
    s_add_u32 s58, s61, 10240
    buffer_load_dwordx4 a[140:143], v6, s[8:11], s58 offen sc1
    s_add_u32 s58, s61, 4096
    buffer_load_dwordx4 a[144:147], v6, s[8:11], s58 offen sc1
    s_add_u32 s58, s61, 11264
    buffer_load_dwordx4 a[148:151], v6, s[8:11], s58 offen sc1
    s_add_u32 s58, s61, 5120
    buffer_load_dwordx4 a[152:155], v6, s[8:11], s58 offen sc1
    s_add_u32 s58, s61, 12288
    buffer_load_dwordx4 a[156:159], v6, s[8:11], s58 offen sc1
    s_add_u32 s58, s61, 6144
    buffer_load_dwordx4 a[160:163], v6, s[8:11], s58 offen sc1
    s_add_u32 s58, s61, 13312
    buffer_load_dwordx4 a[164:167], v6, s[8:11], s58 offen sc1
    s_waitcnt vmcnt(13)
    v_mfma_f32_16x16x32_bf16 v[144:147], v[16:19], a[112:115], v[144:147]
    s_waitcnt vmcnt(12)
    v_mfma_f32_16x16x32_bf16 v[144:147], v[20:23], a[116:119], v[144:147]
    s_add_u32 s58, s46, 0
    ds_read_b64_tr_b16 v[80:81], v1 offset:18432
    ds_read_b64_tr_b16 v[82:83], v1 offset:23040
    v_mfma_f32_16x16x32_bf16 v[172:175], v[24:27], a[112:115], v[172:175]
    buffer_load_dwordx4 a[168:171], v6, s[8:11], s58 offen sc1
    v_mfma_f32_16x16x32_bf16 v[172:175], v[28:31], a[116:119], v[172:175]
    s_add_u32 s58, s46, 7168
    ds_read_b64_tr_b16 v[84:85], v1 offset:27648
    ds_read_b64_tr_b16 v[86:87], v1 offset:32256
    v_mfma_f32_16x16x32_bf16 v[200:203], v[32:35], a[112:115], v[200:203]
    buffer_load_dwordx4 a[172:175], v6, s[8:11], s58 offen sc1
    v_mfma_f32_16x16x32_bf16 v[200:203], v[36:39], a[116:119], v[200:203]
    s_add_u32 s58, s46, 1024
    ds_read_b64_tr_b16 v[88:89], v2 offset:18432
    ds_read_b64_tr_b16 v[90:91], v2 offset:23040
    v_mfma_f32_16x16x32_bf16 v[228:231], v[40:43], a[112:115], v[228:231]
    buffer_load_dwordx4 a[176:179], v6, s[8:11], s58 offen sc1
    v_mfma_f32_16x16x32_bf16 v[228:231], v[44:47], a[116:119], v[228:231]
    s_add_u32 s58, s46, 8192
    ds_read_b64_tr_b16 v[92:93], v2 offset:27648
    ds_read_b64_tr_b16 v[94:95], v2 offset:32256
    v_mfma_f32_16x16x32_bf16 a[0:3], v[48:51], a[112:115], a[0:3]
    buffer_load_dwordx4 a[180:183], v6, s[8:11], s58 offen sc1
    v_mfma_f32_16x16x32_bf16 a[0:3], v[52:55], a[116:119], a[0:3]
    s_add_u32 s58, s46, 2048
    ds_read_b64_tr_b16 v[96:97], v3 offset:18432
    ds_read_b64_tr_b16 v[98:99], v3 offset:23040
    v_mfma_f32_16x16x32_bf16 a[28:31], v[56:59], a[112:115], a[28:31]
    buffer_load_dwordx4 a[184:187], v6, s[8:11], s58 offen sc1
    v_mfma_f32_16x16x32_bf16 a[28:31], v[60:63], a[116:119], a[28:31]
    s_add_u32 s58, s46, 9216
    ds_read_b64_tr_b16 v[100:101], v3 offset:27648
    ds_read_b64_tr_b16 v[102:103], v3 offset:32256
    v_mfma_f32_16x16x32_bf16 a[56:59], v[64:67], a[112:115], a[56:59]
    buffer_load_dwordx4 a[188:191], v6, s[8:11], s58 offen sc1
    v_mfma_f32_16x16x32_bf16 a[56:59], v[68:71], a[116:119], a[56:59]
    s_add_u32 s58, s46, 3072
    ds_read_b64_tr_b16 v[104:105], v4 offset:18432
    ds_read_b64_tr_b16 v[106:107], v4 offset:23040
    v_mfma_f32_16x16x32_bf16 a[84:87], v[72:75], a[112:115], a[84:87]
    buffer_load_dwordx4 a[192:195], v6, s[8:11], s58 offen sc1
    v_mfma_f32_16x16x32_bf16 a[84:87], v[76:79], a[116:119], a[84:87]
    s_waitcnt vmcnt(17)
    s_add_u32 s58, s46, 10240
    ds_read_b64_tr_b16 v[108:109], v4 offset:27648
    ds_read_b64_tr_b16 v[110:111], v4 offset:32256
    v_mfma_f32_16x16x32_bf16 v[148:151], v[16:19], a[120:123], v[148:151]
    buffer_load_dwordx4 a[196:199], v6, s[8:11], s58 offen sc1
    v_mfma_f32_16x16x32_bf16 v[148:151], v[20:23], a[124:127], v[148:151]
    s_add_u32 s58, s46, 4096
    ds_read_b64_tr_b16 v[112:113], v1 offset:18560
    ds_read_b64_tr_b16 v[114:115], v1 offset:23168
    v_mfma_f32_16x16x32_bf16 v[176:179], v[24:27], a[120:123], v[176:179]
    buffer_load_dwordx4 a[200:203], v6, s[8:11], s58 offen sc1
    v_mfma_f32_16x16x32_bf16 v[176:179], v[28:31], a[124:127], v[176:179]
    s_add_u32 s58, s46, 11264
    ds_read_b64_tr_b16 v[116:117], v1 offset:27776
    ds_read_b64_tr_b16 v[118:119], v1 offset:32384
    v_mfma_f32_16x16x32_bf16 v[204:207], v[32:35], a[120:123], v[204:207]
    buffer_load_dwordx4 a[204:207], v6, s[8:11], s58 offen sc1
    v_mfma_f32_16x16x32_bf16 v[204:207], v[36:39], a[124:127], v[204:207]
    s_add_u32 s58, s46, 5120
    ds_read_b64_tr_b16 v[120:121], v2 offset:18560
    ds_read_b64_tr_b16 v[122:123], v2 offset:23168
    v_mfma_f32_16x16x32_bf16 v[232:235], v[40:43], a[120:123], v[232:235]
    buffer_load_dwordx4 a[208:211], v6, s[8:11], s58 offen sc1
    v_mfma_f32_16x16x32_bf16 v[232:235], v[44:47], a[124:127], v[232:235]
    s_add_u32 s58, s46, 12288
    ds_read_b64_tr_b16 v[124:125], v2 offset:27776
    ds_read_b64_tr_b16 v[126:127], v2 offset:32384
    v_mfma_f32_16x16x32_bf16 a[4:7], v[48:51], a[120:123], a[4:7]
    buffer_load_dwordx4 a[212:215], v6, s[8:11], s58 offen sc1
    v_mfma_f32_16x16x32_bf16 a[4:7], v[52:55], a[124:127], a[4:7]
    s_add_u32 s58, s46, 6144
    ds_read_b64_tr_b16 v[128:129], v3 offset:18560
    ds_read_b64_tr_b16 v[130:131], v3 offset:23168
    v_mfma_f32_16x16x32_bf16 a[32:35], v[56:59], a[120:123], a[32:35]
    buffer_load_dwordx4 a[216:219], v6, s[8:11], s58 offen sc1
    v_mfma_f32_16x16x32_bf16 a[32:35], v[60:63], a[124:127], a[32:35]
    s_add_u32 s58, s46, 13312
    ds_read_b64_tr_b16 v[132:133], v3 offset:27776
    ds_read_b64_tr_b16 v[134:135], v3 offset:32384
    v_mfma_f32_16x16x32_bf16 a[60:63], v[64:67], a[120:123], a[60:63]
    buffer_load_dwordx4 a[220:223], v6, s[8:11], s58 offen sc1
    v_mfma_f32_16x16x32_bf16 a[60:63], v[68:71], a[124:127], a[60:63]
    ds_read_b64_tr_b16 v[136:137], v4 offset:18560
    ds_read_b64_tr_b16 v[138:139], v4 offset:23168
    v_mfma_f32_16x16x32_bf16 a[88:91], v[72:75], a[120:123], a[88:91]
    ds_read_b64_tr_b16 v[140:141], v4 offset:27776
    ds_read_b64_tr_b16 v[142:143], v4 offset:32384
    v_mfma_f32_16x16x32_bf16 a[88:91], v[76:79], a[124:127], a[88:91]
    s_waitcnt vmcnt(22)
    v_mfma_f32_16x16x32_bf16 v[152:155], v[16:19], a[128:131], v[152:155]
    v_mfma_f32_16x16x32_bf16 v[152:155], v[20:23], a[132:135], v[152:155]
    s_add_u32 s58, s48, 0
    v_mfma_f32_16x16x32_bf16 v[180:183], v[24:27], a[128:131], v[180:183]
    s_waitcnt lgkmcnt(0)
    buffer_load_dwordx4 a[112:115], v6, s[8:11], s58 offen sc1
    v_mfma_f32_16x16x32_bf16 v[180:183], v[28:31], a[132:135], v[180:183]
    s_add_u32 s58, s48, 7168
    v_mfma_f32_16x16x32_bf16 v[208:211], v[32:35], a[128:131], v[208:211]
    buffer_load_dwordx4 a[116:119], v6, s[8:11], s58 offen sc1
    v_mfma_f32_16x16x32_bf16 v[208:211], v[36:39], a[132:135], v[208:211]
    s_add_u32 s58, s48, 1024
    v_mfma_f32_16x16x32_bf16 v[236:239], v[40:43], a[128:131], v[236:239]
    buffer_load_dwordx4 a[120:123], v6, s[8:11], s58 offen sc1
    v_mfma_f32_16x16x32_bf16 v[236:239], v[44:47], a[132:135], v[236:239]
    s_add_u32 s58, s48, 8192
    v_mfma_f32_16x16x32_bf16 a[8:11], v[48:51], a[128:131], a[8:11]
    buffer_load_dwordx4 a[124:127], v6, s[8:11], s58 offen sc1
    v_mfma_f32_16x16x32_bf16 a[8:11], v[52:55], a[132:135], a[8:11]
    s_add_u32 m0, s50, 18432
    v_mfma_f32_16x16x32_bf16 a[36:39], v[56:59], a[128:131], a[36:39]
    buffer_load_dwordx4 v5, s[4:7], s47 offen lds
    v_mfma_f32_16x16x32_bf16 a[36:39], v[60:63], a[132:135], a[36:39]
    v_mfma_f32_16x16x32_bf16 a[64:67], v[64:67], a[128:131], a[64:67]
    v_mfma_f32_16x16x32_bf16 a[64:67], v[68:71], a[132:135], a[64:67]
    s_add_u32 m0, s50, 19584
    s_add_u32 s49, s47, 8192
    v_mfma_f32_16x16x32_bf16 a[92:95], v[72:75], a[128:131], a[92:95]
    buffer_load_dwordx4 v5, s[4:7], s49 offen lds
    v_mfma_f32_16x16x32_bf16 a[92:95], v[76:79], a[132:135], a[92:95]
    s_waitcnt vmcnt(26)
    v_mfma_f32_16x16x32_bf16 v[156:159], v[16:19], a[136:139], v[156:159]
    v_mfma_f32_16x16x32_bf16 v[156:159], v[20:23], a[140:143], v[156:159]
    s_add_u32 s58, s48, 2048
    v_mfma_f32_16x16x32_bf16 v[184:187], v[24:27], a[136:139], v[184:187]
    buffer_load_dwordx4 a[128:131], v6, s[8:11], s58 offen sc1
    v_mfma_f32_16x16x32_bf16 v[184:187], v[28:31], a[140:143], v[184:187]
    s_add_u32 s58, s48, 9216
    v_mfma_f32_16x16x32_bf16 v[212:215], v[32:35], a[136:139], v[212:215]
    buffer_load_dwordx4 a[132:135], v6, s[8:11], s58 offen sc1
    v_mfma_f32_16x16x32_bf16 v[212:215], v[36:39], a[140:143], v[212:215]
    s_add_u32 m0, s50, 20736
    s_add_u32 s49, s47, 16384
    v_mfma_f32_16x16x32_bf16 v[240:243], v[40:43], a[136:139], v[240:243]
    buffer_load_dwordx4 v5, s[4:7], s49 offen lds
    v_mfma_f32_16x16x32_bf16 v[240:243], v[44:47], a[140:143], v[240:243]
    s_add_u32 m0, s50, 21888
    s_add_u32 s49, s47, 24576
    v_mfma_f32_16x16x32_bf16 a[12:15], v[48:51], a[136:139], a[12:15]
    buffer_load_dwordx4 v5, s[4:7], s49 offen lds
    v_mfma_f32_16x16x32_bf16 a[12:15], v[52:55], a[140:143], a[12:15]
    s_add_u32 m0, s50, 23040
    s_add_u32 s49, s47, 32768
    v_mfma_f32_16x16x32_bf16 a[40:43], v[56:59], a[136:139], a[40:43]
    buffer_load_dwordx4 v5, s[4:7], s49 offen lds
    v_mfma_f32_16x16x32_bf16 a[40:43], v[60:63], a[140:143], a[40:43]
    v_mfma_f32_16x16x32_bf16 a[68:71], v[64:67], a[136:139], a[68:71]
    v_mfma_f32_16x16x32_bf16 a[68:71], v[68:71], a[140:143], a[68:71]
    s_add_u32 m0, s50, 24192
    s_add_u32 s49, s47, 40960
    v_mfma_f32_16x16x32_bf16 a[96:99], v[72:75], a[136:139], a[96:99]
    buffer_load_dwordx4 v5, s[4:7], s49 offen lds
    v_mfma_f32_16x16x32_bf16 a[96:99], v[76:79], a[140:143], a[96:99]
    s_waitcnt vmcnt(30)
    v_mfma_f32_16x16x32_bf16 v[160:163], v[16:19], a[144:147], v[160:163]
    v_mfma_f32_16x16x32_bf16 v[160:163], v[20:23], a[148:151], v[160:163]
    s_add_u32 s58, s48, 3072
    v_mfma_f32_16x16x32_bf16 v[188:191], v[24:27], a[144:147], v[188:191]
    buffer_load_dwordx4 a[136:139], v6, s[8:11], s58 offen sc1
    v_mfma_f32_16x16x32_bf16 v[188:191], v[28:31], a[148:151], v[188:191]
    s_add_u32 s58, s48, 10240
    v_mfma_f32_16x16x32_bf16 v[216:219], v[32:35], a[144:147], v[216:219]
    buffer_load_dwordx4 a[140:143], v6, s[8:11], s58 offen sc1
    v_mfma_f32_16x16x32_bf16 v[216:219], v[36:39], a[148:151], v[216:219]
    s_add_u32 m0, s50, 25344
    s_add_u32 s49, s47, 49152
    v_mfma_f32_16x16x32_bf16 v[244:247], v[40:43], a[144:147], v[244:247]
    buffer_load_dwordx4 v5, s[4:7], s49 offen lds
    v_mfma_f32_16x16x32_bf16 v[244:247], v[44:47], a[148:151], v[244:247]
    s_add_u32 m0, s50, 26496
    s_add_u32 s49, s47, 57344
    v_mfma_f32_16x16x32_bf16 a[16:19], v[48:51], a[144:147], a[16:19]
    buffer_load_dwordx4 v5, s[4:7], s49 offen lds
    v_mfma_f32_16x16x32_bf16 a[16:19], v[52:55], a[148:151], a[16:19]
    v_mfma_f32_16x16x32_bf16 a[44:47], v[56:59], a[144:147], a[44:47]
    s_add_u32 m0, s50, 27648
    s_add_u32 s49, s47, 65536
    v_mfma_f32_16x16x32_bf16 a[44:47], v[60:63], a[148:151], a[44:47]
    buffer_load_dwordx4 v5, s[4:7], s49 offen lds
    v_mfma_f32_16x16x32_bf16 a[72:75], v[64:67], a[144:147], a[72:75]
    v_mfma_f32_16x16x32_bf16 a[72:75], v[68:71], a[148:151], a[72:75]
    v_mfma_f32_16x16x32_bf16 a[100:103], v[72:75], a[144:147], a[100:103]
    s_add_u32 m0, s50, 28800
    s_add_u32 s49, s47, 73728
    v_mfma_f32_16x16x32_bf16 a[100:103], v[76:79], a[148:151], a[100:103]
    s_waitcnt vmcnt(33)
    buffer_load_dwordx4 v5, s[4:7], s49 offen lds
    v_mfma_f32_16x16x32_bf16 v[164:167], v[16:19], a[152:155], v[164:167]
    v_mfma_f32_16x16x32_bf16 v[164:167], v[20:23], a[156:159], v[164:167]
    s_add_u32 s58, s48, 4096
    v_mfma_f32_16x16x32_bf16 v[192:195], v[24:27], a[152:155], v[192:195]
    buffer_load_dwordx4 a[144:147], v6, s[8:11], s58 offen sc1
    v_mfma_f32_16x16x32_bf16 v[192:195], v[28:31], a[156:159], v[192:195]
    s_add_u32 s58, s48, 11264
    v_mfma_f32_16x16x32_bf16 v[220:223], v[32:35], a[152:155], v[220:223]
    buffer_load_dwordx4 a[148:151], v6, s[8:11], s58 offen sc1
    v_mfma_f32_16x16x32_bf16 v[220:223], v[36:39], a[156:159], v[220:223]
    s_add_u32 m0, s50, 29952
    s_add_u32 s49, s47, 81920
    v_mfma_f32_16x16x32_bf16 v[248:251], v[40:43], a[152:155], v[248:251]
    buffer_load_dwordx4 v5, s[4:7], s49 offen lds
    v_mfma_f32_16x16x32_bf16 v[248:251], v[44:47], a[156:159], v[248:251]
    s_add_u32 m0, s50, 31104
    s_add_u32 s49, s47, 90112
    v_mfma_f32_16x16x32_bf16 a[20:23], v[48:51], a[152:155], a[20:23]
    buffer_load_dwordx4 v5, s[4:7], s49 offen lds
    v_mfma_f32_16x16x32_bf16 a[20:23], v[52:55], a[156:159], a[20:23]
    v_mfma_f32_16x16x32_bf16 a[48:51], v[56:59], a[152:155], a[48:51]
    s_add_u32 m0, s50, 32256
    s_add_u32 s49, s47, 98304
    v_mfma_f32_16x16x32_bf16 a[48:51], v[60:63], a[156:159], a[48:51]
    buffer_load_dwordx4 v5, s[4:7], s49 offen lds
    v_mfma_f32_16x16x32_bf16 a[76:79], v[64:67], a[152:155], a[76:79]
    v_mfma_f32_16x16x32_bf16 a[76:79], v[68:71], a[156:159], a[76:79]
    v_mfma_f32_16x16x32_bf16 a[104:107], v[72:75], a[152:155], a[104:107]
    s_add_u32 m0, s50, 33408
    s_add_u32 s49, s47, 106496
    v_mfma_f32_16x16x32_bf16 a[104:107], v[76:79], a[156:159], a[104:107]
    s_waitcnt vmcnt(37)
    buffer_load_dwordx4 v5, s[4:7], s49 offen lds
    v_mfma_f32_16x16x32_bf16 v[168:171], v[16:19], a[160:163], v[168:171]
    v_mfma_f32_16x16x32_bf16 v[168:171], v[20:23], a[164:167], v[168:171]
    s_add_u32 s58, s48, 5120
    v_mfma_f32_16x16x32_bf16 v[196:199], v[24:27], a[160:163], v[196:199]
    buffer_load_dwordx4 a[152:155], v6, s[8:11], s58 offen sc1
    v_mfma_f32_16x16x32_bf16 v[196:199], v[28:31], a[164:167], v[196:199]
    s_add_u32 s58, s48, 12288
    v_mfma_f32_16x16x32_bf16 v[224:227], v[32:35], a[160:163], v[224:227]
    buffer_load_dwordx4 a[156:159], v6, s[8:11], s58 offen sc1
    v_mfma_f32_16x16x32_bf16 v[224:227], v[36:39], a[164:167], v[224:227]
    s_add_u32 m0, s50, 34560
    s_add_u32 s49, s47, 114688
    v_mfma_f32_16x16x32_bf16 v[252:255], v[40:43], a[160:163], v[252:255]
    buffer_load_dwordx4 v5, s[4:7], s49 offen lds
    v_mfma_f32_16x16x32_bf16 v[252:255], v[44:47], a[164:167], v[252:255]
    s_add_u32 m0, s50, 35712
    s_add_u32 s49, s47, 122880
    v_mfma_f32_16x16x32_bf16 a[24:27], v[48:51], a[160:163], a[24:27]
    buffer_load_dwordx4 v5, s[4:7], s49 offen lds
    v_mfma_f32_16x16x32_bf16 a[24:27], v[52:55], a[164:167], a[24:27]
    s_mov_b32 s46, s48
    v_mfma_f32_16x16x32_bf16 a[52:55], v[56:59], a[160:163], a[52:55]
    s_mul_i32 s48, s60, 14336
    v_mfma_f32_16x16x32_bf16 a[52:55], v[60:63], a[164:167], a[52:55]
    s_add_u32 s60, s59, 1
    v_mfma_f32_16x16x32_bf16 a[80:83], v[64:67], a[160:163], a[80:83]
    s_mov_b32 s59, s60
    s_lshl_b32 s47, s60, 17
    v_mfma_f32_16x16x32_bf16 a[80:83], v[68:71], a[164:167], a[80:83]
    v_mfma_f32_16x16x32_bf16 a[108:111], v[72:75], a[160:163], a[108:111]
    v_mfma_f32_16x16x32_bf16 a[108:111], v[76:79], a[164:167], a[108:111]
    s_waitcnt vmcnt(41)
    s_mov_b32 s55, 6
    .p2align 6
L_o:
    v_mfma_f32_16x16x32_bf16 v[144:147], v[80:83], a[168:171], v[144:147]
    s_waitcnt vmcnt(30)
    v_mfma_f32_16x16x32_bf16 v[144:147], v[84:87], a[172:175], v[144:147]
    s_add_u32 s58, s46, 6144
    ds_read_b64_tr_b16 v[16:17], v1 offset:0
    v_mfma_f32_16x16x32_bf16 v[172:175], v[88:91], a[168:171], v[172:175]
    buffer_load_dwordx4 a[160:163], v6, s[8:11], s58 offen sc1
    v_mfma_f32_16x16x32_bf16 v[172:175], v[92:95], a[172:175], v[172:175]
    s_add_u32 s58, s46, 13312
    ds_read_b64_tr_b16 v[18:19], v1 offset:4608
    v_mfma_f32_16x16x32_bf16 v[200:203], v[96:99], a[168:171], v[200:203]
    buffer_load_dwordx4 a[164:167], v6, s[8:11], s58 offen sc1
    v_mfma_f32_16x16x32_bf16 v[200:203], v[100:103], a[172:175], v[200:203]
    ds_read_b64_tr_b16 v[20:21], v1 offset:9216
    v_mfma_f32_16x16x32_bf16 v[228:231], v[104:107], a[168:171], v[228:231]
    ds_read_b64_tr_b16 v[22:23], v1 offset:13824
    v_mfma_f32_16x16x32_bf16 v[228:231], v[108:111], a[172:175], v[228:231]
    ds_read_b64_tr_b16 v[24:25], v2 offset:0
    v_mfma_f32_16x16x32_bf16 a[0:3], v[112:115], a[168:171], a[0:3]
    ds_read_b64_tr_b16 v[26:27], v2 offset:4608
    v_mfma_f32_16x16x32_bf16 a[0:3], v[116:119], a[172:175], a[0:3]
    ds_read_b64_tr_b16 v[28:29], v2 offset:9216
    v_mfma_f32_16x16x32_bf16 a[28:31], v[120:123], a[168:171], a[28:31]
    ds_read_b64_tr_b16 v[30:31], v2 offset:13824
    v_mfma_f32_16x16x32_bf16 a[28:31], v[124:127], a[172:175], a[28:31]
    ds_read_b64_tr_b16 v[32:33], v3 offset:0
    v_mfma_f32_16x16x32_bf16 a[56:59], v[128:131], a[168:171], a[56:59]
    ds_read_b64_tr_b16 v[34:35], v3 offset:4608
    v_mfma_f32_16x16x32_bf16 a[56:59], v[132:135], a[172:175], a[56:59]
    ds_read_b64_tr_b16 v[36:37], v3 offset:9216
    v_mfma_f32_16x16x32_bf16 a[84:87], v[136:139], a[168:171], a[84:87]
    ds_read_b64_tr_b16 v[38:39], v3 offset:13824
    v_mfma_f32_16x16x32_bf16 a[84:87], v[140:143], a[172:175], a[84:87]
    s_waitcnt vmcnt(40)
    ds_read_b64_tr_b16 v[40:41], v4 offset:0
    v_mfma_f32_16x16x32_bf16 v[148:151], v[80:83], a[176:179], v[148:151]
    ds_read_b64_tr_b16 v[42:43], v4 offset:4608
    v_mfma_f32_16x16x32_bf16 v[148:151], v[84:87], a[180:183], v[148:151]
    s_add_u32 s58, s48, 0
    ds_read_b64_tr_b16 v[44:45], v4 offset:9216
    v_mfma_f32_16x16x32_bf16 v[176:179], v[88:91], a[176:179], v[176:179]
    buffer_load_dwordx4 a[168:171], v6, s[8:11], s58 offen sc1
    v_mfma_f32_16x16x32_bf16 v[176:179], v[92:95], a[180:183], v[176:179]
    s_add_u32 s58, s48, 7168
    ds_read_b64_tr_b16 v[46:47], v4 offset:13824
    v_mfma_f32_16x16x32_bf16 v[204:207], v[96:99], a[176:179], v[204:207]
    buffer_load_dwordx4 a[172:175], v6, s[8:11], s58 offen sc1
    v_mfma_f32_16x16x32_bf16 v[204:207], v[100:103], a[180:183], v[204:207]
    ds_read_b64_tr_b16 v[48:49], v1 offset:128
    v_mfma_f32_16x16x32_bf16 v[232:235], v[104:107], a[176:179], v[232:235]
    ds_read_b64_tr_b16 v[50:51], v1 offset:4736
    v_mfma_f32_16x16x32_bf16 v[232:235], v[108:111], a[180:183], v[232:235]
    ds_read_b64_tr_b16 v[52:53], v1 offset:9344
    v_mfma_f32_16x16x32_bf16 a[4:7], v[112:115], a[176:179], a[4:7]
    ds_read_b64_tr_b16 v[54:55], v1 offset:13952
    v_mfma_f32_16x16x32_bf16 a[4:7], v[116:119], a[180:183], a[4:7]
    ds_read_b64_tr_b16 v[56:57], v2 offset:128
    v_mfma_f32_16x16x32_bf16 a[32:35], v[120:123], a[176:179], a[32:35]
    ds_read_b64_tr_b16 v[58:59], v2 offset:4736
    v_mfma_f32_16x16x32_bf16 a[32:35], v[124:127], a[180:183], a[32:35]
    ds_read_b64_tr_b16 v[60:61], v2 offset:9344
    v_mfma_f32_16x16x32_bf16 a[60:63], v[128:131], a[176:179], a[60:63]
    ds_read_b64_tr_b16 v[62:63], v2 offset:13952
    v_mfma_f32_16x16x32_bf16 a[60:63], v[132:135], a[180:183], a[60:63]
    ds_read_b64_tr_b16 v[64:65], v3 offset:128
    v_mfma_f32_16x16x32_bf16 a[88:91], v[136:139], a[176:179], a[88:91]
    ds_read_b64_tr_b16 v[66:67], v3 offset:4736
    v_mfma_f32_16x16x32_bf16 a[88:91], v[140:143], a[180:183], a[88:91]
    s_waitcnt vmcnt(40)
    ds_read_b64_tr_b16 v[68:69], v3 offset:9344
    v_mfma_f32_16x16x32_bf16 v[152:155], v[80:83], a[184:187], v[152:155]
    ds_read_b64_tr_b16 v[70:71], v3 offset:13952
    v_mfma_f32_16x16x32_bf16 v[152:155], v[84:87], a[188:191], v[152:155]
    s_add_u32 s58, s48, 1024
    ds_read_b64_tr_b16 v[72:73], v4 offset:128
    v_mfma_f32_16x16x32_bf16 v[180:183], v[88:91], a[184:187], v[180:183]
    buffer_load_dwordx4 a[176:179], v6, s[8:11], s58 offen sc1
    v_mfma_f32_16x16x32_bf16 v[180:183], v[92:95], a[188:191], v[180:183]
    s_add_u32 s58, s48, 8192
    ds_read_b64_tr_b16 v[74:75], v4 offset:4736
    v_mfma_f32_16x16x32_bf16 v[208:211], v[96:99], a[184:187], v[208:211]
    buffer_load_dwordx4 a[180:183], v6, s[8:11], s58 offen sc1
    v_mfma_f32_16x16x32_bf16 v[208:211], v[100:103], a[188:191], v[208:211]
    ds_read_b64_tr_b16 v[76:77], v4 offset:9344
    v_mfma_f32_16x16x32_bf16 v[236:239], v[104:107], a[184:187], v[236:239]
    ds_read_b64_tr_b16 v[78:79], v4 offset:13952
    v_mfma_f32_16x16x32_bf16 v[236:239], v[108:111], a[188:191], v[236:239]
    v_mfma_f32_16x16x32_bf16 a[8:11], v[112:115], a[184:187], a[8:11]
    v_mfma_f32_16x16x32_bf16 a[8:11], v[116:119], a[188:191], a[8:11]
    v_mfma_f32_16x16x32_bf16 a[36:39], v[120:123], a[184:187], a[36:39]
    s_waitcnt lgkmcnt(0)
    v_mfma_f32_16x16x32_bf16 a[36:39], v[124:127], a[188:191], a[36:39]
    s_add_u32 m0, s50, 0
    v_mfma_f32_16x16x32_bf16 a[64:67], v[128:131], a[184:187], a[64:67]
    buffer_load_dwordx4 v5, s[4:7], s47 offen lds
    v_mfma_f32_16x16x32_bf16 a[64:67], v[132:135], a[188:191], a[64:67]
    v_mfma_f32_16x16x32_bf16 a[92:95], v[136:139], a[184:187], a[92:95]
    v_mfma_f32_16x16x32_bf16 a[92:95], v[140:143], a[188:191], a[92:95]
    s_waitcnt vmcnt(41)
    v_mfma_f32_16x16x32_bf16 v[156:159], v[80:83], a[192:195], v[156:159]
    s_add_u32 m0, s50, 1152
    s_add_u32 s49, s47, 8192
    v_mfma_f32_16x16x32_bf16 v[156:159], v[84:87], a[196:199], v[156:159]
    s_add_u32 s58, s48, 2048
    buffer_load_dwordx4 v5, s[4:7], s49 offen lds
    v_mfma_f32_16x16x32_bf16 v[184:187], v[88:91], a[192:195], v[184:187]
    buffer_load_dwordx4 a[184:187], v6, s[8:11], s58 offen sc1
    v_mfma_f32_16x16x32_bf16 v[184:187], v[92:95], a[196:199], v[184:187]
    s_add_u32 s58, s48, 9216
    v_mfma_f32_16x16x32_bf16 v[212:215], v[96:99], a[192:195], v[212:215]
    buffer_load_dwordx4 a[188:191], v6, s[8:11], s58 offen sc1
    v_mfma_f32_16x16x32_bf16 v[212:215], v[100:103], a[196:199], v[212:215]
    s_add_u32 m0, s50, 2304
    s_add_u32 s49, s47, 16384
    v_mfma_f32_16x16x32_bf16 v[240:243], v[104:107], a[192:195], v[240:243]
    buffer_load_dwordx4 v5, s[4:7], s49 offen lds
    v_mfma_f32_16x16x32_bf16 v[240:243], v[108:111], a[196:199], v[240:243]
    s_add_u32 m0, s50, 3456
    s_add_u32 s49, s47, 24576
    v_mfma_f32_16x16x32_bf16 a[12:15], v[112:115], a[192:195], a[12:15]
    buffer_load_dwordx4 v5, s[4:7], s49 offen lds
    v_mfma_f32_16x16x32_bf16 a[12:15], v[116:119], a[196:199], a[12:15]
    v_mfma_f32_16x16x32_bf16 a[40:43], v[120:123], a[192:195], a[40:43]
    v_mfma_f32_16x16x32_bf16 a[40:43], v[124:127], a[196:199], a[40:43]
    s_add_u32 m0, s50, 4608
    s_add_u32 s49, s47, 32768
    v_mfma_f32_16x16x32_bf16 a[68:71], v[128:131], a[192:195], a[68:71]
    buffer_load_dwordx4 v5, s[4:7], s49 offen lds
    v_mfma_f32_16x16x32_bf16 a[68:71], v[132:135], a[196:199], a[68:71]
    v_mfma_f32_16x16x32_bf16 a[96:99], v[136:139], a[192:195], a[96:99]
    v_mfma_f32_16x16x32_bf16 a[96:99], v[140:143], a[196:199], a[96:99]
    s_waitcnt vmcnt(45)
    v_mfma_f32_16x16x32_bf16 v[160:163], v[80:83], a[200:203], v[160:163]
    s_add_u32 m0, s50, 5760
    s_add_u32 s49, s47, 40960
    v_mfma_f32_16x16x32_bf16 v[160:163], v[84:87], a[204:207], v[160:163]
    s_add_u32 s58, s48, 3072
    buffer_load_dwordx4 v5, s[4:7], s49 offen lds
    v_mfma_f32_16x16x32_bf16 v[188:191], v[88:91], a[200:203], v[188:191]
    buffer_load_dwordx4 a[192:195], v6, s[8:11], s58 offen sc1
    v_mfma_f32_16x16x32_bf16 v[188:191], v[92:95], a[204:207], v[188:191]
    s_add_u32 s58, s48, 10240
    v_mfma_f32_16x16x32_bf16 v[216:219], v[96:99], a[200:203], v[216:219]
    buffer_load_dwordx4 a[196:199], v6, s[8:11], s58 offen sc1
    v_mfma_f32_16x16x32_bf16 v[216:219], v[100:103], a[204:207], v[216:219]
    s_add_u32 m0, s50, 6912
    s_add_u32 s49, s47, 49152
    v_mfma_f32_16x16x32_bf16 v[244:247], v[104:107], a[200:203], v[244:247]
    buffer_load_dwordx4 v5, s[4:7], s49 offen lds
    v_mfma_f32_16x16x32_bf16 v[244:247], v[108:111], a[204:207], v[244:247]
    s_add_u32 m0, s50, 8064
    s_add_u32 s49, s47, 57344
    v_mfma_f32_16x16x32_bf16 a[16:19], v[112:115], a[200:203], a[16:19]
    buffer_load_dwordx4 v5, s[4:7], s49 offen lds
    v_mfma_f32_16x16x32_bf16 a[16:19], v[116:119], a[204:207], a[16:19]
    v_mfma_f32_16x16x32_bf16 a[44:47], v[120:123], a[200:203], a[44:47]
    v_mfma_f32_16x16x32_bf16 a[44:47], v[124:127], a[204:207], a[44:47]
    s_add_u32 m0, s50, 9216
    s_add_u32 s49, s47, 65536
    v_mfma_f32_16x16x32_bf16 a[72:75], v[128:131], a[200:203], a[72:75]
    buffer_load_dwordx4 v5, s[4:7], s49 offen lds
    v_mfma_f32_16x16x32_bf16 a[72:75], v[132:135], a[204:207], a[72:75]
    v_mfma_f32_16x16x32_bf16 a[100:103], v[136:139], a[200:203], a[100:103]
    v_mfma_f32_16x16x32_bf16 a[100:103], v[140:143], a[204:207], a[100:103]
    s_waitcnt vmcnt(49)
    v_mfma_f32_16x16x32_bf16 v[164:167], v[80:83], a[208:211], v[164:167]
    s_add_u32 m0, s50, 10368
    s_add_u32 s49, s47, 73728
    v_mfma_f32_16x16x32_bf16 v[164:167], v[84:87], a[212:215], v[164:167]
    s_add_u32 s58, s48, 4096
    buffer_load_dwordx4 v5, s[4:7], s49 offen lds
    v_mfma_f32_16x16x32_bf16 v[192:195], v[88:91], a[208:211], v[192:195]
    buffer_load_dwordx4 a[200:203], v6, s[8:11], s58 offen sc1
    v_mfma_f32_16x16x32_bf16 v[192:195], v[92:95], a[212:215], v[192:195]
    s_add_u32 s58, s48, 11264
    v_mfma_f32_16x16x32_bf16 v[220:223], v[96:99], a[208:211], v[220:223]
    buffer_load_dwordx4 a[204:207], v6, s[8:11], s58 offen sc1
    v_mfma_f32_16x16x32_bf16 v[220:223], v[100:103], a[212:215], v[220:223]
    s_add_u32 m0, s50, 11520
    s_add_u32 s49, s47, 81920
    v_mfma_f32_16x16x32_bf16 v[248:251], v[104:107], a[208:211], v[248:251]
    buffer_load_dwordx4 v5, s[4:7], s49 offen lds
    v_mfma_f32_16x16x32_bf16 v[248:251], v[108:111], a[212:215], v[248:251]
    s_add_u32 m0, s50, 12672
    s_add_u32 s49, s47, 90112
    v_mfma_f32_16x16x32_bf16 a[20:23], v[112:115], a[208:211], a[20:23]
    buffer_load_dwordx4 v5, s[4:7], s49 offen lds
    v_mfma_f32_16x16x32_bf16 a[20:23], v[116:119], a[212:215], a[20:23]
    v_mfma_f32_16x16x32_bf16 a[48:51], v[120:123], a[208:211], a[48:51]
    v_mfma_f32_16x16x32_bf16 a[48:51], v[124:127], a[212:215], a[48:51]
    s_add_u32 m0, s50, 13824
    s_add_u32 s49, s47, 98304
    v_mfma_f32_16x16x32_bf16 a[76:79], v[128:131], a[208:211], a[76:79]
    buffer_load_dwordx4 v5, s[4:7], s49 offen lds
    v_mfma_f32_16x16x32_bf16 a[76:79], v[132:135], a[212:215], a[76:79]
    v_mfma_f32_16x16x32_bf16 a[104:107], v[136:139], a[208:211], a[104:107]
    v_mfma_f32_16x16x32_bf16 a[104:107], v[140:143], a[212:215], a[104:107]
    s_waitcnt vmcnt(53)
    v_mfma_f32_16x16x32_bf16 v[168:171], v[80:83], a[216:219], v[168:171]
    s_add_u32 m0, s50, 14976
    s_add_u32 s49, s47, 106496
    v_mfma_f32_16x16x32_bf16 v[168:171], v[84:87], a[220:223], v[168:171]
    s_add_u32 s58, s48, 5120
    buffer_load_dwordx4 v5, s[4:7], s49 offen lds
    v_mfma_f32_16x16x32_bf16 v[196:199], v[88:91], a[216:219], v[196:199]
    buffer_load_dwordx4 a[208:211], v6, s[8:11], s58 offen sc1
    v_mfma_f32_16x16x32_bf16 v[196:199], v[92:95], a[220:223], v[196:199]
    s_add_u32 s58, s48, 12288
    v_mfma_f32_16x16x32_bf16 v[224:227], v[96:99], a[216:219], v[224:227]
    buffer_load_dwordx4 a[212:215], v6, s[8:11], s58 offen sc1
    v_mfma_f32_16x16x32_bf16 v[224:227], v[100:103], a[220:223], v[224:227]
    s_add_u32 m0, s50, 16128
    s_add_u32 s49, s47, 114688
    v_mfma_f32_16x16x32_bf16 v[252:255], v[104:107], a[216:219], v[252:255]
    buffer_load_dwordx4 v5, s[4:7], s49 offen lds
    v_mfma_f32_16x16x32_bf16 v[252:255], v[108:111], a[220:223], v[252:255]
    s_add_u32 m0, s50, 17280
    s_add_u32 s49, s47, 122880
    v_mfma_f32_16x16x32_bf16 a[24:27], v[112:115], a[216:219], a[24:27]
    buffer_load_dwordx4 v5, s[4:7], s49 offen lds
    v_mfma_f32_16x16x32_bf16 a[24:27], v[116:119], a[220:223], a[24:27]
    s_mov_b32 s46, s48
    v_mfma_f32_16x16x32_bf16 a[52:55], v[120:123], a[216:219], a[52:55]
    s_mul_i32 s48, s60, 14336
    v_mfma_f32_16x16x32_bf16 a[52:55], v[124:127], a[220:223], a[52:55]
    s_add_u32 s60, s59, 1
    v_mfma_f32_16x16x32_bf16 a[80:83], v[128:131], a[216:219], a[80:83]
    s_mov_b32 s59, s60
    s_lshl_b32 s47, s60, 17
    v_mfma_f32_16x16x32_bf16 a[80:83], v[132:135], a[220:223], a[80:83]
    v_mfma_f32_16x16x32_bf16 a[108:111], v[136:139], a[216:219], a[108:111]
    v_mfma_f32_16x16x32_bf16 a[108:111], v[140:143], a[220:223], a[108:111]
    s_waitcnt vmcnt(57)
    v_mfma_f32_16x16x32_bf16 v[144:147], v[16:19], a[112:115], v[144:147]
    s_waitcnt vmcnt(30)
    v_mfma_f32_16x16x32_bf16 v[144:147], v[20:23], a[116:119], v[144:147]
    s_add_u32 s58, s46, 6144
    ds_read_b64_tr_b16 v[80:81], v1 offset:18432
    v_mfma_f32_16x16x32_bf16 v[172:175], v[24:27], a[112:115], v[172:175]
    buffer_load_dwordx4 a[216:219], v6, s[8:11], s58 offen sc1
    v_mfma_f32_16x16x32_bf16 v[172:175], v[28:31], a[116:119], v[172:175]
    s_add_u32 s58, s46, 13312
    ds_read_b64_tr_b16 v[82:83], v1 offset:23040
    v_mfma_f32_16x16x32_bf16 v[200:203], v[32:35], a[112:115], v[200:203]
    buffer_load_dwordx4 a[220:223], v6, s[8:11], s58 offen sc1
    v_mfma_f32_16x16x32_bf16 v[200:203], v[36:39], a[116:119], v[200:203]
    ds_read_b64_tr_b16 v[84:85], v1 offset:27648
    v_mfma_f32_16x16x32_bf16 v[228:231], v[40:43], a[112:115], v[228:231]
    ds_read_b64_tr_b16 v[86:87], v1 offset:32256
    v_mfma_f32_16x16x32_bf16 v[228:231], v[44:47], a[116:119], v[228:231]
    ds_read_b64_tr_b16 v[88:89], v2 offset:18432
    v_mfma_f32_16x16x32_bf16 a[0:3], v[48:51], a[112:115], a[0:3]
    ds_read_b64_tr_b16 v[90:91], v2 offset:23040
    v_mfma_f32_16x16x32_bf16 a[0:3], v[52:55], a[116:119], a[0:3]
    ds_read_b64_tr_b16 v[92:93], v2 offset:27648
    v_mfma_f32_16x16x32_bf16 a[28:31], v[56:59], a[112:115], a[28:31]
    ds_read_b64_tr_b16 v[94:95], v2 offset:32256
    v_mfma_f32_16x16x32_bf16 a[28:31], v[60:63], a[116:119], a[28:31]
    ds_read_b64_tr_b16 v[96:97], v3 offset:18432
    v_mfma_f32_16x16x32_bf16 a[56:59], v[64:67], a[112:115], a[56:59]
    ds_read_b64_tr_b16 v[98:99], v3 offset:23040
    v_mfma_f32_16x16x32_bf16 a[56:59], v[68:71], a[116:119], a[56:59]
    ds_read_b64_tr_b16 v[100:101], v3 offset:27648
    v_mfma_f32_16x16x32_bf16 a[84:87], v[72:75], a[112:115], a[84:87]
    ds_read_b64_tr_b16 v[102:103], v3 offset:32256
    v_mfma_f32_16x16x32_bf16 a[84:87], v[76:79], a[116:119], a[84:87]
    s_waitcnt vmcnt(56)
    ds_read_b64_tr_b16 v[104:105], v4 offset:18432
    v_mfma_f32_16x16x32_bf16 v[148:151], v[16:19], a[120:123], v[148:151]
    ds_read_b64_tr_b16 v[106:107], v4 offset:23040
    v_mfma_f32_16x16x32_bf16 v[148:151], v[20:23], a[124:127], v[148:151]
    s_add_u32 s58, s48, 0
    ds_read_b64_tr_b16 v[108:109], v4 offset:27648
    v_mfma_f32_16x16x32_bf16 v[176:179], v[24:27], a[120:123], v[176:179]
    buffer_load_dwordx4 a[112:115], v6, s[8:11], s58 offen sc1
    v_mfma_f32_16x16x32_bf16 v[176:179], v[28:31], a[124:127], v[176:179]
    s_add_u32 s58, s48, 7168
    ds_read_b64_tr_b16 v[110:111], v4 offset:32256
    v_mfma_f32_16x16x32_bf16 v[204:207], v[32:35], a[120:123], v[204:207]
    buffer_load_dwordx4 a[116:119], v6, s[8:11], s58 offen sc1
    v_mfma_f32_16x16x32_bf16 v[204:207], v[36:39], a[124:127], v[204:207]
    ds_read_b64_tr_b16 v[112:113], v1 offset:18560
    v_mfma_f32_16x16x32_bf16 v[232:235], v[40:43], a[120:123], v[232:235]
    ds_read_b64_tr_b16 v[114:115], v1 offset:23168
    v_mfma_f32_16x16x32_bf16 v[232:235], v[44:47], a[124:127], v[232:235]
    ds_read_b64_tr_b16 v[116:117], v1 offset:27776
    v_mfma_f32_16x16x32_bf16 a[4:7], v[48:51], a[120:123], a[4:7]
    ds_read_b64_tr_b16 v[118:119], v1 offset:32384
    v_mfma_f32_16x16x32_bf16 a[4:7], v[52:55], a[124:127], a[4:7]
    ds_read_b64_tr_b16 v[120:121], v2 offset:18560
    v_mfma_f32_16x16x32_bf16 a[32:35], v[56:59], a[120:123], a[32:35]
    ds_read_b64_tr_b16 v[122:123], v2 offset:23168
    v_mfma_f32_16x16x32_bf16 a[32:35], v[60:63], a[124:127], a[32:35]
    ds_read_b64_tr_b16 v[124:125], v2 offset:27776
    v_mfma_f32_16x16x32_bf16 a[60:63], v[64:67], a[120:123], a[60:63]
    ds_read_b64_tr_b16 v[126:127], v2 offset:32384
    v_mfma_f32_16x16x32_bf16 a[60:63], v[68:71], a[124:127], a[60:63]
    ds_read_b64_tr_b16 v[128:129], v3 offset:18560
    v_mfma_f32_16x16x32_bf16 a[88:91], v[72:75], a[120:123], a[88:91]
    ds_read_b64_tr_b16 v[130:131], v3 offset:23168
    v_mfma_f32_16x16x32_bf16 a[88:91], v[76:79], a[124:127], a[88:91]
    s_waitcnt vmcnt(54)
    ds_read_b64_tr_b16 v[132:133], v3 offset:27776
    v_mfma_f32_16x16x32_bf16 v[152:155], v[16:19], a[128:131], v[152:155]
    ds_read_b64_tr_b16 v[134:135], v3 offset:32384
    v_mfma_f32_16x16x32_bf16 v[152:155], v[20:23], a[132:135], v[152:155]
    s_add_u32 s58, s48, 1024
    ds_read_b64_tr_b16 v[136:137], v4 offset:18560
    v_mfma_f32_16x16x32_bf16 v[180:183], v[24:27], a[128:131], v[180:183]
    buffer_load_dwordx4 a[120:123], v6, s[8:11], s58 offen sc1
    v_mfma_f32_16x16x32_bf16 v[180:183], v[28:31], a[132:135], v[180:183]
    s_add_u32 s58, s48, 8192
    ds_read_b64_tr_b16 v[138:139], v4 offset:23168
    v_mfma_f32_16x16x32_bf16 v[208:211], v[32:35], a[128:131], v[208:211]
    buffer_load_dwordx4 a[124:127], v6, s[8:11], s58 offen sc1
    v_mfma_f32_16x16x32_bf16 v[208:211], v[36:39], a[132:135], v[208:211]
    ds_read_b64_tr_b16 v[140:141], v4 offset:27776
    v_mfma_f32_16x16x32_bf16 v[236:239], v[40:43], a[128:131], v[236:239]
    ds_read_b64_tr_b16 v[142:143], v4 offset:32384
    v_mfma_f32_16x16x32_bf16 v[236:239], v[44:47], a[132:135], v[236:239]
    v_mfma_f32_16x16x32_bf16 a[8:11], v[48:51], a[128:131], a[8:11]
    v_mfma_f32_16x16x32_bf16 a[8:11], v[52:55], a[132:135], a[8:11]
    v_mfma_f32_16x16x32_bf16 a[36:39], v[56:59], a[128:131], a[36:39]
    s_waitcnt lgkmcnt(0)
    v_mfma_f32_16x16x32_bf16 a[36:39], v[60:63], a[132:135], a[36:39]
    s_add_u32 m0, s50, 18432
    v_mfma_f32_16x16x32_bf16 a[64:67], v[64:67], a[128:131], a[64:67]
    buffer_load_dwordx4 v5, s[4:7], s47 offen lds
    v_mfma_f32_16x16x32_bf16 a[64:67], v[68:71], a[132:135], a[64:67]
    v_mfma_f32_16x16x32_bf16 a[92:95], v[72:75], a[128:131], a[92:95]
    v_mfma_f32_16x16x32_bf16 a[92:95], v[76:79], a[132:135], a[92:95]
    s_waitcnt vmcnt(51)
    v_mfma_f32_16x16x32_bf16 v[156:159], v[16:19], a[136:139], v[156:159]
    s_add_u32 m0, s50, 19584
    s_add_u32 s49, s47, 8192
    v_mfma_f32_16x16x32_bf16 v[156:159], v[20:23], a[140:143], v[156:159]
    s_add_u32 s58, s48, 2048
    buffer_load_dwordx4 v5, s[4:7], s49 offen lds
    v_mfma_f32_16x16x32_bf16 v[184:187], v[24:27], a[136:139], v[184:187]
    buffer_load_dwordx4 a[128:131], v6, s[8:11], s58 offen sc1
    v_mfma_f32_16x16x32_bf16 v[184:187], v[28:31], a[140:143], v[184:187]
    s_add_u32 s58, s48, 9216
    v_mfma_f32_16x16x32_bf16 v[212:215], v[32:35], a[136:139], v[212:215]
    buffer_load_dwordx4 a[132:135], v6, s[8:11], s58 offen sc1
    v_mfma_f32_16x16x32_bf16 v[212:215], v[36:39], a[140:143], v[212:215]
    s_add_u32 m0, s50, 20736
    s_add_u32 s49, s47, 16384
    v_mfma_f32_16x16x32_bf16 v[240:243], v[40:43], a[136:139], v[240:243]
    buffer_load_dwordx4 v5, s[4:7], s49 offen lds
    v_mfma_f32_16x16x32_bf16 v[240:243], v[44:47], a[140:143], v[240:243]
    s_add_u32 m0, s50, 21888
    s_add_u32 s49, s47, 24576
    v_mfma_f32_16x16x32_bf16 a[12:15], v[48:51], a[136:139], a[12:15]
    buffer_load_dwordx4 v5, s[4:7], s49 offen lds
    v_mfma_f32_16x16x32_bf16 a[12:15], v[52:55], a[140:143], a[12:15]
    v_mfma_f32_16x16x32_bf16 a[40:43], v[56:59], a[136:139], a[40:43]
    v_mfma_f32_16x16x32_bf16 a[40:43], v[60:63], a[140:143], a[40:43]
    s_add_u32 m0, s50, 23040
    s_add_u32 s49, s47, 32768
    v_mfma_f32_16x16x32_bf16 a[68:71], v[64:67], a[136:139], a[68:71]
    buffer_load_dwordx4 v5, s[4:7], s49 offen lds
    v_mfma_f32_16x16x32_bf16 a[68:71], v[68:71], a[140:143], a[68:71]
    v_mfma_f32_16x16x32_bf16 a[96:99], v[72:75], a[136:139], a[96:99]
    v_mfma_f32_16x16x32_bf16 a[96:99], v[76:79], a[140:143], a[96:99]
    s_waitcnt vmcnt(51)
    v_mfma_f32_16x16x32_bf16 v[160:163], v[16:19], a[144:147], v[160:163]
    s_add_u32 m0, s50, 24192
    s_add_u32 s49, s47, 40960
    v_mfma_f32_16x16x32_bf16 v[160:163], v[20:23], a[148:151], v[160:163]
    s_add_u32 s58, s48, 3072
    buffer_load_dwordx4 v5, s[4:7], s49 offen lds
    v_mfma_f32_16x16x32_bf16 v[188:191], v[24:27], a[144:147], v[188:191]
    buffer_load_dwordx4 a[136:139], v6, s[8:11], s58 offen sc1
    v_mfma_f32_16x16x32_bf16 v[188:191], v[28:31], a[148:151], v[188:191]
    s_add_u32 s58, s48, 10240
    v_mfma_f32_16x16x32_bf16 v[216:219], v[32:35], a[144:147], v[216:219]
    buffer_load_dwordx4 a[140:143], v6, s[8:11], s58 offen sc1
    v_mfma_f32_16x16x32_bf16 v[216:219], v[36:39], a[148:151], v[216:219]
    s_add_u32 m0, s50, 25344
    s_add_u32 s49, s47, 49152
    v_mfma_f32_16x16x32_bf16 v[244:247], v[40:43], a[144:147], v[244:247]
    buffer_load_dwordx4 v5, s[4:7], s49 offen lds
    v_mfma_f32_16x16x32_bf16 v[244:247], v[44:47], a[148:151], v[244:247]
    s_add_u32 m0, s50, 26496
    s_add_u32 s49, s47, 57344
    v_mfma_f32_16x16x32_bf16 a[16:19], v[48:51], a[144:147], a[16:19]
    buffer_load_dwordx4 v5, s[4:7], s49 offen lds
    v_mfma_f32_16x16x32_bf16 a[16:19], v[52:55], a[148:151], a[16:19]
    v_mfma_f32_16x16x32_bf16 a[44:47], v[56:59], a[144:147], a[44:47]
    v_mfma_f32_16x16x32_bf16 a[44:47], v[60:63], a[148:151], a[44:47]
    s_add_u32 m0, s50, 27648
    s_add_u32 s49, s47, 65536
    v_mfma_f32_16x16x32_bf16 a[72:75], v[64:67], a[144:147], a[72:75]
    buffer_load_dwordx4 v5, s[4:7], s49 offen lds
    v_mfma_f32_16x16x32_bf16 a[72:75], v[68:71], a[148:151], a[72:75]
    v_mfma_f32_16x16x32_bf16 a[100:103], v[72:75], a[144:147], a[100:103]
    v_mfma_f32_16x16x32_bf16 a[100:103], v[76:79], a[148:151], a[100:103]
    s_waitcnt vmcnt(51)
    v_mfma_f32_16x16x32_bf16 v[164:167], v[16:19], a[152:155], v[164:167]
    s_add_u32 m0, s50, 28800
    s_add_u32 s49, s47, 73728
    v_mfma_f32_16x16x32_bf16 v[164:167], v[20:23], a[156:159], v[164:167]
    s_add_u32 s58, s48, 4096
    buffer_load_dwordx4 v5, s[4:7], s49 offen lds
    v_mfma_f32_16x16x32_bf16 v[192:195], v[24:27], a[152:155], v[192:195]
    buffer_load_dwordx4 a[144:147], v6, s[8:11], s58 offen sc1
    v_mfma_f32_16x16x32_bf16 v[192:195], v[28:31], a[156:159], v[192:195]
    s_add_u32 s58, s48, 11264
    v_mfma_f32_16x16x32_bf16 v[220:223], v[32:35], a[152:155], v[220:223]
    buffer_load_dwordx4 a[148:151], v6, s[8:11], s58 offen sc1
    v_mfma_f32_16x16x32_bf16 v[220:223], v[36:39], a[156:159], v[220:223]
    s_add_u32 m0, s50, 29952
    s_add_u32 s49, s47, 81920
    v_mfma_f32_16x16x32_bf16 v[248:251], v[40:43], a[152:155], v[248:251]
    buffer_load_dwordx4 v5, s[4:7], s49 offen lds
    v_mfma_f32_16x16x32_bf16 v[248:251], v[44:47], a[156:159], v[248:251]
    s_add_u32 m0, s50, 31104
    s_add_u32 s49, s47, 90112
    v_mfma_f32_16x16x32_bf16 a[20:23], v[48:51], a[152:155], a[20:23]
    buffer_load_dwordx4 v5, s[4:7], s49 offen lds
    v_mfma_f32_16x16x32_bf16 a[20:23], v[52:55], a[156:159], a[20:23]
    v_mfma_f32_16x16x32_bf16 a[48:51], v[56:59], a[152:155], a[48:51]
    v_mfma_f32_16x16x32_bf16 a[48:51], v[60:63], a[156:159], a[48:51]
    s_add_u32 m0, s50, 32256
    s_add_u32 s49, s47, 98304
    v_mfma_f32_16x16x32_bf16 a[76:79], v[64:67], a[152:155], a[76:79]
    buffer_load_dwordx4 v5, s[4:7], s49 offen lds
    v_mfma_f32_16x16x32_bf16 a[76:79], v[68:71], a[156:159], a[76:79]
    v_mfma_f32_16x16x32_bf16 a[104:107], v[72:75], a[152:155], a[104:107]
    v_mfma_f32_16x16x32_bf16 a[104:107], v[76:79], a[156:159], a[104:107]
    s_waitcnt vmcnt(53)
    v_mfma_f32_16x16x32_bf16 v[168:171], v[16:19], a[160:163], v[168:171]
    s_add_u32 m0, s50, 33408
    s_add_u32 s49, s47, 106496
    v_mfma_f32_16x16x32_bf16 v[168:171], v[20:23], a[164:167], v[168:171]
    s_add_u32 s58, s48, 5120
    buffer_load_dwordx4 v5, s[4:7], s49 offen lds
    v_mfma_f32_16x16x32_bf16 v[196:199], v[24:27], a[160:163], v[196:199]
    buffer_load_dwordx4 a[152:155], v6, s[8:11], s58 offen sc1
    v_mfma_f32_16x16x32_bf16 v[196:199], v[28:31], a[164:167], v[196:199]
    s_add_u32 s58, s48, 12288
    v_mfma_f32_16x16x32_bf16 v[224:227], v[32:35], a[160:163], v[224:227]
    buffer_load_dwordx4 a[156:159], v6, s[8:11], s58 offen sc1
    v_mfma_f32_16x16x32_bf16 v[224:227], v[36:39], a[164:167], v[224:227]
    s_add_u32 m0, s50, 34560
    s_add_u32 s49, s47, 114688
    v_mfma_f32_16x16x32_bf16 v[252:255], v[40:43], a[160:163], v[252:255]
    buffer_load_dwordx4 v5, s[4:7], s49 offen lds
    v_mfma_f32_16x16x32_bf16 v[252:255], v[44:47], a[164:167], v[252:255]
    s_add_u32 m0, s50, 35712
    s_add_u32 s49, s47, 122880
    v_mfma_f32_16x16x32_bf16 a[24:27], v[48:51], a[160:163], a[24:27]
    buffer_load_dwordx4 v5, s[4:7], s49 offen lds
    v_mfma_f32_16x16x32_bf16 a[24:27], v[52:55], a[164:167], a[24:27]
    s_mov_b32 s46, s48
    v_mfma_f32_16x16x32_bf16 a[52:55], v[56:59], a[160:163], a[52:55]
    s_mul_i32 s48, s60, 14336
    v_mfma_f32_16x16x32_bf16 a[52:55], v[60:63], a[164:167], a[52:55]
    s_add_u32 s60, s59, 1
    v_mfma_f32_16x16x32_bf16 a[80:83], v[64:67], a[160:163], a[80:83]
    s_mov_b32 s59, s60
    s_lshl_b32 s47, s60, 17
    v_mfma_f32_16x16x32_bf16 a[80:83], v[68:71], a[164:167], a[80:83]
    s_sub_u32 s55, s55, 1
    v_mfma_f32_16x16x32_bf16 a[108:111], v[72:75], a[160:163], a[108:111]
    s_cmp_lg_u32 s55, 0
    v_mfma_f32_16x16x32_bf16 a[108:111], v[76:79], a[164:167], a[108:111]
    s_waitcnt vmcnt(57)
    s_cbranch_scc1 L_o
    v_mfma_f32_16x16x32_bf16 v[144:147], v[80:83], a[168:171], v[144:147]
    s_waitcnt vmcnt(30)
    v_mfma_f32_16x16x32_bf16 v[144:147], v[84:87], a[172:175], v[144:147]
    s_add_u32 s58, s46, 6144
    ds_read_b64_tr_b16 v[16:17], v1 offset:0
    v_mfma_f32_16x16x32_bf16 v[172:175], v[88:91], a[168:171], v[172:175]
    buffer_load_dwordx4 a[160:163], v6, s[8:11], s58 offen sc1
    v_mfma_f32_16x16x32_bf16 v[172:175], v[92:95], a[172:175], v[172:175]
    s_add_u32 s58, s46, 13312
    ds_read_b64_tr_b16 v[18:19], v1 offset:4608
    v_mfma_f32_16x16x32_bf16 v[200:203], v[96:99], a[168:171], v[200:203]
    buffer_load_dwordx4 a[164:167], v6, s[8:11], s58 offen sc1
    v_mfma_f32_16x16x32_bf16 v[200:203], v[100:103], a[172:175], v[200:203]
    ds_read_b64_tr_b16 v[20:21], v1 offset:9216
    v_mfma_f32_16x16x32_bf16 v[228:231], v[104:107], a[168:171], v[228:231]
    ds_read_b64_tr_b16 v[22:23], v1 offset:13824
    v_mfma_f32_16x16x32_bf16 v[228:231], v[108:111], a[172:175], v[228:231]
    ds_read_b64_tr_b16 v[24:25], v2 offset:0
    v_mfma_f32_16x16x32_bf16 a[0:3], v[112:115], a[168:171], a[0:3]
    ds_read_b64_tr_b16 v[26:27], v2 offset:4608
    v_mfma_f32_16x16x32_bf16 a[0:3], v[116:119], a[172:175], a[0:3]
    ds_read_b64_tr_b16 v[28:29], v2 offset:9216
    v_mfma_f32_16x16x32_bf16 a[28:31], v[120:123], a[168:171], a[28:31]
    ds_read_b64_tr_b16 v[30:31], v2 offset:13824
    v_mfma_f32_16x16x32_bf16 a[28:31], v[124:127], a[172:175], a[28:31]
    ds_read_b64_tr_b16 v[32:33], v3 offset:0
    v_mfma_f32_16x16x32_bf16 a[56:59], v[128:131], a[168:171], a[56:59]
    ds_read_b64_tr_b16 v[34:35], v3 offset:4608
    v_mfma_f32_16x16x32_bf16 a[56:59], v[132:135], a[172:175], a[56:59]
    ds_read_b64_tr_b16 v[36:37], v3 offset:9216
    v_mfma_f32_16x16x32_bf16 a[84:87], v[136:139], a[168:171], a[84:87]
    ds_read_b64_tr_b16 v[38:39], v3 offset:13824
    v_mfma_f32_16x16x32_bf16 a[84:87], v[140:143], a[172:175], a[84:87]
    s_waitcnt vmcnt(56)
    ds_read_b64_tr_b16 v[40:41], v4 offset:0
    v_mfma_f32_16x16x32_bf16 v[148:151], v[80:83], a[176:179], v[148:151]
    ds_read_b64_tr_b16 v[42:43], v4 offset:4608
    v_mfma_f32_16x16x32_bf16 v[148:151], v[84:87], a[180:183], v[148:151]
    s_add_u32 s58, s48, 0
    ds_read_b64_tr_b16 v[44:45], v4 offset:9216
    v_mfma_f32_16x16x32_bf16 v[176:179], v[88:91], a[176:179], v[176:179]
    buffer_load_dwordx4 a[168:171], v6, s[8:11], s58 offen sc1
    v_mfma_f32_16x16x32_bf16 v[176:179], v[92:95], a[180:183], v[176:179]
    s_add_u32 s58, s48, 7168
    ds_read_b64_tr_b16 v[46:47], v4 offset:13824
    v_mfma_f32_16x16x32_bf16 v[204:207], v[96:99], a[176:179], v[204:207]
    buffer_load_dwordx4 a[172:175], v6, s[8:11], s58 offen sc1
    v_mfma_f32_16x16x32_bf16 v[204:207], v[100:103], a[180:183], v[204:207]
    ds_read_b64_tr_b16 v[48:49], v1 offset:128
    v_mfma_f32_16x16x32_bf16 v[232:235], v[104:107], a[176:179], v[232:235]
    ds_read_b64_tr_b16 v[50:51], v1 offset:4736
    v_mfma_f32_16x16x32_bf16 v[232:235], v[108:111], a[180:183], v[232:235]
    ds_read_b64_tr_b16 v[52:53], v1 offset:9344
    v_mfma_f32_16x16x32_bf16 a[4:7], v[112:115], a[176:179], a[4:7]
    ds_read_b64_tr_b16 v[54:55], v1 offset:13952
    v_mfma_f32_16x16x32_bf16 a[4:7], v[116:119], a[180:183], a[4:7]
    ds_read_b64_tr_b16 v[56:57], v2 offset:128
    v_mfma_f32_16x16x32_bf16 a[32:35], v[120:123], a[176:179], a[32:35]
    ds_read_b64_tr_b16 v[58:59], v2 offset:4736
    v_mfma_f32_16x16x32_bf16 a[32:35], v[124:127], a[180:183], a[32:35]
    ds_read_b64_tr_b16 v[60:61], v2 offset:9344
    v_mfma_f32_16x16x32_bf16 a[60:63], v[128:131], a[176:179], a[60:63]
    ds_read_b64_tr_b16 v[62:63], v2 offset:13952
    v_mfma_f32_16x16x32_bf16 a[60:63], v[132:135], a[180:183], a[60:63]
    ds_read_b64_tr_b16 v[64:65], v3 offset:128
    v_mfma_f32_16x16x32_bf16 a[88:91], v[136:139], a[176:179], a[88:91]
    ds_read_b64_tr_b16 v[66:67], v3 offset:4736
    v_mfma_f32_16x16x32_bf16 a[88:91], v[140:143], a[180:183], a[88:91]
    s_waitcnt vmcnt(54)
    ds_read_b64_tr_b16 v[68:69], v3 offset:9344
    v_mfma_f32_16x16x32_bf16 v[152:155], v[80:83], a[184:187], v[152:155]
    ds_read_b64_tr_b16 v[70:71], v3 offset:13952
    v_mfma_f32_16x16x32_bf16 v[152:155], v[84:87], a[188:191], v[152:155]
    s_add_u32 s58, s48, 1024
    ds_read_b64_tr_b16 v[72:73], v4 offset:128
    v_mfma_f32_16x16x32_bf16 v[180:183], v[88:91], a[184:187], v[180:183]
    buffer_load_dwordx4 a[176:179], v6, s[8:11], s58 offen sc1
    v_mfma_f32_16x16x32_bf16 v[180:183], v[92:95], a[188:191], v[180:183]
    s_add_u32 s58, s48, 8192
    ds_read_b64_tr_b16 v[74:75], v4 offset:4736
    v_mfma_f32_16x16x32_bf16 v[208:211], v[96:99], a[184:187], v[208:211]
    buffer_load_dwordx4 a[180:183], v6, s[8:11], s58 offen sc1
    v_mfma_f32_16x16x32_bf16 v[208:211], v[100:103], a[188:191], v[208:211]
    ds_read_b64_tr_b16 v[76:77], v4 offset:9344
    v_mfma_f32_16x16x32_bf16 v[236:239], v[104:107], a[184:187], v[236:239]
    ds_read_b64_tr_b16 v[78:79], v4 offset:13952
    v_mfma_f32_16x16x32_bf16 v[236:239], v[108:111], a[188:191], v[236:239]
    v_mfma_f32_16x16x32_bf16 a[8:11], v[112:115], a[184:187], a[8:11]
    v_mfma_f32_16x16x32_bf16 a[8:11], v[116:119], a[188:191], a[8:11]
    v_mfma_f32_16x16x32_bf16 a[36:39], v[120:123], a[184:187], a[36:39]
    s_waitcnt lgkmcnt(0)
    v_mfma_f32_16x16x32_bf16 a[36:39], v[124:127], a[188:191], a[36:39]
    v_mfma_f32_16x16x32_bf16 a[64:67], v[128:131], a[184:187], a[64:67]
    v_mfma_f32_16x16x32_bf16 a[64:67], v[132:135], a[188:191], a[64:67]
    v_mfma_f32_16x16x32_bf16 a[92:95], v[136:139], a[184:187], a[92:95]
    v_mfma_f32_16x16x32_bf16 a[92:95], v[140:143], a[188:191], a[92:95]
    s_waitcnt vmcnt(50)
    v_mfma_f32_16x16x32_bf16 v[156:159], v[80:83], a[192:195], v[156:159]
    v_mfma_f32_16x16x32_bf16 v[156:159], v[84:87], a[196:199], v[156:159]
    s_add_u32 s58, s48, 2048
    v_mfma_f32_16x16x32_bf16 v[184:187], v[88:91], a[192:195], v[184:187]
    buffer_load_dwordx4 a[184:187], v6, s[8:11], s58 offen sc1
    v_mfma_f32_16x16x32_bf16 v[184:187], v[92:95], a[196:199], v[184:187]
    s_add_u32 s58, s48, 9216
    v_mfma_f32_16x16x32_bf16 v[212:215], v[96:99], a[192:195], v[212:215]
    buffer_load_dwordx4 a[188:191], v6, s[8:11], s58 offen sc1
    v_mfma_f32_16x16x32_bf16 v[212:215], v[100:103], a[196:199], v[212:215]
    v_mfma_f32_16x16x32_bf16 v[240:243], v[104:107], a[192:195], v[240:243]
    v_mfma_f32_16x16x32_bf16 v[240:243], v[108:111], a[196:199], v[240:243]
    v_mfma_f32_16x16x32_bf16 a[12:15], v[112:115], a[192:195], a[12:15]
    v_mfma_f32_16x16x32_bf16 a[12:15], v[116:119], a[196:199], a[12:15]
    v_mfma_f32_16x16x32_bf16 a[40:43], v[120:123], a[192:195], a[40:43]
    v_mfma_f32_16x16x32_bf16 a[40:43], v[124:127], a[196:199], a[40:43]
    v_mfma_f32_16x16x32_bf16 a[68:71], v[128:131], a[192:195], a[68:71]
    v_mfma_f32_16x16x32_bf16 a[68:71], v[132:135], a[196:199], a[68:71]
    v_mfma_f32_16x16x32_bf16 a[96:99], v[136:139], a[192:195], a[96:99]
    v_mfma_f32_16x16x32_bf16 a[96:99], v[140:143], a[196:199], a[96:99]
    s_waitcnt vmcnt(46)
    v_mfma_f32_16x16x32_bf16 v[160:163], v[80:83], a[200:203], v[160:163]
    v_mfma_f32_16x16x32_bf16 v[160:163], v[84:87], a[204:207], v[160:163]
    s_add_u32 s58, s48, 3072
    v_mfma_f32_16x16x32_bf16 v[188:191], v[88:91], a[200:203], v[188:191]
    buffer_load_dwordx4 a[192:195], v6, s[8:11], s58 offen sc1
    v_mfma_f32_16x16x32_bf16 v[188:191], v[92:95], a[204:207], v[188:191]
    s_add_u32 s58, s48, 10240
    v_mfma_f32_16x16x32_bf16 v[216:219], v[96:99], a[200:203], v[216:219]
    buffer_load_dwordx4 a[196:199], v6, s[8:11], s58 offen sc1
    v_mfma_f32_16x16x32_bf16 v[216:219], v[100:103], a[204:207], v[216:219]
    v_mfma_f32_16x16x32_bf16 v[244:247], v[104:107], a[200:203], v[244:247]
    v_mfma_f32_16x16x32_bf16 v[244:247], v[108:111], a[204:207], v[244:247]
    v_mfma_f32_16x16x32_bf16 a[16:19], v[112:115], a[200:203], a[16:19]
    v_mfma_f32_16x16x32_bf16 a[16:19], v[116:119], a[204:207], a[16:19]
    v_mfma_f32_16x16x32_bf16 a[44:47], v[120:123], a[200:203], a[44:47]
    v_mfma_f32_16x16x32_bf16 a[44:47], v[124:127], a[204:207], a[44:47]
    v_mfma_f32_16x16x32_bf16 a[72:75], v[128:131], a[200:203], a[72:75]
    v_mfma_f32_16x16x32_bf16 a[72:75], v[132:135], a[204:207], a[72:75]
    v_mfma_f32_16x16x32_bf16 a[100:103], v[136:139], a[200:203], a[100:103]
    v_mfma_f32_16x16x32_bf16 a[100:103], v[140:143], a[204:207], a[100:103]
    s_waitcnt vmcnt(42)
    v_mfma_f32_16x16x32_bf16 v[164:167], v[80:83], a[208:211], v[164:167]
    v_mfma_f32_16x16x32_bf16 v[164:167], v[84:87], a[212:215], v[164:167]
    s_add_u32 s58, s48, 4096
    v_mfma_f32_16x16x32_bf16 v[192:195], v[88:91], a[208:211], v[192:195]
    buffer_load_dwordx4 a[200:203], v6, s[8:11], s58 offen sc1
    v_mfma_f32_16x16x32_bf16 v[192:195], v[92:95], a[212:215], v[192:195]
    s_add_u32 s58, s48, 11264
    v_mfma_f32_16x16x32_bf16 v[220:223], v[96:99], a[208:211], v[220:223]
    buffer_load_dwordx4 a[204:207], v6, s[8:11], s58 offen sc1
    v_mfma_f32_16x16x32_bf16 v[220:223], v[100:103], a[212:215], v[220:223]
    v_mfma_f32_16x16x32_bf16 v[248:251], v[104:107], a[208:211], v[248:251]
    v_mfma_f32_16x16x32_bf16 v[248:251], v[108:111], a[212:215], v[248:251]
    v_mfma_f32_16x16x32_bf16 a[20:23], v[112:115], a[208:211], a[20:23]
    v_mfma_f32_16x16x32_bf16 a[20:23], v[116:119], a[212:215], a[20:23]
    v_mfma_f32_16x16x32_bf16 a[48:51], v[120:123], a[208:211], a[48:51]
    v_mfma_f32_16x16x32_bf16 a[48:51], v[124:127], a[212:215], a[48:51]
    v_mfma_f32_16x16x32_bf16 a[76:79], v[128:131], a[208:211], a[76:79]
    v_mfma_f32_16x16x32_bf16 a[76:79], v[132:135], a[212:215], a[76:79]
    v_mfma_f32_16x16x32_bf16 a[104:107], v[136:139], a[208:211], a[104:107]
    v_mfma_f32_16x16x32_bf16 a[104:107], v[140:143], a[212:215], a[104:107]
    s_waitcnt vmcnt(40)
    v_mfma_f32_16x16x32_bf16 v[168:171], v[80:83], a[216:219], v[168:171]
    v_mfma_f32_16x16x32_bf16 v[168:171], v[84:87], a[220:223], v[168:171]
    s_add_u32 s58, s48, 5120
    v_mfma_f32_16x16x32_bf16 v[196:199], v[88:91], a[216:219], v[196:199]
    buffer_load_dwordx4 a[208:211], v6, s[8:11], s58 offen sc1
    v_mfma_f32_16x16x32_bf16 v[196:199], v[92:95], a[220:223], v[196:199]
    s_add_u32 s58, s48, 12288
    v_mfma_f32_16x16x32_bf16 v[224:227], v[96:99], a[216:219], v[224:227]
    s_waitcnt vmcnt(13)
    buffer_load_dwordx4 a[212:215], v6, s[8:11], s58 offen sc1
    v_mfma_f32_16x16x32_bf16 v[224:227], v[100:103], a[220:223], v[224:227]
    v_mfma_f32_16x16x32_bf16 v[252:255], v[104:107], a[216:219], v[252:255]
    v_mfma_f32_16x16x32_bf16 v[252:255], v[108:111], a[220:223], v[252:255]
    v_mfma_f32_16x16x32_bf16 a[24:27], v[112:115], a[216:219], a[24:27]
    v_mfma_f32_16x16x32_bf16 a[24:27], v[116:119], a[220:223], a[24:27]
    s_mov_b32 s46, s48
    v_mfma_f32_16x16x32_bf16 a[52:55], v[120:123], a[216:219], a[52:55]
    v_mfma_f32_16x16x32_bf16 a[52:55], v[124:127], a[220:223], a[52:55]
    v_mfma_f32_16x16x32_bf16 a[80:83], v[128:131], a[216:219], a[80:83]
    v_mfma_f32_16x16x32_bf16 a[80:83], v[132:135], a[220:223], a[80:83]
    v_mfma_f32_16x16x32_bf16 a[108:111], v[136:139], a[216:219], a[108:111]
    v_mfma_f32_16x16x32_bf16 a[108:111], v[140:143], a[220:223], a[108:111]
    s_waitcnt vmcnt(1)
    v_mfma_f32_16x16x32_bf16 a[56:59], v[64:67], a[112:115], a[56:59]
    s_add_u32 s58, s46, 6144
    ds_read_b64_tr_b16 v[128:129], v3 offset:18560
    v_mfma_f32_16x16x32_bf16 a[56:59], v[68:71], a[116:119], a[56:59]
    buffer_load_dwordx4 a[216:219], v6, s[8:11], s58 offen sc1
    v_mfma_f32_16x16x32_bf16 a[60:63], v[64:67], a[120:123], a[60:63]
    s_add_u32 s58, s46, 13312
    ds_read_b64_tr_b16 v[130:131], v3 offset:23168
    v_mfma_f32_16x16x32_bf16 a[60:63], v[68:71], a[124:127], a[60:63]
    buffer_load_dwordx4 a[220:223], v6, s[8:11], s58 offen sc1
    v_mfma_f32_16x16x32_bf16 a[64:67], v[64:67], a[128:131], a[64:67]
    ds_read_b64_tr_b16 v[132:133], v3 offset:27776
    v_mfma_f32_16x16x32_bf16 a[64:67], v[68:71], a[132:135], a[64:67]
    ds_read_b64_tr_b16 v[134:135], v3 offset:32384
    v_mfma_f32_16x16x32_bf16 a[68:71], v[64:67], a[136:139], a[68:71]
    ds_read_b64_tr_b16 v[136:137], v4 offset:18560
    v_mfma_f32_16x16x32_bf16 a[68:71], v[68:71], a[140:143], a[68:71]
    ds_read_b64_tr_b16 v[138:139], v4 offset:23168
    v_mfma_f32_16x16x32_bf16 a[72:75], v[64:67], a[144:147], a[72:75]
    ds_read_b64_tr_b16 v[140:141], v4 offset:27776
    v_mfma_f32_16x16x32_bf16 a[72:75], v[68:71], a[148:151], a[72:75]
    ds_read_b64_tr_b16 v[142:143], v4 offset:32384
    v_mfma_f32_16x16x32_bf16 a[76:79], v[64:67], a[152:155], a[76:79]
    ds_read_b64_tr_b16 v[112:113], v1 offset:18560
    v_mfma_f32_16x16x32_bf16 a[76:79], v[68:71], a[156:159], a[76:79]
    ds_read_b64_tr_b16 v[114:115], v1 offset:23168
    v_mfma_f32_16x16x32_bf16 a[80:83], v[64:67], a[160:163], a[80:83]
    s_waitcnt lgkmcnt(6)
    ds_read_b64_tr_b16 v[116:117], v1 offset:27776
    v_mfma_f32_16x16x32_bf16 a[80:83], v[68:71], a[164:167], a[80:83]
    ds_read_b64_tr_b16 v[118:119], v1 offset:32384
    v_mfma_f32_16x16x32_bf16 a[56:59], v[128:131], a[168:171], a[56:59]
    ds_read_b64_tr_b16 v[120:121], v2 offset:18560
    v_mfma_f32_16x16x32_bf16 a[56:59], v[132:135], a[172:175], a[56:59]
    ds_read_b64_tr_b16 v[122:123], v2 offset:23168
    v_mfma_f32_16x16x32_bf16 a[60:63], v[128:131], a[176:179], a[60:63]
    ds_read_b64_tr_b16 v[124:125], v2 offset:27776
    v_mfma_f32_16x16x32_bf16 a[60:63], v[132:135], a[180:183], a[60:63]
    ds_read_b64_tr_b16 v[126:127], v2 offset:32384
    v_mfma_f32_16x16x32_bf16 a[64:67], v[128:131], a[184:187], a[64:67]
    ds_read_b64_tr_b16 v[96:97], v3 offset:18432
    v_mfma_f32_16x16x32_bf16 a[64:67], v[132:135], a[188:191], a[64:67]
    ds_read_b64_tr_b16 v[98:99], v3 offset:23040
    v_mfma_f32_16x16x32_bf16 a[68:71], v[128:131], a[192:195], a[68:71]
    ds_read_b64_tr_b16 v[100:101], v3 offset:27648
    v_mfma_f32_16x16x32_bf16 a[68:71], v[132:135], a[196:199], a[68:71]
    ds_read_b64_tr_b16 v[102:103], v3 offset:32256
    v_mfma_f32_16x16x32_bf16 a[72:75], v[128:131], a[200:203], a[72:75]
    ds_read_b64_tr_b16 v[104:105], v4 offset:18432
    v_mfma_f32_16x16x32_bf16 a[72:75], v[132:135], a[204:207], a[72:75]
    ds_read_b64_tr_b16 v[106:107], v4 offset:23040
    v_mfma_f32_16x16x32_bf16 a[76:79], v[128:131], a[208:211], a[76:79]
    s_waitcnt vmcnt(0) lgkmcnt(14)
    ds_read_b64_tr_b16 v[108:109], v4 offset:27648
    v_mfma_f32_16x16x32_bf16 a[76:79], v[132:135], a[212:215], a[76:79]
    ds_read_b64_tr_b16 v[110:111], v4 offset:32256
    v_mfma_f32_16x16x32_bf16 a[80:83], v[128:131], a[216:219], a[80:83]
    ds_read_b64_tr_b16 v[80:81], v1 offset:18432
    v_mfma_f32_16x16x32_bf16 a[80:83], v[132:135], a[220:223], a[80:83]
    ds_read_b64_tr_b16 v[82:83], v1 offset:23040
    v_mfma_f32_16x16x32_bf16 a[84:87], v[72:75], a[112:115], a[84:87]
    ds_read_b64_tr_b16 v[84:85], v1 offset:27648
    v_mfma_f32_16x16x32_bf16 a[84:87], v[76:79], a[116:119], a[84:87]
    ds_read_b64_tr_b16 v[86:87], v1 offset:32256
    v_mfma_f32_16x16x32_bf16 a[84:87], v[136:139], a[168:171], a[84:87]
    ds_read_b64_tr_b16 v[88:89], v2 offset:18432
    v_mfma_f32_16x16x32_bf16 a[84:87], v[140:143], a[172:175], a[84:87]
    ds_read_b64_tr_b16 v[90:91], v2 offset:23040
    v_mfma_f32_16x16x32_bf16 a[88:91], v[72:75], a[120:123], a[88:91]
    ds_read_b64_tr_b16 v[92:93], v2 offset:27648
    v_mfma_f32_16x16x32_bf16 a[88:91], v[76:79], a[124:127], a[88:91]
    ds_read_b64_tr_b16 v[94:95], v2 offset:32256
    v_mfma_f32_16x16x32_bf16 a[88:91], v[136:139], a[176:179], a[88:91]
    v_mfma_f32_16x16x32_bf16 a[88:91], v[140:143], a[180:183], a[88:91]
    v_mfma_f32_16x16x32_bf16 a[92:95], v[72:75], a[128:131], a[92:95]
    v_mfma_f32_16x16x32_bf16 a[92:95], v[76:79], a[132:135], a[92:95]
    v_mfma_f32_16x16x32_bf16 a[92:95], v[136:139], a[184:187], a[92:95]
    v_mfma_f32_16x16x32_bf16 a[92:95], v[140:143], a[188:191], a[92:95]
    v_mfma_f32_16x16x32_bf16 a[96:99], v[72:75], a[136:139], a[96:99]
    v_mfma_f32_16x16x32_bf16 a[96:99], v[76:79], a[140:143], a[96:99]
    v_mfma_f32_16x16x32_bf16 a[96:99], v[136:139], a[192:195], a[96:99]
    v_mfma_f32_16x16x32_bf16 a[96:99], v[140:143], a[196:199], a[96:99]
    v_mfma_f32_16x16x32_bf16 a[100:103], v[72:75], a[144:147], a[100:103]
    v_mfma_f32_16x16x32_bf16 a[100:103], v[76:79], a[148:151], a[100:103]
    v_mfma_f32_16x16x32_bf16 a[100:103], v[136:139], a[200:203], a[100:103]
    v_mfma_f32_16x16x32_bf16 a[100:103], v[140:143], a[204:207], a[100:103]
    v_mfma_f32_16x16x32_bf16 a[104:107], v[72:75], a[152:155], a[104:107]
    v_mfma_f32_16x16x32_bf16 a[104:107], v[76:79], a[156:159], a[104:107]
    v_mfma_f32_16x16x32_bf16 a[104:107], v[136:139], a[208:211], a[104:107]
    v_mfma_f32_16x16x32_bf16 a[104:107], v[140:143], a[212:215], a[104:107]
    v_mfma_f32_16x16x32_bf16 a[108:111], v[72:75], a[160:163], a[108:111]
    v_mfma_f32_16x16x32_bf16 a[108:111], v[76:79], a[164:167], a[108:111]
    v_mfma_f32_16x16x32_bf16 a[108:111], v[136:139], a[216:219], a[108:111]
    s_waitcnt lgkmcnt(0)
    v_mfma_f32_16x16x32_bf16 a[108:111], v[140:143], a[220:223], a[108:111]
    v_mfma_f32_16x16x32_bf16 a[0:3], v[48:51], a[112:115], a[0:3]
    v_mfma_f32_16x16x32_bf16 a[0:3], v[52:55], a[116:119], a[0:3]
    ds_write_b128 v8, a[56:59] offset:0
    v_mfma_f32_16x16x32_bf16 a[0:3], v[112:115], a[168:171], a[0:3]
    v_mfma_f32_16x16x32_bf16 a[0:3], v[116:119], a[172:175], a[0:3]
    v_mfma_f32_16x16x32_bf16 a[4:7], v[48:51], a[120:123], a[4:7]
    ds_write_b128 v8, a[60:63] offset:1024
    v_mfma_f32_16x16x32_bf16 a[4:7], v[52:55], a[124:127], a[4:7]
    v_mfma_f32_16x16x32_bf16 a[4:7], v[112:115], a[176:179], a[4:7]
    v_mfma_f32_16x16x32_bf16 a[4:7], v[116:119], a[180:183], a[4:7]
    v_mfma_f32_16x16x32_bf16 a[8:11], v[48:51], a[128:131], a[8:11]
    ds_write_b128 v8, a[64:67] offset:2048
    v_mfma_f32_16x16x32_bf16 a[8:11], v[52:55], a[132:135], a[8:11]
    v_mfma_f32_16x16x32_bf16 a[8:11], v[112:115], a[184:187], a[8:11]
    v_mfma_f32_16x16x32_bf16 a[8:11], v[116:119], a[188:191], a[8:11]
    v_mfma_f32_16x16x32_bf16 a[12:15], v[48:51], a[136:139], a[12:15]
    ds_write_b128 v8, a[68:71] offset:3072
    v_mfma_f32_16x16x32_bf16 a[12:15], v[52:55], a[140:143], a[12:15]
    v_mfma_f32_16x16x32_bf16 a[12:15], v[112:115], a[192:195], a[12:15]
    v_mfma_f32_16x16x32_bf16 a[12:15], v[116:119], a[196:199], a[12:15]
    v_mfma_f32_16x16x32_bf16 a[16:19], v[48:51], a[144:147], a[16:19]
    ds_write_b128 v8, a[72:75] offset:4096
    v_mfma_f32_16x16x32_bf16 a[16:19], v[52:55], a[148:151], a[16:19]
    v_mfma_f32_16x16x32_bf16 a[16:19], v[112:115], a[200:203], a[16:19]
    v_mfma_f32_16x16x32_bf16 a[16:19], v[116:119], a[204:207], a[16:19]
    v_mfma_f32_16x16x32_bf16 a[20:23], v[48:51], a[152:155], a[20:23]
    ds_write_b128 v8, a[76:79] offset:5120
    v_mfma_f32_16x16x32_bf16 a[20:23], v[52:55], a[156:159], a[20:23]
    v_mfma_f32_16x16x32_bf16 a[20:23], v[112:115], a[208:211], a[20:23]
    v_mfma_f32_16x16x32_bf16 a[20:23], v[116:119], a[212:215], a[20:23]
    v_mfma_f32_16x16x32_bf16 a[24:27], v[48:51], a[160:163], a[24:27]
    ds_write_b128 v8, a[80:83] offset:6144
    v_mfma_f32_16x16x32_bf16 a[24:27], v[52:55], a[164:167], a[24:27]
    v_mfma_f32_16x16x32_bf16 a[24:27], v[112:115], a[216:219], a[24:27]
    v_mfma_f32_16x16x32_bf16 a[24:27], v[116:119], a[220:223], a[24:27]
    v_mfma_f32_16x16x32_bf16 a[28:31], v[56:59], a[112:115], a[28:31]
    ds_write_b128 v8, a[84:87] offset:7168
    v_mfma_f32_16x16x32_bf16 a[28:31], v[60:63], a[116:119], a[28:31]
    v_mfma_f32_16x16x32_bf16 a[28:31], v[120:123], a[168:171], a[28:31]
    v_mfma_f32_16x16x32_bf16 a[28:31], v[124:127], a[172:175], a[28:31]
    v_mfma_f32_16x16x32_bf16 a[32:35], v[56:59], a[120:123], a[32:35]
    ds_write_b128 v8, a[88:91] offset:8192
    v_mfma_f32_16x16x32_bf16 a[32:35], v[60:63], a[124:127], a[32:35]
    v_mfma_f32_16x16x32_bf16 a[32:35], v[120:123], a[176:179], a[32:35]
    v_mfma_f32_16x16x32_bf16 a[32:35], v[124:127], a[180:183], a[32:35]
    v_mfma_f32_16x16x32_bf16 a[36:39], v[56:59], a[128:131], a[36:39]
    ds_write_b128 v8, a[92:95] offset:9216
    v_mfma_f32_16x16x32_bf16 a[36:39], v[60:63], a[132:135], a[36:39]
    v_mfma_f32_16x16x32_bf16 a[36:39], v[120:123], a[184:187], a[36:39]
    v_mfma_f32_16x16x32_bf16 a[36:39], v[124:127], a[188:191], a[36:39]
    v_mfma_f32_16x16x32_bf16 a[40:43], v[56:59], a[136:139], a[40:43]
    ds_write_b128 v8, a[96:99] offset:10240
    v_mfma_f32_16x16x32_bf16 a[40:43], v[60:63], a[140:143], a[40:43]
    v_mfma_f32_16x16x32_bf16 a[40:43], v[120:123], a[192:195], a[40:43]
    v_mfma_f32_16x16x32_bf16 a[40:43], v[124:127], a[196:199], a[40:43]
    v_mfma_f32_16x16x32_bf16 a[44:47], v[56:59], a[144:147], a[44:47]
    ds_write_b128 v8, a[100:103] offset:11264
    v_mfma_f32_16x16x32_bf16 a[44:47], v[60:63], a[148:151], a[44:47]
    v_mfma_f32_16x16x32_bf16 a[44:47], v[120:123], a[200:203], a[44:47]
    v_mfma_f32_16x16x32_bf16 a[44:47], v[124:127], a[204:207], a[44:47]
    v_mfma_f32_16x16x32_bf16 a[48:51], v[56:59], a[152:155], a[48:51]
    ds_write_b128 v8, a[104:107] offset:12288
    v_mfma_f32_16x16x32_bf16 a[48:51], v[60:63], a[156:159], a[48:51]
    v_mfma_f32_16x16x32_bf16 a[48:51], v[120:123], a[208:211], a[48:51]
    v_mfma_f32_16x16x32_bf16 a[48:51], v[124:127], a[212:215], a[48:51]
    v_mfma_f32_16x16x32_bf16 a[52:55], v[56:59], a[160:163], a[52:55]
    ds_write_b128 v8, a[108:111] offset:13312
    v_mfma_f32_16x16x32_bf16 a[52:55], v[60:63], a[164:167], a[52:55]
    v_mfma_f32_16x16x32_bf16 a[52:55], v[120:123], a[216:219], a[52:55]
    v_mfma_f32_16x16x32_bf16 a[52:55], v[124:127], a[220:223], a[52:55]
    v_mfma_f32_16x16x32_bf16 v[200:203], v[32:35], a[112:115], v[200:203]
    v_mfma_f32_16x16x32_bf16 v[200:203], v[36:39], a[116:119], v[200:203]
    s_waitcnt lgkmcnt(0)
    v_mfma_f32_16x16x32_bf16 v[200:203], v[96:99], a[168:171], v[200:203]
    s_barrier
    v_mfma_f32_16x16x32_bf16 v[200:203], v[100:103], a[172:175], v[200:203]
    ds_write_b128 v8, a[0:3] offset:14336
    v_mfma_f32_16x16x32_bf16 v[204:207], v[32:35], a[120:123], v[204:207]
    v_mfma_f32_16x16x32_bf16 v[204:207], v[36:39], a[124:127], v[204:207]
    ds_read_b128 v[48:51], v10 offset:0
    v_mfma_f32_16x16x32_bf16 v[204:207], v[96:99], a[176:179], v[204:207]
    ds_write_b128 v8, a[4:7] offset:15360
    v_mfma_f32_16x16x32_bf16 v[204:207], v[100:103], a[180:183], v[204:207]
    v_mfma_f32_16x16x32_bf16 v[208:211], v[32:35], a[128:131], v[208:211]
    ds_read_b128 v[52:55], v10 offset:1024
    v_mfma_f32_16x16x32_bf16 v[208:211], v[36:39], a[132:135], v[208:211]
    v_mfma_f32_16x16x32_bf16 v[208:211], v[96:99], a[184:187], v[208:211]
    ds_write_b128 v8, a[8:11] offset:16384
    v_mfma_f32_16x16x32_bf16 v[208:211], v[100:103], a[188:191], v[208:211]
    v_mfma_f32_16x16x32_bf16 v[212:215], v[32:35], a[136:139], v[212:215]
    ds_read_b128 v[56:59], v10 offset:2048
    v_mfma_f32_16x16x32_bf16 v[212:215], v[36:39], a[140:143], v[212:215]
    v_mfma_f32_16x16x32_bf16 v[212:215], v[96:99], a[192:195], v[212:215]
    ds_write_b128 v8, a[12:15] offset:17408
    v_mfma_f32_16x16x32_bf16 v[212:215], v[100:103], a[196:199], v[212:215]
    v_mfma_f32_16x16x32_bf16 v[216:219], v[32:35], a[144:147], v[216:219]
    ds_read_b128 v[60:63], v10 offset:3072
    v_mfma_f32_16x16x32_bf16 v[216:219], v[36:39], a[148:151], v[216:219]
    ds_write_b128 v8, a[16:19] offset:18432
    v_mfma_f32_16x16x32_bf16 v[216:219], v[96:99], a[200:203], v[216:219]
    v_mfma_f32_16x16x32_bf16 v[216:219], v[100:103], a[204:207], v[216:219]
    ds_read_b128 v[64:67], v10 offset:4096
    v_mfma_f32_16x16x32_bf16 v[220:223], v[32:35], a[152:155], v[220:223]
    v_mfma_f32_16x16x32_bf16 v[220:223], v[36:39], a[156:159], v[220:223]
    ds_write_b128 v8, a[20:23] offset:19456
    v_mfma_f32_16x16x32_bf16 v[220:223], v[96:99], a[208:211], v[220:223]
    v_mfma_f32_16x16x32_bf16 v[220:223], v[100:103], a[212:215], v[220:223]
    ds_read_b128 v[68:71], v10 offset:5120
    v_mfma_f32_16x16x32_bf16 v[224:227], v[32:35], a[160:163], v[224:227]
    v_mfma_f32_16x16x32_bf16 v[224:227], v[36:39], a[164:167], v[224:227]
    ds_write_b128 v8, a[24:27] offset:20480
    v_mfma_f32_16x16x32_bf16 v[224:227], v[96:99], a[216:219], v[224:227]
    v_mfma_f32_16x16x32_bf16 v[224:227], v[100:103], a[220:223], v[224:227]
    ds_read_b128 v[72:75], v10 offset:6144
    v_mfma_f32_16x16x32_bf16 v[228:231], v[40:43], a[112:115], v[228:231]
    v_mfma_f32_16x16x32_bf16 v[228:231], v[44:47], a[116:119], v[228:231]
    ds_write_b128 v8, a[28:31] offset:21504
    v_mfma_f32_16x16x32_bf16 v[228:231], v[104:107], a[168:171], v[228:231]
    v_mfma_f32_16x16x32_bf16 v[228:231], v[108:111], a[172:175], v[228:231]
    ds_read_b128 v[76:79], v10 offset:7168
    v_mfma_f32_16x16x32_bf16 v[232:235], v[40:43], a[120:123], v[232:235]
    ds_write_b128 v8, a[32:35] offset:22528
    v_mfma_f32_16x16x32_bf16 v[232:235], v[44:47], a[124:127], v[232:235]
    v_mfma_f32_16x16x32_bf16 v[232:235], v[104:107], a[176:179], v[232:235]
    ds_read_b128 v[112:115], v10 offset:8192
    v_mfma_f32_16x16x32_bf16 v[232:235], v[108:111], a[180:183], v[232:235]
    v_mfma_f32_16x16x32_bf16 v[236:239], v[40:43], a[128:131], v[236:239]
    ds_write_b128 v8, a[36:39] offset:23552
    v_mfma_f32_16x16x32_bf16 v[236:239], v[44:47], a[132:135], v[236:239]
    v_mfma_f32_16x16x32_bf16 v[236:239], v[104:107], a[184:187], v[236:239]
    ds_read_b128 v[116:119], v10 offset:9216
    v_mfma_f32_16x16x32_bf16 v[236:239], v[108:111], a[188:191], v[236:239]
    v_mfma_f32_16x16x32_bf16 v[240:243], v[40:43], a[136:139], v[240:243]
    ds_write_b128 v8, a[40:43] offset:24576
    v_mfma_f32_16x16x32_bf16 v[240:243], v[44:47], a[140:143], v[240:243]
    v_mfma_f32_16x16x32_bf16 v[240:243], v[104:107], a[192:195], v[240:243]
    ds_read_b128 v[120:123], v10 offset:10240
    v_mfma_f32_16x16x32_bf16 v[240:243], v[108:111], a[196:199], v[240:243]
    ds_write_b128 v8, a[44:47] offset:25600
    v_mfma_f32_16x16x32_bf16 v[244:247], v[40:43], a[144:147], v[244:247]
    v_mfma_f32_16x16x32_bf16 v[244:247], v[44:47], a[148:151], v[244:247]
    ds_read_b128 v[124:127], v10 offset:11264
    v_mfma_f32_16x16x32_bf16 v[244:247], v[104:107], a[200:203], v[244:247]
    v_mfma_f32_16x16x32_bf16 v[244:247], v[108:111], a[204:207], v[244:247]
    ds_write_b128 v8, a[48:51] offset:26624
    v_mfma_f32_16x16x32_bf16 v[248:251], v[40:43], a[152:155], v[248:251]
    v_mfma_f32_16x16x32_bf16 v[248:251], v[44:47], a[156:159], v[248:251]
    ds_read_b128 v[128:131], v10 offset:12288
    v_mfma_f32_16x16x32_bf16 v[248:251], v[104:107], a[208:211], v[248:251]
    v_mfma_f32_16x16x32_bf16 v[248:251], v[108:111], a[212:215], v[248:251]
    ds_write_b128 v8, a[52:55] offset:27648
    v_mfma_f32_16x16x32_bf16 v[252:255], v[40:43], a[160:163], v[252:255]
    v_mfma_f32_16x16x32_bf16 v[252:255], v[44:47], a[164:167], v[252:255]
    ds_read_b128 v[132:135], v10 offset:13312
    v_mfma_f32_16x16x32_bf16 v[252:255], v[104:107], a[216:219], v[252:255]
    v_mfma_f32_16x16x32_bf16 v[252:255], v[108:111], a[220:223], v[252:255]
    v_mfma_f32_16x16x32_bf16 v[144:147], v[16:19], a[112:115], v[144:147]
    v_mfma_f32_16x16x32_bf16 v[144:147], v[20:23], a[116:119], v[144:147]
    s_waitcnt lgkmcnt(0)
    v_mfma_f32_16x16x32_bf16 v[144:147], v[80:83], a[168:171], v[144:147]
    s_barrier
    v_mfma_f32_16x16x32_bf16 v[144:147], v[84:87], a[172:175], v[144:147]
    ds_write_b128 v10, v[200:203] offset:0
    v_mfma_f32_16x16x32_bf16 v[148:151], v[16:19], a[120:123], v[148:151]
    v_mfma_f32_16x16x32_bf16 v[148:151], v[20:23], a[124:127], v[148:151]
    ds_read_b128 v[32:35], v9 offset:14336
    v_mfma_f32_16x16x32_bf16 v[148:151], v[80:83], a[176:179], v[148:151]
    ds_write_b128 v10, v[204:207] offset:1024
    v_mfma_f32_16x16x32_bf16 v[148:151], v[84:87], a[180:183], v[148:151]
    v_mfma_f32_16x16x32_bf16 v[152:155], v[16:19], a[128:131], v[152:155]
    ds_read_b128 v[36:39], v9 offset:15360
    v_mfma_f32_16x16x32_bf16 v[152:155], v[20:23], a[132:135], v[152:155]
    ds_write_b128 v10, v[208:211] offset:2048
    v_mfma_f32_16x16x32_bf16 v[152:155], v[80:83], a[184:187], v[152:155]
    v_mfma_f32_16x16x32_bf16 v[152:155], v[84:87], a[188:191], v[152:155]
    ds_read_b128 v[40:43], v9 offset:16384
    v_mfma_f32_16x16x32_bf16 v[156:159], v[16:19], a[136:139], v[156:159]
    ds_write_b128 v10, v[212:215] offset:3072
    v_mfma_f32_16x16x32_bf16 v[156:159], v[20:23], a[140:143], v[156:159]
    v_mfma_f32_16x16x32_bf16 v[156:159], v[80:83], a[192:195], v[156:159]
    ds_read_b128 v[44:47], v9 offset:17408
    v_mfma_f32_16x16x32_bf16 v[156:159], v[84:87], a[196:199], v[156:159]
    v_mfma_f32_16x16x32_bf16 v[160:163], v[16:19], a[144:147], v[160:163]
    ds_write_b128 v10, v[216:219] offset:4096
    v_mfma_f32_16x16x32_bf16 v[160:163], v[20:23], a[148:151], v[160:163]
    v_mfma_f32_16x16x32_bf16 v[160:163], v[80:83], a[200:203], v[160:163]
    ds_read_b128 v[96:99], v9 offset:18432
    v_mfma_f32_16x16x32_bf16 v[160:163], v[84:87], a[204:207], v[160:163]
    ds_write_b128 v10, v[220:223] offset:5120
    v_mfma_f32_16x16x32_bf16 v[164:167], v[16:19], a[152:155], v[164:167]
    v_mfma_f32_16x16x32_bf16 v[164:167], v[20:23], a[156:159], v[164:167]
    ds_read_b128 v[100:103], v9 offset:19456
    v_mfma_f32_16x16x32_bf16 v[164:167], v[80:83], a[208:211], v[164:167]
    ds_write_b128 v10, v[224:227] offset:6144
    v_mfma_f32_16x16x32_bf16 v[164:167], v[84:87], a[212:215], v[164:167]
    v_mfma_f32_16x16x32_bf16 v[168:171], v[16:19], a[160:163], v[168:171]
    ds_read_b128 v[104:107], v9 offset:20480
    v_mfma_f32_16x16x32_bf16 v[168:171], v[20:23], a[164:167], v[168:171]
    v_mfma_f32_16x16x32_bf16 v[168:171], v[80:83], a[216:219], v[168:171]
    ds_write_b128 v10, v[228:231] offset:7168
    v_mfma_f32_16x16x32_bf16 v[168:171], v[84:87], a[220:223], v[168:171]
    v_mfma_f32_16x16x32_bf16 v[172:175], v[24:27], a[112:115], v[172:175]
    ds_read_b128 v[108:111], v9 offset:21504
    v_mfma_f32_16x16x32_bf16 v[172:175], v[28:31], a[116:119], v[172:175]
    ds_write_b128 v10, v[232:235] offset:8192
    v_mfma_f32_16x16x32_bf16 v[172:175], v[88:91], a[168:171], v[172:175]
    v_mfma_f32_16x16x32_bf16 v[172:175], v[92:95], a[172:175], v[172:175]
    ds_read_b128 v[136:139], v9 offset:22528
    v_mfma_f32_16x16x32_bf16 v[176:179], v[24:27], a[120:123], v[176:179]
    ds_write_b128 v10, v[236:239] offset:9216
    v_mfma_f32_16x16x32_bf16 v[176:179], v[28:31], a[124:127], v[176:179]
    v_mfma_f32_16x16x32_bf16 v[176:179], v[88:91], a[176:179], v[176:179]
    ds_read_b128 v[140:143], v9 offset:23552
    v_mfma_f32_16x16x32_bf16 v[176:179], v[92:95], a[180:183], v[176:179]
    ds_write_b128 v10, v[240:243] offset:10240
    v_mfma_f32_16x16x32_bf16 v[180:183], v[24:27], a[128:131], v[180:183]
    v_mfma_f32_16x16x32_bf16 v[180:183], v[28:31], a[132:135], v[180:183]
    v_mfma_f32_16x16x32_bf16 v[180:183], v[88:91], a[184:187], v[180:183]
    v_mfma_f32_16x16x32_bf16 v[180:183], v[92:95], a[188:191], v[180:183]
    s_waitcnt lgkmcnt(5)
    ds_write_b128 v10, v[244:247] offset:11264
    v_mfma_f32_16x16x32_bf16 v[184:187], v[24:27], a[136:139], v[184:187]
    v_add_f32 v48, v48, v32
    v_add_f32 v49, v49, v33
    v_mfma_f32_16x16x32_bf16 v[184:187], v[28:31], a[140:143], v[184:187]
    v_add_f32 v50, v50, v34
    v_add_f32 v51, v51, v35
    v_mfma_f32_16x16x32_bf16 v[184:187], v[88:91], a[192:195], v[184:187]
    ds_write_b128 v10, v[248:251] offset:12288
    v_add_f32 v52, v52, v36
    v_add_f32 v53, v53, v37
    v_mfma_f32_16x16x32_bf16 v[184:187], v[92:95], a[196:199], v[184:187]
    v_add_f32 v54, v54, v38
    v_add_f32 v55, v55, v39
    v_mfma_f32_16x16x32_bf16 v[188:191], v[24:27], a[144:147], v[188:191]
    v_add_f32 v56, v56, v40
    v_add_f32 v57, v57, v41
    v_mfma_f32_16x16x32_bf16 v[188:191], v[28:31], a[148:151], v[188:191]
    ds_write_b128 v10, v[252:255] offset:13312
    v_add_f32 v58, v58, v42
    v_add_f32 v59, v59, v43
    v_mfma_f32_16x16x32_bf16 v[188:191], v[88:91], a[200:203], v[188:191]
    v_add_f32 v60, v60, v44
    v_add_f32 v61, v61, v45
    v_mfma_f32_16x16x32_bf16 v[188:191], v[92:95], a[204:207], v[188:191]
    v_add_f32 v62, v62, v46
    v_add_f32 v63, v63, v47
    v_mfma_f32_16x16x32_bf16 v[192:195], v[24:27], a[152:155], v[192:195]
    v_add_f32 v64, v64, v96
    v_add_f32 v65, v65, v97
    v_mfma_f32_16x16x32_bf16 v[192:195], v[28:31], a[156:159], v[192:195]
    v_add_f32 v66, v66, v98
    v_add_f32 v67, v67, v99
    v_mfma_f32_16x16x32_bf16 v[192:195], v[88:91], a[208:211], v[192:195]
    v_add_f32 v68, v68, v100
    v_add_f32 v69, v69, v101
    v_mfma_f32_16x16x32_bf16 v[192:195], v[92:95], a[212:215], v[192:195]
    v_add_f32 v70, v70, v102
    v_add_f32 v71, v71, v103
    v_mfma_f32_16x16x32_bf16 v[196:199], v[24:27], a[160:163], v[196:199]
    v_add_f32 v72, v72, v104
    v_add_f32 v73, v73, v105
    v_mfma_f32_16x16x32_bf16 v[196:199], v[28:31], a[164:167], v[196:199]
    v_add_f32 v74, v74, v106
    v_add_f32 v75, v75, v107
    v_mfma_f32_16x16x32_bf16 v[196:199], v[88:91], a[216:219], v[196:199]
    v_add_f32 v76, v76, v108
    v_add_f32 v77, v77, v109
    v_mfma_f32_16x16x32_bf16 v[196:199], v[92:95], a[220:223], v[196:199]
    v_add_f32 v78, v78, v110
    v_add_f32 v79, v79, v111
    ds_read_b128 v[32:35], v9 offset:24576
    ds_read_b128 v[36:39], v9 offset:25600
    ds_read_b128 v[40:43], v9 offset:26624
    ds_read_b128 v[44:47], v9 offset:27648
    s_waitcnt lgkmcnt(4)
    s_barrier
    ds_read_b128 v[16:19], v9 offset:0
    ds_read_b128 v[92:95], v9 offset:7168
    ds_read_b128 v[20:23], v9 offset:1024
    ds_read_b128 v[200:203], v9 offset:8192
    ds_read_b128 v[24:27], v9 offset:2048
    ds_read_b128 v[204:207], v9 offset:9216
    ds_read_b128 v[28:31], v9 offset:3072
    ds_read_b128 v[208:211], v9 offset:10240
    ds_read_b128 v[80:83], v9 offset:4096
    ds_read_b128 v[212:215], v9 offset:11264
    ds_read_b128 v[84:87], v9 offset:5120
    ds_read_b128 v[216:219], v9 offset:12288
    ds_read_b128 v[88:91], v9 offset:6144
    ds_read_b128 v[220:223], v9 offset:13312
    v_pk_add_f32 v[112:113], v[112:113], v[136:137]
    v_pk_add_f32 v[114:115], v[114:115], v[138:139]
    v_pk_add_f32 v[116:117], v[116:117], v[140:141]
    v_pk_add_f32 v[118:119], v[118:119], v[142:143]
    s_waitcnt lgkmcnt(14)
    v_pk_add_f32 v[120:121], v[120:121], v[32:33]
    v_pk_add_f32 v[122:123], v[122:123], v[34:35]
    v_pk_add_f32 v[124:125], v[124:125], v[36:37]
    v_pk_add_f32 v[126:127], v[126:127], v[38:39]
    v_pk_add_f32 v[128:129], v[128:129], v[40:41]
    v_pk_add_f32 v[130:131], v[130:131], v[42:43]
    v_pk_add_f32 v[132:133], v[132:133], v[44:45]
    v_pk_add_f32 v[134:135], v[134:135], v[46:47]
    v_pk_add_f32 v[144:145], v[144:145], v[48:49]
    v_pk_add_f32 v[146:147], v[146:147], v[50:51]
    v_pk_add_f32 v[172:173], v[172:173], v[76:77]
    v_pk_add_f32 v[174:175], v[174:175], v[78:79]
    v_pk_add_f32 v[148:149], v[148:149], v[52:53]
    v_pk_add_f32 v[150:151], v[150:151], v[54:55]
    v_pk_add_f32 v[176:177], v[176:177], v[112:113]
    v_pk_add_f32 v[178:179], v[178:179], v[114:115]
    v_pk_add_f32 v[152:153], v[152:153], v[56:57]
    v_pk_add_f32 v[154:155], v[154:155], v[58:59]
    v_pk_add_f32 v[180:181], v[180:181], v[116:117]
    v_pk_add_f32 v[182:183], v[182:183], v[118:119]
    v_pk_add_f32 v[156:157], v[156:157], v[60:61]
    v_pk_add_f32 v[158:159], v[158:159], v[62:63]
    v_pk_add_f32 v[184:185], v[184:185], v[120:121]
    v_pk_add_f32 v[186:187], v[186:187], v[122:123]
    v_pk_add_f32 v[160:161], v[160:161], v[64:65]
    v_pk_add_f32 v[162:163], v[162:163], v[66:67]
    v_pk_add_f32 v[188:189], v[188:189], v[124:125]
    v_pk_add_f32 v[190:191], v[190:191], v[126:127]
    v_pk_add_f32 v[164:165], v[164:165], v[68:69]
    v_pk_add_f32 v[166:167], v[166:167], v[70:71]
    v_pk_add_f32 v[192:193], v[192:193], v[128:129]
    v_pk_add_f32 v[194:195], v[194:195], v[130:131]
    v_pk_add_f32 v[168:169], v[168:169], v[72:73]
    v_pk_add_f32 v[170:171], v[170:171], v[74:75]
    v_pk_add_f32 v[196:197], v[196:197], v[132:133]
    v_pk_add_f32 v[198:199], v[198:199], v[134:135]
    s_waitcnt lgkmcnt(10)
    v_pk_add_f32 v[144:145], v[144:145], v[16:17]
    v_pk_add_f32 v[146:147], v[146:147], v[18:19]
    v_pk_add_f32 v[172:173], v[172:173], v[92:93]
    v_pk_add_f32 v[174:175], v[174:175], v[94:95]
    v_cvt_pk_bf16_f32 v224, v144, v145
    v_cvt_pk_bf16_f32 v225, v146, v147
    v_cvt_pk_bf16_f32 v226, v172, v173
    v_cvt_pk_bf16_f32 v227, v174, v175
    s_nop 0
    s_mov_b32 s49, 0
    v_permlane32_swap_b32 v224, v226
    v_permlane32_swap_b32 v225, v227
    v_pk_add_f32 v[148:149], v[148:149], v[20:21]
    v_pk_add_f32 v[150:151], v[150:151], v[22:23]
    v_pk_add_f32 v[176:177], v[176:177], v[200:201]
    v_pk_add_f32 v[178:179], v[178:179], v[202:203]
    v_cvt_pk_bf16_f32 v228, v148, v149
    v_cvt_pk_bf16_f32 v229, v150, v151
    v_cvt_pk_bf16_f32 v230, v176, v177
    v_cvt_pk_bf16_f32 v231, v178, v179
    v_permlane16_swap_b32 v224, v226
    v_permlane16_swap_b32 v225, v227
    buffer_store_dwordx4 v[224:227], v7, s[12:15], s49 offen
    s_mov_b32 s58, 65536
    v_permlane32_swap_b32 v228, v230
    v_permlane32_swap_b32 v229, v231
    s_waitcnt lgkmcnt(6)
    v_pk_add_f32 v[152:153], v[152:153], v[24:25]
    v_pk_add_f32 v[154:155], v[154:155], v[26:27]
    v_pk_add_f32 v[180:181], v[180:181], v[204:205]
    v_pk_add_f32 v[182:183], v[182:183], v[206:207]
    v_cvt_pk_bf16_f32 v232, v152, v153
    v_cvt_pk_bf16_f32 v233, v154, v155
    v_cvt_pk_bf16_f32 v234, v180, v181
    v_cvt_pk_bf16_f32 v235, v182, v183
    v_permlane16_swap_b32 v228, v230
    v_permlane16_swap_b32 v229, v231
    buffer_store_dwordx4 v[228:231], v7, s[12:15], s58 offen
    s_mov_b32 s49, 131072
    v_permlane32_swap_b32 v232, v234
    v_permlane32_swap_b32 v233, v235
    v_pk_add_f32 v[156:157], v[156:157], v[28:29]
    v_pk_add_f32 v[158:159], v[158:159], v[30:31]
    v_pk_add_f32 v[184:185], v[184:185], v[208:209]
    v_pk_add_f32 v[186:187], v[186:187], v[210:211]
    v_cvt_pk_bf16_f32 v236, v156, v157
    v_cvt_pk_bf16_f32 v237, v158, v159
    v_cvt_pk_bf16_f32 v238, v184, v185
    v_cvt_pk_bf16_f32 v239, v186, v187
    v_permlane16_swap_b32 v232, v234
    v_permlane16_swap_b32 v233, v235
    buffer_store_dwordx4 v[232:235], v7, s[12:15], s49 offen
    s_mov_b32 s58, 196608
    v_permlane32_swap_b32 v236, v238
    v_permlane32_swap_b32 v237, v239
    s_waitcnt lgkmcnt(0)
    v_pk_add_f32 v[160:161], v[160:161], v[80:81]
    v_pk_add_f32 v[162:163], v[162:163], v[82:83]
    v_pk_add_f32 v[188:189], v[188:189], v[212:213]
    v_pk_add_f32 v[190:191], v[190:191], v[214:215]
    v_cvt_pk_bf16_f32 v240, v160, v161
    v_cvt_pk_bf16_f32 v241, v162, v163
    v_cvt_pk_bf16_f32 v242, v188, v189
    v_cvt_pk_bf16_f32 v243, v190, v191
    v_permlane16_swap_b32 v236, v238
    v_permlane16_swap_b32 v237, v239
    buffer_store_dwordx4 v[236:239], v7, s[12:15], s58 offen
    s_mov_b32 s49, 262144
    v_permlane32_swap_b32 v240, v242
    v_permlane32_swap_b32 v241, v243
    v_pk_add_f32 v[164:165], v[164:165], v[84:85]
    v_pk_add_f32 v[166:167], v[166:167], v[86:87]
    v_pk_add_f32 v[192:193], v[192:193], v[216:217]
    v_pk_add_f32 v[194:195], v[194:195], v[218:219]
    v_cvt_pk_bf16_f32 v244, v164, v165
    v_cvt_pk_bf16_f32 v245, v166, v167
    v_cvt_pk_bf16_f32 v246, v192, v193
    v_cvt_pk_bf16_f32 v247, v194, v195
    v_permlane16_swap_b32 v240, v242
    v_permlane16_swap_b32 v241, v243
    buffer_store_dwordx4 v[240:243], v7, s[12:15], s49 offen
    s_mov_b32 s58, 327680
    v_permlane32_swap_b32 v244, v246
    v_permlane32_swap_b32 v245, v247
    v_pk_add_f32 v[168:169], v[168:169], v[88:89]
    v_pk_add_f32 v[170:171], v[170:171], v[90:91]
    v_pk_add_f32 v[196:197], v[196:197], v[220:221]
    v_pk_add_f32 v[198:199], v[198:199], v[222:223]
    v_cvt_pk_bf16_f32 v248, v168, v169
    v_cvt_pk_bf16_f32 v249, v170, v171
    v_cvt_pk_bf16_f32 v250, v196, v197
    v_cvt_pk_bf16_f32 v251, v198, v199
    v_permlane16_swap_b32 v244, v246
    v_permlane16_swap_b32 v245, v247
    buffer_store_dwordx4 v[244:247], v7, s[12:15], s58 offen
    s_mov_b32 s49, 393216
    v_permlane32_swap_b32 v248, v250
    v_permlane32_swap_b32 v249, v251
    s_nop 0
    v_permlane16_swap_b32 v248, v250
    v_permlane16_swap_b32 v249, v251
    buffer_store_dwordx4 v[248:251], v7, s[12:15], s49 offen
    s_waitcnt vmcnt(0)
L_end:
    s_endpgm
L_code_end:
L_slow:
    s_waitcnt vmcnt(0)
    s_barrier
    v_mov_b32 v1, 0xff800000
    v_mov_b32 v2, 0xff800000
    v_mov_b32 v3, 0xff800000
    v_mov_b32 v4, 0xff800000
    v_mov_b32 v5, 0xff800000
    v_mov_b32 v6, 0xff800000
    v_mov_b32 v7, 0xff800000
    s_mov_b32 s48, s42
    s_add_u32 m0, s52, 0
    s_nop 0
    buffer_load_dwordx4 v13, s[12:15], s48 offen nt lds
    s_add_u32 m0, m0, s53
    s_add_u32 s48, s48, 5120
    buffer_load_dwordx4 v13, s[12:15], s48 offen nt lds
    s_add_u32 m0, m0, s53
    s_add_u32 s48, s48, 5120
    buffer_load_dwordx4 v13, s[12:15], s48 offen nt lds
    s_add_u32 m0, m0, s53
    s_add_u32 s48, s48, 5120
    buffer_load_dwordx4 v13, s[12:15], s48 offen nt lds
    s_add_u32 m0, m0, s53
    s_add_u32 s48, s48, 1024
    buffer_load_dwordx4 v13, s[12:15], s48 offen nt lds
    s_add_u32 m0, m0, s53
    s_add_u32 s48, s48, 5120
    buffer_load_dwordx4 v13, s[12:15], s48 offen nt lds
    s_add_u32 m0, m0, s53
    s_add_u32 s48, s48, 5120
    buffer_load_dwordx4 v13, s[12:15], s48 offen nt lds
    s_add_u32 m0, m0, s53
    s_add_u32 s48, s48, 5120
    buffer_load_dwordx4 v13, s[12:15], s48 offen nt lds
    s_add_u32 s48, s48, -30720
    s_add_u32 m0, s52, 35840
    s_nop 0
    buffer_load_dwordx4 v13, s[12:15], s48 offen nt lds
    s_add_u32 m0, m0, s53
    s_add_u32 s48, s48, 5120
    buffer_load_dwordx4 v13, s[12:15], s48 offen nt lds
    s_add_u32 m0, m0, s53
    s_add_u32 s48, s48, 5120
    buffer_load_dwordx4 v13, s[12:15], s48 offen nt lds
    s_add_u32 m0, m0, s53
    s_add_u32 s48, s48, 1024
    buffer_load_dwordx4 v13, s[12:15], s48 offen nt lds
    s_add_u32 m0, m0, s53
    s_add_u32 s48, s48, 5120
    buffer_load_dwordx4 v13, s[12:15], s48 offen nt lds
    s_add_u32 m0, m0, s53
    s_add_u32 s48, s48, 5120
    buffer_load_dwordx4 v13, s[12:15], s48 offen nt lds
    s_add_u32 m0, m0, s53
    s_add_u32 s48, s48, 5120
    buffer_load_dwordx4 v13, s[12:15], s48 offen nt lds
    s_add_u32 m0, m0, s53
    s_add_u32 s48, s48, 1024
    buffer_load_dwordx4 v13, s[12:15], s48 offen nt lds
    s_add_u32 s48, s48, -26624
    s_add_u32 m0, s52, 71680
    s_nop 0
    buffer_load_dwordx4 v13, s[12:15], s48 offen nt lds
    s_add_u32 m0, m0, s53
    s_add_u32 s48, s48, 5120
    buffer_load_dwordx4 v13, s[12:15], s48 offen nt lds
    s_add_u32 m0, m0, s53
    s_add_u32 s48, s48, 1024
    buffer_load_dwordx4 v13, s[12:15], s48 offen nt lds
    s_add_u32 m0, m0, s53
    s_add_u32 s48, s48, 5120
    buffer_load_dwordx4 v13, s[12:15], s48 offen nt lds
    s_add_u32 m0, m0, s53
    s_add_u32 s48, s48, 5120
    buffer_load_dwordx4 v13, s[12:15], s48 offen nt lds
    s_add_u32 m0, m0, s53
    s_add_u32 s48, s48, 5120
    buffer_load_dwordx4 v13, s[12:15], s48 offen nt lds
    s_add_u32 m0, m0, s53
    s_add_u32 s48, s48, 1024
    buffer_load_dwordx4 v13, s[12:15], s48 offen nt lds
    s_add_u32 m0, m0, s53
    s_add_u32 s48, s48, 5120
    buffer_load_dwordx4 v13, s[12:15], s48 offen nt lds
    s_add_u32 s48, s48, -26624
    s_add_u32 m0, s52, 107520
    s_nop 0
    buffer_load_dwordx4 v13, s[12:15], s48 offen nt lds
    s_add_u32 m0, m0, s53
    s_add_u32 s48, s48, 1024
    buffer_load_dwordx4 v13, s[12:15], s48 offen nt lds
    s_add_u32 m0, m0, s53
    s_add_u32 s48, s48, 5120
    buffer_load_dwordx4 v13, s[12:15], s48 offen nt lds
    s_add_u32 m0, m0, s53
    s_add_u32 s48, s48, 5120
    buffer_load_dwordx4 v13, s[12:15], s48 offen nt lds
    s_add_u32 m0, m0, s53
    s_add_u32 s48, s48, 5120
    buffer_load_dwordx4 v13, s[12:15], s48 offen nt lds
    s_add_u32 m0, m0, s53
    s_add_u32 s48, s48, 1024
    buffer_load_dwordx4 v13, s[12:15], s48 offen nt lds
    s_add_u32 m0, m0, s53
    s_add_u32 s48, s48, 5120
    buffer_load_dwordx4 v13, s[12:15], s48 offen nt lds
    s_add_u32 m0, m0, s53
    s_add_u32 s48, s48, 5120
    buffer_load_dwordx4 v13, s[12:15], s48 offen nt lds
    s_add_u32 s48, s48, 2048
    v_mov_b32 v56, 0
    v_mov_b32 v57, 0
    v_mov_b32 v58, 0
    v_mov_b32 v59, 0
    v_mov_b32 v60, 0
    v_mov_b32 v61, 0
    v_mov_b32 v62, 0
    v_mov_b32 v63, 0
    s_waitcnt vmcnt(24)
    s_barrier
    ds_read_b128 a[144:147], v14 offset:0
    ds_read_b128 a[148:151], v14 offset:64
    ds_read_b128 a[152:155], v14 offset:128
    ds_read_b128 a[156:159], v14 offset:192
    ds_read_b128 a[160:163], v14 offset:4352
    ds_read_b128 a[164:167], v14 offset:4416
    ds_read_b128 a[168:171], v14 offset:4480
    ds_read_b128 a[172:175], v14 offset:4544
    s_waitcnt lgkmcnt(7)
    ds_read_b64_tr_b16 a[176:177], v16 offset:0
    ds_read_b64_tr_b16 a[178:179], v16 offset:4608
    ds_read_b64_tr_b16 a[180:181], v17 offset:0
    ds_read_b64_tr_b16 a[182:183], v17 offset:4608
    ds_read_b64_tr_b16 a[184:185], v18 offset:0
    ds_read_b64_tr_b16 a[186:187], v18 offset:4608
    ds_read_b64_tr_b16 a[188:189], v19 offset:0
    ds_read_b64_tr_b16 a[190:191], v19 offset:4608
    s_waitcnt lgkmcnt(7)
    ds_read_b64_tr_b16 a[192:193], v16 offset:128
    ds_read_b64_tr_b16 a[194:195], v16 offset:4736
    ds_read_b64_tr_b16 a[196:197], v17 offset:128
    ds_read_b64_tr_b16 a[198:199], v17 offset:4736
    ds_read_b64_tr_b16 a[200:201], v18 offset:128
    ds_read_b64_tr_b16 a[202:203], v18 offset:4736
    ds_read_b64_tr_b16 a[204:205], v19 offset:128
    ds_read_b64_tr_b16 a[206:207], v19 offset:4736
    s_waitcnt lgkmcnt(7)
    v_mfma_f32_32x32x16_bf16 v[64:79], v[56:59], v[56:59], 0
    v_mfma_f32_32x32x16_bf16 v[80:95], v[56:59], v[56:59], 0
    v_mfma_f32_32x32x16_bf16 v[96:111], v[56:59], v[56:59], 0
    v_mfma_f32_32x32x16_bf16 v[112:127], v[56:59], v[56:59], 0
    v_mfma_f32_32x32x16_bf16 v[128:143], v[56:59], v[56:59], 0
    v_mfma_f32_32x32x16_bf16 v[144:159], v[56:59], v[56:59], 0
    v_mfma_f32_32x32x16_bf16 v[160:175], v[56:59], v[56:59], 0
    v_mfma_f32_32x32x16_bf16 v[176:191], v[56:59], v[56:59], 0
    v_mfma_f32_32x32x16_bf16 v[192:207], v[56:59], v[56:59], 0
    v_mfma_f32_32x32x16_bf16 v[208:223], v[56:59], v[56:59], 0
    v_mfma_f32_32x32x16_bf16 v[224:239], v[56:59], v[56:59], 0
    v_mfma_f32_32x32x16_bf16 v[240:255], v[56:59], v[56:59], 0
    v_mfma_f32_32x32x16_bf16 a[0:15], v[56:59], v[56:59], 0
    v_mfma_f32_32x32x16_bf16 a[16:31], v[56:59], v[56:59], 0
    v_mfma_f32_32x32x16_bf16 a[208:223], v[56:59], v[56:59], 0
    v_mfma_f32_32x32x16_bf16 a[224:239], v[56:59], v[56:59], 0
    s_waitcnt lgkmcnt(0)
    v_mov_b32 v24, 0
    v_mov_b32 v25, 0
    v_mov_b32 v26, 0
    v_mov_b32 v27, 0
    v_mov_b32 v28, 0
    v_mov_b32 v29, 0
    v_mov_b32 v30, 0
    s_add_u32 m0, s52, 0
    v_mfma_f32_16x16x32_bf16 v[32:35], a[144:147], a[32:35], 0
    v_mfma_f32_16x16x32_bf16 v[32:35], a[148:151], a[36:39], v[32:35]
    v_mfma_f32_16x16x32_bf16 v[32:35], a[152:155], a[40:43], v[32:35]
    v_mfma_f32_16x16x32_bf16 v[32:35], a[156:159], a[44:47], v[32:35]
    v_mfma_f32_16x16x32_bf16 v[36:39], a[160:163], a[32:35], 0
    v_mfma_f32_16x16x32_bf16 v[36:39], a[164:167], a[36:39], v[36:39]
    v_mfma_f32_16x16x32_bf16 v[36:39], a[168:171], a[40:43], v[36:39]
    v_mfma_f32_16x16x32_bf16 v[36:39], a[172:175], a[44:47], v[36:39]
    s_nop 3
    s_mov_b32 s55, 8
    .p2align 6
L_am:
    v_mfma_f32_16x16x32_bf16 v[40:43], a[144:147], a[48:51], 0
    s_waitcnt vmcnt(3) lgkmcnt(0)
    v_mfma_f32_16x16x32_bf16 v[40:43], a[148:151], a[52:55], v[40:43]
    s_barrier
    buffer_load_dwordx4 v13, s[12:15], s48 offen nt lds
    v_mfma_f32_16x16x32_bf16 v[40:43], a[152:155], a[56:59], v[40:43]
    v_max3_f32 v1, v32, v33, v1
    v_mfma_f32_16x16x32_bf16 v[40:43], a[156:159], a[60:63], v[40:43]
    v_mfma_f32_16x16x32_bf16 a[0:3], a[208:211], v[60:63], a[0:3]
    v_mfma_f32_16x16x32_bf16 a[4:7], a[212:215], v[60:63], a[4:7]
    v_mfma_f32_16x16x32_bf16 a[8:11], a[216:219], v[60:63], a[8:11]
    v_max3_f32 v1, v34, v35, v1
    v_mfma_f32_16x16x32_bf16 a[12:15], a[220:223], v[60:63], a[12:15]
    v_mfma_f32_16x16x32_bf16 v[44:47], a[160:163], a[48:51], 0
    v_mfma_f32_16x16x32_bf16 v[44:47], a[164:167], a[52:55], v[44:47]
    v_mfma_f32_16x16x32_bf16 v[44:47], a[168:171], a[56:59], v[44:47]
    v_max3_f32 v1, v36, v37, v1
    v_mfma_f32_16x16x32_bf16 v[44:47], a[172:175], a[60:63], v[44:47]
    v_mfma_f32_16x16x32_bf16 a[16:19], a[224:227], v[60:63], a[16:19]
    v_mfma_f32_16x16x32_bf16 a[20:23], a[228:231], v[60:63], a[20:23]
    v_mfma_f32_16x16x32_bf16 a[24:27], a[232:235], v[60:63], a[24:27]
    v_max3_f32 v1, v38, v39, v1
    v_mfma_f32_16x16x32_bf16 a[28:31], a[236:239], v[60:63], a[28:31]
    s_add_u32 s48, s48, 5120
    v_mfma_f32_16x16x32_bf16 v[32:35], a[144:147], a[64:67], 0
    s_add_u32 m0, m0, s53
    v_mfma_f32_16x16x32_bf16 v[32:35], a[148:151], a[68:71], v[32:35]
    s_waitcnt vmcnt(4)
    buffer_load_dwordx4 v13, s[12:15], s48 offen nt lds
    v_mfma_f32_16x16x32_bf16 v[32:35], a[152:155], a[72:75], v[32:35]
    v_max3_f32 v2, v40, v41, v2
    v_mfma_f32_16x16x32_bf16 v[32:35], a[156:159], a[76:79], v[32:35]
    v_mfma_f32_16x16x32_bf16 v[64:67], a[176:179], v[56:59], v[64:67]
    v_mfma_f32_16x16x32_bf16 v[68:71], a[180:183], v[56:59], v[68:71]
    v_mfma_f32_16x16x32_bf16 v[72:75], a[184:187], v[56:59], v[72:75]
    v_max3_f32 v2, v42, v43, v2
    v_mfma_f32_16x16x32_bf16 v[76:79], a[188:191], v[56:59], v[76:79]
    v_mfma_f32_16x16x32_bf16 v[36:39], a[160:163], a[64:67], 0
    v_mfma_f32_16x16x32_bf16 v[36:39], a[164:167], a[68:71], v[36:39]
    ds_read_b64_tr_b16 a[208:209], v16 offset:35840
    v_mfma_f32_16x16x32_bf16 v[36:39], a[168:171], a[72:75], v[36:39]
    v_max3_f32 v2, v44, v45, v2
    v_mfma_f32_16x16x32_bf16 v[36:39], a[172:175], a[76:79], v[36:39]
    v_mfma_f32_16x16x32_bf16 v[80:83], a[192:195], v[56:59], v[80:83]
    v_mfma_f32_16x16x32_bf16 v[84:87], a[196:199], v[56:59], v[84:87]
    ds_read_b64_tr_b16 a[210:211], v16 offset:40448
    v_mfma_f32_16x16x32_bf16 v[88:91], a[200:203], v[56:59], v[88:91]
    v_max3_f32 v2, v46, v47, v2
    v_mfma_f32_16x16x32_bf16 v[92:95], a[204:207], v[56:59], v[92:95]
    s_add_u32 s48, s48, 5120
    v_mfma_f32_16x16x32_bf16 v[40:43], a[144:147], a[80:83], 0
    s_add_u32 m0, m0, s53
    v_mfma_f32_16x16x32_bf16 v[40:43], a[148:151], a[84:87], v[40:43]
    s_waitcnt vmcnt(4)
    buffer_load_dwordx4 v13, s[12:15], s48 offen nt lds
    v_mfma_f32_16x16x32_bf16 v[40:43], a[152:155], a[88:91], v[40:43]
    v_max3_f32 v3, v32, v33, v3
    v_mfma_f32_16x16x32_bf16 v[40:43], a[156:159], a[92:95], v[40:43]
    v_mfma_f32_16x16x32_bf16 v[96:99], a[176:179], v[60:63], v[96:99]
    v_mfma_f32_16x16x32_bf16 v[100:103], a[180:183], v[60:63], v[100:103]
    v_mfma_f32_16x16x32_bf16 v[104:107], a[184:187], v[60:63], v[104:107]
    v_max3_f32 v3, v34, v35, v3
    v_mfma_f32_16x16x32_bf16 v[108:111], a[188:191], v[60:63], v[108:111]
    s_add_u32 s48, s48, 5120
    v_mfma_f32_16x16x32_bf16 v[44:47], a[160:163], a[80:83], 0
    s_add_u32 m0, m0, s53
    v_mfma_f32_16x16x32_bf16 v[44:47], a[164:167], a[84:87], v[44:47]
    s_waitcnt vmcnt(4)
    buffer_load_dwordx4 v13, s[12:15], s48 offen nt lds
    v_mfma_f32_16x16x32_bf16 v[44:47], a[168:171], a[88:91], v[44:47]
    v_max3_f32 v3, v36, v37, v3
    v_mfma_f32_16x16x32_bf16 v[44:47], a[172:175], a[92:95], v[44:47]
    ds_read_b64_tr_b16 a[212:213], v17 offset:35840
    v_mfma_f32_16x16x32_bf16 v[112:115], a[192:195], v[60:63], v[112:115]
    v_mfma_f32_16x16x32_bf16 v[116:119], a[196:199], v[60:63], v[116:119]
    v_mfma_f32_16x16x32_bf16 v[120:123], a[200:203], v[60:63], v[120:123]
    v_max3_f32 v3, v38, v39, v3
    v_mfma_f32_16x16x32_bf16 v[124:127], a[204:207], v[60:63], v[124:127]
    ds_read_b64_tr_b16 a[214:215], v17 offset:40448
    v_mfma_f32_16x16x32_bf16 v[32:35], a[144:147], a[96:99], 0
    v_mfma_f32_16x16x32_bf16 v[32:35], a[148:151], a[100:103], v[32:35]
    ds_read_b64_tr_b16 a[216:217], v18 offset:35840
    v_mfma_f32_16x16x32_bf16 v[32:35], a[152:155], a[104:107], v[32:35]
    v_max3_f32 v4, v40, v41, v4
    v_mfma_f32_16x16x32_bf16 v[32:35], a[156:159], a[108:111], v[32:35]
    ds_read_b64_tr_b16 a[218:219], v18 offset:40448
    v_mfma_f32_16x16x32_bf16 v[128:131], a[176:179], v[56:59], v[128:131]
    v_mfma_f32_16x16x32_bf16 v[132:135], a[180:183], v[56:59], v[132:135]
    ds_read_b64_tr_b16 a[220:221], v19 offset:35840
    v_mfma_f32_16x16x32_bf16 v[136:139], a[184:187], v[56:59], v[136:139]
    v_max3_f32 v4, v42, v43, v4
    v_mfma_f32_16x16x32_bf16 v[140:143], a[188:191], v[56:59], v[140:143]
    s_add_u32 s48, s48, 1024
    ds_read_b64_tr_b16 a[222:223], v19 offset:40448
    v_mfma_f32_16x16x32_bf16 v[36:39], a[160:163], a[96:99], 0
    s_add_u32 m0, m0, s53
    v_mfma_f32_16x16x32_bf16 v[36:39], a[164:167], a[100:103], v[36:39]
    s_waitcnt vmcnt(4)
    buffer_load_dwordx4 v13, s[12:15], s48 offen nt lds
    v_mfma_f32_16x16x32_bf16 v[36:39], a[168:171], a[104:107], v[36:39]
    v_max3_f32 v4, v44, v45, v4
    v_mfma_f32_16x16x32_bf16 v[36:39], a[172:175], a[108:111], v[36:39]
    ds_read_b64_tr_b16 a[224:225], v16 offset:35968
    v_mfma_f32_16x16x32_bf16 v[144:147], a[192:195], v[56:59], v[144:147]
    v_mfma_f32_16x16x32_bf16 v[148:151], a[196:199], v[56:59], v[148:151]
    v_mfma_f32_16x16x32_bf16 v[152:155], a[200:203], v[56:59], v[152:155]
    v_max3_f32 v4, v46, v47, v4
    v_mfma_f32_16x16x32_bf16 v[156:159], a[204:207], v[56:59], v[156:159]
    ds_read_b64_tr_b16 a[226:227], v16 offset:40576
    v_mfma_f32_16x16x32_bf16 v[40:43], a[144:147], a[112:115], 0
    v_mfma_f32_16x16x32_bf16 v[40:43], a[148:151], a[116:119], v[40:43]
    ds_read_b64_tr_b16 a[228:229], v17 offset:35968
    v_mfma_f32_16x16x32_bf16 v[40:43], a[152:155], a[120:123], v[40:43]
    v_max3_f32 v5, v32, v33, v5
    v_mfma_f32_16x16x32_bf16 v[40:43], a[156:159], a[124:127], v[40:43]
    ds_read_b64_tr_b16 a[230:231], v17 offset:40576
    v_mfma_f32_16x16x32_bf16 v[160:163], a[176:179], v[60:63], v[160:163]
    v_mfma_f32_16x16x32_bf16 v[164:167], a[180:183], v[60:63], v[164:167]
    ds_read_b64_tr_b16 a[232:233], v18 offset:35968
    v_mfma_f32_16x16x32_bf16 v[168:171], a[184:187], v[60:63], v[168:171]
    v_max3_f32 v5, v34, v35, v5
    v_mfma_f32_16x16x32_bf16 v[172:175], a[188:191], v[60:63], v[172:175]
    s_add_u32 s48, s48, 5120
    ds_read_b64_tr_b16 a[234:235], v18 offset:40576
    v_mfma_f32_16x16x32_bf16 v[44:47], a[160:163], a[112:115], 0
    s_add_u32 m0, m0, s53
    v_mfma_f32_16x16x32_bf16 v[44:47], a[164:167], a[116:119], v[44:47]
    s_waitcnt vmcnt(4)
    buffer_load_dwordx4 v13, s[12:15], s48 offen nt lds
    v_mfma_f32_16x16x32_bf16 v[44:47], a[168:171], a[120:123], v[44:47]
    v_max3_f32 v5, v36, v37, v5
    v_mfma_f32_16x16x32_bf16 v[44:47], a[172:175], a[124:127], v[44:47]
    ds_read_b64_tr_b16 a[236:237], v19 offset:35968
    v_mfma_f32_16x16x32_bf16 v[176:179], a[192:195], v[60:63], v[176:179]
    v_mfma_f32_16x16x32_bf16 v[180:183], a[196:199], v[60:63], v[180:183]
    v_mfma_f32_16x16x32_bf16 v[184:187], a[200:203], v[60:63], v[184:187]
    v_max3_f32 v5, v38, v39, v5
    v_mfma_f32_16x16x32_bf16 v[188:191], a[204:207], v[60:63], v[188:191]
    ds_read_b64_tr_b16 a[238:239], v19 offset:40576
    v_mfma_f32_16x16x32_bf16 v[32:35], a[144:147], a[128:131], 0
    v_mfma_f32_16x16x32_bf16 v[32:35], a[148:151], a[132:135], v[32:35]
    ds_read_b128 a[144:147], v14 offset:35840
    v_mfma_f32_16x16x32_bf16 v[32:35], a[152:155], a[136:139], v[32:35]
    v_max3_f32 v6, v40, v41, v6
    v_mfma_f32_16x16x32_bf16 v[32:35], a[156:159], a[140:143], v[32:35]
    ds_read_b128 a[148:151], v14 offset:35904
    v_mfma_f32_16x16x32_bf16 v[192:195], a[176:179], v[56:59], v[192:195]
    v_mfma_f32_16x16x32_bf16 v[196:199], a[180:183], v[56:59], v[196:199]
    ds_read_b128 a[152:155], v14 offset:35968
    v_mfma_f32_16x16x32_bf16 v[200:203], a[184:187], v[56:59], v[200:203]
    v_max3_f32 v6, v42, v43, v6
    v_mfma_f32_16x16x32_bf16 v[204:207], a[188:191], v[56:59], v[204:207]
    ds_read_b128 a[156:159], v14 offset:36032
    v_mfma_f32_16x16x32_bf16 v[36:39], a[160:163], a[128:131], 0
    v_mfma_f32_16x16x32_bf16 v[36:39], a[164:167], a[132:135], v[36:39]
    ds_read_b128 a[160:163], v14 offset:40192
    v_mfma_f32_16x16x32_bf16 v[36:39], a[168:171], a[136:139], v[36:39]
    v_max3_f32 v6, v44, v45, v6
    v_mfma_f32_16x16x32_bf16 v[36:39], a[172:175], a[140:143], v[36:39]
    ds_read_b128 a[164:167], v14 offset:40256
    v_mfma_f32_16x16x32_bf16 v[208:211], a[192:195], v[56:59], v[208:211]
    v_mfma_f32_16x16x32_bf16 v[212:215], a[196:199], v[56:59], v[212:215]
    ds_read_b128 a[168:171], v14 offset:40320
    v_mfma_f32_16x16x32_bf16 v[216:219], a[200:203], v[56:59], v[216:219]
    v_max3_f32 v6, v46, v47, v6
    v_mfma_f32_16x16x32_bf16 v[220:223], a[204:207], v[56:59], v[220:223]
    s_add_u32 s48, s48, 5120
    s_waitcnt lgkmcnt(3)
    ds_read_b128 a[172:175], v14 offset:40384
    v_mfma_f32_16x16x32_bf16 v[40:43], a[144:147], a[32:35], 0
    s_add_u32 m0, m0, s53
    v_mfma_f32_16x16x32_bf16 v[40:43], a[148:151], a[36:39], v[40:43]
    s_waitcnt vmcnt(4)
    buffer_load_dwordx4 v13, s[12:15], s48 offen nt lds
    v_mfma_f32_16x16x32_bf16 v[40:43], a[152:155], a[40:43], v[40:43]
    v_max3_f32 v7, v32, v33, v7
    v_mfma_f32_16x16x32_bf16 v[40:43], a[156:159], a[44:47], v[40:43]
    v_mfma_f32_16x16x32_bf16 v[224:227], a[176:179], v[60:63], v[224:227]
    v_mfma_f32_16x16x32_bf16 v[228:231], a[180:183], v[60:63], v[228:231]
    v_mfma_f32_16x16x32_bf16 v[232:235], a[184:187], v[60:63], v[232:235]
    v_max3_f32 v7, v34, v35, v7
    v_mfma_f32_16x16x32_bf16 v[236:239], a[188:191], v[60:63], v[236:239]
    s_add_u32 s48, s48, 5120
    s_waitcnt lgkmcnt(0)
    v_mfma_f32_16x16x32_bf16 v[44:47], a[160:163], a[32:35], 0
    s_add_u32 m0, m0, s53
    v_mfma_f32_16x16x32_bf16 v[44:47], a[164:167], a[36:39], v[44:47]
    s_waitcnt vmcnt(4)
    buffer_load_dwordx4 v13, s[12:15], s48 offen nt lds
    v_mfma_f32_16x16x32_bf16 v[44:47], a[168:171], a[40:43], v[44:47]
    v_max3_f32 v7, v36, v37, v7
    v_mfma_f32_16x16x32_bf16 v[44:47], a[172:175], a[44:47], v[44:47]
    s_add_u32 s48, s48, -30720
    v_mfma_f32_16x16x32_bf16 v[240:243], a[192:195], v[60:63], v[240:243]
    v_mfma_f32_16x16x32_bf16 v[244:247], a[196:199], v[60:63], v[244:247]
    s_add_u32 m0, s52, 35840
    v_mfma_f32_16x16x32_bf16 v[248:251], a[200:203], v[60:63], v[248:251]
    v_max3_f32 v7, v38, v39, v7
    v_mfma_f32_16x16x32_bf16 v[252:255], a[204:207], v[60:63], v[252:255]
    v_mfma_f32_16x16x32_bf16 v[32:35], a[144:147], a[48:51], 0
    s_waitcnt vmcnt(3) lgkmcnt(0)
    v_mfma_f32_16x16x32_bf16 v[32:35], a[148:151], a[52:55], v[32:35]
    s_barrier
    buffer_load_dwordx4 v13, s[12:15], s48 offen nt lds
    v_mfma_f32_16x16x32_bf16 v[32:35], a[152:155], a[56:59], v[32:35]
    v_max3_f32 v1, v40, v41, v1
    v_mfma_f32_16x16x32_bf16 v[32:35], a[156:159], a[60:63], v[32:35]
    v_mfma_f32_16x16x32_bf16 a[0:3], a[176:179], v[56:59], a[0:3]
    v_mfma_f32_16x16x32_bf16 a[4:7], a[180:183], v[56:59], a[4:7]
    v_mfma_f32_16x16x32_bf16 a[8:11], a[184:187], v[56:59], a[8:11]
    v_max3_f32 v1, v42, v43, v1
    v_mfma_f32_16x16x32_bf16 a[12:15], a[188:191], v[56:59], a[12:15]
    v_mfma_f32_16x16x32_bf16 v[36:39], a[160:163], a[48:51], 0
    v_mfma_f32_16x16x32_bf16 v[36:39], a[164:167], a[52:55], v[36:39]
    v_mfma_f32_16x16x32_bf16 v[36:39], a[168:171], a[56:59], v[36:39]
    v_max3_f32 v1, v44, v45, v1
    v_mfma_f32_16x16x32_bf16 v[36:39], a[172:175], a[60:63], v[36:39]
    v_mfma_f32_16x16x32_bf16 a[16:19], a[192:195], v[56:59], a[16:19]
    v_mfma_f32_16x16x32_bf16 a[20:23], a[196:199], v[56:59], a[20:23]
    v_mfma_f32_16x16x32_bf16 a[24:27], a[200:203], v[56:59], a[24:27]
    v_max3_f32 v1, v46, v47, v1
    v_mfma_f32_16x16x32_bf16 a[28:31], a[204:207], v[56:59], a[28:31]
    s_add_u32 s48, s48, 5120
    v_mfma_f32_16x16x32_bf16 v[40:43], a[144:147], a[64:67], 0
    s_add_u32 m0, m0, s53
    v_mfma_f32_16x16x32_bf16 v[40:43], a[148:151], a[68:71], v[40:43]
    s_waitcnt vmcnt(4)
    buffer_load_dwordx4 v13, s[12:15], s48 offen nt lds
    v_mfma_f32_16x16x32_bf16 v[40:43], a[152:155], a[72:75], v[40:43]
    v_max3_f32 v2, v32, v33, v2
    v_mfma_f32_16x16x32_bf16 v[40:43], a[156:159], a[76:79], v[40:43]
    v_mfma_f32_16x16x32_bf16 v[64:67], a[208:211], v[60:63], v[64:67]
    v_mfma_f32_16x16x32_bf16 v[68:71], a[212:215], v[60:63], v[68:71]
    v_mfma_f32_16x16x32_bf16 v[72:75], a[216:219], v[60:63], v[72:75]
    v_max3_f32 v2, v34, v35, v2
    v_mfma_f32_16x16x32_bf16 v[76:79], a[220:223], v[60:63], v[76:79]
    v_mfma_f32_16x16x32_bf16 v[44:47], a[160:163], a[64:67], 0
    v_mfma_f32_16x16x32_bf16 v[44:47], a[164:167], a[68:71], v[44:47]
    ds_read_b64_tr_b16 a[176:177], v20 offset:0
    v_mfma_f32_16x16x32_bf16 v[44:47], a[168:171], a[72:75], v[44:47]
    v_max3_f32 v2, v36, v37, v2
    v_mfma_f32_16x16x32_bf16 v[44:47], a[172:175], a[76:79], v[44:47]
    v_mfma_f32_16x16x32_bf16 v[80:83], a[224:227], v[60:63], v[80:83]
    v_mfma_f32_16x16x32_bf16 v[84:87], a[228:231], v[60:63], v[84:87]
    ds_read_b64_tr_b16 a[178:179], v20 offset:4608
    v_mfma_f32_16x16x32_bf16 v[88:91], a[232:235], v[60:63], v[88:91]
    v_max3_f32 v2, v38, v39, v2
    v_mfma_f32_16x16x32_bf16 v[92:95], a[236:239], v[60:63], v[92:95]
    s_add_u32 s48, s48, 5120
    v_mfma_f32_16x16x32_bf16 v[32:35], a[144:147], a[80:83], 0
    s_add_u32 m0, m0, s53
    v_mfma_f32_16x16x32_bf16 v[32:35], a[148:151], a[84:87], v[32:35]
    s_waitcnt vmcnt(4)
    buffer_load_dwordx4 v13, s[12:15], s48 offen nt lds
    v_mfma_f32_16x16x32_bf16 v[32:35], a[152:155], a[88:91], v[32:35]
    v_max3_f32 v3, v40, v41, v3
    v_mfma_f32_16x16x32_bf16 v[32:35], a[156:159], a[92:95], v[32:35]
    v_mfma_f32_16x16x32_bf16 v[96:99], a[208:211], v[56:59], v[96:99]
    v_mfma_f32_16x16x32_bf16 v[100:103], a[212:215], v[56:59], v[100:103]
    v_mfma_f32_16x16x32_bf16 v[104:107], a[216:219], v[56:59], v[104:107]
    v_max3_f32 v3, v42, v43, v3
    v_mfma_f32_16x16x32_bf16 v[108:111], a[220:223], v[56:59], v[108:111]
    s_add_u32 s48, s48, 1024
    v_mfma_f32_16x16x32_bf16 v[36:39], a[160:163], a[80:83], 0
    s_add_u32 m0, m0, s53
    v_mfma_f32_16x16x32_bf16 v[36:39], a[164:167], a[84:87], v[36:39]
    s_waitcnt vmcnt(4)
    buffer_load_dwordx4 v13, s[12:15], s48 offen nt lds
    v_mfma_f32_16x16x32_bf16 v[36:39], a[168:171], a[88:91], v[36:39]
    v_max3_f32 v3, v44, v45, v3
    v_mfma_f32_16x16x32_bf16 v[36:39], a[172:175], a[92:95], v[36:39]
    ds_read_b64_tr_b16 a[180:181], v21 offset:0
    v_mfma_f32_16x16x32_bf16 v[112:115], a[224:227], v[56:59], v[112:115]
    v_mfma_f32_16x16x32_bf16 v[116:119], a[228:231], v[56:59], v[116:119]
    v_mfma_f32_16x16x32_bf16 v[120:123], a[232:235], v[56:59], v[120:123]
    v_max3_f32 v3, v46, v47, v3
    v_mfma_f32_16x16x32_bf16 v[124:127], a[236:239], v[56:59], v[124:127]
    ds_read_b64_tr_b16 a[182:183], v21 offset:4608
    v_mfma_f32_16x16x32_bf16 v[40:43], a[144:147], a[96:99], 0
    v_mfma_f32_16x16x32_bf16 v[40:43], a[148:151], a[100:103], v[40:43]
    ds_read_b64_tr_b16 a[184:185], v22 offset:0
    v_mfma_f32_16x16x32_bf16 v[40:43], a[152:155], a[104:107], v[40:43]
    v_max3_f32 v4, v32, v33, v4
    v_mfma_f32_16x16x32_bf16 v[40:43], a[156:159], a[108:111], v[40:43]
    ds_read_b64_tr_b16 a[186:187], v22 offset:4608
    v_mfma_f32_16x16x32_bf16 v[128:131], a[208:211], v[60:63], v[128:131]
    v_mfma_f32_16x16x32_bf16 v[132:135], a[212:215], v[60:63], v[132:135]
    ds_read_b64_tr_b16 a[188:189], v23 offset:0
    v_mfma_f32_16x16x32_bf16 v[136:139], a[216:219], v[60:63], v[136:139]
    v_max3_f32 v4, v34, v35, v4
    v_mfma_f32_16x16x32_bf16 v[140:143], a[220:223], v[60:63], v[140:143]
    s_add_u32 s48, s48, 5120
    ds_read_b64_tr_b16 a[190:191], v23 offset:4608
    v_mfma_f32_16x16x32_bf16 v[44:47], a[160:163], a[96:99], 0
    s_add_u32 m0, m0, s53
    v_mfma_f32_16x16x32_bf16 v[44:47], a[164:167], a[100:103], v[44:47]
    s_waitcnt vmcnt(4)
    buffer_load_dwordx4 v13, s[12:15], s48 offen nt lds
    v_mfma_f32_16x16x32_bf16 v[44:47], a[168:171], a[104:107], v[44:47]
    v_max3_f32 v4, v36, v37, v4
    v_mfma_f32_16x16x32_bf16 v[44:47], a[172:175], a[108:111], v[44:47]
    ds_read_b64_tr_b16 a[192:193], v20 offset:128
    v_mfma_f32_16x16x32_bf16 v[144:147], a[224:227], v[60:63], v[144:147]
    v_mfma_f32_16x16x32_bf16 v[148:151], a[228:231], v[60:63], v[148:151]
    v_mfma_f32_16x16x32_bf16 v[152:155], a[232:235], v[60:63], v[152:155]
    v_max3_f32 v4, v38, v39, v4
    v_mfma_f32_16x16x32_bf16 v[156:159], a[236:239], v[60:63], v[156:159]
    ds_read_b64_tr_b16 a[194:195], v20 offset:4736
    v_mfma_f32_16x16x32_bf16 v[32:35], a[144:147], a[112:115], 0
    v_mfma_f32_16x16x32_bf16 v[32:35], a[148:151], a[116:119], v[32:35]
    ds_read_b64_tr_b16 a[196:197], v21 offset:128
    v_mfma_f32_16x16x32_bf16 v[32:35], a[152:155], a[120:123], v[32:35]
    v_max3_f32 v5, v40, v41, v5
    v_mfma_f32_16x16x32_bf16 v[32:35], a[156:159], a[124:127], v[32:35]
    ds_read_b64_tr_b16 a[198:199], v21 offset:4736
    v_mfma_f32_16x16x32_bf16 v[160:163], a[208:211], v[56:59], v[160:163]
    v_mfma_f32_16x16x32_bf16 v[164:167], a[212:215], v[56:59], v[164:167]
    ds_read_b64_tr_b16 a[200:201], v22 offset:128
    v_mfma_f32_16x16x32_bf16 v[168:171], a[216:219], v[56:59], v[168:171]
    v_max3_f32 v5, v42, v43, v5
    v_mfma_f32_16x16x32_bf16 v[172:175], a[220:223], v[56:59], v[172:175]
    s_add_u32 s48, s48, 5120
    ds_read_b64_tr_b16 a[202:203], v22 offset:4736
    v_mfma_f32_16x16x32_bf16 v[36:39], a[160:163], a[112:115], 0
    s_add_u32 m0, m0, s53
    v_mfma_f32_16x16x32_bf16 v[36:39], a[164:167], a[116:119], v[36:39]
    s_waitcnt vmcnt(4)
    buffer_load_dwordx4 v13, s[12:15], s48 offen nt lds
    v_mfma_f32_16x16x32_bf16 v[36:39], a[168:171], a[120:123], v[36:39]
    v_max3_f32 v5, v44, v45, v5
    v_mfma_f32_16x16x32_bf16 v[36:39], a[172:175], a[124:127], v[36:39]
    ds_read_b64_tr_b16 a[204:205], v23 offset:128
    v_mfma_f32_16x16x32_bf16 v[176:179], a[224:227], v[56:59], v[176:179]
    v_mfma_f32_16x16x32_bf16 v[180:183], a[228:231], v[56:59], v[180:183]
    v_mfma_f32_16x16x32_bf16 v[184:187], a[232:235], v[56:59], v[184:187]
    v_max3_f32 v5, v46, v47, v5
    v_mfma_f32_16x16x32_bf16 v[188:191], a[236:239], v[56:59], v[188:191]
    ds_read_b64_tr_b16 a[206:207], v23 offset:4736
    v_mfma_f32_16x16x32_bf16 v[40:43], a[144:147], a[128:131], 0
    v_mfma_f32_16x16x32_bf16 v[40:43], a[148:151], a[132:135], v[40:43]
    ds_read_b128 a[144:147], v15 offset:0
    v_mfma_f32_16x16x32_bf16 v[40:43], a[152:155], a[136:139], v[40:43]
    v_max3_f32 v6, v32, v33, v6
    v_mfma_f32_16x16x32_bf16 v[40:43], a[156:159], a[140:143], v[40:43]
    ds_read_b128 a[148:151], v15 offset:64
    v_mfma_f32_16x16x32_bf16 v[192:195], a[208:211], v[60:63], v[192:195]
    v_mfma_f32_16x16x32_bf16 v[196:199], a[212:215], v[60:63], v[196:199]
    ds_read_b128 a[152:155], v15 offset:128
    v_mfma_f32_16x16x32_bf16 v[200:203], a[216:219], v[60:63], v[200:203]
    v_max3_f32 v6, v34, v35, v6
    v_mfma_f32_16x16x32_bf16 v[204:207], a[220:223], v[60:63], v[204:207]
    ds_read_b128 a[156:159], v15 offset:192
    v_mfma_f32_16x16x32_bf16 v[44:47], a[160:163], a[128:131], 0
    v_mfma_f32_16x16x32_bf16 v[44:47], a[164:167], a[132:135], v[44:47]
    ds_read_b128 a[160:163], v15 offset:4352
    v_mfma_f32_16x16x32_bf16 v[44:47], a[168:171], a[136:139], v[44:47]
    v_max3_f32 v6, v36, v37, v6
    v_mfma_f32_16x16x32_bf16 v[44:47], a[172:175], a[140:143], v[44:47]
    ds_read_b128 a[164:167], v15 offset:4416
    v_mfma_f32_16x16x32_bf16 v[208:211], a[224:227], v[60:63], v[208:211]
    v_mfma_f32_16x16x32_bf16 v[212:215], a[228:231], v[60:63], v[212:215]
    ds_read_b128 a[168:171], v15 offset:4480
    v_mfma_f32_16x16x32_bf16 v[216:219], a[232:235], v[60:63], v[216:219]
    v_max3_f32 v6, v38, v39, v6
    v_mfma_f32_16x16x32_bf16 v[220:223], a[236:239], v[60:63], v[220:223]
    s_add_u32 s48, s48, 5120
    s_waitcnt lgkmcnt(3)
    ds_read_b128 a[172:175], v15 offset:4544
    v_mfma_f32_16x16x32_bf16 v[32:35], a[144:147], a[32:35], 0
    s_add_u32 m0, m0, s53
    v_mfma_f32_16x16x32_bf16 v[32:35], a[148:151], a[36:39], v[32:35]
    s_waitcnt vmcnt(4)
    buffer_load_dwordx4 v13, s[12:15], s48 offen nt lds
    v_mfma_f32_16x16x32_bf16 v[32:35], a[152:155], a[40:43], v[32:35]
    v_max3_f32 v7, v40, v41, v7
    v_mfma_f32_16x16x32_bf16 v[32:35], a[156:159], a[44:47], v[32:35]
    v_mfma_f32_16x16x32_bf16 v[224:227], a[208:211], v[56:59], v[224:227]
    v_mfma_f32_16x16x32_bf16 v[228:231], a[212:215], v[56:59], v[228:231]
    v_mfma_f32_16x16x32_bf16 v[232:235], a[216:219], v[56:59], v[232:235]
    v_max3_f32 v7, v42, v43, v7
    v_mfma_f32_16x16x32_bf16 v[236:239], a[220:223], v[56:59], v[236:239]
    s_add_u32 s48, s48, 1024
    s_waitcnt lgkmcnt(0)
    v_mfma_f32_16x16x32_bf16 v[36:39], a[160:163], a[32:35], 0
    s_add_u32 m0, m0, s53
    v_mfma_f32_16x16x32_bf16 v[36:39], a[164:167], a[36:39], v[36:39]
    s_waitcnt vmcnt(4)
    buffer_load_dwordx4 v13, s[12:15], s48 offen nt lds
    v_mfma_f32_16x16x32_bf16 v[36:39], a[168:171], a[40:43], v[36:39]
    v_max3_f32 v7, v44, v45, v7
    v_mfma_f32_16x16x32_bf16 v[36:39], a[172:175], a[44:47], v[36:39]
    s_add_u32 s48, s48, -26624
    v_mfma_f32_16x16x32_bf16 v[240:243], a[224:227], v[56:59], v[240:243]
    v_mfma_f32_16x16x32_bf16 v[244:247], a[228:231], v[56:59], v[244:247]
    s_add_u32 m0, s52, 71680
    v_mfma_f32_16x16x32_bf16 v[248:251], a[232:235], v[56:59], v[248:251]
    v_max3_f32 v7, v46, v47, v7
    v_mfma_f32_16x16x32_bf16 v[252:255], a[236:239], v[56:59], v[252:255]
    v_mfma_f32_16x16x32_bf16 v[40:43], a[144:147], a[48:51], 0
    s_waitcnt vmcnt(3) lgkmcnt(0)
    v_mfma_f32_16x16x32_bf16 v[40:43], a[148:151], a[52:55], v[40:43]
    s_barrier
    buffer_load_dwordx4 v13, s[12:15], s48 offen nt lds
    v_mfma_f32_16x16x32_bf16 v[40:43], a[152:155], a[56:59], v[40:43]
    v_max3_f32 v1, v32, v33, v1
    v_mfma_f32_16x16x32_bf16 v[40:43], a[156:159], a[60:63], v[40:43]
    v_mfma_f32_16x16x32_bf16 a[0:3], a[208:211], v[60:63], a[0:3]
    v_mfma_f32_16x16x32_bf16 a[4:7], a[212:215], v[60:63], a[4:7]
    v_mfma_f32_16x16x32_bf16 a[8:11], a[216:219], v[60:63], a[8:11]
    v_max3_f32 v1, v34, v35, v1
    v_mfma_f32_16x16x32_bf16 a[12:15], a[220:223], v[60:63], a[12:15]
    v_mfma_f32_16x16x32_bf16 v[44:47], a[160:163], a[48:51], 0
    v_mfma_f32_16x16x32_bf16 v[44:47], a[164:167], a[52:55], v[44:47]
    v_mfma_f32_16x16x32_bf16 v[44:47], a[168:171], a[56:59], v[44:47]
    v_max3_f32 v1, v36, v37, v1
    v_mfma_f32_16x16x32_bf16 v[44:47], a[172:175], a[60:63], v[44:47]
    v_mfma_f32_16x16x32_bf16 a[16:19], a[224:227], v[60:63], a[16:19]
    v_mfma_f32_16x16x32_bf16 a[20:23], a[228:231], v[60:63], a[20:23]
    v_mfma_f32_16x16x32_bf16 a[24:27], a[232:235], v[60:63], a[24:27]
    v_max3_f32 v1, v38, v39, v1
    v_mfma_f32_16x16x32_bf16 a[28:31], a[236:239], v[60:63], a[28:31]
    s_add_u32 s48, s48, 5120
    v_mfma_f32_16x16x32_bf16 v[32:35], a[144:147], a[64:67], 0
    s_add_u32 m0, m0, s53
    v_mfma_f32_16x16x32_bf16 v[32:35], a[148:151], a[68:71], v[32:35]
    s_waitcnt vmcnt(4)
    buffer_load_dwordx4 v13, s[12:15], s48 offen nt lds
    v_mfma_f32_16x16x32_bf16 v[32:35], a[152:155], a[72:75], v[32:35]
    v_max3_f32 v2, v40, v41, v2
    v_mfma_f32_16x16x32_bf16 v[32:35], a[156:159], a[76:79], v[32:35]
    v_mfma_f32_16x16x32_bf16 v[64:67], a[176:179], v[56:59], v[64:67]
    v_mfma_f32_16x16x32_bf16 v[68:71], a[180:183], v[56:59], v[68:71]
    v_mfma_f32_16x16x32_bf16 v[72:75], a[184:187], v[56:59], v[72:75]
    v_max3_f32 v2, v42, v43, v2
    v_mfma_f32_16x16x32_bf16 v[76:79], a[188:191], v[56:59], v[76:79]
    v_mfma_f32_16x16x32_bf16 v[36:39], a[160:163], a[64:67], 0
    v_mfma_f32_16x16x32_bf16 v[36:39], a[164:167], a[68:71], v[36:39]
    ds_read_b64_tr_b16 a[208:209], v20 offset:35840
    v_mfma_f32_16x16x32_bf16 v[36:39], a[168:171], a[72:75], v[36:39]
    v_max3_f32 v2, v44, v45, v2
    v_mfma_f32_16x16x32_bf16 v[36:39], a[172:175], a[76:79], v[36:39]
    v_mfma_f32_16x16x32_bf16 v[80:83], a[192:195], v[56:59], v[80:83]
    v_mfma_f32_16x16x32_bf16 v[84:87], a[196:199], v[56:59], v[84:87]
    ds_read_b64_tr_b16 a[210:211], v20 offset:40448
    v_mfma_f32_16x16x32_bf16 v[88:91], a[200:203], v[56:59], v[88:91]
    v_max3_f32 v2, v46, v47, v2
    v_mfma_f32_16x16x32_bf16 v[92:95], a[204:207], v[56:59], v[92:95]
    s_add_u32 s48, s48, 1024
    v_mfma_f32_16x16x32_bf16 v[40:43], a[144:147], a[80:83], 0
    s_add_u32 m0, m0, s53
    v_mfma_f32_16x16x32_bf16 v[40:43], a[148:151], a[84:87], v[40:43]
    s_waitcnt vmcnt(4)
    buffer_load_dwordx4 v13, s[12:15], s48 offen nt lds
    v_mfma_f32_16x16x32_bf16 v[40:43], a[152:155], a[88:91], v[40:43]
    v_max3_f32 v3, v32, v33, v3
    v_mfma_f32_16x16x32_bf16 v[40:43], a[156:159], a[92:95], v[40:43]
    v_mfma_f32_16x16x32_bf16 v[96:99], a[176:179], v[60:63], v[96:99]
    v_mfma_f32_16x16x32_bf16 v[100:103], a[180:183], v[60:63], v[100:103]
    v_mfma_f32_16x16x32_bf16 v[104:107], a[184:187], v[60:63], v[104:107]
    v_max3_f32 v3, v34, v35, v3
    v_mfma_f32_16x16x32_bf16 v[108:111], a[188:191], v[60:63], v[108:111]
    s_add_u32 s48, s48, 5120
    v_mfma_f32_16x16x32_bf16 v[44:47], a[160:163], a[80:83], 0
    s_add_u32 m0, m0, s53
    v_mfma_f32_16x16x32_bf16 v[44:47], a[164:167], a[84:87], v[44:47]
    s_waitcnt vmcnt(4)
    buffer_load_dwordx4 v13, s[12:15], s48 offen nt lds
    v_mfma_f32_16x16x32_bf16 v[44:47], a[168:171], a[88:91], v[44:47]
    v_max3_f32 v3, v36, v37, v3
    v_mfma_f32_16x16x32_bf16 v[44:47], a[172:175], a[92:95], v[44:47]
    ds_read_b64_tr_b16 a[212:213], v21 offset:35840
    v_mfma_f32_16x16x32_bf16 v[112:115], a[192:195], v[60:63], v[112:115]
    v_mfma_f32_16x16x32_bf16 v[116:119], a[196:199], v[60:63], v[116:119]
    v_mfma_f32_16x16x32_bf16 v[120:123], a[200:203], v[60:63], v[120:123]
    v_max3_f32 v3, v38, v39, v3
    v_mfma_f32_16x16x32_bf16 v[124:127], a[204:207], v[60:63], v[124:127]
    ds_read_b64_tr_b16 a[214:215], v21 offset:40448
    v_mfma_f32_16x16x32_bf16 v[32:35], a[144:147], a[96:99], 0
    v_mfma_f32_16x16x32_bf16 v[32:35], a[148:151], a[100:103], v[32:35]
    ds_read_b64_tr_b16 a[216:217], v22 offset:35840
    v_mfma_f32_16x16x32_bf16 v[32:35], a[152:155], a[104:107], v[32:35]
    v_max3_f32 v4, v40, v41, v4
    v_mfma_f32_16x16x32_bf16 v[32:35], a[156:159], a[108:111], v[32:35]
    ds_read_b64_tr_b16 a[218:219], v22 offset:40448
    v_mfma_f32_16x16x32_bf16 v[128:131], a[176:179], v[56:59], v[128:131]
    v_mfma_f32_16x16x32_bf16 v[132:135], a[180:183], v[56:59], v[132:135]
    ds_read_b64_tr_b16 a[220:221], v23 offset:35840
    v_mfma_f32_16x16x32_bf16 v[136:139], a[184:187], v[56:59], v[136:139]
    v_max3_f32 v4, v42, v43, v4
    v_mfma_f32_16x16x32_bf16 v[140:143], a[188:191], v[56:59], v[140:143]
    s_add_u32 s48, s48, 5120
    ds_read_b64_tr_b16 a[222:223], v23 offset:40448
    v_mfma_f32_16x16x32_bf16 v[36:39], a[160:163], a[96:99], 0
    s_add_u32 m0, m0, s53
    v_mfma_f32_16x16x32_bf16 v[36:39], a[164:167], a[100:103], v[36:39]
    s_waitcnt vmcnt(4)
    buffer_load_dwordx4 v13, s[12:15], s48 offen nt lds
    v_mfma_f32_16x16x32_bf16 v[36:39], a[168:171], a[104:107], v[36:39]
    v_max3_f32 v4, v44, v45, v4
    v_mfma_f32_16x16x32_bf16 v[36:39], a[172:175], a[108:111], v[36:39]
    ds_read_b64_tr_b16 a[224:225], v20 offset:35968
    v_mfma_f32_16x16x32_bf16 v[144:147], a[192:195], v[56:59], v[144:147]
    v_mfma_f32_16x16x32_bf16 v[148:151], a[196:199], v[56:59], v[148:151]
    v_mfma_f32_16x16x32_bf16 v[152:155], a[200:203], v[56:59], v[152:155]
    v_max3_f32 v4, v46, v47, v4
    v_mfma_f32_16x16x32_bf16 v[156:159], a[204:207], v[56:59], v[156:159]
    ds_read_b64_tr_b16 a[226:227], v20 offset:40576
    v_mfma_f32_16x16x32_bf16 v[40:43], a[144:147], a[112:115], 0
    v_mfma_f32_16x16x32_bf16 v[40:43], a[148:151], a[116:119], v[40:43]
    ds_read_b64_tr_b16 a[228:229], v21 offset:35968
    v_mfma_f32_16x16x32_bf16 v[40:43], a[152:155], a[120:123], v[40:43]
    v_max3_f32 v5, v32, v33, v5
    v_mfma_f32_16x16x32_bf16 v[40:43], a[156:159], a[124:127], v[40:43]
    ds_read_b64_tr_b16 a[230:231], v21 offset:40576
    v_mfma_f32_16x16x32_bf16 v[160:163], a[176:179], v[60:63], v[160:163]
    v_mfma_f32_16x16x32_bf16 v[164:167], a[180:183], v[60:63], v[164:167]
    ds_read_b64_tr_b16 a[232:233], v22 offset:35968
    v_mfma_f32_16x16x32_bf16 v[168:171], a[184:187], v[60:63], v[168:171]
    v_max3_f32 v5, v34, v35, v5
    v_mfma_f32_16x16x32_bf16 v[172:175], a[188:191], v[60:63], v[172:175]
    s_add_u32 s48, s48, 5120
    ds_read_b64_tr_b16 a[234:235], v22 offset:40576
    v_mfma_f32_16x16x32_bf16 v[44:47], a[160:163], a[112:115], 0
    s_add_u32 m0, m0, s53
    v_mfma_f32_16x16x32_bf16 v[44:47], a[164:167], a[116:119], v[44:47]
    s_waitcnt vmcnt(4)
    buffer_load_dwordx4 v13, s[12:15], s48 offen nt lds
    v_mfma_f32_16x16x32_bf16 v[44:47], a[168:171], a[120:123], v[44:47]
    v_max3_f32 v5, v36, v37, v5
    v_mfma_f32_16x16x32_bf16 v[44:47], a[172:175], a[124:127], v[44:47]
    ds_read_b64_tr_b16 a[236:237], v23 offset:35968
    v_mfma_f32_16x16x32_bf16 v[176:179], a[192:195], v[60:63], v[176:179]
    v_mfma_f32_16x16x32_bf16 v[180:183], a[196:199], v[60:63], v[180:183]
    v_mfma_f32_16x16x32_bf16 v[184:187], a[200:203], v[60:63], v[184:187]
    v_max3_f32 v5, v38, v39, v5
    v_mfma_f32_16x16x32_bf16 v[188:191], a[204:207], v[60:63], v[188:191]
    ds_read_b64_tr_b16 a[238:239], v23 offset:40576
    v_mfma_f32_16x16x32_bf16 v[32:35], a[144:147], a[128:131], 0
    v_mfma_f32_16x16x32_bf16 v[32:35], a[148:151], a[132:135], v[32:35]
    ds_read_b128 a[144:147], v15 offset:35840
    v_mfma_f32_16x16x32_bf16 v[32:35], a[152:155], a[136:139], v[32:35]
    v_max3_f32 v6, v40, v41, v6
    v_mfma_f32_16x16x32_bf16 v[32:35], a[156:159], a[140:143], v[32:35]
    ds_read_b128 a[148:151], v15 offset:35904
    v_mfma_f32_16x16x32_bf16 v[192:195], a[176:179], v[56:59], v[192:195]
    v_mfma_f32_16x16x32_bf16 v[196:199], a[180:183], v[56:59], v[196:199]
    ds_read_b128 a[152:155], v15 offset:35968
    v_mfma_f32_16x16x32_bf16 v[200:203], a[184:187], v[56:59], v[200:203]
    v_max3_f32 v6, v42, v43, v6
    v_mfma_f32_16x16x32_bf16 v[204:207], a[188:191], v[56:59], v[204:207]
    ds_read_b128 a[156:159], v15 offset:36032
    v_mfma_f32_16x16x32_bf16 v[36:39], a[160:163], a[128:131], 0
    v_mfma_f32_16x16x32_bf16 v[36:39], a[164:167], a[132:135], v[36:39]
    ds_read_b128 a[160:163], v15 offset:40192
    v_mfma_f32_16x16x32_bf16 v[36:39], a[168:171], a[136:139], v[36:39]
    v_max3_f32 v6, v44, v45, v6
    v_mfma_f32_16x16x32_bf16 v[36:39], a[172:175], a[140:143], v[36:39]
    ds_read_b128 a[164:167], v15 offset:40256
    v_mfma_f32_16x16x32_bf16 v[208:211], a[192:195], v[56:59], v[208:211]
    v_mfma_f32_16x16x32_bf16 v[212:215], a[196:199], v[56:59], v[212:215]
    ds_read_b128 a[168:171], v15 offset:40320
    v_mfma_f32_16x16x32_bf16 v[216:219], a[200:203], v[56:59], v[216:219]
    v_max3_f32 v6, v46, v47, v6
    v_mfma_f32_16x16x32_bf16 v[220:223], a[204:207], v[56:59], v[220:223]
    s_add_u32 s48, s48, 1024
    s_waitcnt lgkmcnt(3)
    ds_read_b128 a[172:175], v15 offset:40384
    v_mfma_f32_16x16x32_bf16 v[40:43], a[144:147], a[32:35], 0
    s_add_u32 m0, m0, s53
    v_mfma_f32_16x16x32_bf16 v[40:43], a[148:151], a[36:39], v[40:43]
    s_waitcnt vmcnt(4)
    buffer_load_dwordx4 v13, s[12:15], s48 offen nt lds
    v_mfma_f32_16x16x32_bf16 v[40:43], a[152:155], a[40:43], v[40:43]
    v_max3_f32 v7, v32, v33, v7
    v_mfma_f32_16x16x32_bf16 v[40:43], a[156:159], a[44:47], v[40:43]
    v_mfma_f32_16x16x32_bf16 v[224:227], a[176:179], v[60:63], v[224:227]
    v_mfma_f32_16x16x32_bf16 v[228:231], a[180:183], v[60:63], v[228:231]
    v_mfma_f32_16x16x32_bf16 v[232:235], a[184:187], v[60:63], v[232:235]
    v_max3_f32 v7, v34, v35, v7
    v_mfma_f32_16x16x32_bf16 v[236:239], a[188:191], v[60:63], v[236:239]
    s_add_u32 s48, s48, 5120
    s_waitcnt lgkmcnt(0)
    v_mfma_f32_16x16x32_bf16 v[44:47], a[160:163], a[32:35], 0
    s_add_u32 m0, m0, s53
    v_mfma_f32_16x16x32_bf16 v[44:47], a[164:167], a[36:39], v[44:47]
    s_waitcnt vmcnt(4)
    buffer_load_dwordx4 v13, s[12:15], s48 offen nt lds
    v_mfma_f32_16x16x32_bf16 v[44:47], a[168:171], a[40:43], v[44:47]
    v_max3_f32 v7, v36, v37, v7
    v_mfma_f32_16x16x32_bf16 v[44:47], a[172:175], a[44:47], v[44:47]
    s_add_u32 s48, s48, -26624
    v_mfma_f32_16x16x32_bf16 v[240:243], a[192:195], v[60:63], v[240:243]
    v_mfma_f32_16x16x32_bf16 v[244:247], a[196:199], v[60:63], v[244:247]
    s_add_u32 m0, s52, 107520
    v_mfma_f32_16x16x32_bf16 v[248:251], a[200:203], v[60:63], v[248:251]
    v_max3_f32 v7, v38, v39, v7
    v_mfma_f32_16x16x32_bf16 v[252:255], a[204:207], v[60:63], v[252:255]
    v_mfma_f32_16x16x32_bf16 v[32:35], a[144:147], a[48:51], 0
    s_waitcnt vmcnt(3) lgkmcnt(0)
    v_mfma_f32_16x16x32_bf16 v[32:35], a[148:151], a[52:55], v[32:35]
    s_barrier
    buffer_load_dwordx4 v13, s[12:15], s48 offen nt lds
    v_mfma_f32_16x16x32_bf16 v[32:35], a[152:155], a[56:59], v[32:35]
    v_max3_f32 v1, v40, v41, v1
    v_mfma_f32_16x16x32_bf16 v[32:35], a[156:159], a[60:63], v[32:35]
    v_mfma_f32_16x16x32_bf16 a[0:3], a[176:179], v[56:59], a[0:3]
    v_mfma_f32_16x16x32_bf16 a[4:7], a[180:183], v[56:59], a[4:7]
    v_mfma_f32_16x16x32_bf16 a[8:11], a[184:187], v[56:59], a[8:11]
    v_max3_f32 v1, v42, v43, v1
    v_mfma_f32_16x16x32_bf16 a[12:15], a[188:191], v[56:59], a[12:15]
    v_mfma_f32_16x16x32_bf16 v[36:39], a[160:163], a[48:51], 0
    v_mfma_f32_16x16x32_bf16 v[36:39], a[164:167], a[52:55], v[36:39]
    v_mfma_f32_16x16x32_bf16 v[36:39], a[168:171], a[56:59], v[36:39]
    v_max3_f32 v1, v44, v45, v1
    v_mfma_f32_16x16x32_bf16 v[36:39], a[172:175], a[60:63], v[36:39]
    v_mfma_f32_16x16x32_bf16 a[16:19], a[192:195], v[56:59], a[16:19]
    v_mfma_f32_16x16x32_bf16 a[20:23], a[196:199], v[56:59], a[20:23]
    v_mfma_f32_16x16x32_bf16 a[24:27], a[200:203], v[56:59], a[24:27]
    v_max3_f32 v1, v46, v47, v1
    v_mfma_f32_16x16x32_bf16 a[28:31], a[204:207], v[56:59], a[28:31]
    s_add_u32 s48, s48, 1024
    v_mfma_f32_16x16x32_bf16 v[40:43], a[144:147], a[64:67], 0
    s_add_u32 m0, m0, s53
    v_mfma_f32_16x16x32_bf16 v[40:43], a[148:151], a[68:71], v[40:43]
    s_waitcnt vmcnt(4)
    buffer_load_dwordx4 v13, s[12:15], s48 offen nt lds
    v_mfma_f32_16x16x32_bf16 v[40:43], a[152:155], a[72:75], v[40:43]
    v_max3_f32 v2, v32, v33, v2
    v_mfma_f32_16x16x32_bf16 v[40:43], a[156:159], a[76:79], v[40:43]
    v_mfma_f32_16x16x32_bf16 v[64:67], a[208:211], v[60:63], v[64:67]
    v_mfma_f32_16x16x32_bf16 v[68:71], a[212:215], v[60:63], v[68:71]
    v_mfma_f32_16x16x32_bf16 v[72:75], a[216:219], v[60:63], v[72:75]
    v_max3_f32 v2, v34, v35, v2
    v_mfma_f32_16x16x32_bf16 v[76:79], a[220:223], v[60:63], v[76:79]
    v_mfma_f32_16x16x32_bf16 v[44:47], a[160:163], a[64:67], 0
    v_mfma_f32_16x16x32_bf16 v[44:47], a[164:167], a[68:71], v[44:47]
    ds_read_b64_tr_b16 a[176:177], v16 offset:0
    v_mfma_f32_16x16x32_bf16 v[44:47], a[168:171], a[72:75], v[44:47]
    v_max3_f32 v2, v36, v37, v2
    v_mfma_f32_16x16x32_bf16 v[44:47], a[172:175], a[76:79], v[44:47]
    v_mfma_f32_16x16x32_bf16 v[80:83], a[224:227], v[60:63], v[80:83]
    v_mfma_f32_16x16x32_bf16 v[84:87], a[228:231], v[60:63], v[84:87]
    ds_read_b64_tr_b16 a[178:179], v16 offset:4608
    v_mfma_f32_16x16x32_bf16 v[88:91], a[232:235], v[60:63], v[88:91]
    v_max3_f32 v2, v38, v39, v2
    v_mfma_f32_16x16x32_bf16 v[92:95], a[236:239], v[60:63], v[92:95]
    s_add_u32 s48, s48, 5120
    v_mfma_f32_16x16x32_bf16 v[32:35], a[144:147], a[80:83], 0
    s_add_u32 m0, m0, s53
    v_mfma_f32_16x16x32_bf16 v[32:35], a[148:151], a[84:87], v[32:35]
    s_waitcnt vmcnt(4)
    buffer_load_dwordx4 v13, s[12:15], s48 offen nt lds
    v_mfma_f32_16x16x32_bf16 v[32:35], a[152:155], a[88:91], v[32:35]
    v_max3_f32 v3, v40, v41, v3
    v_mfma_f32_16x16x32_bf16 v[32:35], a[156:159], a[92:95], v[32:35]
    v_mfma_f32_16x16x32_bf16 v[96:99], a[208:211], v[56:59], v[96:99]
    v_mfma_f32_16x16x32_bf16 v[100:103], a[212:215], v[56:59], v[100:103]
    v_mfma_f32_16x16x32_bf16 v[104:107], a[216:219], v[56:59], v[104:107]
    v_max3_f32 v3, v42, v43, v3
    v_mfma_f32_16x16x32_bf16 v[108:111], a[220:223], v[56:59], v[108:111]
    s_add_u32 s48, s48, 5120
    v_mfma_f32_16x16x32_bf16 v[36:39], a[160:163], a[80:83], 0
    s_add_u32 m0, m0, s53
    v_mfma_f32_16x16x32_bf16 v[36:39], a[164:167], a[84:87], v[36:39]
    s_waitcnt vmcnt(4)
    buffer_load_dwordx4 v13, s[12:15], s48 offen nt lds
    v_mfma_f32_16x16x32_bf16 v[36:39], a[168:171], a[88:91], v[36:39]
    v_max3_f32 v3, v44, v45, v3
    v_mfma_f32_16x16x32_bf16 v[36:39], a[172:175], a[92:95], v[36:39]
    ds_read_b64_tr_b16 a[180:181], v17 offset:0
    v_mfma_f32_16x16x32_bf16 v[112:115], a[224:227], v[56:59], v[112:115]
    v_mfma_f32_16x16x32_bf16 v[116:119], a[228:231], v[56:59], v[116:119]
    v_mfma_f32_16x16x32_bf16 v[120:123], a[232:235], v[56:59], v[120:123]
    v_max3_f32 v3, v46, v47, v3
    v_mfma_f32_16x16x32_bf16 v[124:127], a[236:239], v[56:59], v[124:127]
    ds_read_b64_tr_b16 a[182:183], v17 offset:4608
    v_mfma_f32_16x16x32_bf16 v[40:43], a[144:147], a[96:99], 0
    v_mfma_f32_16x16x32_bf16 v[40:43], a[148:151], a[100:103], v[40:43]
    ds_read_b64_tr_b16 a[184:185], v18 offset:0
    v_mfma_f32_16x16x32_bf16 v[40:43], a[152:155], a[104:107], v[40:43]
    v_max3_f32 v4, v32, v33, v4
    v_mfma_f32_16x16x32_bf16 v[40:43], a[156:159], a[108:111], v[40:43]
    ds_read_b64_tr_b16 a[186:187], v18 offset:4608
    v_mfma_f32_16x16x32_bf16 v[128:131], a[208:211], v[60:63], v[128:131]
    v_mfma_f32_16x16x32_bf16 v[132:135], a[212:215], v[60:63], v[132:135]
    ds_read_b64_tr_b16 a[188:189], v19 offset:0
    v_mfma_f32_16x16x32_bf16 v[136:139], a[216:219], v[60:63], v[136:139]
    v_max3_f32 v4, v34, v35, v4
    v_mfma_f32_16x16x32_bf16 v[140:143], a[220:223], v[60:63], v[140:143]
    s_add_u32 s48, s48, 5120
    ds_read_b64_tr_b16 a[190:191], v19 offset:4608
    v_mfma_f32_16x16x32_bf16 v[44:47], a[160:163], a[96:99], 0
    s_add_u32 m0, m0, s53
    v_mfma_f32_16x16x32_bf16 v[44:47], a[164:167], a[100:103], v[44:47]
    s_waitcnt vmcnt(4)
    buffer_load_dwordx4 v13, s[12:15], s48 offen nt lds
    v_mfma_f32_16x16x32_bf16 v[44:47], a[168:171], a[104:107], v[44:47]
    v_max3_f32 v4, v36, v37, v4
    v_mfma_f32_16x16x32_bf16 v[44:47], a[172:175], a[108:111], v[44:47]
    ds_read_b64_tr_b16 a[192:193], v16 offset:128
    v_mfma_f32_16x16x32_bf16 v[144:147], a[224:227], v[60:63], v[144:147]
    v_mfma_f32_16x16x32_bf16 v[148:151], a[228:231], v[60:63], v[148:151]
    v_mfma_f32_16x16x32_bf16 v[152:155], a[232:235], v[60:63], v[152:155]
    v_max3_f32 v4, v38, v39, v4
    v_mfma_f32_16x16x32_bf16 v[156:159], a[236:239], v[60:63], v[156:159]
    ds_read_b64_tr_b16 a[194:195], v16 offset:4736
    v_mfma_f32_16x16x32_bf16 v[32:35], a[144:147], a[112:115], 0
    v_mfma_f32_16x16x32_bf16 v[32:35], a[148:151], a[116:119], v[32:35]
    ds_read_b64_tr_b16 a[196:197], v17 offset:128
    v_mfma_f32_16x16x32_bf16 v[32:35], a[152:155], a[120:123], v[32:35]
    v_max3_f32 v5, v40, v41, v5
    v_mfma_f32_16x16x32_bf16 v[32:35], a[156:159], a[124:127], v[32:35]
    ds_read_b64_tr_b16 a[198:199], v17 offset:4736
    v_mfma_f32_16x16x32_bf16 v[160:163], a[208:211], v[56:59], v[160:163]
    v_mfma_f32_16x16x32_bf16 v[164:167], a[212:215], v[56:59], v[164:167]
    ds_read_b64_tr_b16 a[200:201], v18 offset:128
    v_mfma_f32_16x16x32_bf16 v[168:171], a[216:219], v[56:59], v[168:171]
    v_max3_f32 v5, v42, v43, v5
    v_mfma_f32_16x16x32_bf16 v[172:175], a[220:223], v[56:59], v[172:175]
    s_add_u32 s48, s48, 1024
    ds_read_b64_tr_b16 a[202:203], v18 offset:4736
    v_mfma_f32_16x16x32_bf16 v[36:39], a[160:163], a[112:115], 0
    s_add_u32 m0, m0, s53
    v_mfma_f32_16x16x32_bf16 v[36:39], a[164:167], a[116:119], v[36:39]
    s_waitcnt vmcnt(4)
    buffer_load_dwordx4 v13, s[12:15], s48 offen nt lds
    v_mfma_f32_16x16x32_bf16 v[36:39], a[168:171], a[120:123], v[36:39]
    v_max3_f32 v5, v44, v45, v5
    v_mfma_f32_16x16x32_bf16 v[36:39], a[172:175], a[124:127], v[36:39]
    ds_read_b64_tr_b16 a[204:205], v19 offset:128
    v_mfma_f32_16x16x32_bf16 v[176:179], a[224:227], v[56:59], v[176:179]
    v_mfma_f32_16x16x32_bf16 v[180:183], a[228:231], v[56:59], v[180:183]
    v_mfma_f32_16x16x32_bf16 v[184:187], a[232:235], v[56:59], v[184:187]
    v_max3_f32 v5, v46, v47, v5
    v_mfma_f32_16x16x32_bf16 v[188:191], a[236:239], v[56:59], v[188:191]
    ds_read_b64_tr_b16 a[206:207], v19 offset:4736
    v_mfma_f32_16x16x32_bf16 v[40:43], a[144:147], a[128:131], 0
    v_mfma_f32_16x16x32_bf16 v[40:43], a[148:151], a[132:135], v[40:43]
    ds_read_b128 a[144:147], v14 offset:0
    v_mfma_f32_16x16x32_bf16 v[40:43], a[152:155], a[136:139], v[40:43]
    v_max3_f32 v6, v32, v33, v6
    v_mfma_f32_16x16x32_bf16 v[40:43], a[156:159], a[140:143], v[40:43]
    ds_read_b128 a[148:151], v14 offset:64
    v_mfma_f32_16x16x32_bf16 v[192:195], a[208:211], v[60:63], v[192:195]
    v_mfma_f32_16x16x32_bf16 v[196:199], a[212:215], v[60:63], v[196:199]
    ds_read_b128 a[152:155], v14 offset:128
    v_mfma_f32_16x16x32_bf16 v[200:203], a[216:219], v[60:63], v[200:203]
    v_max3_f32 v6, v34, v35, v6
    v_mfma_f32_16x16x32_bf16 v[204:207], a[220:223], v[60:63], v[204:207]
    ds_read_b128 a[156:159], v14 offset:192
    v_mfma_f32_16x16x32_bf16 v[44:47], a[160:163], a[128:131], 0
    v_mfma_f32_16x16x32_bf16 v[44:47], a[164:167], a[132:135], v[44:47]
    ds_read_b128 a[160:163], v14 offset:4352
    v_mfma_f32_16x16x32_bf16 v[44:47], a[168:171], a[136:139], v[44:47]
    v_max3_f32 v6, v36, v37, v6
    v_mfma_f32_16x16x32_bf16 v[44:47], a[172:175], a[140:143], v[44:47]
    ds_read_b128 a[164:167], v14 offset:4416
    v_mfma_f32_16x16x32_bf16 v[208:211], a[224:227], v[60:63], v[208:211]
    v_mfma_f32_16x16x32_bf16 v[212:215], a[228:231], v[60:63], v[212:215]
    ds_read_b128 a[168:171], v14 offset:4480
    v_mfma_f32_16x16x32_bf16 v[216:219], a[232:235], v[60:63], v[216:219]
    v_max3_f32 v6, v38, v39, v6
    v_mfma_f32_16x16x32_bf16 v[220:223], a[236:239], v[60:63], v[220:223]
    s_add_u32 s48, s48, 5120
    s_waitcnt lgkmcnt(3)
    ds_read_b128 a[172:175], v14 offset:4544
    v_mfma_f32_16x16x32_bf16 v[32:35], a[144:147], a[32:35], 0
    s_add_u32 m0, m0, s53
    v_mfma_f32_16x16x32_bf16 v[32:35], a[148:151], a[36:39], v[32:35]
    s_waitcnt vmcnt(4)
    buffer_load_dwordx4 v13, s[12:15], s48 offen nt lds
    v_mfma_f32_16x16x32_bf16 v[32:35], a[152:155], a[40:43], v[32:35]
    v_max3_f32 v7, v40, v41, v7
    v_mfma_f32_16x16x32_bf16 v[32:35], a[156:159], a[44:47], v[32:35]
    v_mfma_f32_16x16x32_bf16 v[224:227], a[208:211], v[56:59], v[224:227]
    v_mfma_f32_16x16x32_bf16 v[228:231], a[212:215], v[56:59], v[228:231]
    v_mfma_f32_16x16x32_bf16 v[232:235], a[216:219], v[56:59], v[232:235]
    v_max3_f32 v7, v42, v43, v7
    v_mfma_f32_16x16x32_bf16 v[236:239], a[220:223], v[56:59], v[236:239]
    s_add_u32 s48, s48, 5120
    s_waitcnt lgkmcnt(0)
    v_mfma_f32_16x16x32_bf16 v[36:39], a[160:163], a[32:35], 0
    s_add_u32 m0, m0, s53
    v_mfma_f32_16x16x32_bf16 v[36:39], a[164:167], a[36:39], v[36:39]
    s_waitcnt vmcnt(4)
    buffer_load_dwordx4 v13, s[12:15], s48 offen nt lds
    v_mfma_f32_16x16x32_bf16 v[36:39], a[168:171], a[40:43], v[36:39]
    v_max3_f32 v7, v44, v45, v7
    v_mfma_f32_16x16x32_bf16 v[36:39], a[172:175], a[44:47], v[36:39]
    s_add_u32 s48, s48, 2048
    v_mfma_f32_16x16x32_bf16 v[240:243], a[224:227], v[56:59], v[240:243]
    v_mfma_f32_16x16x32_bf16 v[244:247], a[228:231], v[56:59], v[244:247]
    s_add_u32 m0, s52, 0
    v_mfma_f32_16x16x32_bf16 v[248:251], a[232:235], v[56:59], v[248:251]
    s_sub_u32 s55, s55, 1
    v_max3_f32 v7, v46, v47, v7
    v_mfma_f32_16x16x32_bf16 v[252:255], a[236:239], v[56:59], v[252:255]
    s_cmp_lg_u32 s55, 0
    s_cbranch_scc1 L_am
    s_nop 1
    v_mfma_f32_16x16x32_bf16 a[0:3], a[208:211], v[60:63], a[0:3]
    v_mfma_f32_16x16x32_bf16 a[4:7], a[212:215], v[60:63], a[4:7]
    v_mfma_f32_16x16x32_bf16 a[8:11], a[216:219], v[60:63], a[8:11]
    v_mfma_f32_16x16x32_bf16 a[12:15], a[220:223], v[60:63], a[12:15]
    v_mfma_f32_16x16x32_bf16 a[16:19], a[224:227], v[60:63], a[16:19]
    v_mfma_f32_16x16x32_bf16 a[20:23], a[228:231], v[60:63], a[20:23]
    v_mfma_f32_16x16x32_bf16 a[24:27], a[232:235], v[60:63], a[24:27]
    v_mfma_f32_16x16x32_bf16 a[28:31], a[236:239], v[60:63], a[28:31]
    v_mov_b32 v32, v1
    v_mov_b32 v33, v2
    v_mov_b32 v34, v3
    v_mov_b32 v35, v4
    v_mov_b32 v36, v5
    v_mov_b32 v37, v6
    v_mov_b32 v38, v7
    s_nop 0
    v_permlane32_swap_b32 v1, v32
    v_permlane32_swap_b32 v2, v33
    v_permlane32_swap_b32 v3, v34
    v_permlane32_swap_b32 v4, v35
    v_permlane32_swap_b32 v5, v36
    v_permlane32_swap_b32 v6, v37
    v_permlane32_swap_b32 v7, v38
    v_max_f32 v1, v1, v32
    v_max_f32 v2, v2, v33
    v_max_f32 v3, v3, v34
    v_max_f32 v4, v4, v35
    v_max_f32 v5, v5, v36
    v_max_f32 v6, v6, v37
    v_max_f32 v7, v7, v38
    v_mov_b32 v32, v1
    v_mov_b32 v33, v2
    v_mov_b32 v34, v3
    v_mov_b32 v35, v4
    v_mov_b32 v36, v5
    v_mov_b32 v37, v6
    v_mov_b32 v38, v7
    s_nop 0
    v_permlane16_swap_b32 v1, v32
    v_permlane16_swap_b32 v2, v33
    v_permlane16_swap_b32 v3, v34
    v_permlane16_swap_b32 v4, v35
    v_permlane16_swap_b32 v5, v36
    v_permlane16_swap_b32 v6, v37
    v_permlane16_swap_b32 v7, v38
    v_max_f32 v1, v1, v32
    v_max_f32 v2, v2, v33
    v_max_f32 v3, v3, v34
    v_max_f32 v4, v4, v35
    v_max_f32 v5, v5, v36
    v_max_f32 v6, v6, v37
    v_max_f32 v7, v7, v38
    s_waitcnt vmcnt(0) lgkmcnt(0)
    s_barrier
    s_mov_b32 s48, s42
    s_add_u32 m0, s52, 0
    s_nop 0
    buffer_load_dwordx4 v13, s[12:15], s48 offen nt lds
    s_add_u32 m0, m0, s53
    s_add_u32 s48, s48, 5120
    buffer_load_dwordx4 v13, s[12:15], s48 offen nt lds
    s_add_u32 m0, m0, s53
    s_add_u32 s48, s48, 5120
    buffer_load_dwordx4 v13, s[12:15], s48 offen nt lds
    s_add_u32 m0, m0, s53
    s_add_u32 s48, s48, 5120
    buffer_load_dwordx4 v13, s[12:15], s48 offen nt lds
    s_add_u32 m0, m0, s53
    s_add_u32 s48, s48, 1024
    buffer_load_dwordx4 v13, s[12:15], s48 offen nt lds
    s_add_u32 m0, m0, s53
    s_add_u32 s48, s48, 5120
    buffer_load_dwordx4 v13, s[12:15], s48 offen nt lds
    s_add_u32 m0, m0, s53
    s_add_u32 s48, s48, 5120
    buffer_load_dwordx4 v13, s[12:15], s48 offen nt lds
    s_add_u32 m0, m0, s53
    s_add_u32 s48, s48, 5120
    buffer_load_dwordx4 v13, s[12:15], s48 offen nt lds
    s_add_u32 s48, s48, -30720
    s_add_u32 m0, s52, 35840
    s_nop 0
    buffer_load_dwordx4 v13, s[12:15], s48 offen nt lds
    s_add_u32 m0, m0, s53
    s_add_u32 s48, s48, 5120
    buffer_load_dwordx4 v13, s[12:15], s48 offen nt lds
    s_add_u32 m0, m0, s53
    s_add_u32 s48, s48, 5120
    buffer_load_dwordx4 v13, s[12:15], s48 offen nt lds
    s_add_u32 m0, m0, s53
    s_add_u32 s48, s48, 1024
    buffer_load_dwordx4 v13, s[12:15], s48 offen nt lds
    s_add_u32 m0, m0, s53
    s_add_u32 s48, s48, 5120
    buffer_load_dwordx4 v13, s[12:15], s48 offen nt lds
    s_add_u32 m0, m0, s53
    s_add_u32 s48, s48, 5120
    buffer_load_dwordx4 v13, s[12:15], s48 offen nt lds
    s_add_u32 m0, m0, s53
    s_add_u32 s48, s48, 5120
    buffer_load_dwordx4 v13, s[12:15], s48 offen nt lds
    s_add_u32 m0, m0, s53
    s_add_u32 s48, s48, 1024
    buffer_load_dwordx4 v13, s[12:15], s48 offen nt lds
    s_add_u32 s48, s48, -26624
    s_add_u32 m0, s52, 71680
    s_nop 0
    buffer_load_dwordx4 v13, s[12:15], s48 offen nt lds
    s_add_u32 m0, m0, s53
    s_add_u32 s48, s48, 5120
    buffer_load_dwordx4 v13, s[12:15], s48 offen nt lds
    s_add_u32 m0, m0, s53
    s_add_u32 s48, s48, 1024
    buffer_load_dwordx4 v13, s[12:15], s48 offen nt lds
    s_add_u32 m0, m0, s53
    s_add_u32 s48, s48, 5120
    buffer_load_dwordx4 v13, s[12:15], s48 offen nt lds
    s_add_u32 m0, m0, s53
    s_add_u32 s48, s48, 5120
    buffer_load_dwordx4 v13, s[12:15], s48 offen nt lds
    s_add_u32 m0, m0, s53
    s_add_u32 s48, s48, 5120
    buffer_load_dwordx4 v13, s[12:15], s48 offen nt lds
    s_add_u32 m0, m0, s53
    s_add_u32 s48, s48, 1024
    buffer_load_dwordx4 v13, s[12:15], s48 offen nt lds
    s_add_u32 m0, m0, s53
    s_add_u32 s48, s48, 5120
    buffer_load_dwordx4 v13, s[12:15], s48 offen nt lds
    s_add_u32 s48, s48, -26624
    s_add_u32 m0, s52, 107520
    s_nop 0
    buffer_load_dwordx4 v13, s[12:15], s48 offen nt lds
    s_add_u32 m0, m0, s53
    s_add_u32 s48, s48, 1024
    buffer_load_dwordx4 v13, s[12:15], s48 offen nt lds
    s_add_u32 m0, m0, s53
    s_add_u32 s48, s48, 5120
    buffer_load_dwordx4 v13, s[12:15], s48 offen nt lds
    s_add_u32 m0, m0, s53
    s_add_u32 s48, s48, 5120
    buffer_load_dwordx4 v13, s[12:15], s48 offen nt lds
    s_add_u32 m0, m0, s53
    s_add_u32 s48, s48, 5120
    buffer_load_dwordx4 v13, s[12:15], s48 offen nt lds
    s_add_u32 m0, m0, s53
    s_add_u32 s48, s48, 1024
    buffer_load_dwordx4 v13, s[12:15], s48 offen nt lds
    s_add_u32 m0, m0, s53
    s_add_u32 s48, s48, 5120
    buffer_load_dwordx4 v13, s[12:15], s48 offen nt lds
    s_add_u32 m0, m0, s53
    s_add_u32 s48, s48, 5120
    buffer_load_dwordx4 v13, s[12:15], s48 offen nt lds
    s_add_u32 s48, s48, 2048
    v_mov_b32 v56, 0
    v_mov_b32 v57, 0
    v_mov_b32 v58, 0
    v_mov_b32 v59, 0
    v_mov_b32 v60, 0
    v_mov_b32 v61, 0
    v_mov_b32 v62, 0
    v_mov_b32 v63, 0
    s_waitcnt vmcnt(24)
    s_barrier
    ds_read_b128 a[144:147], v14 offset:0
    ds_read_b128 a[148:151], v14 offset:64
    ds_read_b128 a[152:155], v14 offset:128
    ds_read_b128 a[156:159], v14 offset:192
    ds_read_b128 a[160:163], v14 offset:4352
    ds_read_b128 a[164:167], v14 offset:4416
    ds_read_b128 a[168:171], v14 offset:4480
    ds_read_b128 a[172:175], v14 offset:4544
    s_waitcnt lgkmcnt(7)
    ds_read_b64_tr_b16 a[176:177], v16 offset:0
    ds_read_b64_tr_b16 a[178:179], v16 offset:4608
    ds_read_b64_tr_b16 a[180:181], v17 offset:0
    ds_read_b64_tr_b16 a[182:183], v17 offset:4608
    ds_read_b64_tr_b16 a[184:185], v18 offset:0
    ds_read_b64_tr_b16 a[186:187], v18 offset:4608
    ds_read_b64_tr_b16 a[188:189], v19 offset:0
    ds_read_b64_tr_b16 a[190:191], v19 offset:4608
    s_waitcnt lgkmcnt(7)
    ds_read_b64_tr_b16 a[192:193], v16 offset:128
    ds_read_b64_tr_b16 a[194:195], v16 offset:4736
    ds_read_b64_tr_b16 a[196:197], v17 offset:128
    ds_read_b64_tr_b16 a[198:199], v17 offset:4736
    ds_read_b64_tr_b16 a[200:201], v18 offset:128
    ds_read_b64_tr_b16 a[202:203], v18 offset:4736
    ds_read_b64_tr_b16 a[204:205], v19 offset:128
    ds_read_b64_tr_b16 a[206:207], v19 offset:4736
    s_waitcnt lgkmcnt(7)
    v_mfma_f32_32x32x16_bf16 v[64:79], v[56:59], v[56:59], 0
    v_mfma_f32_32x32x16_bf16 v[80:95], v[56:59], v[56:59], 0
    v_mfma_f32_32x32x16_bf16 v[96:111], v[56:59], v[56:59], 0
    v_mfma_f32_32x32x16_bf16 v[112:127], v[56:59], v[56:59], 0
    v_mfma_f32_32x32x16_bf16 v[128:143], v[56:59], v[56:59], 0
    v_mfma_f32_32x32x16_bf16 v[144:159], v[56:59], v[56:59], 0
    v_mfma_f32_32x32x16_bf16 v[160:175], v[56:59], v[56:59], 0
    v_mfma_f32_32x32x16_bf16 v[176:191], v[56:59], v[56:59], 0
    v_mfma_f32_32x32x16_bf16 v[192:207], v[56:59], v[56:59], 0
    v_mfma_f32_32x32x16_bf16 v[208:223], v[56:59], v[56:59], 0
    v_mfma_f32_32x32x16_bf16 v[224:239], v[56:59], v[56:59], 0
    v_mfma_f32_32x32x16_bf16 v[240:255], v[56:59], v[56:59], 0
    v_mfma_f32_32x32x16_bf16 a[0:15], v[56:59], v[56:59], 0
    v_mfma_f32_32x32x16_bf16 a[16:31], v[56:59], v[56:59], 0
    v_mfma_f32_32x32x16_bf16 a[208:223], v[56:59], v[56:59], 0
    v_mfma_f32_32x32x16_bf16 a[224:239], v[56:59], v[56:59], 0
    s_waitcnt lgkmcnt(0)
    v_mov_b32 v24, 0
    v_mov_b32 v25, 0
    v_mov_b32 v26, 0
    v_mov_b32 v27, 0
    v_mov_b32 v28, 0
    v_mov_b32 v29, 0
    v_mov_b32 v30, 0
    s_add_u32 m0, s52, 0
    v_mfma_f32_16x16x32_bf16 v[32:35], a[144:147], a[32:35], 0
    v_mfma_f32_16x16x32_bf16 v[32:35], a[148:151], a[36:39], v[32:35]
    v_mfma_f32_16x16x32_bf16 v[32:35], a[152:155], a[40:43], v[32:35]
    v_mfma_f32_16x16x32_bf16 v[32:35], a[156:159], a[44:47], v[32:35]
    v_mfma_f32_16x16x32_bf16 v[36:39], a[160:163], a[32:35], 0
    v_mfma_f32_16x16x32_bf16 v[36:39], a[164:167], a[36:39], v[36:39]
    v_mfma_f32_16x16x32_bf16 v[36:39], a[168:171], a[40:43], v[36:39]
    v_mfma_f32_16x16x32_bf16 v[36:39], a[172:175], a[44:47], v[36:39]
    s_nop 3
    s_mov_b32 s55, 8
    .p2align 6
L_as:
    v_mfma_f32_16x16x32_bf16 v[40:43], a[144:147], a[48:51], 0
    s_waitcnt vmcnt(3) lgkmcnt(0)
    v_sub_f32 v32, v32, v1
    v_exp_f32 v32, v32
    v_mfma_f32_16x16x32_bf16 v[40:43], a[148:151], a[52:55], v[40:43]
    s_barrier
    buffer_load_dwordx4 v13, s[12:15], s48 offen nt lds
    v_mfma_f32_16x16x32_bf16 v[40:43], a[152:155], a[56:59], v[40:43]
    v_sub_f32 v33, v33, v1
    v_exp_f32 v33, v33
    v_mfma_f32_16x16x32_bf16 v[40:43], a[156:159], a[60:63], v[40:43]
    v_add_f32 v24, v24, v33
    v_cvt_pk_bf16_f32 v56, v32, v33
    v_mfma_f32_16x16x32_bf16 a[0:3], a[208:211], v[60:63], a[0:3]
    v_sub_f32 v34, v34, v1
    v_exp_f32 v34, v34
    v_mfma_f32_16x16x32_bf16 a[4:7], a[212:215], v[60:63], a[4:7]
    v_add_f32 v24, v24, v32
    v_add_f32 v24, v24, v34
    v_mfma_f32_16x16x32_bf16 a[8:11], a[216:219], v[60:63], a[8:11]
    v_sub_f32 v35, v35, v1
    v_exp_f32 v35, v35
    v_mfma_f32_16x16x32_bf16 a[12:15], a[220:223], v[60:63], a[12:15]
    v_add_f32 v24, v24, v35
    v_cvt_pk_bf16_f32 v57, v34, v35
    v_mfma_f32_16x16x32_bf16 v[44:47], a[160:163], a[48:51], 0
    v_sub_f32 v36, v36, v1
    v_exp_f32 v36, v36
    v_mfma_f32_16x16x32_bf16 v[44:47], a[164:167], a[52:55], v[44:47]
    v_add_f32 v24, v24, v36
    v_mfma_f32_16x16x32_bf16 v[44:47], a[168:171], a[56:59], v[44:47]
    v_sub_f32 v37, v37, v1
    v_exp_f32 v37, v37
    v_mfma_f32_16x16x32_bf16 v[44:47], a[172:175], a[60:63], v[44:47]
    v_add_f32 v24, v24, v37
    v_cvt_pk_bf16_f32 v58, v36, v37
    v_mfma_f32_16x16x32_bf16 a[16:19], a[224:227], v[60:63], a[16:19]
    v_sub_f32 v38, v38, v1
    v_exp_f32 v38, v38
    v_mfma_f32_16x16x32_bf16 a[20:23], a[228:231], v[60:63], a[20:23]
    v_add_f32 v24, v24, v38
    v_mfma_f32_16x16x32_bf16 a[24:27], a[232:235], v[60:63], a[24:27]
    v_sub_f32 v39, v39, v1
    v_exp_f32 v39, v39
    v_mfma_f32_16x16x32_bf16 a[28:31], a[236:239], v[60:63], a[28:31]
    s_add_u32 s48, s48, 5120
    v_add_f32 v24, v24, v39
    v_cvt_pk_bf16_f32 v59, v38, v39
    v_mfma_f32_16x16x32_bf16 v[32:35], a[144:147], a[64:67], 0
    s_add_u32 m0, m0, s53
    v_sub_f32 v40, v40, v2
    v_exp_f32 v40, v40
    v_mfma_f32_16x16x32_bf16 v[32:35], a[148:151], a[68:71], v[32:35]
    s_waitcnt vmcnt(4)
    buffer_load_dwordx4 v13, s[12:15], s48 offen nt lds
    v_mfma_f32_16x16x32_bf16 v[32:35], a[152:155], a[72:75], v[32:35]
    v_sub_f32 v41, v41, v2
    v_exp_f32 v41, v41
    v_mfma_f32_16x16x32_bf16 v[32:35], a[156:159], a[76:79], v[32:35]
    v_add_f32 v25, v25, v41
    v_cvt_pk_bf16_f32 v60, v40, v41
    v_mfma_f32_16x16x32_bf16 v[64:67], a[176:179], v[56:59], v[64:67]
    v_sub_f32 v42, v42, v2
    v_exp_f32 v42, v42
    v_mfma_f32_16x16x32_bf16 v[68:71], a[180:183], v[56:59], v[68:71]
    v_add_f32 v25, v25, v40
    v_add_f32 v25, v25, v42
    v_mfma_f32_16x16x32_bf16 v[72:75], a[184:187], v[56:59], v[72:75]
    v_sub_f32 v43, v43, v2
    v_exp_f32 v43, v43
    v_mfma_f32_16x16x32_bf16 v[76:79], a[188:191], v[56:59], v[76:79]
    v_add_f32 v25, v25, v43
    v_cvt_pk_bf16_f32 v61, v42, v43
    v_mfma_f32_16x16x32_bf16 v[36:39], a[160:163], a[64:67], 0
    v_sub_f32 v44, v44, v2
    v_exp_f32 v44, v44
    v_mfma_f32_16x16x32_bf16 v[36:39], a[164:167], a[68:71], v[36:39]
    ds_read_b64_tr_b16 a[208:209], v16 offset:35840
    v_add_f32 v25, v25, v44
    v_mfma_f32_16x16x32_bf16 v[36:39], a[168:171], a[72:75], v[36:39]
    v_sub_f32 v45, v45, v2
    v_exp_f32 v45, v45
    v_mfma_f32_16x16x32_bf16 v[36:39], a[172:175], a[76:79], v[36:39]
    v_add_f32 v25, v25, v45
    v_cvt_pk_bf16_f32 v62, v44, v45
    v_mfma_f32_16x16x32_bf16 v[80:83], a[192:195], v[56:59], v[80:83]
    v_sub_f32 v46, v46, v2
    v_exp_f32 v46, v46
    v_mfma_f32_16x16x32_bf16 v[84:87], a[196:199], v[56:59], v[84:87]
    ds_read_b64_tr_b16 a[210:211], v16 offset:40448
    v_add_f32 v25, v25, v46
    v_mfma_f32_16x16x32_bf16 v[88:91], a[200:203], v[56:59], v[88:91]
    v_sub_f32 v47, v47, v2
    v_exp_f32 v47, v47
    v_mfma_f32_16x16x32_bf16 v[92:95], a[204:207], v[56:59], v[92:95]
    s_add_u32 s48, s48, 5120
    v_add_f32 v25, v25, v47
    v_cvt_pk_bf16_f32 v63, v46, v47
    v_mfma_f32_16x16x32_bf16 v[40:43], a[144:147], a[80:83], 0
    s_add_u32 m0, m0, s53
    v_sub_f32 v32, v32, v3
    v_exp_f32 v32, v32
    v_mfma_f32_16x16x32_bf16 v[40:43], a[148:151], a[84:87], v[40:43]
    s_waitcnt vmcnt(4)
    buffer_load_dwordx4 v13, s[12:15], s48 offen nt lds
    v_mfma_f32_16x16x32_bf16 v[40:43], a[152:155], a[88:91], v[40:43]
    v_sub_f32 v33, v33, v3
    v_exp_f32 v33, v33
    v_mfma_f32_16x16x32_bf16 v[40:43], a[156:159], a[92:95], v[40:43]
    v_add_f32 v26, v26, v33
    v_cvt_pk_bf16_f32 v56, v32, v33
    v_mfma_f32_16x16x32_bf16 v[96:99], a[176:179], v[60:63], v[96:99]
    v_sub_f32 v34, v34, v3
    v_exp_f32 v34, v34
    v_mfma_f32_16x16x32_bf16 v[100:103], a[180:183], v[60:63], v[100:103]
    v_add_f32 v26, v26, v32
    v_add_f32 v26, v26, v34
    v_mfma_f32_16x16x32_bf16 v[104:107], a[184:187], v[60:63], v[104:107]
    v_sub_f32 v35, v35, v3
    v_exp_f32 v35, v35
    v_mfma_f32_16x16x32_bf16 v[108:111], a[188:191], v[60:63], v[108:111]
    s_add_u32 s48, s48, 5120
    v_add_f32 v26, v26, v35
    v_cvt_pk_bf16_f32 v57, v34, v35
    v_mfma_f32_16x16x32_bf16 v[44:47], a[160:163], a[80:83], 0
    s_add_u32 m0, m0, s53
    v_sub_f32 v36, v36, v3
    v_exp_f32 v36, v36
    v_mfma_f32_16x16x32_bf16 v[44:47], a[164:167], a[84:87], v[44:47]
    s_waitcnt vmcnt(4)
    buffer_load_dwordx4 v13, s[12:15], s48 offen nt lds
    v_mfma_f32_16x16x32_bf16 v[44:47], a[168:171], a[88:91], v[44:47]
    v_sub_f32 v37, v37, v3
    v_exp_f32 v37, v37
    v_mfma_f32_16x16x32_bf16 v[44:47], a[172:175], a[92:95], v[44:47]
    ds_read_b64_tr_b16 a[212:213], v17 offset:35840
    v_add_f32 v26, v26, v37
    v_cvt_pk_bf16_f32 v58, v36, v37
    v_mfma_f32_16x16x32_bf16 v[112:115], a[192:195], v[60:63], v[112:115]
    v_sub_f32 v38, v38, v3
    v_exp_f32 v38, v38
    v_mfma_f32_16x16x32_bf16 v[116:119], a[196:199], v[60:63], v[116:119]
    v_add_f32 v26, v26, v36
    v_add_f32 v26, v26, v38
    v_mfma_f32_16x16x32_bf16 v[120:123], a[200:203], v[60:63], v[120:123]
    v_sub_f32 v39, v39, v3
    v_exp_f32 v39, v39
    v_mfma_f32_16x16x32_bf16 v[124:127], a[204:207], v[60:63], v[124:127]
    ds_read_b64_tr_b16 a[214:215], v17 offset:40448
    v_add_f32 v26, v26, v39
    v_cvt_pk_bf16_f32 v59, v38, v39
    v_mfma_f32_16x16x32_bf16 v[32:35], a[144:147], a[96:99], 0
    v_sub_f32 v40, v40, v4
    v_exp_f32 v40, v40
    v_mfma_f32_16x16x32_bf16 v[32:35], a[148:151], a[100:103], v[32:35]
    ds_read_b64_tr_b16 a[216:217], v18 offset:35840
    v_add_f32 v27, v27, v40
    v_mfma_f32_16x16x32_bf16 v[32:35], a[152:155], a[104:107], v[32:35]
    v_sub_f32 v41, v41, v4
    v_exp_f32 v41, v41
    v_mfma_f32_16x16x32_bf16 v[32:35], a[156:159], a[108:111], v[32:35]
    ds_read_b64_tr_b16 a[218:219], v18 offset:40448
    v_add_f32 v27, v27, v41
    v_cvt_pk_bf16_f32 v60, v40, v41
    v_mfma_f32_16x16x32_bf16 v[128:131], a[176:179], v[56:59], v[128:131]
    v_sub_f32 v42, v42, v4
    v_exp_f32 v42, v42
    v_mfma_f32_16x16x32_bf16 v[132:135], a[180:183], v[56:59], v[132:135]
    ds_read_b64_tr_b16 a[220:221], v19 offset:35840
    v_add_f32 v27, v27, v42
    v_mfma_f32_16x16x32_bf16 v[136:139], a[184:187], v[56:59], v[136:139]
    v_sub_f32 v43, v43, v4
    v_exp_f32 v43, v43
    v_mfma_f32_16x16x32_bf16 v[140:143], a[188:191], v[56:59], v[140:143]
    s_add_u32 s48, s48, 1024
    ds_read_b64_tr_b16 a[222:223], v19 offset:40448
    v_add_f32 v27, v27, v43
    v_cvt_pk_bf16_f32 v61, v42, v43
    v_mfma_f32_16x16x32_bf16 v[36:39], a[160:163], a[96:99], 0
    s_add_u32 m0, m0, s53
    v_sub_f32 v44, v44, v4
    v_exp_f32 v44, v44
    v_mfma_f32_16x16x32_bf16 v[36:39], a[164:167], a[100:103], v[36:39]
    s_waitcnt vmcnt(4)
    buffer_load_dwordx4 v13, s[12:15], s48 offen nt lds
    v_mfma_f32_16x16x32_bf16 v[36:39], a[168:171], a[104:107], v[36:39]
    v_sub_f32 v45, v45, v4
    v_exp_f32 v45, v45
    v_mfma_f32_16x16x32_bf16 v[36:39], a[172:175], a[108:111], v[36:39]
    ds_read_b64_tr_b16 a[224:225], v16 offset:35968
    v_add_f32 v27, v27, v45
    v_cvt_pk_bf16_f32 v62, v44, v45
    v_mfma_f32_16x16x32_bf16 v[144:147], a[192:195], v[56:59], v[144:147]
    v_sub_f32 v46, v46, v4
    v_exp_f32 v46, v46
    v_mfma_f32_16x16x32_bf16 v[148:151], a[196:199], v[56:59], v[148:151]
    v_add_f32 v27, v27, v44
    v_add_f32 v27, v27, v46
    v_mfma_f32_16x16x32_bf16 v[152:155], a[200:203], v[56:59], v[152:155]
    v_sub_f32 v47, v47, v4
    v_exp_f32 v47, v47
    v_mfma_f32_16x16x32_bf16 v[156:159], a[204:207], v[56:59], v[156:159]
    ds_read_b64_tr_b16 a[226:227], v16 offset:40576
    v_add_f32 v27, v27, v47
    v_cvt_pk_bf16_f32 v63, v46, v47
    v_mfma_f32_16x16x32_bf16 v[40:43], a[144:147], a[112:115], 0
    v_sub_f32 v32, v32, v5
    v_exp_f32 v32, v32
    v_mfma_f32_16x16x32_bf16 v[40:43], a[148:151], a[116:119], v[40:43]
    ds_read_b64_tr_b16 a[228:229], v17 offset:35968
    v_add_f32 v28, v28, v32
    v_mfma_f32_16x16x32_bf16 v[40:43], a[152:155], a[120:123], v[40:43]
    v_sub_f32 v33, v33, v5
    v_exp_f32 v33, v33
    v_mfma_f32_16x16x32_bf16 v[40:43], a[156:159], a[124:127], v[40:43]
    ds_read_b64_tr_b16 a[230:231], v17 offset:40576
    v_add_f32 v28, v28, v33
    v_cvt_pk_bf16_f32 v56, v32, v33
    v_mfma_f32_16x16x32_bf16 v[160:163], a[176:179], v[60:63], v[160:163]
    v_sub_f32 v34, v34, v5
    v_exp_f32 v34, v34
    v_mfma_f32_16x16x32_bf16 v[164:167], a[180:183], v[60:63], v[164:167]
    ds_read_b64_tr_b16 a[232:233], v18 offset:35968
    v_add_f32 v28, v28, v34
    v_mfma_f32_16x16x32_bf16 v[168:171], a[184:187], v[60:63], v[168:171]
    v_sub_f32 v35, v35, v5
    v_exp_f32 v35, v35
    v_mfma_f32_16x16x32_bf16 v[172:175], a[188:191], v[60:63], v[172:175]
    s_add_u32 s48, s48, 5120
    ds_read_b64_tr_b16 a[234:235], v18 offset:40576
    v_add_f32 v28, v28, v35
    v_cvt_pk_bf16_f32 v57, v34, v35
    v_mfma_f32_16x16x32_bf16 v[44:47], a[160:163], a[112:115], 0
    s_add_u32 m0, m0, s53
    v_sub_f32 v36, v36, v5
    v_exp_f32 v36, v36
    v_mfma_f32_16x16x32_bf16 v[44:47], a[164:167], a[116:119], v[44:47]
    s_waitcnt vmcnt(4)
    buffer_load_dwordx4 v13, s[12:15], s48 offen nt lds
    v_mfma_f32_16x16x32_bf16 v[44:47], a[168:171], a[120:123], v[44:47]
    v_sub_f32 v37, v37, v5
    v_exp_f32 v37, v37
    v_mfma_f32_16x16x32_bf16 v[44:47], a[172:175], a[124:127], v[44:47]
    ds_read_b64_tr_b16 a[236:237], v19 offset:35968
    v_add_f32 v28, v28, v37
    v_cvt_pk_bf16_f32 v58, v36, v37
    v_mfma_f32_16x16x32_bf16 v[176:179], a[192:195], v[60:63], v[176:179]
    v_sub_f32 v38, v38, v5
    v_exp_f32 v38, v38
    v_mfma_f32_16x16x32_bf16 v[180:183], a[196:199], v[60:63], v[180:183]
    v_add_f32 v28, v28, v36
    v_add_f32 v28, v28, v38
    v_mfma_f32_16x16x32_bf16 v[184:187], a[200:203], v[60:63], v[184:187]
    v_sub_f32 v39, v39, v5
    v_exp_f32 v39, v39
    v_mfma_f32_16x16x32_bf16 v[188:191], a[204:207], v[60:63], v[188:191]
    ds_read_b64_tr_b16 a[238:239], v19 offset:40576
    v_add_f32 v28, v28, v39
    v_cvt_pk_bf16_f32 v59, v38, v39
    v_mfma_f32_16x16x32_bf16 v[32:35], a[144:147], a[128:131], 0
    v_sub_f32 v40, v40, v6
    v_exp_f32 v40, v40
    v_mfma_f32_16x16x32_bf16 v[32:35], a[148:151], a[132:135], v[32:35]
    ds_read_b128 a[144:147], v14 offset:35840
    v_add_f32 v29, v29, v40
    v_mfma_f32_16x16x32_bf16 v[32:35], a[152:155], a[136:139], v[32:35]
    v_sub_f32 v41, v41, v6
    v_exp_f32 v41, v41
    v_mfma_f32_16x16x32_bf16 v[32:35], a[156:159], a[140:143], v[32:35]
    ds_read_b128 a[148:151], v14 offset:35904
    v_add_f32 v29, v29, v41
    v_cvt_pk_bf16_f32 v60, v40, v41
    v_mfma_f32_16x16x32_bf16 v[192:195], a[176:179], v[56:59], v[192:195]
    v_sub_f32 v42, v42, v6
    v_exp_f32 v42, v42
    v_mfma_f32_16x16x32_bf16 v[196:199], a[180:183], v[56:59], v[196:199]
    ds_read_b128 a[152:155], v14 offset:35968
    v_add_f32 v29, v29, v42
    v_mfma_f32_16x16x32_bf16 v[200:203], a[184:187], v[56:59], v[200:203]
    v_sub_f32 v43, v43, v6
    v_exp_f32 v43, v43
    v_mfma_f32_16x16x32_bf16 v[204:207], a[188:191], v[56:59], v[204:207]
    ds_read_b128 a[156:159], v14 offset:36032
    v_add_f32 v29, v29, v43
    v_cvt_pk_bf16_f32 v61, v42, v43
    v_mfma_f32_16x16x32_bf16 v[36:39], a[160:163], a[128:131], 0
    v_sub_f32 v44, v44, v6
    v_exp_f32 v44, v44
    v_mfma_f32_16x16x32_bf16 v[36:39], a[164:167], a[132:135], v[36:39]
    ds_read_b128 a[160:163], v14 offset:40192
    v_add_f32 v29, v29, v44
    v_mfma_f32_16x16x32_bf16 v[36:39], a[168:171], a[136:139], v[36:39]
    v_sub_f32 v45, v45, v6
    v_exp_f32 v45, v45
    v_mfma_f32_16x16x32_bf16 v[36:39], a[172:175], a[140:143], v[36:39]
    ds_read_b128 a[164:167], v14 offset:40256
    v_add_f32 v29, v29, v45
    v_cvt_pk_bf16_f32 v62, v44, v45
    v_mfma_f32_16x16x32_bf16 v[208:211], a[192:195], v[56:59], v[208:211]
    v_sub_f32 v46, v46, v6
    v_exp_f32 v46, v46
    v_mfma_f32_16x16x32_bf16 v[212:215], a[196:199], v[56:59], v[212:215]
    ds_read_b128 a[168:171], v14 offset:40320
    v_add_f32 v29, v29, v46
    v_mfma_f32_16x16x32_bf16 v[216:219], a[200:203], v[56:59], v[216:219]
    v_sub_f32 v47, v47, v6
    v_exp_f32 v47, v47
    v_mfma_f32_16x16x32_bf16 v[220:223], a[204:207], v[56:59], v[220:223]
    s_add_u32 s48, s48, 5120
    s_waitcnt lgkmcnt(3)
    ds_read_b128 a[172:175], v14 offset:40384
    v_add_f32 v29, v29, v47
    v_cvt_pk_bf16_f32 v63, v46, v47
    v_mfma_f32_16x16x32_bf16 v[40:43], a[144:147], a[32:35], 0
    s_add_u32 m0, m0, s53
    v_sub_f32 v32, v32, v7
    v_exp_f32 v32, v32
    v_mfma_f32_16x16x32_bf16 v[40:43], a[148:151], a[36:39], v[40:43]
    s_waitcnt vmcnt(4)
    buffer_load_dwordx4 v13, s[12:15], s48 offen nt lds
    v_mfma_f32_16x16x32_bf16 v[40:43], a[152:155], a[40:43], v[40:43]
    v_sub_f32 v33, v33, v7
    v_exp_f32 v33, v33
    v_mfma_f32_16x16x32_bf16 v[40:43], a[156:159], a[44:47], v[40:43]
    v_add_f32 v30, v30, v33
    v_cvt_pk_bf16_f32 v56, v32, v33
    v_mfma_f32_16x16x32_bf16 v[224:227], a[176:179], v[60:63], v[224:227]
    v_sub_f32 v34, v34, v7
    v_exp_f32 v34, v34
    v_mfma_f32_16x16x32_bf16 v[228:231], a[180:183], v[60:63], v[228:231]
    v_add_f32 v30, v30, v32
    v_add_f32 v30, v30, v34
    v_mfma_f32_16x16x32_bf16 v[232:235], a[184:187], v[60:63], v[232:235]
    v_sub_f32 v35, v35, v7
    v_exp_f32 v35, v35
    v_mfma_f32_16x16x32_bf16 v[236:239], a[188:191], v[60:63], v[236:239]
    s_add_u32 s48, s48, 5120
    s_waitcnt lgkmcnt(0)
    v_add_f32 v30, v30, v35
    v_cvt_pk_bf16_f32 v57, v34, v35
    v_mfma_f32_16x16x32_bf16 v[44:47], a[160:163], a[32:35], 0
    s_add_u32 m0, m0, s53
    v_sub_f32 v36, v36, v7
    v_exp_f32 v36, v36
    v_mfma_f32_16x16x32_bf16 v[44:47], a[164:167], a[36:39], v[44:47]
    s_waitcnt vmcnt(4)
    buffer_load_dwordx4 v13, s[12:15], s48 offen nt lds
    v_mfma_f32_16x16x32_bf16 v[44:47], a[168:171], a[40:43], v[44:47]
    v_sub_f32 v37, v37, v7
    v_exp_f32 v37, v37
    v_mfma_f32_16x16x32_bf16 v[44:47], a[172:175], a[44:47], v[44:47]
    s_add_u32 s48, s48, -30720
    v_add_f32 v30, v30, v37
    v_cvt_pk_bf16_f32 v58, v36, v37
    v_mfma_f32_16x16x32_bf16 v[240:243], a[192:195], v[60:63], v[240:243]
    v_sub_f32 v38, v38, v7
    v_exp_f32 v38, v38
    v_mfma_f32_16x16x32_bf16 v[244:247], a[196:199], v[60:63], v[244:247]
    s_add_u32 m0, s52, 35840
    v_add_f32 v30, v30, v36
    v_add_f32 v30, v30, v38
    v_mfma_f32_16x16x32_bf16 v[248:251], a[200:203], v[60:63], v[248:251]
    v_sub_f32 v39, v39, v7
    v_exp_f32 v39, v39
    v_mfma_f32_16x16x32_bf16 v[252:255], a[204:207], v[60:63], v[252:255]
    v_add_f32 v30, v30, v39
    v_cvt_pk_bf16_f32 v59, v38, v39
    v_mfma_f32_16x16x32_bf16 v[32:35], a[144:147], a[48:51], 0
    s_waitcnt vmcnt(3) lgkmcnt(0)
    v_sub_f32 v40, v40, v1
    v_exp_f32 v40, v40
    v_mfma_f32_16x16x32_bf16 v[32:35], a[148:151], a[52:55], v[32:35]
    s_barrier
    buffer_load_dwordx4 v13, s[12:15], s48 offen nt lds
    v_mfma_f32_16x16x32_bf16 v[32:35], a[152:155], a[56:59], v[32:35]
    v_sub_f32 v41, v41, v1
    v_exp_f32 v41, v41
    v_mfma_f32_16x16x32_bf16 v[32:35], a[156:159], a[60:63], v[32:35]
    v_add_f32 v24, v24, v41
    v_cvt_pk_bf16_f32 v60, v40, v41
    v_mfma_f32_16x16x32_bf16 a[0:3], a[176:179], v[56:59], a[0:3]
    v_sub_f32 v42, v42, v1
    v_exp_f32 v42, v42
    v_mfma_f32_16x16x32_bf16 a[4:7], a[180:183], v[56:59], a[4:7]
    v_add_f32 v24, v24, v40
    v_add_f32 v24, v24, v42
    v_mfma_f32_16x16x32_bf16 a[8:11], a[184:187], v[56:59], a[8:11]
    v_sub_f32 v43, v43, v1
    v_exp_f32 v43, v43
    v_mfma_f32_16x16x32_bf16 a[12:15], a[188:191], v[56:59], a[12:15]
    v_add_f32 v24, v24, v43
    v_cvt_pk_bf16_f32 v61, v42, v43
    v_mfma_f32_16x16x32_bf16 v[36:39], a[160:163], a[48:51], 0
    v_sub_f32 v44, v44, v1
    v_exp_f32 v44, v44
    v_mfma_f32_16x16x32_bf16 v[36:39], a[164:167], a[52:55], v[36:39]
    v_add_f32 v24, v24, v44
    v_mfma_f32_16x16x32_bf16 v[36:39], a[168:171], a[56:59], v[36:39]
    v_sub_f32 v45, v45, v1
    v_exp_f32 v45, v45
    v_mfma_f32_16x16x32_bf16 v[36:39], a[172:175], a[60:63], v[36:39]
    v_add_f32 v24, v24, v45
    v_cvt_pk_bf16_f32 v62, v44, v45
    v_mfma_f32_16x16x32_bf16 a[16:19], a[192:195], v[56:59], a[16:19]
    v_sub_f32 v46, v46, v1
    v_exp_f32 v46, v46
    v_mfma_f32_16x16x32_bf16 a[20:23], a[196:199], v[56:59], a[20:23]
    v_add_f32 v24, v24, v46
    v_mfma_f32_16x16x32_bf16 a[24:27], a[200:203], v[56:59], a[24:27]
    v_sub_f32 v47, v47, v1
    v_exp_f32 v47, v47
    v_mfma_f32_16x16x32_bf16 a[28:31], a[204:207], v[56:59], a[28:31]
    s_add_u32 s48, s48, 5120
    v_add_f32 v24, v24, v47
    v_cvt_pk_bf16_f32 v63, v46, v47
    v_mfma_f32_16x16x32_bf16 v[40:43], a[144:147], a[64:67], 0
    s_add_u32 m0, m0, s53
    v_sub_f32 v32, v32, v2
    v_exp_f32 v32, v32
    v_mfma_f32_16x16x32_bf16 v[40:43], a[148:151], a[68:71], v[40:43]
    s_waitcnt vmcnt(4)
    buffer_load_dwordx4 v13, s[12:15], s48 offen nt lds
    v_mfma_f32_16x16x32_bf16 v[40:43], a[152:155], a[72:75], v[40:43]
    v_sub_f32 v33, v33, v2
    v_exp_f32 v33, v33
    v_mfma_f32_16x16x32_bf16 v[40:43], a[156:159], a[76:79], v[40:43]
    v_add_f32 v25, v25, v33
    v_cvt_pk_bf16_f32 v56, v32, v33
    v_mfma_f32_16x16x32_bf16 v[64:67], a[208:211], v[60:63], v[64:67]
    v_sub_f32 v34, v34, v2
    v_exp_f32 v34, v34
    v_mfma_f32_16x16x32_bf16 v[68:71], a[212:215], v[60:63], v[68:71]
    v_add_f32 v25, v25, v32
    v_add_f32 v25, v25, v34
    v_mfma_f32_16x16x32_bf16 v[72:75], a[216:219], v[60:63], v[72:75]
    v_sub_f32 v35, v35, v2
    v_exp_f32 v35, v35
    v_mfma_f32_16x16x32_bf16 v[76:79], a[220:223], v[60:63], v[76:79]
    v_add_f32 v25, v25, v35
    v_cvt_pk_bf16_f32 v57, v34, v35
    v_mfma_f32_16x16x32_bf16 v[44:47], a[160:163], a[64:67], 0
    v_sub_f32 v36, v36, v2
    v_exp_f32 v36, v36
    v_mfma_f32_16x16x32_bf16 v[44:47], a[164:167], a[68:71], v[44:47]
    ds_read_b64_tr_b16 a[176:177], v20 offset:0
    v_add_f32 v25, v25, v36
    v_mfma_f32_16x16x32_bf16 v[44:47], a[168:171], a[72:75], v[44:47]
    v_sub_f32 v37, v37, v2
    v_exp_f32 v37, v37
    v_mfma_f32_16x16x32_bf16 v[44:47], a[172:175], a[76:79], v[44:47]
    v_add_f32 v25, v25, v37
    v_cvt_pk_bf16_f32 v58, v36, v37
    v_mfma_f32_16x16x32_bf16 v[80:83], a[224:227], v[60:63], v[80:83]
    v_sub_f32 v38, v38, v2
    v_exp_f32 v38, v38
    v_mfma_f32_16x16x32_bf16 v[84:87], a[228:231], v[60:63], v[84:87]
    ds_read_b64_tr_b16 a[178:179], v20 offset:4608
    v_add_f32 v25, v25, v38
    v_mfma_f32_16x16x32_bf16 v[88:91], a[232:235], v[60:63], v[88:91]
    v_sub_f32 v39, v39, v2
    v_exp_f32 v39, v39
    v_mfma_f32_16x16x32_bf16 v[92:95], a[236:239], v[60:63], v[92:95]
    s_add_u32 s48, s48, 5120
    v_add_f32 v25, v25, v39
    v_cvt_pk_bf16_f32 v59, v38, v39
    v_mfma_f32_16x16x32_bf16 v[32:35], a[144:147], a[80:83], 0
    s_add_u32 m0, m0, s53
    v_sub_f32 v40, v40, v3
    v_exp_f32 v40, v40
    v_mfma_f32_16x16x32_bf16 v[32:35], a[148:151], a[84:87], v[32:35]
    s_waitcnt vmcnt(4)
    buffer_load_dwordx4 v13, s[12:15], s48 offen nt lds
    v_mfma_f32_16x16x32_bf16 v[32:35], a[152:155], a[88:91], v[32:35]
    v_sub_f32 v41, v41, v3
    v_exp_f32 v41, v41
    v_mfma_f32_16x16x32_bf16 v[32:35], a[156:159], a[92:95], v[32:35]
    v_add_f32 v26, v26, v41
    v_cvt_pk_bf16_f32 v60, v40, v41
    v_mfma_f32_16x16x32_bf16 v[96:99], a[208:211], v[56:59], v[96:99]
    v_sub_f32 v42, v42, v3
    v_exp_f32 v42, v42
    v_mfma_f32_16x16x32_bf16 v[100:103], a[212:215], v[56:59], v[100:103]
    v_add_f32 v26, v26, v40
    v_add_f32 v26, v26, v42
    v_mfma_f32_16x16x32_bf16 v[104:107], a[216:219], v[56:59], v[104:107]
    v_sub_f32 v43, v43, v3
    v_exp_f32 v43, v43
    v_mfma_f32_16x16x32_bf16 v[108:111], a[220:223], v[56:59], v[108:111]
    s_add_u32 s48, s48, 1024
    v_add_f32 v26, v26, v43
    v_cvt_pk_bf16_f32 v61, v42, v43
    v_mfma_f32_16x16x32_bf16 v[36:39], a[160:163], a[80:83], 0
    s_add_u32 m0, m0, s53
    v_sub_f32 v44, v44, v3
    v_exp_f32 v44, v44
    v_mfma_f32_16x16x32_bf16 v[36:39], a[164:167], a[84:87], v[36:39]
    s_waitcnt vmcnt(4)
    buffer_load_dwordx4 v13, s[12:15], s48 offen nt lds
    v_mfma_f32_16x16x32_bf16 v[36:39], a[168:171], a[88:91], v[36:39]
    v_sub_f32 v45, v45, v3
    v_exp_f32 v45, v45
    v_mfma_f32_16x16x32_bf16 v[36:39], a[172:175], a[92:95], v[36:39]
    ds_read_b64_tr_b16 a[180:181], v21 offset:0
    v_add_f32 v26, v26, v45
    v_cvt_pk_bf16_f32 v62, v44, v45
    v_mfma_f32_16x16x32_bf16 v[112:115], a[224:227], v[56:59], v[112:115]
    v_sub_f32 v46, v46, v3
    v_exp_f32 v46, v46
    v_mfma_f32_16x16x32_bf16 v[116:119], a[228:231], v[56:59], v[116:119]
    v_add_f32 v26, v26, v44
    v_add_f32 v26, v26, v46
    v_mfma_f32_16x16x32_bf16 v[120:123], a[232:235], v[56:59], v[120:123]
    v_sub_f32 v47, v47, v3
    v_exp_f32 v47, v47
    v_mfma_f32_16x16x32_bf16 v[124:127], a[236:239], v[56:59], v[124:127]
    ds_read_b64_tr_b16 a[182:183], v21 offset:4608
    v_add_f32 v26, v26, v47
    v_cvt_pk_bf16_f32 v63, v46, v47
    v_mfma_f32_16x16x32_bf16 v[40:43], a[144:147], a[96:99], 0
    v_sub_f32 v32, v32, v4
    v_exp_f32 v32, v32
    v_mfma_f32_16x16x32_bf16 v[40:43], a[148:151], a[100:103], v[40:43]
    ds_read_b64_tr_b16 a[184:185], v22 offset:0
    v_add_f32 v27, v27, v32
    v_mfma_f32_16x16x32_bf16 v[40:43], a[152:155], a[104:107], v[40:43]
    v_sub_f32 v33, v33, v4
    v_exp_f32 v33, v33
    v_mfma_f32_16x16x32_bf16 v[40:43], a[156:159], a[108:111], v[40:43]
    ds_read_b64_tr_b16 a[186:187], v22 offset:4608
    v_add_f32 v27, v27, v33
    v_cvt_pk_bf16_f32 v56, v32, v33
    v_mfma_f32_16x16x32_bf16 v[128:131], a[208:211], v[60:63], v[128:131]
    v_sub_f32 v34, v34, v4
    v_exp_f32 v34, v34
    v_mfma_f32_16x16x32_bf16 v[132:135], a[212:215], v[60:63], v[132:135]
    ds_read_b64_tr_b16 a[188:189], v23 offset:0
    v_add_f32 v27, v27, v34
    v_mfma_f32_16x16x32_bf16 v[136:139], a[216:219], v[60:63], v[136:139]
    v_sub_f32 v35, v35, v4
    v_exp_f32 v35, v35
    v_mfma_f32_16x16x32_bf16 v[140:143], a[220:223], v[60:63], v[140:143]
    s_add_u32 s48, s48, 5120
    ds_read_b64_tr_b16 a[190:191], v23 offset:4608
    v_add_f32 v27, v27, v35
    v_cvt_pk_bf16_f32 v57, v34, v35
    v_mfma_f32_16x16x32_bf16 v[44:47], a[160:163], a[96:99], 0
    s_add_u32 m0, m0, s53
    v_sub_f32 v36, v36, v4
    v_exp_f32 v36, v36
    v_mfma_f32_16x16x32_bf16 v[44:47], a[164:167], a[100:103], v[44:47]
    s_waitcnt vmcnt(4)
    buffer_load_dwordx4 v13, s[12:15], s48 offen nt lds
    v_mfma_f32_16x16x32_bf16 v[44:47], a[168:171], a[104:107], v[44:47]
    v_sub_f32 v37, v37, v4
    v_exp_f32 v37, v37
    v_mfma_f32_16x16x32_bf16 v[44:47], a[172:175], a[108:111], v[44:47]
    ds_read_b64_tr_b16 a[192:193], v20 offset:128
    v_add_f32 v27, v27, v37
    v_cvt_pk_bf16_f32 v58, v36, v37
    v_mfma_f32_16x16x32_bf16 v[144:147], a[224:227], v[60:63], v[144:147]
    v_sub_f32 v38, v38, v4
    v_exp_f32 v38, v38
    v_mfma_f32_16x16x32_bf16 v[148:151], a[228:231], v[60:63], v[148:151]
    v_add_f32 v27, v27, v36
    v_add_f32 v27, v27, v38
    v_mfma_f32_16x16x32_bf16 v[152:155], a[232:235], v[60:63], v[152:155]
    v_sub_f32 v39, v39, v4
    v_exp_f32 v39, v39
    v_mfma_f32_16x16x32_bf16 v[156:159], a[236:239], v[60:63], v[156:159]
    ds_read_b64_tr_b16 a[194:195], v20 offset:4736
    v_add_f32 v27, v27, v39
    v_cvt_pk_bf16_f32 v59, v38, v39
    v_mfma_f32_16x16x32_bf16 v[32:35], a[144:147], a[112:115], 0
    v_sub_f32 v40, v40, v5
    v_exp_f32 v40, v40
    v_mfma_f32_16x16x32_bf16 v[32:35], a[148:151], a[116:119], v[32:35]
    ds_read_b64_tr_b16 a[196:197], v21 offset:128
    v_add_f32 v28, v28, v40
    v_mfma_f32_16x16x32_bf16 v[32:35], a[152:155], a[120:123], v[32:35]
    v_sub_f32 v41, v41, v5
    v_exp_f32 v41, v41
    v_mfma_f32_16x16x32_bf16 v[32:35], a[156:159], a[124:127], v[32:35]
    ds_read_b64_tr_b16 a[198:199], v21 offset:4736
    v_add_f32 v28, v28, v41
    v_cvt_pk_bf16_f32 v60, v40, v41
    v_mfma_f32_16x16x32_bf16 v[160:163], a[208:211], v[56:59], v[160:163]
    v_sub_f32 v42, v42, v5
    v_exp_f32 v42, v42
    v_mfma_f32_16x16x32_bf16 v[164:167], a[212:215], v[56:59], v[164:167]
    ds_read_b64_tr_b16 a[200:201], v22 offset:128
    v_add_f32 v28, v28, v42
    v_mfma_f32_16x16x32_bf16 v[168:171], a[216:219], v[56:59], v[168:171]
    v_sub_f32 v43, v43, v5
    v_exp_f32 v43, v43
    v_mfma_f32_16x16x32_bf16 v[172:175], a[220:223], v[56:59], v[172:175]
    s_add_u32 s48, s48, 5120
    ds_read_b64_tr_b16 a[202:203], v22 offset:4736
    v_add_f32 v28, v28, v43
    v_cvt_pk_bf16_f32 v61, v42, v43
    v_mfma_f32_16x16x32_bf16 v[36:39], a[160:163], a[112:115], 0
    s_add_u32 m0, m0, s53
    v_sub_f32 v44, v44, v5
    v_exp_f32 v44, v44
    v_mfma_f32_16x16x32_bf16 v[36:39], a[164:167], a[116:119], v[36:39]
    s_waitcnt vmcnt(4)
    buffer_load_dwordx4 v13, s[12:15], s48 offen nt lds
    v_mfma_f32_16x16x32_bf16 v[36:39], a[168:171], a[120:123], v[36:39]
    v_sub_f32 v45, v45, v5
    v_exp_f32 v45, v45
    v_mfma_f32_16x16x32_bf16 v[36:39], a[172:175], a[124:127], v[36:39]
    ds_read_b64_tr_b16 a[204:205], v23 offset:128
    v_add_f32 v28, v28, v45
    v_cvt_pk_bf16_f32 v62, v44, v45
    v_mfma_f32_16x16x32_bf16 v[176:179], a[224:227], v[56:59], v[176:179]
    v_sub_f32 v46, v46, v5
    v_exp_f32 v46, v46
    v_mfma_f32_16x16x32_bf16 v[180:183], a[228:231], v[56:59], v[180:183]
    v_add_f32 v28, v28, v44
    v_add_f32 v28, v28, v46
    v_mfma_f32_16x16x32_bf16 v[184:187], a[232:235], v[56:59], v[184:187]
    v_sub_f32 v47, v47, v5
    v_exp_f32 v47, v47
    v_mfma_f32_16x16x32_bf16 v[188:191], a[236:239], v[56:59], v[188:191]
    ds_read_b64_tr_b16 a[206:207], v23 offset:4736
    v_add_f32 v28, v28, v47
    v_cvt_pk_bf16_f32 v63, v46, v47
    v_mfma_f32_16x16x32_bf16 v[40:43], a[144:147], a[128:131], 0
    v_sub_f32 v32, v32, v6
    v_exp_f32 v32, v32
    v_mfma_f32_16x16x32_bf16 v[40:43], a[148:151], a[132:135], v[40:43]
    ds_read_b128 a[144:147], v15 offset:0
    v_add_f32 v29, v29, v32
    v_mfma_f32_16x16x32_bf16 v[40:43], a[152:155], a[136:139], v[40:43]
    v_sub_f32 v33, v33, v6
    v_exp_f32 v33, v33
    v_mfma_f32_16x16x32_bf16 v[40:43], a[156:159], a[140:143], v[40:43]
    ds_read_b128 a[148:151], v15 offset:64
    v_add_f32 v29, v29, v33
    v_cvt_pk_bf16_f32 v56, v32, v33
    v_mfma_f32_16x16x32_bf16 v[192:195], a[208:211], v[60:63], v[192:195]
    v_sub_f32 v34, v34, v6
    v_exp_f32 v34, v34
    v_mfma_f32_16x16x32_bf16 v[196:199], a[212:215], v[60:63], v[196:199]
    ds_read_b128 a[152:155], v15 offset:128
    v_add_f32 v29, v29, v34
    v_mfma_f32_16x16x32_bf16 v[200:203], a[216:219], v[60:63], v[200:203]
    v_sub_f32 v35, v35, v6
    v_exp_f32 v35, v35
    v_mfma_f32_16x16x32_bf16 v[204:207], a[220:223], v[60:63], v[204:207]
    ds_read_b128 a[156:159], v15 offset:192
    v_add_f32 v29, v29, v35
    v_cvt_pk_bf16_f32 v57, v34, v35
    v_mfma_f32_16x16x32_bf16 v[44:47], a[160:163], a[128:131], 0
    v_sub_f32 v36, v36, v6
    v_exp_f32 v36, v36
    v_mfma_f32_16x16x32_bf16 v[44:47], a[164:167], a[132:135], v[44:47]
    ds_read_b128 a[160:163], v15 offset:4352
    v_add_f32 v29, v29, v36
    v_mfma_f32_16x16x32_bf16 v[44:47], a[168:171], a[136:139], v[44:47]
    v_sub_f32 v37, v37, v6
    v_exp_f32 v37, v37
    v_mfma_f32_16x16x32_bf16 v[44:47], a[172:175], a[140:143], v[44:47]
    ds_read_b128 a[164:167], v15 offset:4416
    v_add_f32 v29, v29, v37
    v_cvt_pk_bf16_f32 v58, v36, v37
    v_mfma_f32_16x16x32_bf16 v[208:211], a[224:227], v[60:63], v[208:211]
    v_sub_f32 v38, v38, v6
    v_exp_f32 v38, v38
    v_mfma_f32_16x16x32_bf16 v[212:215], a[228:231], v[60:63], v[212:215]
    ds_read_b128 a[168:171], v15 offset:4480
    v_add_f32 v29, v29, v38
    v_mfma_f32_16x16x32_bf16 v[216:219], a[232:235], v[60:63], v[216:219]
    v_sub_f32 v39, v39, v6
    v_exp_f32 v39, v39
    v_mfma_f32_16x16x32_bf16 v[220:223], a[236:239], v[60:63], v[220:223]
    s_add_u32 s48, s48, 5120
    s_waitcnt lgkmcnt(3)
    ds_read_b128 a[172:175], v15 offset:4544
    v_add_f32 v29, v29, v39
    v_cvt_pk_bf16_f32 v59, v38, v39
    v_mfma_f32_16x16x32_bf16 v[32:35], a[144:147], a[32:35], 0
    s_add_u32 m0, m0, s53
    v_sub_f32 v40, v40, v7
    v_exp_f32 v40, v40
    v_mfma_f32_16x16x32_bf16 v[32:35], a[148:151], a[36:39], v[32:35]
    s_waitcnt vmcnt(4)
    buffer_load_dwordx4 v13, s[12:15], s48 offen nt lds
    v_mfma_f32_16x16x32_bf16 v[32:35], a[152:155], a[40:43], v[32:35]
    v_sub_f32 v41, v41, v7
    v_exp_f32 v41, v41
    v_mfma_f32_16x16x32_bf16 v[32:35], a[156:159], a[44:47], v[32:35]
    v_add_f32 v30, v30, v41
    v_cvt_pk_bf16_f32 v60, v40, v41
    v_mfma_f32_16x16x32_bf16 v[224:227], a[208:211], v[56:59], v[224:227]
    v_sub_f32 v42, v42, v7
    v_exp_f32 v42, v42
    v_mfma_f32_16x16x32_bf16 v[228:231], a[212:215], v[56:59], v[228:231]
    v_add_f32 v30, v30, v40
    v_add_f32 v30, v30, v42
    v_mfma_f32_16x16x32_bf16 v[232:235], a[216:219], v[56:59], v[232:235]
    v_sub_f32 v43, v43, v7
    v_exp_f32 v43, v43
    v_mfma_f32_16x16x32_bf16 v[236:239], a[220:223], v[56:59], v[236:239]
    s_add_u32 s48, s48, 1024
    s_waitcnt lgkmcnt(0)
    v_add_f32 v30, v30, v43
    v_cvt_pk_bf16_f32 v61, v42, v43
    v_mfma_f32_16x16x32_bf16 v[36:39], a[160:163], a[32:35], 0
    s_add_u32 m0, m0, s53
    v_sub_f32 v44, v44, v7
    v_exp_f32 v44, v44
    v_mfma_f32_16x16x32_bf16 v[36:39], a[164:167], a[36:39], v[36:39]
    s_waitcnt vmcnt(4)
    buffer_load_dwordx4 v13, s[12:15], s48 offen nt lds
    v_mfma_f32_16x16x32_bf16 v[36:39], a[168:171], a[40:43], v[36:39]
    v_sub_f32 v45, v45, v7
    v_exp_f32 v45, v45
    v_mfma_f32_16x16x32_bf16 v[36:39], a[172:175], a[44:47], v[36:39]
    s_add_u32 s48, s48, -26624
    v_add_f32 v30, v30, v45
    v_cvt_pk_bf16_f32 v62, v44, v45
    v_mfma_f32_16x16x32_bf16 v[240:243], a[224:227], v[56:59], v[240:243]
    v_sub_f32 v46, v46, v7
    v_exp_f32 v46, v46
    v_mfma_f32_16x16x32_bf16 v[244:247], a[228:231], v[56:59], v[244:247]
    s_add_u32 m0, s52, 71680
    v_add_f32 v30, v30, v44
    v_add_f32 v30, v30, v46
    v_mfma_f32_16x16x32_bf16 v[248:251], a[232:235], v[56:59], v[248:251]
    v_sub_f32 v47, v47, v7
    v_exp_f32 v47, v47
    v_mfma_f32_16x16x32_bf16 v[252:255], a[236:239], v[56:59], v[252:255]
    v_add_f32 v30, v30, v47
    v_cvt_pk_bf16_f32 v63, v46, v47
    v_mfma_f32_16x16x32_bf16 v[40:43], a[144:147], a[48:51], 0
    s_waitcnt vmcnt(3) lgkmcnt(0)
    v_sub_f32 v32, v32, v1
    v_exp_f32 v32, v32
    v_mfma_f32_16x16x32_bf16 v[40:43], a[148:151], a[52:55], v[40:43]
    s_barrier
    buffer_load_dwordx4 v13, s[12:15], s48 offen nt lds
    v_mfma_f32_16x16x32_bf16 v[40:43], a[152:155], a[56:59], v[40:43]
    v_sub_f32 v33, v33, v1
    v_exp_f32 v33, v33
    v_mfma_f32_16x16x32_bf16 v[40:43], a[156:159], a[60:63], v[40:43]
    v_add_f32 v24, v24, v33
    v_cvt_pk_bf16_f32 v56, v32, v33
    v_mfma_f32_16x16x32_bf16 a[0:3], a[208:211], v[60:63], a[0:3]
    v_sub_f32 v34, v34, v1
    v_exp_f32 v34, v34
    v_mfma_f32_16x16x32_bf16 a[4:7], a[212:215], v[60:63], a[4:7]
    v_add_f32 v24, v24, v32
    v_add_f32 v24, v24, v34
    v_mfma_f32_16x16x32_bf16 a[8:11], a[216:219], v[60:63], a[8:11]
    v_sub_f32 v35, v35, v1
    v_exp_f32 v35, v35
    v_mfma_f32_16x16x32_bf16 a[12:15], a[220:223], v[60:63], a[12:15]
    v_add_f32 v24, v24, v35
    v_cvt_pk_bf16_f32 v57, v34, v35
    v_mfma_f32_16x16x32_bf16 v[44:47], a[160:163], a[48:51], 0
    v_sub_f32 v36, v36, v1
    v_exp_f32 v36, v36
    v_mfma_f32_16x16x32_bf16 v[44:47], a[164:167], a[52:55], v[44:47]
    v_add_f32 v24, v24, v36
    v_mfma_f32_16x16x32_bf16 v[44:47], a[168:171], a[56:59], v[44:47]
    v_sub_f32 v37, v37, v1
    v_exp_f32 v37, v37
    v_mfma_f32_16x16x32_bf16 v[44:47], a[172:175], a[60:63], v[44:47]
    v_add_f32 v24, v24, v37
    v_cvt_pk_bf16_f32 v58, v36, v37
    v_mfma_f32_16x16x32_bf16 a[16:19], a[224:227], v[60:63], a[16:19]
    v_sub_f32 v38, v38, v1
    v_exp_f32 v38, v38
    v_mfma_f32_16x16x32_bf16 a[20:23], a[228:231], v[60:63], a[20:23]
    v_add_f32 v24, v24, v38
    v_mfma_f32_16x16x32_bf16 a[24:27], a[232:235], v[60:63], a[24:27]
    v_sub_f32 v39, v39, v1
    v_exp_f32 v39, v39
    v_mfma_f32_16x16x32_bf16 a[28:31], a[236:239], v[60:63], a[28:31]
    s_add_u32 s48, s48, 5120
    v_add_f32 v24, v24, v39
    v_cvt_pk_bf16_f32 v59, v38, v39
    v_mfma_f32_16x16x32_bf16 v[32:35], a[144:147], a[64:67], 0
    s_add_u32 m0, m0, s53
    v_sub_f32 v40, v40, v2
    v_exp_f32 v40, v40
    v_mfma_f32_16x16x32_bf16 v[32:35], a[148:151], a[68:71], v[32:35]
    s_waitcnt vmcnt(4)
    buffer_load_dwordx4 v13, s[12:15], s48 offen nt lds
    v_mfma_f32_16x16x32_bf16 v[32:35], a[152:155], a[72:75], v[32:35]
    v_sub_f32 v41, v41, v2
    v_exp_f32 v41, v41
    v_mfma_f32_16x16x32_bf16 v[32:35], a[156:159], a[76:79], v[32:35]
    v_add_f32 v25, v25, v41
    v_cvt_pk_bf16_f32 v60, v40, v41
    v_mfma_f32_16x16x32_bf16 v[64:67], a[176:179], v[56:59], v[64:67]
    v_sub_f32 v42, v42, v2
    v_exp_f32 v42, v42
    v_mfma_f32_16x16x32_bf16 v[68:71], a[180:183], v[56:59], v[68:71]
    v_add_f32 v25, v25, v40
    v_add_f32 v25, v25, v42
    v_mfma_f32_16x16x32_bf16 v[72:75], a[184:187], v[56:59], v[72:75]
    v_sub_f32 v43, v43, v2
    v_exp_f32 v43, v43
    v_mfma_f32_16x16x32_bf16 v[76:79], a[188:191], v[56:59], v[76:79]
    v_add_f32 v25, v25, v43
    v_cvt_pk_bf16_f32 v61, v42, v43
    v_mfma_f32_16x16x32_bf16 v[36:39], a[160:163], a[64:67], 0
    v_sub_f32 v44, v44, v2
    v_exp_f32 v44, v44
    v_mfma_f32_16x16x32_bf16 v[36:39], a[164:167], a[68:71], v[36:39]
    ds_read_b64_tr_b16 a[208:209], v20 offset:35840
    v_add_f32 v25, v25, v44
    v_mfma_f32_16x16x32_bf16 v[36:39], a[168:171], a[72:75], v[36:39]
    v_sub_f32 v45, v45, v2
    v_exp_f32 v45, v45
    v_mfma_f32_16x16x32_bf16 v[36:39], a[172:175], a[76:79], v[36:39]
    v_add_f32 v25, v25, v45
    v_cvt_pk_bf16_f32 v62, v44, v45
    v_mfma_f32_16x16x32_bf16 v[80:83], a[192:195], v[56:59], v[80:83]
    v_sub_f32 v46, v46, v2
    v_exp_f32 v46, v46
    v_mfma_f32_16x16x32_bf16 v[84:87], a[196:199], v[56:59], v[84:87]
    ds_read_b64_tr_b16 a[210:211], v20 offset:40448
    v_add_f32 v25, v25, v46
    v_mfma_f32_16x16x32_bf16 v[88:91], a[200:203], v[56:59], v[88:91]
    v_sub_f32 v47, v47, v2
    v_exp_f32 v47, v47
    v_mfma_f32_16x16x32_bf16 v[92:95], a[204:207], v[56:59], v[92:95]
    s_add_u32 s48, s48, 1024
    v_add_f32 v25, v25, v47
    v_cvt_pk_bf16_f32 v63, v46, v47
    v_mfma_f32_16x16x32_bf16 v[40:43], a[144:147], a[80:83], 0
    s_add_u32 m0, m0, s53
    v_sub_f32 v32, v32, v3
    v_exp_f32 v32, v32
    v_mfma_f32_16x16x32_bf16 v[40:43], a[148:151], a[84:87], v[40:43]
    s_waitcnt vmcnt(4)
    buffer_load_dwordx4 v13, s[12:15], s48 offen nt lds
    v_mfma_f32_16x16x32_bf16 v[40:43], a[152:155], a[88:91], v[40:43]
    v_sub_f32 v33, v33, v3
    v_exp_f32 v33, v33
    v_mfma_f32_16x16x32_bf16 v[40:43], a[156:159], a[92:95], v[40:43]
    v_add_f32 v26, v26, v33
    v_cvt_pk_bf16_f32 v56, v32, v33
    v_mfma_f32_16x16x32_bf16 v[96:99], a[176:179], v[60:63], v[96:99]
    v_sub_f32 v34, v34, v3
    v_exp_f32 v34, v34
    v_mfma_f32_16x16x32_bf16 v[100:103], a[180:183], v[60:63], v[100:103]
    v_add_f32 v26, v26, v32
    v_add_f32 v26, v26, v34
    v_mfma_f32_16x16x32_bf16 v[104:107], a[184:187], v[60:63], v[104:107]
    v_sub_f32 v35, v35, v3
    v_exp_f32 v35, v35
    v_mfma_f32_16x16x32_bf16 v[108:111], a[188:191], v[60:63], v[108:111]
    s_add_u32 s48, s48, 5120
    v_add_f32 v26, v26, v35
    v_cvt_pk_bf16_f32 v57, v34, v35
    v_mfma_f32_16x16x32_bf16 v[44:47], a[160:163], a[80:83], 0
    s_add_u32 m0, m0, s53
    v_sub_f32 v36, v36, v3
    v_exp_f32 v36, v36
    v_mfma_f32_16x16x32_bf16 v[44:47], a[164:167], a[84:87], v[44:47]
    s_waitcnt vmcnt(4)
    buffer_load_dwordx4 v13, s[12:15], s48 offen nt lds
    v_mfma_f32_16x16x32_bf16 v[44:47], a[168:171], a[88:91], v[44:47]
    v_sub_f32 v37, v37, v3
    v_exp_f32 v37, v37
    v_mfma_f32_16x16x32_bf16 v[44:47], a[172:175], a[92:95], v[44:47]
    ds_read_b64_tr_b16 a[212:213], v21 offset:35840
    v_add_f32 v26, v26, v37
    v_cvt_pk_bf16_f32 v58, v36, v37
    v_mfma_f32_16x16x32_bf16 v[112:115], a[192:195], v[60:63], v[112:115]
    v_sub_f32 v38, v38, v3
    v_exp_f32 v38, v38
    v_mfma_f32_16x16x32_bf16 v[116:119], a[196:199], v[60:63], v[116:119]
    v_add_f32 v26, v26, v36
    v_add_f32 v26, v26, v38
    v_mfma_f32_16x16x32_bf16 v[120:123], a[200:203], v[60:63], v[120:123]
    v_sub_f32 v39, v39, v3
    v_exp_f32 v39, v39
    v_mfma_f32_16x16x32_bf16 v[124:127], a[204:207], v[60:63], v[124:127]
    ds_read_b64_tr_b16 a[214:215], v21 offset:40448
    v_add_f32 v26, v26, v39
    v_cvt_pk_bf16_f32 v59, v38, v39
    v_mfma_f32_16x16x32_bf16 v[32:35], a[144:147], a[96:99], 0
    v_sub_f32 v40, v40, v4
    v_exp_f32 v40, v40
    v_mfma_f32_16x16x32_bf16 v[32:35], a[148:151], a[100:103], v[32:35]
    ds_read_b64_tr_b16 a[216:217], v22 offset:35840
    v_add_f32 v27, v27, v40
    v_mfma_f32_16x16x32_bf16 v[32:35], a[152:155], a[104:107], v[32:35]
    v_sub_f32 v41, v41, v4
    v_exp_f32 v41, v41
    v_mfma_f32_16x16x32_bf16 v[32:35], a[156:159], a[108:111], v[32:35]
    ds_read_b64_tr_b16 a[218:219], v22 offset:40448
    v_add_f32 v27, v27, v41
    v_cvt_pk_bf16_f32 v60, v40, v41
    v_mfma_f32_16x16x32_bf16 v[128:131], a[176:179], v[56:59], v[128:131]
    v_sub_f32 v42, v42, v4
    v_exp_f32 v42, v42
    v_mfma_f32_16x16x32_bf16 v[132:135], a[180:183], v[56:59], v[132:135]
    ds_read_b64_tr_b16 a[220:221], v23 offset:35840
    v_add_f32 v27, v27, v42
    v_mfma_f32_16x16x32_bf16 v[136:139], a[184:187], v[56:59], v[136:139]
    v_sub_f32 v43, v43, v4
    v_exp_f32 v43, v43
    v_mfma_f32_16x16x32_bf16 v[140:143], a[188:191], v[56:59], v[140:143]
    s_add_u32 s48, s48, 5120
    ds_read_b64_tr_b16 a[222:223], v23 offset:40448
    v_add_f32 v27, v27, v43
    v_cvt_pk_bf16_f32 v61, v42, v43
    v_mfma_f32_16x16x32_bf16 v[36:39], a[160:163], a[96:99], 0
    s_add_u32 m0, m0, s53
    v_sub_f32 v44, v44, v4
    v_exp_f32 v44, v44
    v_mfma_f32_16x16x32_bf16 v[36:39], a[164:167], a[100:103], v[36:39]
    s_waitcnt vmcnt(4)
    buffer_load_dwordx4 v13, s[12:15], s48 offen nt lds
    v_mfma_f32_16x16x32_bf16 v[36:39], a[168:171], a[104:107], v[36:39]
    v_sub_f32 v45, v45, v4
    v_exp_f32 v45, v45
    v_mfma_f32_16x16x32_bf16 v[36:39], a[172:175], a[108:111], v[36:39]
    ds_read_b64_tr_b16 a[224:225], v20 offset:35968
    v_add_f32 v27, v27, v45
    v_cvt_pk_bf16_f32 v62, v44, v45
    v_mfma_f32_16x16x32_bf16 v[144:147], a[192:195], v[56:59], v[144:147]
    v_sub_f32 v46, v46, v4
    v_exp_f32 v46, v46
    v_mfma_f32_16x16x32_bf16 v[148:151], a[196:199], v[56:59], v[148:151]
    v_add_f32 v27, v27, v44
    v_add_f32 v27, v27, v46
    v_mfma_f32_16x16x32_bf16 v[152:155], a[200:203], v[56:59], v[152:155]
    v_sub_f32 v47, v47, v4
    v_exp_f32 v47, v47
    v_mfma_f32_16x16x32_bf16 v[156:159], a[204:207], v[56:59], v[156:159]
    ds_read_b64_tr_b16 a[226:227], v20 offset:40576
    v_add_f32 v27, v27, v47
    v_cvt_pk_bf16_f32 v63, v46, v47
    v_mfma_f32_16x16x32_bf16 v[40:43], a[144:147], a[112:115], 0
    v_sub_f32 v32, v32, v5
    v_exp_f32 v32, v32
    v_mfma_f32_16x16x32_bf16 v[40:43], a[148:151], a[116:119], v[40:43]
    ds_read_b64_tr_b16 a[228:229], v21 offset:35968
    v_add_f32 v28, v28, v32
    v_mfma_f32_16x16x32_bf16 v[40:43], a[152:155], a[120:123], v[40:43]
    v_sub_f32 v33, v33, v5
    v_exp_f32 v33, v33
    v_mfma_f32_16x16x32_bf16 v[40:43], a[156:159], a[124:127], v[40:43]
    ds_read_b64_tr_b16 a[230:231], v21 offset:40576
    v_add_f32 v28, v28, v33
    v_cvt_pk_bf16_f32 v56, v32, v33
    v_mfma_f32_16x16x32_bf16 v[160:163], a[176:179], v[60:63], v[160:163]
    v_sub_f32 v34, v34, v5
    v_exp_f32 v34, v34
    v_mfma_f32_16x16x32_bf16 v[164:167], a[180:183], v[60:63], v[164:167]
    ds_read_b64_tr_b16 a[232:233], v22 offset:35968
    v_add_f32 v28, v28, v34
    v_mfma_f32_16x16x32_bf16 v[168:171], a[184:187], v[60:63], v[168:171]
    v_sub_f32 v35, v35, v5
    v_exp_f32 v35, v35
    v_mfma_f32_16x16x32_bf16 v[172:175], a[188:191], v[60:63], v[172:175]
    s_add_u32 s48, s48, 5120
    ds_read_b64_tr_b16 a[234:235], v22 offset:40576
    v_add_f32 v28, v28, v35
    v_cvt_pk_bf16_f32 v57, v34, v35
    v_mfma_f32_16x16x32_bf16 v[44:47], a[160:163], a[112:115], 0
    s_add_u32 m0, m0, s53
    v_sub_f32 v36, v36, v5
    v_exp_f32 v36, v36
    v_mfma_f32_16x16x32_bf16 v[44:47], a[164:167], a[116:119], v[44:47]
    s_waitcnt vmcnt(4)
    buffer_load_dwordx4 v13, s[12:15], s48 offen nt lds
    v_mfma_f32_16x16x32_bf16 v[44:47], a[168:171], a[120:123], v[44:47]
    v_sub_f32 v37, v37, v5
    v_exp_f32 v37, v37
    v_mfma_f32_16x16x32_bf16 v[44:47], a[172:175], a[124:127], v[44:47]
    ds_read_b64_tr_b16 a[236:237], v23 offset:35968
    v_add_f32 v28, v28, v37
    v_cvt_pk_bf16_f32 v58, v36, v37
    v_mfma_f32_16x16x32_bf16 v[176:179], a[192:195], v[60:63], v[176:179]
    v_sub_f32 v38, v38, v5
    v_exp_f32 v38, v38
    v_mfma_f32_16x16x32_bf16 v[180:183], a[196:199], v[60:63], v[180:183]
    v_add_f32 v28, v28, v36
    v_add_f32 v28, v28, v38
    v_mfma_f32_16x16x32_bf16 v[184:187], a[200:203], v[60:63], v[184:187]
    v_sub_f32 v39, v39, v5
    v_exp_f32 v39, v39
    v_mfma_f32_16x16x32_bf16 v[188:191], a[204:207], v[60:63], v[188:191]
    ds_read_b64_tr_b16 a[238:239], v23 offset:40576
    v_add_f32 v28, v28, v39
    v_cvt_pk_bf16_f32 v59, v38, v39
    v_mfma_f32_16x16x32_bf16 v[32:35], a[144:147], a[128:131], 0
    v_sub_f32 v40, v40, v6
    v_exp_f32 v40, v40
    v_mfma_f32_16x16x32_bf16 v[32:35], a[148:151], a[132:135], v[32:35]
    ds_read_b128 a[144:147], v15 offset:35840
    v_add_f32 v29, v29, v40
    v_mfma_f32_16x16x32_bf16 v[32:35], a[152:155], a[136:139], v[32:35]
    v_sub_f32 v41, v41, v6
    v_exp_f32 v41, v41
    v_mfma_f32_16x16x32_bf16 v[32:35], a[156:159], a[140:143], v[32:35]
    ds_read_b128 a[148:151], v15 offset:35904
    v_add_f32 v29, v29, v41
    v_cvt_pk_bf16_f32 v60, v40, v41
    v_mfma_f32_16x16x32_bf16 v[192:195], a[176:179], v[56:59], v[192:195]
    v_sub_f32 v42, v42, v6
    v_exp_f32 v42, v42
    v_mfma_f32_16x16x32_bf16 v[196:199], a[180:183], v[56:59], v[196:199]
    ds_read_b128 a[152:155], v15 offset:35968
    v_add_f32 v29, v29, v42
    v_mfma_f32_16x16x32_bf16 v[200:203], a[184:187], v[56:59], v[200:203]
    v_sub_f32 v43, v43, v6
    v_exp_f32 v43, v43
    v_mfma_f32_16x16x32_bf16 v[204:207], a[188:191], v[56:59], v[204:207]
    ds_read_b128 a[156:159], v15 offset:36032
    v_add_f32 v29, v29, v43
    v_cvt_pk_bf16_f32 v61, v42, v43
    v_mfma_f32_16x16x32_bf16 v[36:39], a[160:163], a[128:131], 0
    v_sub_f32 v44, v44, v6
    v_exp_f32 v44, v44
    v_mfma_f32_16x16x32_bf16 v[36:39], a[164:167], a[132:135], v[36:39]
    ds_read_b128 a[160:163], v15 offset:40192
    v_add_f32 v29, v29, v44
    v_mfma_f32_16x16x32_bf16 v[36:39], a[168:171], a[136:139], v[36:39]
    v_sub_f32 v45, v45, v6
    v_exp_f32 v45, v45
    v_mfma_f32_16x16x32_bf16 v[36:39], a[172:175], a[140:143], v[36:39]
    ds_read_b128 a[164:167], v15 offset:40256
    v_add_f32 v29, v29, v45
    v_cvt_pk_bf16_f32 v62, v44, v45
    v_mfma_f32_16x16x32_bf16 v[208:211], a[192:195], v[56:59], v[208:211]
    v_sub_f32 v46, v46, v6
    v_exp_f32 v46, v46
    v_mfma_f32_16x16x32_bf16 v[212:215], a[196:199], v[56:59], v[212:215]
    ds_read_b128 a[168:171], v15 offset:40320
    v_add_f32 v29, v29, v46
    v_mfma_f32_16x16x32_bf16 v[216:219], a[200:203], v[56:59], v[216:219]
    v_sub_f32 v47, v47, v6
    v_exp_f32 v47, v47
    v_mfma_f32_16x16x32_bf16 v[220:223], a[204:207], v[56:59], v[220:223]
    s_add_u32 s48, s48, 1024
    s_waitcnt lgkmcnt(3)
    ds_read_b128 a[172:175], v15 offset:40384
    v_add_f32 v29, v29, v47
    v_cvt_pk_bf16_f32 v63, v46, v47
    v_mfma_f32_16x16x32_bf16 v[40:43], a[144:147], a[32:35], 0
    s_add_u32 m0, m0, s53
    v_sub_f32 v32, v32, v7
    v_exp_f32 v32, v32
    v_mfma_f32_16x16x32_bf16 v[40:43], a[148:151], a[36:39], v[40:43]
    s_waitcnt vmcnt(4)
    buffer_load_dwordx4 v13, s[12:15], s48 offen nt lds
    v_mfma_f32_16x16x32_bf16 v[40:43], a[152:155], a[40:43], v[40:43]
    v_sub_f32 v33, v33, v7
    v_exp_f32 v33, v33
    v_mfma_f32_16x16x32_bf16 v[40:43], a[156:159], a[44:47], v[40:43]
    v_add_f32 v30, v30, v33
    v_cvt_pk_bf16_f32 v56, v32, v33
    v_mfma_f32_16x16x32_bf16 v[224:227], a[176:179], v[60:63], v[224:227]
    v_sub_f32 v34, v34, v7
    v_exp_f32 v34, v34
    v_mfma_f32_16x16x32_bf16 v[228:231], a[180:183], v[60:63], v[228:231]
    v_add_f32 v30, v30, v32
    v_add_f32 v30, v30, v34
    v_mfma_f32_16x16x32_bf16 v[232:235], a[184:187], v[60:63], v[232:235]
    v_sub_f32 v35, v35, v7
    v_exp_f32 v35, v35
    v_mfma_f32_16x16x32_bf16 v[236:239], a[188:191], v[60:63], v[236:239]
    s_add_u32 s48, s48, 5120
    s_waitcnt lgkmcnt(0)
    v_add_f32 v30, v30, v35
    v_cvt_pk_bf16_f32 v57, v34, v35
    v_mfma_f32_16x16x32_bf16 v[44:47], a[160:163], a[32:35], 0
    s_add_u32 m0, m0, s53
    v_sub_f32 v36, v36, v7
    v_exp_f32 v36, v36
    v_mfma_f32_16x16x32_bf16 v[44:47], a[164:167], a[36:39], v[44:47]
    s_waitcnt vmcnt(4)
    buffer_load_dwordx4 v13, s[12:15], s48 offen nt lds
    v_mfma_f32_16x16x32_bf16 v[44:47], a[168:171], a[40:43], v[44:47]
    v_sub_f32 v37, v37, v7
    v_exp_f32 v37, v37
    v_mfma_f32_16x16x32_bf16 v[44:47], a[172:175], a[44:47], v[44:47]
    s_add_u32 s48, s48, -26624
    v_add_f32 v30, v30, v37
    v_cvt_pk_bf16_f32 v58, v36, v37
    v_mfma_f32_16x16x32_bf16 v[240:243], a[192:195], v[60:63], v[240:243]
    v_sub_f32 v38, v38, v7
    v_exp_f32 v38, v38
    v_mfma_f32_16x16x32_bf16 v[244:247], a[196:199], v[60:63], v[244:247]
    s_add_u32 m0, s52, 107520
    v_add_f32 v30, v30, v36
    v_add_f32 v30, v30, v38
    v_mfma_f32_16x16x32_bf16 v[248:251], a[200:203], v[60:63], v[248:251]
    v_sub_f32 v39, v39, v7
    v_exp_f32 v39, v39
    v_mfma_f32_16x16x32_bf16 v[252:255], a[204:207], v[60:63], v[252:255]
    v_add_f32 v30, v30, v39
    v_cvt_pk_bf16_f32 v59, v38, v39
    v_mfma_f32_16x16x32_bf16 v[32:35], a[144:147], a[48:51], 0
    s_waitcnt vmcnt(3) lgkmcnt(0)
    v_sub_f32 v40, v40, v1
    v_exp_f32 v40, v40
    v_mfma_f32_16x16x32_bf16 v[32:35], a[148:151], a[52:55], v[32:35]
    s_barrier
    buffer_load_dwordx4 v13, s[12:15], s48 offen nt lds
    v_mfma_f32_16x16x32_bf16 v[32:35], a[152:155], a[56:59], v[32:35]
    v_sub_f32 v41, v41, v1
    v_exp_f32 v41, v41
    v_mfma_f32_16x16x32_bf16 v[32:35], a[156:159], a[60:63], v[32:35]
    v_add_f32 v24, v24, v41
    v_cvt_pk_bf16_f32 v60, v40, v41
    v_mfma_f32_16x16x32_bf16 a[0:3], a[176:179], v[56:59], a[0:3]
    v_sub_f32 v42, v42, v1
    v_exp_f32 v42, v42
    v_mfma_f32_16x16x32_bf16 a[4:7], a[180:183], v[56:59], a[4:7]
    v_add_f32 v24, v24, v40
    v_add_f32 v24, v24, v42
    v_mfma_f32_16x16x32_bf16 a[8:11], a[184:187], v[56:59], a[8:11]
    v_sub_f32 v43, v43, v1
    v_exp_f32 v43, v43
    v_mfma_f32_16x16x32_bf16 a[12:15], a[188:191], v[56:59], a[12:15]
    v_add_f32 v24, v24, v43
    v_cvt_pk_bf16_f32 v61, v42, v43
    v_mfma_f32_16x16x32_bf16 v[36:39], a[160:163], a[48:51], 0
    v_sub_f32 v44, v44, v1
    v_exp_f32 v44, v44
    v_mfma_f32_16x16x32_bf16 v[36:39], a[164:167], a[52:55], v[36:39]
    v_add_f32 v24, v24, v44
    v_mfma_f32_16x16x32_bf16 v[36:39], a[168:171], a[56:59], v[36:39]
    v_sub_f32 v45, v45, v1
    v_exp_f32 v45, v45
    v_mfma_f32_16x16x32_bf16 v[36:39], a[172:175], a[60:63], v[36:39]
    v_add_f32 v24, v24, v45
    v_cvt_pk_bf16_f32 v62, v44, v45
    v_mfma_f32_16x16x32_bf16 a[16:19], a[192:195], v[56:59], a[16:19]
    v_sub_f32 v46, v46, v1
    v_exp_f32 v46, v46
    v_mfma_f32_16x16x32_bf16 a[20:23], a[196:199], v[56:59], a[20:23]
    v_add_f32 v24, v24, v46
    v_mfma_f32_16x16x32_bf16 a[24:27], a[200:203], v[56:59], a[24:27]
    v_sub_f32 v47, v47, v1
    v_exp_f32 v47, v47
    v_mfma_f32_16x16x32_bf16 a[28:31], a[204:207], v[56:59], a[28:31]
    s_add_u32 s48, s48, 1024
    v_add_f32 v24, v24, v47
    v_cvt_pk_bf16_f32 v63, v46, v47
    v_mfma_f32_16x16x32_bf16 v[40:43], a[144:147], a[64:67], 0
    s_add_u32 m0, m0, s53
    v_sub_f32 v32, v32, v2
    v_exp_f32 v32, v32
    v_mfma_f32_16x16x32_bf16 v[40:43], a[148:151], a[68:71], v[40:43]
    s_waitcnt vmcnt(4)
    buffer_load_dwordx4 v13, s[12:15], s48 offen nt lds
    v_mfma_f32_16x16x32_bf16 v[40:43], a[152:155], a[72:75], v[40:43]
    v_sub_f32 v33, v33, v2
    v_exp_f32 v33, v33
    v_mfma_f32_16x16x32_bf16 v[40:43], a[156:159], a[76:79], v[40:43]
    v_add_f32 v25, v25, v33
    v_cvt_pk_bf16_f32 v56, v32, v33
    v_mfma_f32_16x16x32_bf16 v[64:67], a[208:211], v[60:63], v[64:67]
    v_sub_f32 v34, v34, v2
    v_exp_f32 v34, v34
    v_mfma_f32_16x16x32_bf16 v[68:71], a[212:215], v[60:63], v[68:71]
    v_add_f32 v25, v25, v32
    v_add_f32 v25, v25, v34
    v_mfma_f32_16x16x32_bf16 v[72:75], a[216:219], v[60:63], v[72:75]
    v_sub_f32 v35, v35, v2
    v_exp_f32 v35, v35
    v_mfma_f32_16x16x32_bf16 v[76:79], a[220:223], v[60:63], v[76:79]
    v_add_f32 v25, v25, v35
    v_cvt_pk_bf16_f32 v57, v34, v35
    v_mfma_f32_16x16x32_bf16 v[44:47], a[160:163], a[64:67], 0
    v_sub_f32 v36, v36, v2
    v_exp_f32 v36, v36
    v_mfma_f32_16x16x32_bf16 v[44:47], a[164:167], a[68:71], v[44:47]
    ds_read_b64_tr_b16 a[176:177], v16 offset:0
    v_add_f32 v25, v25, v36
    v_mfma_f32_16x16x32_bf16 v[44:47], a[168:171], a[72:75], v[44:47]
    v_sub_f32 v37, v37, v2
    v_exp_f32 v37, v37
    v_mfma_f32_16x16x32_bf16 v[44:47], a[172:175], a[76:79], v[44:47]
    v_add_f32 v25, v25, v37
    v_cvt_pk_bf16_f32 v58, v36, v37
    v_mfma_f32_16x16x32_bf16 v[80:83], a[224:227], v[60:63], v[80:83]
    v_sub_f32 v38, v38, v2
    v_exp_f32 v38, v38
    v_mfma_f32_16x16x32_bf16 v[84:87], a[228:231], v[60:63], v[84:87]
    ds_read_b64_tr_b16 a[178:179], v16 offset:4608
    v_add_f32 v25, v25, v38
    v_mfma_f32_16x16x32_bf16 v[88:91], a[232:235], v[60:63], v[88:91]
    v_sub_f32 v39, v39, v2
    v_exp_f32 v39, v39
    v_mfma_f32_16x16x32_bf16 v[92:95], a[236:239], v[60:63], v[92:95]
    s_add_u32 s48, s48, 5120
    v_add_f32 v25, v25, v39
    v_cvt_pk_bf16_f32 v59, v38, v39
    v_mfma_f32_16x16x32_bf16 v[32:35], a[144:147], a[80:83], 0
    s_add_u32 m0, m0, s53
    v_sub_f32 v40, v40, v3
    v_exp_f32 v40, v40
    v_mfma_f32_16x16x32_bf16 v[32:35], a[148:151], a[84:87], v[32:35]
    s_waitcnt vmcnt(4)
    buffer_load_dwordx4 v13, s[12:15], s48 offen nt lds
    v_mfma_f32_16x16x32_bf16 v[32:35], a[152:155], a[88:91], v[32:35]
    v_sub_f32 v41, v41, v3
    v_exp_f32 v41, v41
    v_mfma_f32_16x16x32_bf16 v[32:35], a[156:159], a[92:95], v[32:35]
    v_add_f32 v26, v26, v41
    v_cvt_pk_bf16_f32 v60, v40, v41
    v_mfma_f32_16x16x32_bf16 v[96:99], a[208:211], v[56:59], v[96:99]
    v_sub_f32 v42, v42, v3
    v_exp_f32 v42, v42
    v_mfma_f32_16x16x32_bf16 v[100:103], a[212:215], v[56:59], v[100:103]
    v_add_f32 v26, v26, v40
    v_add_f32 v26, v26, v42
    v_mfma_f32_16x16x32_bf16 v[104:107], a[216:219], v[56:59], v[104:107]
    v_sub_f32 v43, v43, v3
    v_exp_f32 v43, v43
    v_mfma_f32_16x16x32_bf16 v[108:111], a[220:223], v[56:59], v[108:111]
    s_add_u32 s48, s48, 5120
    v_add_f32 v26, v26, v43
    v_cvt_pk_bf16_f32 v61, v42, v43
    v_mfma_f32_16x16x32_bf16 v[36:39], a[160:163], a[80:83], 0
    s_add_u32 m0, m0, s53
    v_sub_f32 v44, v44, v3
    v_exp_f32 v44, v44
    v_mfma_f32_16x16x32_bf16 v[36:39], a[164:167], a[84:87], v[36:39]
    s_waitcnt vmcnt(4)
    buffer_load_dwordx4 v13, s[12:15], s48 offen nt lds
    v_mfma_f32_16x16x32_bf16 v[36:39], a[168:171], a[88:91], v[36:39]
    v_sub_f32 v45, v45, v3
    v_exp_f32 v45, v45
    v_mfma_f32_16x16x32_bf16 v[36:39], a[172:175], a[92:95], v[36:39]
    ds_read_b64_tr_b16 a[180:181], v17 offset:0
    v_add_f32 v26, v26, v45
    v_cvt_pk_bf16_f32 v62, v44, v45
    v_mfma_f32_16x16x32_bf16 v[112:115], a[224:227], v[56:59], v[112:115]
    v_sub_f32 v46, v46, v3
    v_exp_f32 v46, v46
    v_mfma_f32_16x16x32_bf16 v[116:119], a[228:231], v[56:59], v[116:119]
    v_add_f32 v26, v26, v44
    v_add_f32 v26, v26, v46
    v_mfma_f32_16x16x32_bf16 v[120:123], a[232:235], v[56:59], v[120:123]
    v_sub_f32 v47, v47, v3
    v_exp_f32 v47, v47
    v_mfma_f32_16x16x32_bf16 v[124:127], a[236:239], v[56:59], v[124:127]
    ds_read_b64_tr_b16 a[182:183], v17 offset:4608
    v_add_f32 v26, v26, v47
    v_cvt_pk_bf16_f32 v63, v46, v47
    v_mfma_f32_16x16x32_bf16 v[40:43], a[144:147], a[96:99], 0
    v_sub_f32 v32, v32, v4
    v_exp_f32 v32, v32
    v_mfma_f32_16x16x32_bf16 v[40:43], a[148:151], a[100:103], v[40:43]
    ds_read_b64_tr_b16 a[184:185], v18 offset:0
    v_add_f32 v27, v27, v32
    v_mfma_f32_16x16x32_bf16 v[40:43], a[152:155], a[104:107], v[40:43]
    v_sub_f32 v33, v33, v4
    v_exp_f32 v33, v33
    v_mfma_f32_16x16x32_bf16 v[40:43], a[156:159], a[108:111], v[40:43]
    ds_read_b64_tr_b16 a[186:187], v18 offset:4608
    v_add_f32 v27, v27, v33
    v_cvt_pk_bf16_f32 v56, v32, v33
    v_mfma_f32_16x16x32_bf16 v[128:131], a[208:211], v[60:63], v[128:131]
    v_sub_f32 v34, v34, v4
    v_exp_f32 v34, v34
    v_mfma_f32_16x16x32_bf16 v[132:135], a[212:215], v[60:63], v[132:135]
    ds_read_b64_tr_b16 a[188:189], v19 offset:0
    v_add_f32 v27, v27, v34
    v_mfma_f32_16x16x32_bf16 v[136:139], a[216:219], v[60:63], v[136:139]
    v_sub_f32 v35, v35, v4
    v_exp_f32 v35, v35
    v_mfma_f32_16x16x32_bf16 v[140:143], a[220:223], v[60:63], v[140:143]
    s_add_u32 s48, s48, 5120
    ds_read_b64_tr_b16 a[190:191], v19 offset:4608
    v_add_f32 v27, v27, v35
    v_cvt_pk_bf16_f32 v57, v34, v35
    v_mfma_f32_16x16x32_bf16 v[44:47], a[160:163], a[96:99], 0
    s_add_u32 m0, m0, s53
    v_sub_f32 v36, v36, v4
    v_exp_f32 v36, v36
    v_mfma_f32_16x16x32_bf16 v[44:47], a[164:167], a[100:103], v[44:47]
    s_waitcnt vmcnt(4)
    buffer_load_dwordx4 v13, s[12:15], s48 offen nt lds
    v_mfma_f32_16x16x32_bf16 v[44:47], a[168:171], a[104:107], v[44:47]
    v_sub_f32 v37, v37, v4
    v_exp_f32 v37, v37
    v_mfma_f32_16x16x32_bf16 v[44:47], a[172:175], a[108:111], v[44:47]
    ds_read_b64_tr_b16 a[192:193], v16 offset:128
    v_add_f32 v27, v27, v37
    v_cvt_pk_bf16_f32 v58, v36, v37
    v_mfma_f32_16x16x32_bf16 v[144:147], a[224:227], v[60:63], v[144:147]
    v_sub_f32 v38, v38, v4
    v_exp_f32 v38, v38
    v_mfma_f32_16x16x32_bf16 v[148:151], a[228:231], v[60:63], v[148:151]
    v_add_f32 v27, v27, v36
    v_add_f32 v27, v27, v38
    v_mfma_f32_16x16x32_bf16 v[152:155], a[232:235], v[60:63], v[152:155]
    v_sub_f32 v39, v39, v4
    v_exp_f32 v39, v39
    v_mfma_f32_16x16x32_bf16 v[156:159], a[236:239], v[60:63], v[156:159]
    ds_read_b64_tr_b16 a[194:195], v16 offset:4736
    v_add_f32 v27, v27, v39
    v_cvt_pk_bf16_f32 v59, v38, v39
    v_mfma_f32_16x16x32_bf16 v[32:35], a[144:147], a[112:115], 0
    v_sub_f32 v40, v40, v5
    v_exp_f32 v40, v40
    v_mfma_f32_16x16x32_bf16 v[32:35], a[148:151], a[116:119], v[32:35]
    ds_read_b64_tr_b16 a[196:197], v17 offset:128
    v_add_f32 v28, v28, v40
    v_mfma_f32_16x16x32_bf16 v[32:35], a[152:155], a[120:123], v[32:35]
    v_sub_f32 v41, v41, v5
    v_exp_f32 v41, v41
    v_mfma_f32_16x16x32_bf16 v[32:35], a[156:159], a[124:127], v[32:35]
    ds_read_b64_tr_b16 a[198:199], v17 offset:4736
    v_add_f32 v28, v28, v41
    v_cvt_pk_bf16_f32 v60, v40, v41
    v_mfma_f32_16x16x32_bf16 v[160:163], a[208:211], v[56:59], v[160:163]
    v_sub_f32 v42, v42, v5
    v_exp_f32 v42, v42
    v_mfma_f32_16x16x32_bf16 v[164:167], a[212:215], v[56:59], v[164:167]
    ds_read_b64_tr_b16 a[200:201], v18 offset:128
    v_add_f32 v28, v28, v42
    v_mfma_f32_16x16x32_bf16 v[168:171], a[216:219], v[56:59], v[168:171]
    v_sub_f32 v43, v43, v5
    v_exp_f32 v43, v43
    v_mfma_f32_16x16x32_bf16 v[172:175], a[220:223], v[56:59], v[172:175]
    s_add_u32 s48, s48, 1024
    ds_read_b64_tr_b16 a[202:203], v18 offset:4736
    v_add_f32 v28, v28, v43
    v_cvt_pk_bf16_f32 v61, v42, v43
    v_mfma_f32_16x16x32_bf16 v[36:39], a[160:163], a[112:115], 0
    s_add_u32 m0, m0, s53
    v_sub_f32 v44, v44, v5
    v_exp_f32 v44, v44
    v_mfma_f32_16x16x32_bf16 v[36:39], a[164:167], a[116:119], v[36:39]
    s_waitcnt vmcnt(4)
    buffer_load_dwordx4 v13, s[12:15], s48 offen nt lds
    v_mfma_f32_16x16x32_bf16 v[36:39], a[168:171], a[120:123], v[36:39]
    v_sub_f32 v45, v45, v5
    v_exp_f32 v45, v45
    v_mfma_f32_16x16x32_bf16 v[36:39], a[172:175], a[124:127], v[36:39]
    ds_read_b64_tr_b16 a[204:205], v19 offset:128
    v_add_f32 v28, v28, v45
    v_cvt_pk_bf16_f32 v62, v44, v45
    v_mfma_f32_16x16x32_bf16 v[176:179], a[224:227], v[56:59], v[176:179]
    v_sub_f32 v46, v46, v5
    v_exp_f32 v46, v46
    v_mfma_f32_16x16x32_bf16 v[180:183], a[228:231], v[56:59], v[180:183]
    v_add_f32 v28, v28, v44
    v_add_f32 v28, v28, v46
    v_mfma_f32_16x16x32_bf16 v[184:187], a[232:235], v[56:59], v[184:187]
    v_sub_f32 v47, v47, v5
    v_exp_f32 v47, v47
    v_mfma_f32_16x16x32_bf16 v[188:191], a[236:239], v[56:59], v[188:191]
    ds_read_b64_tr_b16 a[206:207], v19 offset:4736
    v_add_f32 v28, v28, v47
    v_cvt_pk_bf16_f32 v63, v46, v47
    v_mfma_f32_16x16x32_bf16 v[40:43], a[144:147], a[128:131], 0
    v_sub_f32 v32, v32, v6
    v_exp_f32 v32, v32
    v_mfma_f32_16x16x32_bf16 v[40:43], a[148:151], a[132:135], v[40:43]
    ds_read_b128 a[144:147], v14 offset:0
    v_add_f32 v29, v29, v32
    v_mfma_f32_16x16x32_bf16 v[40:43], a[152:155], a[136:139], v[40:43]
    v_sub_f32 v33, v33, v6
    v_exp_f32 v33, v33
    v_mfma_f32_16x16x32_bf16 v[40:43], a[156:159], a[140:143], v[40:43]
    ds_read_b128 a[148:151], v14 offset:64
    v_add_f32 v29, v29, v33
    v_cvt_pk_bf16_f32 v56, v32, v33
    v_mfma_f32_16x16x32_bf16 v[192:195], a[208:211], v[60:63], v[192:195]
    v_sub_f32 v34, v34, v6
    v_exp_f32 v34, v34
    v_mfma_f32_16x16x32_bf16 v[196:199], a[212:215], v[60:63], v[196:199]
    ds_read_b128 a[152:155], v14 offset:128
    v_add_f32 v29, v29, v34
    v_mfma_f32_16x16x32_bf16 v[200:203], a[216:219], v[60:63], v[200:203]
    v_sub_f32 v35, v35, v6
    v_exp_f32 v35, v35
    v_mfma_f32_16x16x32_bf16 v[204:207], a[220:223], v[60:63], v[204:207]
    ds_read_b128 a[156:159], v14 offset:192
    v_add_f32 v29, v29, v35
    v_cvt_pk_bf16_f32 v57, v34, v35
    v_mfma_f32_16x16x32_bf16 v[44:47], a[160:163], a[128:131], 0
    v_sub_f32 v36, v36, v6
    v_exp_f32 v36, v36
    v_mfma_f32_16x16x32_bf16 v[44:47], a[164:167], a[132:135], v[44:47]
    ds_read_b128 a[160:163], v14 offset:4352
    v_add_f32 v29, v29, v36
    v_mfma_f32_16x16x32_bf16 v[44:47], a[168:171], a[136:139], v[44:47]
    v_sub_f32 v37, v37, v6
    v_exp_f32 v37, v37
    v_mfma_f32_16x16x32_bf16 v[44:47], a[172:175], a[140:143], v[44:47]
    ds_read_b128 a[164:167], v14 offset:4416
    v_add_f32 v29, v29, v37
    v_cvt_pk_bf16_f32 v58, v36, v37
    v_mfma_f32_16x16x32_bf16 v[208:211], a[224:227], v[60:63], v[208:211]
    v_sub_f32 v38, v38, v6
    v_exp_f32 v38, v38
    v_mfma_f32_16x16x32_bf16 v[212:215], a[228:231], v[60:63], v[212:215]
    ds_read_b128 a[168:171], v14 offset:4480
    v_add_f32 v29, v29, v38
    v_mfma_f32_16x16x32_bf16 v[216:219], a[232:235], v[60:63], v[216:219]
    v_sub_f32 v39, v39, v6
    v_exp_f32 v39, v39
    v_mfma_f32_16x16x32_bf16 v[220:223], a[236:239], v[60:63], v[220:223]
    s_add_u32 s48, s48, 5120
    s_waitcnt lgkmcnt(3)
    ds_read_b128 a[172:175], v14 offset:4544
    v_add_f32 v29, v29, v39
    v_cvt_pk_bf16_f32 v59, v38, v39
    v_mfma_f32_16x16x32_bf16 v[32:35], a[144:147], a[32:35], 0
    s_add_u32 m0, m0, s53
    v_sub_f32 v40, v40, v7
    v_exp_f32 v40, v40
    v_mfma_f32_16x16x32_bf16 v[32:35], a[148:151], a[36:39], v[32:35]
    s_waitcnt vmcnt(4)
    buffer_load_dwordx4 v13, s[12:15], s48 offen nt lds
    v_mfma_f32_16x16x32_bf16 v[32:35], a[152:155], a[40:43], v[32:35]
    v_sub_f32 v41, v41, v7
    v_exp_f32 v41, v41
    v_mfma_f32_16x16x32_bf16 v[32:35], a[156:159], a[44:47], v[32:35]
    v_add_f32 v30, v30, v41
    v_cvt_pk_bf16_f32 v60, v40, v41
    v_mfma_f32_16x16x32_bf16 v[224:227], a[208:211], v[56:59], v[224:227]
    v_sub_f32 v42, v42, v7
    v_exp_f32 v42, v42
    v_mfma_f32_16x16x32_bf16 v[228:231], a[212:215], v[56:59], v[228:231]
    v_add_f32 v30, v30, v40
    v_add_f32 v30, v30, v42
    v_mfma_f32_16x16x32_bf16 v[232:235], a[216:219], v[56:59], v[232:235]
    v_sub_f32 v43, v43, v7
    v_exp_f32 v43, v43
    v_mfma_f32_16x16x32_bf16 v[236:239], a[220:223], v[56:59], v[236:239]
    s_add_u32 s48, s48, 5120
    s_waitcnt lgkmcnt(0)
    v_add_f32 v30, v30, v43
    v_cvt_pk_bf16_f32 v61, v42, v43
    v_mfma_f32_16x16x32_bf16 v[36:39], a[160:163], a[32:35], 0
    s_add_u32 m0, m0, s53
    v_sub_f32 v44, v44, v7
    v_exp_f32 v44, v44
    v_mfma_f32_16x16x32_bf16 v[36:39], a[164:167], a[36:39], v[36:39]
    s_waitcnt vmcnt(4)
    buffer_load_dwordx4 v13, s[12:15], s48 offen nt lds
    v_mfma_f32_16x16x32_bf16 v[36:39], a[168:171], a[40:43], v[36:39]
    v_sub_f32 v45, v45, v7
    v_exp_f32 v45, v45
    v_mfma_f32_16x16x32_bf16 v[36:39], a[172:175], a[44:47], v[36:39]
    s_add_u32 s48, s48, 2048
    v_add_f32 v30, v30, v45
    v_cvt_pk_bf16_f32 v62, v44, v45
    v_mfma_f32_16x16x32_bf16 v[240:243], a[224:227], v[56:59], v[240:243]
    v_sub_f32 v46, v46, v7
    v_exp_f32 v46, v46
    v_mfma_f32_16x16x32_bf16 v[244:247], a[228:231], v[56:59], v[244:247]
    s_add_u32 m0, s52, 0
    v_add_f32 v30, v30, v44
    v_add_f32 v30, v30, v46
    v_mfma_f32_16x16x32_bf16 v[248:251], a[232:235], v[56:59], v[248:251]
    s_sub_u32 s55, s55, 1
    v_sub_f32 v47, v47, v7
    v_exp_f32 v47, v47
    v_mfma_f32_16x16x32_bf16 v[252:255], a[236:239], v[56:59], v[252:255]
    s_cmp_lg_u32 s55, 0
    v_add_f32 v30, v30, v47
    v_cvt_pk_bf16_f32 v63, v46, v47
    s_cbranch_scc1 L_as
    s_nop 1
    v_mfma_f32_16x16x32_bf16 a[0:3], a[208:211], v[60:63], a[0:3]
    v_mfma_f32_16x16x32_bf16 a[4:7], a[212:215], v[60:63], a[4:7]
    v_mfma_f32_16x16x32_bf16 a[8:11], a[216:219], v[60:63], a[8:11]
    v_mfma_f32_16x16x32_bf16 a[12:15], a[220:223], v[60:63], a[12:15]
    v_mfma_f32_16x16x32_bf16 a[16:19], a[224:227], v[60:63], a[16:19]
    v_mfma_f32_16x16x32_bf16 a[20:23], a[228:231], v[60:63], a[20:23]
    v_mfma_f32_16x16x32_bf16 a[24:27], a[232:235], v[60:63], a[24:27]
    v_mfma_f32_16x16x32_bf16 a[28:31], a[236:239], v[60:63], a[28:31]
    v_mov_b32 v32, v24
    v_mov_b32 v33, v25
    v_mov_b32 v34, v26
    v_mov_b32 v35, v27
    v_mov_b32 v36, v28
    v_mov_b32 v37, v29
    v_mov_b32 v38, v30
    s_nop 0
    v_permlane32_swap_b32 v24, v32
    v_permlane32_swap_b32 v25, v33
    v_permlane32_swap_b32 v26, v34
    v_permlane32_swap_b32 v27, v35
    v_permlane32_swap_b32 v28, v36
    v_permlane32_swap_b32 v29, v37
    v_permlane32_swap_b32 v30, v38
    v_add_f32 v24, v24, v32
    v_add_f32 v25, v25, v33
    v_add_f32 v26, v26, v34
    v_add_f32 v27, v27, v35
    v_add_f32 v28, v28, v36
    v_add_f32 v29, v29, v37
    v_add_f32 v30, v30, v38
    v_mov_b32 v32, v24
    v_mov_b32 v33, v25
    v_mov_b32 v34, v26
    v_mov_b32 v35, v27
    v_mov_b32 v36, v28
    v_mov_b32 v37, v29
    v_mov_b32 v38, v30
    s_nop 0
    v_permlane16_swap_b32 v24, v32
    v_permlane16_swap_b32 v25, v33
    v_permlane16_swap_b32 v26, v34
    v_permlane16_swap_b32 v27, v35
    v_permlane16_swap_b32 v28, v36
    v_permlane16_swap_b32 v29, v37
    v_permlane16_swap_b32 v30, v38
    v_add_f32 v24, v24, v32
    v_add_f32 v25, v25, v33
    v_add_f32 v26, v26, v34
    v_add_f32 v27, v27, v35
    v_add_f32 v28, v28, v36
    v_add_f32 v29, v29, v37
    v_add_f32 v30, v30, v38
    v_rcp_f32 v32, v24
    v_rcp_f32 v34, v25
    v_rcp_f32 v36, v26
    v_rcp_f32 v38, v27
    v_rcp_f32 v40, v28
    v_rcp_f32 v42, v29
    v_rcp_f32 v44, v30
    s_waitcnt vmcnt(0) lgkmcnt(0)
    s_barrier
    v_pk_mul_f32 v[64:65], v[64:65], v[32:33] op_sel_hi:[1,0]
    v_pk_mul_f32 v[66:67], v[66:67], v[32:33] op_sel_hi:[1,0]
    v_pk_mul_f32 v[68:69], v[68:69], v[32:33] op_sel_hi:[1,0]
    v_pk_mul_f32 v[70:71], v[70:71], v[32:33] op_sel_hi:[1,0]
    v_pk_mul_f32 v[72:73], v[72:73], v[32:33] op_sel_hi:[1,0]
    v_pk_mul_f32 v[74:75], v[74:75], v[32:33] op_sel_hi:[1,0]
    v_pk_mul_f32 v[76:77], v[76:77], v[32:33] op_sel_hi:[1,0]
    v_pk_mul_f32 v[78:79], v[78:79], v[32:33] op_sel_hi:[1,0]
    v_cvt_pk_bf16_f32 v48, v64, v65
    v_cvt_pk_bf16_f32 v49, v66, v67
    v_cvt_pk_bf16_f32 v50, v68, v69
    v_cvt_pk_bf16_f32 v51, v70, v71
    s_mov_b32 s58, 0
    buffer_store_dwordx4 v[48:51], v31, s[16:19], s58 offen sc1
    v_pk_mul_f32 v[80:81], v[80:81], v[32:33] op_sel_hi:[1,0]
    v_pk_mul_f32 v[82:83], v[82:83], v[32:33] op_sel_hi:[1,0]
    v_pk_mul_f32 v[84:85], v[84:85], v[32:33] op_sel_hi:[1,0]
    v_pk_mul_f32 v[86:87], v[86:87], v[32:33] op_sel_hi:[1,0]
    v_cvt_pk_bf16_f32 v52, v72, v73
    v_cvt_pk_bf16_f32 v53, v74, v75
    v_cvt_pk_bf16_f32 v54, v76, v77
    v_cvt_pk_bf16_f32 v55, v78, v79
    s_mov_b32 s58, 4096
    buffer_store_dwordx4 v[52:55], v31, s[16:19], s58 offen offset:3072 sc1
    v_pk_mul_f32 v[88:89], v[88:89], v[32:33] op_sel_hi:[1,0]
    v_pk_mul_f32 v[90:91], v[90:91], v[32:33] op_sel_hi:[1,0]
    v_pk_mul_f32 v[92:93], v[92:93], v[32:33] op_sel_hi:[1,0]
    v_pk_mul_f32 v[94:95], v[94:95], v[32:33] op_sel_hi:[1,0]
    v_cvt_pk_bf16_f32 v48, v80, v81
    v_cvt_pk_bf16_f32 v49, v82, v83
    v_cvt_pk_bf16_f32 v50, v84, v85
    v_cvt_pk_bf16_f32 v51, v86, v87
    s_mov_b32 s58, 12288
    buffer_store_dwordx4 v[48:51], v31, s[16:19], s58 offen offset:2048 sc1
    v_pk_mul_f32 v[96:97], v[96:97], v[34:35] op_sel_hi:[1,0]
    v_pk_mul_f32 v[98:99], v[98:99], v[34:35] op_sel_hi:[1,0]
    v_pk_mul_f32 v[100:101], v[100:101], v[34:35] op_sel_hi:[1,0]
    v_pk_mul_f32 v[102:103], v[102:103], v[34:35] op_sel_hi:[1,0]
    v_cvt_pk_bf16_f32 v52, v88, v89
    v_cvt_pk_bf16_f32 v53, v90, v91
    v_cvt_pk_bf16_f32 v54, v92, v93
    v_cvt_pk_bf16_f32 v55, v94, v95
    s_mov_b32 s58, 20480
    buffer_store_dwordx4 v[52:55], v31, s[16:19], s58 offen offset:1024 sc1
    v_pk_mul_f32 v[104:105], v[104:105], v[34:35] op_sel_hi:[1,0]
    v_pk_mul_f32 v[106:107], v[106:107], v[34:35] op_sel_hi:[1,0]
    v_pk_mul_f32 v[108:109], v[108:109], v[34:35] op_sel_hi:[1,0]
    v_pk_mul_f32 v[110:111], v[110:111], v[34:35] op_sel_hi:[1,0]
    v_cvt_pk_bf16_f32 v48, v96, v97
    v_cvt_pk_bf16_f32 v49, v98, v99
    v_cvt_pk_bf16_f32 v50, v100, v101
    v_cvt_pk_bf16_f32 v51, v102, v103
    s_mov_b32 s58, 0
    buffer_store_dwordx4 v[48:51], v31, s[16:19], s58 offen offset:1024 sc1
    v_pk_mul_f32 v[112:113], v[112:113], v[34:35] op_sel_hi:[1,0]
    v_pk_mul_f32 v[114:115], v[114:115], v[34:35] op_sel_hi:[1,0]
    v_pk_mul_f32 v[116:117], v[116:117], v[34:35] op_sel_hi:[1,0]
    v_pk_mul_f32 v[118:119], v[118:119], v[34:35] op_sel_hi:[1,0]
    v_cvt_pk_bf16_f32 v52, v104, v105
    v_cvt_pk_bf16_f32 v53, v106, v107
    v_cvt_pk_bf16_f32 v54, v108, v109
    v_cvt_pk_bf16_f32 v55, v110, v111
    s_mov_b32 s58, 8192
    buffer_store_dwordx4 v[52:55], v31, s[16:19], s58 offen sc1
    v_pk_mul_f32 v[120:121], v[120:121], v[34:35] op_sel_hi:[1,0]
    v_pk_mul_f32 v[122:123], v[122:123], v[34:35] op_sel_hi:[1,0]
    v_pk_mul_f32 v[124:125], v[124:125], v[34:35] op_sel_hi:[1,0]
    v_pk_mul_f32 v[126:127], v[126:127], v[34:35] op_sel_hi:[1,0]
    v_cvt_pk_bf16_f32 v48, v112, v113
    v_cvt_pk_bf16_f32 v49, v114, v115
    v_cvt_pk_bf16_f32 v50, v116, v117
    v_cvt_pk_bf16_f32 v51, v118, v119
    s_mov_b32 s58, 12288
    buffer_store_dwordx4 v[48:51], v31, s[16:19], s58 offen offset:3072 sc1
    v_pk_mul_f32 v[128:129], v[128:129], v[36:37] op_sel_hi:[1,0]
    v_pk_mul_f32 v[130:131], v[130:131], v[36:37] op_sel_hi:[1,0]
    v_pk_mul_f32 v[132:133], v[132:133], v[36:37] op_sel_hi:[1,0]
    v_pk_mul_f32 v[134:135], v[134:135], v[36:37] op_sel_hi:[1,0]
    v_cvt_pk_bf16_f32 v52, v120, v121
    v_cvt_pk_bf16_f32 v53, v122, v123
    v_cvt_pk_bf16_f32 v54, v124, v125
    v_cvt_pk_bf16_f32 v55, v126, v127
    s_mov_b32 s58, 20480
    buffer_store_dwordx4 v[52:55], v31, s[16:19], s58 offen offset:2048 sc1
    v_pk_mul_f32 v[136:137], v[136:137], v[36:37] op_sel_hi:[1,0]
    v_pk_mul_f32 v[138:139], v[138:139], v[36:37] op_sel_hi:[1,0]
    v_pk_mul_f32 v[140:141], v[140:141], v[36:37] op_sel_hi:[1,0]
    v_pk_mul_f32 v[142:143], v[142:143], v[36:37] op_sel_hi:[1,0]
    v_cvt_pk_bf16_f32 v48, v128, v129
    v_cvt_pk_bf16_f32 v49, v130, v131
    v_cvt_pk_bf16_f32 v50, v132, v133
    v_cvt_pk_bf16_f32 v51, v134, v135
    s_mov_b32 s58, 0
    buffer_store_dwordx4 v[48:51], v31, s[16:19], s58 offen offset:2048 sc1
    v_pk_mul_f32 v[144:145], v[144:145], v[36:37] op_sel_hi:[1,0]
    v_pk_mul_f32 v[146:147], v[146:147], v[36:37] op_sel_hi:[1,0]
    v_pk_mul_f32 v[148:149], v[148:149], v[36:37] op_sel_hi:[1,0]
    v_pk_mul_f32 v[150:151], v[150:151], v[36:37] op_sel_hi:[1,0]
    v_cvt_pk_bf16_f32 v52, v136, v137
    v_cvt_pk_bf16_f32 v53, v138, v139
    v_cvt_pk_bf16_f32 v54, v140, v141
    v_cvt_pk_bf16_f32 v55, v142, v143
    s_mov_b32 s58, 8192
    buffer_store_dwordx4 v[52:55], v31, s[16:19], s58 offen offset:1024 sc1
    v_pk_mul_f32 v[152:153], v[152:153], v[36:37] op_sel_hi:[1,0]
    v_pk_mul_f32 v[154:155], v[154:155], v[36:37] op_sel_hi:[1,0]
    v_pk_mul_f32 v[156:157], v[156:157], v[36:37] op_sel_hi:[1,0]
    v_pk_mul_f32 v[158:159], v[158:159], v[36:37] op_sel_hi:[1,0]
    v_cvt_pk_bf16_f32 v48, v144, v145
    v_cvt_pk_bf16_f32 v49, v146, v147
    v_cvt_pk_bf16_f32 v50, v148, v149
    v_cvt_pk_bf16_f32 v51, v150, v151
    s_mov_b32 s58, 16384
    buffer_store_dwordx4 v[48:51], v31, s[16:19], s58 offen sc1
    v_pk_mul_f32 v[160:161], v[160:161], v[38:39] op_sel_hi:[1,0]
    v_pk_mul_f32 v[162:163], v[162:163], v[38:39] op_sel_hi:[1,0]
    v_pk_mul_f32 v[164:165], v[164:165], v[38:39] op_sel_hi:[1,0]
    v_pk_mul_f32 v[166:167], v[166:167], v[38:39] op_sel_hi:[1,0]
    v_cvt_pk_bf16_f32 v52, v152, v153
    v_cvt_pk_bf16_f32 v53, v154, v155
    v_cvt_pk_bf16_f32 v54, v156, v157
    v_cvt_pk_bf16_f32 v55, v158, v159
    s_mov_b32 s58, 20480
    buffer_store_dwordx4 v[52:55], v31, s[16:19], s58 offen offset:3072 sc1
    v_pk_mul_f32 v[168:169], v[168:169], v[38:39] op_sel_hi:[1,0]
    v_pk_mul_f32 v[170:171], v[170:171], v[38:39] op_sel_hi:[1,0]
    v_pk_mul_f32 v[172:173], v[172:173], v[38:39] op_sel_hi:[1,0]
    v_pk_mul_f32 v[174:175], v[174:175], v[38:39] op_sel_hi:[1,0]
    v_cvt_pk_bf16_f32 v48, v160, v161
    v_cvt_pk_bf16_f32 v49, v162, v163
    v_cvt_pk_bf16_f32 v50, v164, v165
    v_cvt_pk_bf16_f32 v51, v166, v167
    s_mov_b32 s58, 0
    buffer_store_dwordx4 v[48:51], v31, s[16:19], s58 offen offset:3072 sc1
    v_pk_mul_f32 v[176:177], v[176:177], v[38:39] op_sel_hi:[1,0]
    v_pk_mul_f32 v[178:179], v[178:179], v[38:39] op_sel_hi:[1,0]
    v_pk_mul_f32 v[180:181], v[180:181], v[38:39] op_sel_hi:[1,0]
    v_pk_mul_f32 v[182:183], v[182:183], v[38:39] op_sel_hi:[1,0]
    v_cvt_pk_bf16_f32 v52, v168, v169
    v_cvt_pk_bf16_f32 v53, v170, v171
    v_cvt_pk_bf16_f32 v54, v172, v173
    v_cvt_pk_bf16_f32 v55, v174, v175
    s_mov_b32 s58, 8192
    buffer_store_dwordx4 v[52:55], v31, s[16:19], s58 offen offset:2048 sc1
    v_pk_mul_f32 v[184:185], v[184:185], v[38:39] op_sel_hi:[1,0]
    v_pk_mul_f32 v[186:187], v[186:187], v[38:39] op_sel_hi:[1,0]
    v_pk_mul_f32 v[188:189], v[188:189], v[38:39] op_sel_hi:[1,0]
    v_pk_mul_f32 v[190:191], v[190:191], v[38:39] op_sel_hi:[1,0]
    v_cvt_pk_bf16_f32 v48, v176, v177
    v_cvt_pk_bf16_f32 v49, v178, v179
    v_cvt_pk_bf16_f32 v50, v180, v181
    v_cvt_pk_bf16_f32 v51, v182, v183
    s_mov_b32 s58, 16384
    buffer_store_dwordx4 v[48:51], v31, s[16:19], s58 offen offset:1024 sc1
    v_pk_mul_f32 v[192:193], v[192:193], v[40:41] op_sel_hi:[1,0]
    v_pk_mul_f32 v[194:195], v[194:195], v[40:41] op_sel_hi:[1,0]
    v_pk_mul_f32 v[196:197], v[196:197], v[40:41] op_sel_hi:[1,0]
    v_pk_mul_f32 v[198:199], v[198:199], v[40:41] op_sel_hi:[1,0]
    v_cvt_pk_bf16_f32 v52, v184, v185
    v_cvt_pk_bf16_f32 v53, v186, v187
    v_cvt_pk_bf16_f32 v54, v188, v189
    v_cvt_pk_bf16_f32 v55, v190, v191
    s_mov_b32 s58, 24576
    buffer_store_dwordx4 v[52:55], v31, s[16:19], s58 offen sc1
    v_pk_mul_f32 v[200:201], v[200:201], v[40:41] op_sel_hi:[1,0]
    v_pk_mul_f32 v[202:203], v[202:203], v[40:41] op_sel_hi:[1,0]
    v_pk_mul_f32 v[204:205], v[204:205], v[40:41] op_sel_hi:[1,0]
    v_pk_mul_f32 v[206:207], v[206:207], v[40:41] op_sel_hi:[1,0]
    v_cvt_pk_bf16_f32 v48, v192, v193
    v_cvt_pk_bf16_f32 v49, v194, v195
    v_cvt_pk_bf16_f32 v50, v196, v197
    v_cvt_pk_bf16_f32 v51, v198, v199
    s_mov_b32 s58, 4096
    buffer_store_dwordx4 v[48:51], v31, s[16:19], s58 offen sc1
    v_pk_mul_f32 v[208:209], v[208:209], v[40:41] op_sel_hi:[1,0]
    v_pk_mul_f32 v[210:211], v[210:211], v[40:41] op_sel_hi:[1,0]
    v_pk_mul_f32 v[212:213], v[212:213], v[40:41] op_sel_hi:[1,0]
    v_pk_mul_f32 v[214:215], v[214:215], v[40:41] op_sel_hi:[1,0]
    v_cvt_pk_bf16_f32 v52, v200, v201
    v_cvt_pk_bf16_f32 v53, v202, v203
    v_cvt_pk_bf16_f32 v54, v204, v205
    v_cvt_pk_bf16_f32 v55, v206, v207
    s_mov_b32 s58, 8192
    buffer_store_dwordx4 v[52:55], v31, s[16:19], s58 offen offset:3072 sc1
    v_pk_mul_f32 v[216:217], v[216:217], v[40:41] op_sel_hi:[1,0]
    v_pk_mul_f32 v[218:219], v[218:219], v[40:41] op_sel_hi:[1,0]
    v_pk_mul_f32 v[220:221], v[220:221], v[40:41] op_sel_hi:[1,0]
    v_pk_mul_f32 v[222:223], v[222:223], v[40:41] op_sel_hi:[1,0]
    v_cvt_pk_bf16_f32 v48, v208, v209
    v_cvt_pk_bf16_f32 v49, v210, v211
    v_cvt_pk_bf16_f32 v50, v212, v213
    v_cvt_pk_bf16_f32 v51, v214, v215
    s_mov_b32 s58, 16384
    buffer_store_dwordx4 v[48:51], v31, s[16:19], s58 offen offset:2048 sc1
    v_accvgpr_read_b32 v64, a0
    v_accvgpr_read_b32 v65, a1
    v_accvgpr_read_b32 v66, a2
    v_accvgpr_read_b32 v67, a3
    v_accvgpr_read_b32 v68, a4
    v_accvgpr_read_b32 v69, a5
    v_accvgpr_read_b32 v70, a6
    v_accvgpr_read_b32 v71, a7
    v_pk_mul_f32 v[224:225], v[224:225], v[42:43] op_sel_hi:[1,0]
    v_pk_mul_f32 v[226:227], v[226:227], v[42:43] op_sel_hi:[1,0]
    v_pk_mul_f32 v[228:229], v[228:229], v[42:43] op_sel_hi:[1,0]
    v_pk_mul_f32 v[230:231], v[230:231], v[42:43] op_sel_hi:[1,0]
    v_cvt_pk_bf16_f32 v52, v216, v217
    v_cvt_pk_bf16_f32 v53, v218, v219
    v_cvt_pk_bf16_f32 v54, v220, v221
    v_cvt_pk_bf16_f32 v55, v222, v223
    s_mov_b32 s58, 24576
    buffer_store_dwordx4 v[52:55], v31, s[16:19], s58 offen offset:1024 sc1
    v_accvgpr_read_b32 v72, a8
    v_accvgpr_read_b32 v73, a9
    v_accvgpr_read_b32 v74, a10
    v_accvgpr_read_b32 v75, a11
    v_accvgpr_read_b32 v76, a12
    v_accvgpr_read_b32 v77, a13
    v_accvgpr_read_b32 v78, a14
    v_accvgpr_read_b32 v79, a15
    v_pk_mul_f32 v[232:233], v[232:233], v[42:43] op_sel_hi:[1,0]
    v_pk_mul_f32 v[234:235], v[234:235], v[42:43] op_sel_hi:[1,0]
    v_pk_mul_f32 v[236:237], v[236:237], v[42:43] op_sel_hi:[1,0]
    v_pk_mul_f32 v[238:239], v[238:239], v[42:43] op_sel_hi:[1,0]
    v_cvt_pk_bf16_f32 v48, v224, v225
    v_cvt_pk_bf16_f32 v49, v226, v227
    v_cvt_pk_bf16_f32 v50, v228, v229
    v_cvt_pk_bf16_f32 v51, v230, v231
    s_mov_b32 s58, 4096
    buffer_store_dwordx4 v[48:51], v31, s[16:19], s58 offen offset:1024 sc1
    v_accvgpr_read_b32 v80, a16
    v_accvgpr_read_b32 v81, a17
    v_accvgpr_read_b32 v82, a18
    v_accvgpr_read_b32 v83, a19
    v_accvgpr_read_b32 v84, a20
    v_accvgpr_read_b32 v85, a21
    v_accvgpr_read_b32 v86, a22
    v_accvgpr_read_b32 v87, a23
    v_pk_mul_f32 v[240:241], v[240:241], v[42:43] op_sel_hi:[1,0]
    v_pk_mul_f32 v[242:243], v[242:243], v[42:43] op_sel_hi:[1,0]
    v_pk_mul_f32 v[244:245], v[244:245], v[42:43] op_sel_hi:[1,0]
    v_pk_mul_f32 v[246:247], v[246:247], v[42:43] op_sel_hi:[1,0]
    v_cvt_pk_bf16_f32 v52, v232, v233
    v_cvt_pk_bf16_f32 v53, v234, v235
    v_cvt_pk_bf16_f32 v54, v236, v237
    v_cvt_pk_bf16_f32 v55, v238, v239
    s_mov_b32 s58, 12288
    buffer_store_dwordx4 v[52:55], v31, s[16:19], s58 offen sc1
    v_accvgpr_read_b32 v88, a24
    v_accvgpr_read_b32 v89, a25
    v_accvgpr_read_b32 v90, a26
    v_accvgpr_read_b32 v91, a27
    v_accvgpr_read_b32 v92, a28
    v_accvgpr_read_b32 v93, a29
    v_accvgpr_read_b32 v94, a30
    v_accvgpr_read_b32 v95, a31
    v_pk_mul_f32 v[248:249], v[248:249], v[42:43] op_sel_hi:[1,0]
    v_pk_mul_f32 v[250:251], v[250:251], v[42:43] op_sel_hi:[1,0]
    v_pk_mul_f32 v[252:253], v[252:253], v[42:43] op_sel_hi:[1,0]
    v_pk_mul_f32 v[254:255], v[254:255], v[42:43] op_sel_hi:[1,0]
    v_cvt_pk_bf16_f32 v48, v240, v241
    v_cvt_pk_bf16_f32 v49, v242, v243
    v_cvt_pk_bf16_f32 v50, v244, v245
    v_cvt_pk_bf16_f32 v51, v246, v247
    s_mov_b32 s58, 16384
    buffer_store_dwordx4 v[48:51], v31, s[16:19], s58 offen offset:3072 sc1
    v_pk_mul_f32 v[64:65], v[64:65], v[44:45] op_sel_hi:[1,0]
    v_pk_mul_f32 v[66:67], v[66:67], v[44:45] op_sel_hi:[1,0]
    v_pk_mul_f32 v[68:69], v[68:69], v[44:45] op_sel_hi:[1,0]
    v_pk_mul_f32 v[70:71], v[70:71], v[44:45] op_sel_hi:[1,0]
    v_cvt_pk_bf16_f32 v52, v248, v249
    v_cvt_pk_bf16_f32 v53, v250, v251
    v_cvt_pk_bf16_f32 v54, v252, v253
    v_cvt_pk_bf16_f32 v55, v254, v255
    s_mov_b32 s58, 24576
    buffer_store_dwordx4 v[52:55], v31, s[16:19], s58 offen offset:2048 sc1
    v_pk_mul_f32 v[72:73], v[72:73], v[44:45] op_sel_hi:[1,0]
    v_pk_mul_f32 v[74:75], v[74:75], v[44:45] op_sel_hi:[1,0]
    v_pk_mul_f32 v[76:77], v[76:77], v[44:45] op_sel_hi:[1,0]
    v_pk_mul_f32 v[78:79], v[78:79], v[44:45] op_sel_hi:[1,0]
    v_cvt_pk_bf16_f32 v48, v64, v65
    v_cvt_pk_bf16_f32 v49, v66, v67
    v_cvt_pk_bf16_f32 v50, v68, v69
    v_cvt_pk_bf16_f32 v51, v70, v71
    s_mov_b32 s58, 4096
    buffer_store_dwordx4 v[48:51], v31, s[16:19], s58 offen offset:2048 sc1
    v_pk_mul_f32 v[80:81], v[80:81], v[44:45] op_sel_hi:[1,0]
    v_pk_mul_f32 v[82:83], v[82:83], v[44:45] op_sel_hi:[1,0]
    v_pk_mul_f32 v[84:85], v[84:85], v[44:45] op_sel_hi:[1,0]
    v_pk_mul_f32 v[86:87], v[86:87], v[44:45] op_sel_hi:[1,0]
    v_cvt_pk_bf16_f32 v52, v72, v73
    v_cvt_pk_bf16_f32 v53, v74, v75
    v_cvt_pk_bf16_f32 v54, v76, v77
    v_cvt_pk_bf16_f32 v55, v78, v79
    s_mov_b32 s58, 12288
    buffer_store_dwordx4 v[52:55], v31, s[16:19], s58 offen offset:1024 sc1
    v_pk_mul_f32 v[88:89], v[88:89], v[44:45] op_sel_hi:[1,0]
    v_pk_mul_f32 v[90:91], v[90:91], v[44:45] op_sel_hi:[1,0]
    v_pk_mul_f32 v[92:93], v[92:93], v[44:45] op_sel_hi:[1,0]
    v_pk_mul_f32 v[94:95], v[94:95], v[44:45] op_sel_hi:[1,0]
    v_cvt_pk_bf16_f32 v48, v80, v81
    v_cvt_pk_bf16_f32 v49, v82, v83
    v_cvt_pk_bf16_f32 v50, v84, v85
    v_cvt_pk_bf16_f32 v51, v86, v87
    s_mov_b32 s58, 20480
    buffer_store_dwordx4 v[48:51], v31, s[16:19], s58 offen sc1
    v_cvt_pk_bf16_f32 v52, v88, v89
    v_cvt_pk_bf16_f32 v53, v90, v91
    v_cvt_pk_bf16_f32 v54, v92, v93
    v_cvt_pk_bf16_f32 v55, v94, v95
    s_mov_b32 s58, 24576
    buffer_store_dwordx4 v[52:55], v31, s[16:19], s58 offen offset:3072 sc1
    s_and_b32 s22, s3, 7
    s_add_u32 s62, s33, s22
    s_and_b32 s62, s62, 0
    s_mov_b32 s59, 0
    s_mov_b32 s60, s62
    s_lshl_b32 s47, s62, 17
    s_mul_i32 s50, s28, 36864
    s_lshl_b32 s20, s28, 21
    s_lshl_b32 s23, s22, 8
    s_add_u32 s20, s20, s23
    s_add_u32 s4, s34, s20
    s_addc_u32 s5, s35, 0
    s_mov_b32 s6, 2095360
    s_mov_b32 s7, 0x20000
    v_lshrrev_b32 v1, 4, v0
    v_and_b32 v2, 15, v0
    s_lshl_b32 s20, s28, 2
    v_lshlrev_b32 v3, 1, v1
    v_xor_b32 v3, v3, v2
    v_xor_b32 v3, s20, v3
    v_lshlrev_b32 v3, 4, v3
    v_lshl_add_u32 v5, v1, 11, v3
    s_add_u32 m0, s50, 0
    s_nop 0
    buffer_load_dwordx4 v5, s[4:7], s47 offen lds
    s_add_u32 m0, s50, 1152
    s_add_u32 s49, s47, 8192
    buffer_load_dwordx4 v5, s[4:7], s49 offen lds
    s_add_u32 m0, s50, 2304
    s_add_u32 s49, s47, 16384
    buffer_load_dwordx4 v5, s[4:7], s49 offen lds
    s_add_u32 m0, s50, 3456
    s_add_u32 s49, s47, 24576
    buffer_load_dwordx4 v5, s[4:7], s49 offen lds
    s_add_u32 m0, s50, 4608
    s_add_u32 s49, s47, 32768
    buffer_load_dwordx4 v5, s[4:7], s49 offen lds
    s_add_u32 m0, s50, 5760
    s_add_u32 s49, s47, 40960
    buffer_load_dwordx4 v5, s[4:7], s49 offen lds
    s_add_u32 m0, s50, 6912
    s_add_u32 s49, s47, 49152
    buffer_load_dwordx4 v5, s[4:7], s49 offen lds
    s_add_u32 m0, s50, 8064
    s_add_u32 s49, s47, 57344
    buffer_load_dwordx4 v5, s[4:7], s49 offen lds
    s_add_u32 m0, s50, 9216
    s_add_u32 s49, s47, 65536
    buffer_load_dwordx4 v5, s[4:7], s49 offen lds
    s_add_u32 m0, s50, 10368
    s_add_u32 s49, s47, 73728
    buffer_load_dwordx4 v5, s[4:7], s49 offen lds
    s_add_u32 m0, s50, 11520
    s_add_u32 s49, s47, 81920
    buffer_load_dwordx4 v5, s[4:7], s49 offen lds
    s_add_u32 m0, s50, 12672
    s_add_u32 s49, s47, 90112
    buffer_load_dwordx4 v5, s[4:7], s49 offen lds
    s_add_u32 m0, s50, 13824
    s_add_u32 s49, s47, 98304
    buffer_load_dwordx4 v5, s[4:7], s49 offen lds
    s_add_u32 m0, s50, 14976
    s_add_u32 s49, s47, 106496
    buffer_load_dwordx4 v5, s[4:7], s49 offen lds
    s_add_u32 m0, s50, 16128
    s_add_u32 s49, s47, 114688
    buffer_load_dwordx4 v5, s[4:7], s49 offen lds
    s_add_u32 m0, s50, 17280
    s_add_u32 s49, s47, 122880
    buffer_load_dwordx4 v5, s[4:7], s49 offen lds
    s_mov_b32 s46, s48
    s_mul_i32 s48, s60, 14336
    s_add_u32 s60, s59, 1
    s_mov_b32 s59, s60
    s_lshl_b32 s47, s60, 17
    s_branch L_join
L_late:
    buffer_load_dword v82, v81, s[24:27], 0 offen sc1
    s_sub_u32 s52, s52, 1
    s_waitcnt vmcnt(0)
    v_readfirstlane_b32 s20, v82
    s_cmp_eq_u32 s52, 0
    s_cbranch_scc1 L_all_in
    s_cmp_ge_u32 s20, s51
    s_cbranch_scc1 L_all_in
    s_sleep 8
    s_branch L_late
.section .rodata,"a"
.p2align 6
.amdhsa_kernel concat_heads__mha_block_cached__mha_block_cached__near_ridge_kernel
  .amdhsa_next_free_vgpr 512
  .amdhsa_next_free_sgpr 102
  .amdhsa_accum_offset 256
  .amdhsa_group_segment_fixed_size 0
  .amdhsa_kernarg_size 104
  .amdhsa_user_sgpr_count 2
  .amdhsa_user_sgpr_kernarg_segment_ptr 1
  .amdhsa_system_sgpr_workgroup_id_x 1
.end_amdhsa_kernel
```
